```python
import torch

def _softmax(x, axis=-1):
    return torch.softmax(x, dim=axis)

def _gelu(x):
    return torch.nn.functional.gelu(x, approximate='tanh')

def _silu(x):
    return torch.nn.functional.silu(x)

def _sigmoid(x):
    return torch.sigmoid(x)

def _layernorm(x, axis=-1, eps=1e-05):
    m = x.mean(dim=axis, keepdim=True)
    v = x.var(dim=axis, keepdim=True, unbiased=False)
    return (x - m) / torch.sqrt(v + eps)

def _scatter_add(tgt, idx, src, axis=0):
    return tgt.clone().index_add_(axis, idx, src)

def _segment_sum(src, seg, n):
    out = torch.zeros((n,) + src.shape[1:], dtype=src.dtype)
    return out.index_add_(0, seg, src)

def _pad(x, pw):
    flat = tuple((v for pair in reversed(pw) for v in pair))
    return torch.nn.functional.pad(x, flat)
kernel_name = 'sequential_preLN__spectral_gfnet__mixer_gmlp__prompt'

def setup_inputs():

    _w = lambda a: (lambda t: t.to(torch.bfloat16) if t.is_floating_point() else t)(torch.as_tensor(a))

    def _A_setup():
        B, S, D = (1, 2048, 640)
        Df = D // 2 + 1
        return {'x': _w((lambda *s: torch.randn(*s, dtype=torch.bfloat16) * 0.05)(B, S, D)), 'w_r': _w((lambda *s: torch.randn(*s, dtype=torch.bfloat16) * 0.4)(S, Df) * 0.02), 'w_i': _w((lambda *s: torch.randn(*s, dtype=torch.bfloat16) * 0.4)(S, Df) * 0.02)}
    _A_in = _A_setup()

    def _B_setup():
        B, S, D, F = (1, 2048, 640, 1728)
        Fh = F // 2
        return {'x': _w((lambda *s: torch.randn(*s, dtype=torch.bfloat16) * 0.05)(B, S, D)), 'w_in': _w((lambda *s: torch.randn(*s, dtype=torch.bfloat16) * 0.4)(D, 2 * Fh)), 'w_sp': _w(0.01 * (lambda *s: torch.randn(*s, dtype=torch.bfloat16) * 0.4)(S, S)), 'b_sp': _w(1.0 + 0.01 * (lambda *s: torch.randn(*s, dtype=torch.bfloat16) * 0.05)(S)), 'w_out': _w((lambda *s: torch.randn(*s, dtype=torch.bfloat16) * 0.05)(Fh, D))}
    _B_in = _B_setup()
    return {'A_x': _A_in['x'], 'A_w_r': _A_in['w_r'], 'A_w_i': _A_in['w_i'], 'B_x': _B_in['x'], 'B_w_in': _B_in['w_in'], 'B_w_sp': _B_in['w_sp'], 'B_b_sp': _B_in['b_sp'], 'B_w_out': _B_in['w_out']}

def reference(A_x, A_w_r, A_w_i, B_x, B_w_in, B_w_sp, B_b_sp, B_w_out):

    def _A_ref(x, w_r, w_i):
        B, S, D = x.shape
        X = (lambda x, axes=(-2, -1): torch.fft.rfft2(x.float(), dim=axes))(x, axes=(-2, -1))
        W = w_r + 1j * w_i
        X = X * W
        y = (lambda x, s, axes=(-2, -1): torch.fft.irfft2(x, s=s, dim=axes).to(torch.bfloat16))(X, (S, D), axes=(-2, -1))
        return y

    def _B_ref(x, w_in, w_sp, b_sp, w_out):
        B, S, D = x.shape
        F = w_in.shape[-1]
        Fh = F // 2
        z = _gelu(torch.einsum('bsd,df->bsf', x, w_in))
        z1 = z[..., :Fh].clone()
        z2 = _layernorm(z[..., Fh:], axis=-1)
        g = torch.einsum('ts,bsf->btf', w_sp, z2) + b_sp[None, :, None]
        return torch.einsum('bsf,fd->bsd', z1 * g, w_out)
    x = A_x
    h = x + _A_ref(_layernorm(x, axis=-1), A_w_r, A_w_i)
    h2 = h + _B_ref(_layernorm(h, axis=-1), B_w_in, B_w_sp, B_b_sp, B_w_out)
    return h2
```

```asm
; @launch kernel=pk_kernel grid=(256,1,1) block=(256,1,1) lds=163840
.amdgcn_target "amdgcn-amd-amdhsa--gfx950"
.text
.p2align 8
.type tbl,@object
tbl:
.quad 0x3e653e653e653e65,0x3e65,0x3e073e393e5a3e65,0x3d8e,0xbd8e3d8e3e393e65,0xbe39,0xbe5abd8e3e073e65,0xbe39
.quad 0xbe39be393d8e3e65,0x3d8e,0xa43dbe65237d3e65,0x3e65,0x3e39be39bd8e3e65,0x3d8e,0x3e5abd8ebe073e65,0xbe39
.quad 0x3d8e3d8ebe393e65,0xbe39,0xbe073e39be5a3e65,0x3d8e,0xbe653e65be653e65,0x3e65,0x0,0x0
.quad 0x0,0x0,0x0,0x0,0x0,0x0,0x0,0x0
.quad 0x3e653e653e653e65,0x3e65,0xbe39be07bd8e237d,0xbe5a,0x3d8ebd8ebe39be65,0x3e39,0x3d8e3e5a3e39a43d,0xbe07
.quad 0xbe39be393d8e3e65,0x3d8e,0x3e65a43dbe65237d,0x237d,0xbe393e393d8ebe65,0xbd8e,0x3d8ebe5a3e39a43d,0x3e07
.quad 0x3d8e3d8ebe393e65,0xbe39,0xbe393e07bd8e237d,0x3e5a,0x3e65be653e65be65,0xbe65,0x0,0x0
.quad 0x0,0x0,0x0,0x0,0x0,0x0,0x0,0x0
.quad 0x3e653e653e653e65,0x3e65,0xbe07be39be5abe65,0xbd8e,0xbd8e3d8e3e393e65,0xbe39,0x3e5a3d8ebe07be65,0x3e39
.quad 0xbe39be393d8e3e65,0x3d8e,0x237d3e65a43dbe65,0xbe65,0x3e39be39bd8e3e65,0x3d8e,0xbe5a3d8e3e07be65,0x3e39
.quad 0x3d8e3d8ebe393e65,0xbe39,0x3e07be393e5abe65,0xbd8e,0xbe653e65be653e65,0x3e65,0x0,0x0
.quad 0x0,0x0,0x0,0x0,0x0,0x0,0x0,0x0
.quad 0x3e653e653e653e65,0x3e65,0x3e393e073d8ea43d,0x3e5a,0x3d8ebd8ebe39be65,0x3e39,0xbd8ebe5abe39237d,0x3e07
.quad 0xbe39be393d8e3e65,0x3d8e,0xbe65237d3e65a43d,0xa43d,0xbe393e393d8ebe65,0xbd8e,0xbd8e3e5abe39237d,0xbe07
.quad 0x3d8e3d8ebe393e65,0xbe39,0x3e39be073d8ea43d,0xbe5a,0x3e65be653e65be65,0xbe65,0x0,0x0
.quad 0x0,0x0,0x0,0x0,0x0,0x0,0x0,0x0
.quad 0xb7dab7dab7dab7da,0xb7da,0xb9d33979b96fb7da,0xb979,0x3979b9793979b7da,0xb979,0x396f3979b9d3b7da,0xb979
.quad 0xb979b979b979b7da,0xb979,0x9fdc37da9edbb7da,0xb7da,0x3979b9793979b7da,0xb979,0xb96f397939d3b7da,0xb979
.quad 0xb979b979b979b7da,0xb979,0x39d33979396fb7da,0xb979,0x37dab7da37dab7da,0xb7da,0x0,0x0
.quad 0x0,0x0,0x0,0x0,0x0,0x0,0x0,0x0
.quad 0xb7dab7dab7dab7da,0xb7da,0xb97939d339799edb,0x396f,0xb9793979b97937da,0x3979,0xb979b96f39799fdc,0x39d3
.quad 0xb979b979b979b7da,0xb979,0xb7da9fdc37da9edb,0x9edb,0xb9793979b97937da,0x3979,0xb979396f39799fdc,0xb9d3
.quad 0xb979b979b979b7da,0xb979,0xb979b9d339799edb,0xb96f,0xb7da37dab7da37da,0x37da,0x0,0x0
.quad 0x0,0x0,0x0,0x0,0x0,0x0,0x0,0x0
.quad 0xb7dab7dab7dab7da,0xb7da,0x39d3b979396f37da,0x3979,0x3979b9793979b7da,0xb979,0xb96fb97939d337da,0x3979
.quad 0xb979b979b979b7da,0xb979,0x9edbb7da9fdc37da,0x37da,0x3979b9793979b7da,0xb979,0x396fb979b9d337da,0x3979
.quad 0xb979b979b979b7da,0xb979,0xb9d3b979b96f37da,0x3979,0x37dab7da37dab7da,0xb7da,0x0,0x0
.quad 0x0,0x0,0x0,0x0,0x0,0x0,0x0,0x0
.quad 0xb7dab7dab7dab7da,0xb7da,0x3979b9d3b9799fdc,0xb96f,0xb9793979b97937da,0x3979,0x3979396fb9799edb,0xb9d3
.quad 0xb979b979b979b7da,0xb979,0x37da9edbb7da9fdc,0x9fdc,0xb9793979b97937da,0x3979,0x3979b96fb9799edb,0x39d3
.quad 0xb979b979b979b7da,0xb979,0x397939d3b9799fdc,0x396f,0xb7da37dab7da37da,0x37da,0x0,0x0
.quad 0x0,0x0,0x0,0x0,0x0,0x0,0x0,0x0
.quad 0x8000800080008000,0x8000,0xbe39be07bd8e8000,0xbe5a,0xbe5abe5abe078000,0xbe07,0xbd8ebe5abe398000,0x3e07
.quad 0x3e07be07be5a8000,0x3e5a,0x3e65a3fdbe658000,0x8000,0x3e073e07be5a8000,0xbe5a,0xbd8e3e5abe398000,0xbe07
.quad 0xbe5a3e5abe078000,0x3e07,0xbe393e07bd8e8000,0x3e5a,0xa3fd8000a3fd8000,0x8000,0x0,0x0
.quad 0x0,0x0,0x0,0x0,0x0,0x0,0x0,0x0
.quad 0x8000800080008000,0x8000,0xbe07be39be5abe65,0xbd8e,0x3e5a3e5a3e07a3fd,0x3e07,0xbe5abd8e3e073e65,0xbe39
.quad 0x3e07be07be5a8000,0x3e5a,0x80003e65a3fdbe65,0xbe65,0xbe07be073e5aa3fd,0x3e5a,0x3e5abd8ebe073e65,0xbe39
.quad 0xbe5a3e5abe078000,0x3e07,0x3e07be393e5abe65,0xbd8e,0x8000a3fd8000a3fd,0xa3fd,0x0,0x0
.quad 0x0,0x0,0x0,0x0,0x0,0x0,0x0,0x0
.quad 0x8000800080008000,0x8000,0x3e393e073d8ea3fd,0x3e5a,0xbe5abe5abe078000,0xbe07,0x3d8e3e5a3e39a3fd,0xbe07
.quad 0x3e07be07be5a8000,0x3e5a,0xbe6580003e65a3fd,0xa3fd,0x3e073e07be5a8000,0xbe5a,0x3d8ebe5a3e39a3fd,0x3e07
.quad 0xbe5a3e5abe078000,0x3e07,0x3e39be073d8ea3fd,0xbe5a,0xa3fd8000a3fd8000,0x8000,0x0,0x0
.quad 0x0,0x0,0x0,0x0,0x0,0x0,0x0,0x0
.quad 0x8000800080008000,0x8000,0x3e073e393e5a3e65,0x3d8e,0x3e5a3e5a3e07a3fd,0x3e07,0x3e5a3d8ebe07be65,0x3e39
.quad 0x3e07be07be5a8000,0x3e5a,0xa3fdbe6580003e65,0x3e65,0xbe07be073e5aa3fd,0x3e5a,0xbe5a3d8e3e07be65,0x3e39
.quad 0xbe5a3e5abe078000,0x3e07,0xbe073e39be5a3e65,0x3d8e,0x8000a3fd8000a3fd,0xa3fd,0x0,0x0
.quad 0x0,0x0,0x0,0x0,0x0,0x0,0x0,0x0
.quad 0x0,0x0,0xb97939d339790000,0x396f,0x396f396f39d30000,0x39d3,0x3979396fb9790000,0xb9d3
.quad 0xb9d339d3396f0000,0xb96f,0xb7da1f5b37da0000,0x0,0xb9d3b9d3396f0000,0x396f,0x3979b96fb9790000,0x39d3
.quad 0x396fb96f39d30000,0xb9d3,0xb979b9d339790000,0xb96f,0x1f5b00001f5b0000,0x0,0x0,0x0
.quad 0x0,0x0,0x0,0x0,0x0,0x0,0x0,0x0
.quad 0x0,0x0,0x39d3b979396f37da,0x3979,0xb96fb96fb9d31f5b,0xb9d3,0x396f3979b9d3b7da,0xb979
.quad 0xb9d339d3396f0000,0xb96f,0xb7da1f5b37da,0x37da,0x39d339d3b96f1f5b,0xb96f,0xb96f397939d3b7da,0xb979
.quad 0x396fb96f39d30000,0xb9d3,0xb9d3b979b96f37da,0x3979,0x1f5b00001f5b,0x1f5b,0x0,0x0
.quad 0x0,0x0,0x0,0x0,0x0,0x0,0x0,0x0
.quad 0x0,0x0,0x3979b9d3b9791f5b,0xb96f,0x396f396f39d30000,0x39d3,0xb979b96f39791f5b,0x39d3
.quad 0xb9d339d3396f0000,0xb96f,0x37da0000b7da1f5b,0x1f5b,0xb9d3b9d3396f0000,0x396f,0xb979396f39791f5b,0xb9d3
.quad 0x396fb96f39d30000,0xb9d3,0x397939d3b9791f5b,0x396f,0x1f5b00001f5b0000,0x0,0x0,0x0
.quad 0x0,0x0,0x0,0x0,0x0,0x0,0x0,0x0
.quad 0x0,0x0,0xb9d33979b96fb7da,0xb979,0xb96fb96fb9d31f5b,0xb9d3,0xb96fb97939d337da,0x3979
.quad 0xb9d339d3396f0000,0xb96f,0x1f5b37da0000b7da,0xb7da,0x39d339d3b96f1f5b,0xb96f,0x396fb979b9d337da,0x3979
.quad 0x396fb96f39d30000,0xb9d3,0x39d33979396fb7da,0xb979,0x1f5b00001f5b,0x1f5b,0x0,0x0
.quad 0x0,0x0,0x0,0x0,0x0,0x0,0x0,0x0
.quad 0x800000003f800000,0x800000003f800000,0x800000003f800000,0xbca0d6d63f7ff35e,0x800000003f800000,0xbd20cee73f7fcd79,0x800000003f800000,0xbd7122833f7f8e56
.quad 0x800000003f800000,0xbda0af2a3f7f35f9,0x800000003f800000,0xbdc8bd363f7ec46d,0x800000003f800000,0xbdf0b7723f7e39bc,0x800000003f800000,0xbe0c4cf73f7d95f4
.quad 0x800000003f800000,0xbe20305b3f7cd925,0x800000003f800000,0xbe3403f13f7c0361,0x800000003f800000,0xbe47c5c23f7b14be,0x800000003f800000,0xbe5b73dc3f7a0d54
.quad 0x800000003f800000,0xbe6f0c4d3f78ed3c,0x800000003f800000,0xbe8146933f77b493,0x800000003f800000,0xbe8afa3e3f766377,0x800000003f800000,0xbe94a0313f74fa0b
.quad 0x800000003f800000,0x800000003f800000,0xbda0af2a3f7f35f9,0xbdc8bd363f7ec46d,0xbe20305b3f7cd925,0xbe47c5c23f7b14be,0xbe6f0c4d3f78ed3c,0xbe94a0313f74fa0b
.quad 0xbe9e377a3f737871,0xbec3ef153f6c835e,0xbec3ef153f6c835e,0xbef15aea3f61c598,0xbee871713f641901,0xbf0e39da3f54db31,0xbf05c2773f5a46a0,0xbf2267993f45e403
.quad 0xbf1679183f4f1bbd,0xbf3504f33f3504f3,0xbf26423a3f42a9f7,0xbf45e4033f226799,0xbf3504f33f3504f3,0xbf54db313f0e39da,0xbf42a9f73f26423a,0xbf61c5983ef15aea
.quad 0xbf4f1bbd3f167918,0xbf6c835e3ec3ef15,0xbf5a46a03f05c277,0xbf74fa0b3e94a031,0xbf6419013ee87171,0xbf7b14be3e47c5c2,0xbf6c835e3ec3ef15,0xbf7ec46d3dc8bd36
.quad 0x800000003f800000,0x800000003f800000,0xbe20305b3f7cd925,0xbe3403f13f7c0361,0xbe9e377a3f737871,0xbeb136413f702d4f,0xbee871713f641901,0xbf0172c33f5cdc29
.quad 0xbf1679183f4f1bbd,0xbf26423a3f42a9f7,0xbf3504f33f3504f3,0xbf45e4033f226799,0xbf4f1bbd3f167918,0xbf5f5be63efa2c90,0xbf6419013ee87171,0xbf71decf3ea7bf25
.quad 0xbf7378713e9e377a,0xbf7cd9253e20305b,0xbf7cd9253e20305b,0xbf7ff35ebca0d6d6,0xbf800000248d3132,0xbf7b14bebe47c5c2,0xbf7cd925be20305b,0xbf6e641abeba9be1
.quad 0xbf737871be9e377a,0xbf5a46a0bf05c277,0xbf641901bee87171,0xbf3f5cb5bf2a0c73,0xbf4f1bbdbf167918,0xbf1e7cf1bf490a88,0xbf3504f3bf3504f3,0xbef15aeabf61c598
.quad 0x800000003f800000,0x800000003f800000,0xbe6f0c4d3f78ed3c,0xbe8146933f77b493,0xbee871713f641901,0xbefa2c903f5f5be6,0xbf26423a3f42a9f7,0xbf316e2c3f3889dc
.quad 0xbf4f1bbd3f167918,0xbf5a46a03f05c277,0xbf6c835e3ec3ef15,0xbf74fa0b3e94a031,0xbf7cd9253e20305b,0xbf7fcd793d20cee7,0xbf7f35f9bda0af2a,0xbf7a0d54be5b73dc
.quad 0xbf737871be9e377a,0xbf641901bee87171,0xbf5a46a0bf05c277,0xbf3f5cb5bf2a0c73,0xbf3504f3bf3504f3,0xbf0e39dabf54db31,0xbf05c277bf5a46a0,0xbea7bf25bf71decf
.quad 0xbe9e377abf737871,0xbda0af2abf7f35f9,0xbda0af2abf7f35f9,0x3e3403f1bf7c0361,0x3e20305bbf7cd925,0x3ed65a92bf687c12,0x3ec3ef15bf6c835e,0x3f226799bf45e403
.quad 0x800000003f800000,0x800000003f800000,0xbd20cee73f7fcd79,0xbd7122833f7f8e56,0xbda0af2a3f7f35f9,0xbdf0b7723f7e39bc,0xbdf0b7723f7e39bc,0xbe3403f13f7c0361
.quad 0xbe20305b3f7cd925,0xbe6f0c4d3f78ed3c,0xbe47c5c23f7b14be,0xbe94a0313f74fa0b,0xbe6f0c4d3f78ed3c,0xbeb136413f702d4f,0xbe8afa3e3f766377,0xbecd2ef33f6a8b4b
.quad 0xbe9e377a3f737871,0xbee871713f641901,0xbeb136413f702d4f,0xbf0172c33f5cdc29,0xbec3ef153f6c835e,0xbf0e39da3f54db31,0xbed65a923f687c12,0xbf1a82a43f4c1d35
.quad 0xbee871713f641901,0xbf26423a3f42a9f7,0xbefa2c903f5f5be6,0xbf316e2c3f3889dc,0xbf05c2773f5a46a0,0xbf3bfc8f3f2dc5e3,0xbf0e39da3f54db31,0xbf45e4033f226799
.quad 0x800000003f800000,0x800000003f800000,0xbdf0b7723f7e39bc,0xbe0c4cf73f7d95f4,0xbe6f0c4d3f78ed3c,0xbe8afa3e3f766377,0xbeb136413f702d4f,0xbecd2ef33f6a8b4b
.quad 0xbee871713f641901,0xbf05c2773f5a46a0,0xbf0e39da3f54db31,0xbf2267993f45e403,0xbf26423a3f42a9f7,0xbf3bfc8f3f2dc5e3,0xbf3bfc8f3f2dc5e3,0xbf5205d43f1260b2
.quad 0xbf4f1bbd3f167918,0xbf6419013ee87171,0xbf5f5be63efa2c90,0xbf71decf3ea7bf25,0xbf6c835e3ec3ef15,0xbf7b14be3e47c5c2,0xbf7663773e8afa3e,0xbf7f8e563d712283
.quad 0xbf7cd9253e20305b,0xbf7f35f9bda0af2a,0xbf7fcd793d20cee7,0xbf7a0d54be5b73dc,0xbf7f35f9bda0af2a,0xbf702d4fbeb13641,0xbf7b14bebe47c5c2,0xbf61c598bef15aea
.quad 0x800000003f800000,0x800000003f800000,0xbe47c5c23f7b14be,0xbe5b73dc3f7a0d54,0xbec3ef153f6c835e,0xbed65a923f687c12,0xbf0e39da3f54db31,0xbf1a82a43f4c1d35
.quad 0xbf3504f33f3504f3,0xbf42a9f73f26423a,0xbf54db313f0e39da,0xbf61c5983ef15aea,0xbf6c835e3ec3ef15,0xbf7663773e8afa3e,0xbf7b14be3e47c5c2,0xbf7f8e563d712283
.quad 0xbf800000248d3132,0xbf7cd925be20305b,0xbf7b14bebe47c5c2,0xbf6e641abeba9be1,0xbf6c835ebec3ef15,0xbf54db31bf0e39da,0xbf54db31bf0e39da,0xbf316e2cbf3889dc
.quad 0xbf3504f3bf3504f3,0xbf05c277bf5a46a0,0xbf0e39dabf54db31,0xbea7bf25bf71decf,0xbec3ef15bf6c835e,0xbdf0b772bf7e39bc,0xbe47c5c2bf7b14be,0x3dc8bd36bf7ec46d
.quad 0x800000003f800000,0x800000003f800000,0xbe8afa3e3f766377,0xbe94a0313f74fa0b,0xbf05c2773f5a46a0,0xbf0e39da3f54db31,0xbf3bfc8f3f2dc5e3,0xbf45e4033f226799
.quad 0xbf6419013ee87171,0xbf6c835e3ec3ef15,0xbf7b14be3e47c5c2,0xbf7ec46d3dc8bd36,0xbf7f35f9bda0af2a,0xbf7b14bebe47c5c2,0xbf702d4fbeb13641,0xbf61c598bef15aea
.quad 0xbf4f1bbdbf167918,0xbf3504f3bf3504f3,0xbf1e7cf1bf490a88,0xbef15aeabf61c598,0xbec3ef15bf6c835e,0xbe47c5c2bf7b14be,0xbdf0b772bf7e39bc,0x3dc8bd36bf7ec46d
.quad 0x3e20305bbf7cd925,0x3ec3ef15bf6c835e,0x3ed65a92bf687c12,0x3f226799bf45e403,0x3f26423abf42a9f7,0x3f54db31bf0e39da,0x3f54db31bf0e39da,0x3f74fa0bbe94a031
.quad 0x800000003f800000,0x800000003f800000,0xbc20d8d23f7ffcd7,0xbcf13d4c3f7fe394,0xbca0d6d63f7ff35e,0xbd7122833f7f8e56,0xbcf13d4c3f7fe394,0xbdb4b86a3f7f0059
.quad 0xbd20cee73f7fcd79,0xbdf0b7723f7e39bc,0xbd48fb303f7fb10f,0xbe1640833f7d3aac,0xbd7122833f7f8e56,0xbe3403f13f7c0361,0xbd8ca1f23f7f654e,0xbe519f653f7a9421
.quad 0xbda0af2a3f7f35f9,0xbe6f0c4d3f78ed3c,0xbdb4b86a3f7f0059,0xbe8622103f770f11,0xbdc8bd363f7ec46d,0xbe94a0313f74fa0b,0xbddcbd0d3f7e8238,0xbea2fd523f72ae9e
.quad 0xbdf0b7723f7e39bc,0xbeb136413f702d4f,0xbe0255f43f7deafa,0xbebf47d73f6d76aa,0xbe0c4cf73f7d95f4,0xbecd2ef33f6a8b4b,0xbe1640833f7d3aac,0xbedae8803f676bd8
.quad 0x800000003f800000,0x800000003f800000,0xbdb4b86a3f7f0059,0xbddcbd0d3f7e8238,0xbe3403f13f7c0361,0xbe5b73dc3f7a0d54,0xbe8622103f770f11,0xbea2fd523f72ae9e
.quad 0xbeb136413f702d4f,0xbed65a923f687c12,0xbedae8803f676bd8,0xbf039c3d3f5b941a,0xbf0172c33f5cdc29,0xbf1a82a43f4c1d35,0xbf146eba3f50935b,0xbf2f9c323f3a4582
.quad 0xbf26423a3f42a9f7,0xbf42a9f73f26423a,0xbf36c9a93f333bc6,0xbf53731f3f104f0e,0xbf45e4033f226799,0xbf61c5983ef15aea,0xbf53731f3f104f0e,0xbf6d76aa3ebf47d7
.quad 0xbf5f5be63efa2c90,0xbf7663773e8afa3e,0xbf6986903ed1c759,0xbf7c71603e2a1c3f,0xbf71decf3ea7bf25,0xbf7f8e563d712283,0xbf7853f83e78cfcc,0xbf7fb10fbd48fb30
.quad 0x800000003f800000,0x800000003f800000,0xbe2a1c3f3f7c7160,0xbe3de7313f7b8f2a,0xbea7bf253f71decf,0xbeba9be13f6e641a,0xbef5c6c53f609384,0xbf07e5653f58f3c4
.quad 0xbf1e7cf13f490a88,0xbf2dc5e33f3bfc8f,0xbf3daef93f2beb4a,0xbf4d9f023f187fc0,0xbf579b8c3f0a04f8,0xbf6655e73edf7108,0xbf6b8a3d3ec8917e,0xbf770f113e862210
.quad 0xbf78ed3c3e6f0c4d,0xbf7f35f93da0af2a,0xbf7f654e3d8ca1f2,0xbf7e8238bddcbd0d,0xbf7ec46dbdc8bd36,0xbf74fa0bbe94a031,0xbf770f11be862210,0xbf62f219beece91a
.quad 0xbf687c12bed65a92,0xbf490a88bf1e7cf1,0xbf53731fbf104f0e,0xbf28296abf4105b8,0xbf3889dcbf316e2c,0xbf0172c3bf5cdc29,0xbf187fc0bf4d9f02,0xbeac7cd4bf710908
.quad 0x800000003f800000,0x800000003f800000,0xbe78cfcc3f7853f8,0xbe8622103f770f11,0xbef15aea3f61c598,0xbf0172c33f5cdc29,0xbf2beb4a3f3daef9,0xbf36c9a93f333bc6
.quad 0xbf54db313f0e39da,0xbf5f5be63efa2c90,0xbf7109083eac7cd4,0xbf7853f83e78cfcc,0xbf7ec46d3dc8bd36,0xbf7ff35ebca0d6d6,0xbf7d3aacbe164083,0xbf75b1c9be8fcefe
.quad 0xbf6c835ebec3ef15,0xbf5a46a0bf05c277,0xbf4d9f02bf187fc0,0xbf2f9c32bf3a4582,0xbf226799bf45e403,0xbef15aeabf61c598,0xbedae880bf676bd8,0xbe6542e9bf79805c
.quad 0xbe47c5c2bf7b14be,0x3d20cee7bf7fcd79,0x3d48fb30bf7fb10f,0x3e996dbabf743c41,0x3e94a031bf74fa0b,0x3f0a04f8bf579b8c,0x3f039c3dbf5b941a,0x3f3daef9bf2beb4a
.quad 0x800000003f800000,0x800000003f800000,0xbd48fb303f7fb10f,0xbd8ca1f23f7f654e,0xbdc8bd363f7ec46d,0xbe0c4cf73f7d95f4,0xbe1640833f7d3aac,0xbe519f653f7a9421
.quad 0xbe47c5c23f7b14be,0xbe8afa3e3f766377,0xbe78cfcc3f7853f8,0xbeac7cd43f710908,0xbe94a0313f74fa0b,0xbecd2ef33f6a8b4b,0xbeac7cd43f710908,0xbeece91a3f62f219
.quad 0xbec3ef153f6c835e,0xbf05c2773f5a46a0,0xbedae8803f676bd8,0xbf146eba3f50935b,0xbef15aea3f61c598,0xbf2267993f45e403,0xbf039c3d3f5b941a,0xbf2f9c323f3a4582
.quad 0xbf0e39da3f54db31,0xbf3bfc8f3f2dc5e3,0xbf187fc03f4d9f02,0xbf4779bc3f207440,0xbf2267993f45e403,0xbf5205d43f1260b2,0xbf2beb4a3f3daef9,0xbf5b941a3f039c3d
.quad 0x800000003f800000,0x800000003f800000,0xbe0255f43f7deafa,0xbe1640833f7d3aac,0xbe8146933f77b493,0xbe94a0313f74fa0b,0xbebf47d73f6d76aa,0xbedae8803f676bd8
.quad 0xbefa2c903f5f5be6,0xbf0e39da3f54db31,0xbf187fc03f4d9f02,0xbf2beb4a3f3daef9,0xbf316e2c3f3889dc,0xbf45e4033f226799,0xbf4779bc3f207440,0xbf5b941a3f039c3d
.quad 0xbf5a46a03f05c277,0xbf6c835e3ec3ef15,0xbf6986903ed1c759,0xbf7853f83e78cfcc,0xbf74fa0b3e94a031,0xbf7ec46d3dc8bd36,0xbf7c71603e2a1c3f,0xbf7fb10fbd48fb30
.quad 0xbf7fcd793d20cee7,0xbf7b14bebe47c5c2,0xbf7f0059bdb4b86a,0xbf710908beac7cd4,0xbf7a0d54be5b73dc,0xbf61c598bef15aea,0xbf710908beac7cd4,0xbf4d9f02bf187fc0
.quad 0x800000003f800000,0x800000003f800000,0xbe519f653f7a9421,0xbe6542e93f79805c,0xbecd2ef33f6a8b4b,0xbedf71083f6655e7,0xbf146eba3f50935b,0xbf2074403f4779bc
.quad 0xbf3bfc8f3f2dc5e3,0xbf490a883f1e7cf1,0xbf5b941a3f039c3d,0xbf676bd83edae880,0xbf71decf3ea7bf25,0xbf7a0d543e5b73dc,0xbf7deafa3e0255f4,0xbf7ffcd7bc20d8d2
.quad 0xbf7f35f9bda0af2a,0xbf78ed3cbe6f0c4d,0xbf75b1c9be8fcefe,0xbf653a48bee3f40d,0xbf61c598bef15aea,0xbf45e403bf226799,0xbf444969bf2456f1,0xbf1c81b9bf4a965e
.quad 0xbf1e7cf1bf490a88,0xbed65a92bf687c12,0xbee3f40dbf653a48,0xbe519f65bf7a9421,0xbe814693bf77b493,0x3ca0d6d6bf7ff35e,0xbd48fb30bf7fb10f,0x3e78cfccbf7853f8
.quad 0x800000003f800000,0x800000003f800000,0xbe8fcefe3f75b1c9,0xbe996dba3f743c41,0xbf0a04f83f579b8c,0xbf1260b23f5205d4,0xbf4105b83f28296a,0xbf4a965e3f1c81b9
.quad 0xbf687c123ed65a92,0xbf702d4f3eb13641,0xbf7d3aac3e164083,0xbf7fb10f3d48fb30,0xbf7d95f4be0c4cf7,0xbf77b493be814693,0xbf698690bed1c759,0xbf58f3c4bf07e565
.quad 0xbf42a9f7bf26423a,0xbf26423abf42a9f7,0xbf0c2124bf563e03,0xbec8917ebf6b8a3d,0xbe94a031bf74fa0b,0xbdc8bd36bf7ec46d,0xbc20d8d2bf7ffcd7,0x3e519f65bf7a9421
.quad 0x3e8afa3ebf766377,0x3efa2c90bf5f5be6,0x3f07e565bf58f3c4,0x3f3a4582bf2f9c32,0x3f3f5cb5bf2a0c73,0x3f6655e7bedf7108,0x3f676bd8bedae880,0x3f7d3aacbe164083
.quad 0x31a8000031a8,0x31a8000031a8,0x31a8800031a88000,0x31a8800031a88000,0x2c54313a000031a8,0x313a2c5430003000,0x313aac5431a88000,0x2c54b13a3000b000
.quad 0x30003000000031a8,0x3000b00031a80000,0x3000b00031a88000,0xb000b0000000b1a8,0x313a2c54000031a8,0xac54b13a3000b000,0x2c54b13a31a88000,0xb13a2c54b000b000
.quad 0x31a80000000031a8,0xb1a880000000b1a8,0xb1a831a88000,0x800031a8b1a88000,0x313aac54000031a8,0xac54313ab000b000,0xac54b13a31a88000,0x313a2c54b0003000
.quad 0x3000b000000031a8,0x30003000b1a88000,0xb000b00031a88000,0x3000b000800031a8,0x2c54b13a000031a8,0x313aac54b0003000,0xb13aac5431a88000,0xac54b13a30003000
.quad 0x31a8000031a8,0x31a8000031a8,0x31a8800031a88000,0x31a8800031a88000,0x313aac5431a80000,0x2c54b13a3000b000,0xac54b13a0000b1a8,0xb13aac54b000b000
.quad 0xb000b0000000b1a8,0xb0003000b1a88000,0xb0003000b1a88000,0x30003000800031a8,0xac54313ab1a88000,0x313aac5430003000,0x313a2c54800031a8,0xac54b13a3000b000
.quad 0x31a80000000031a8,0xb1a880000000b1a8,0xb1a831a88000,0x800031a8b1a88000,0xac54b13a31a80000,0x313a2c54b0003000,0xb13a2c540000b1a8,0x2c54b13a30003000
.quad 0xb00030000000b1a8,0xb000b00031a80000,0x30003000b1a88000,0xb00030000000b1a8,0x313a2c54b1a88000,0x2c54313ab000b000,0x2c54b13a800031a8,0x313aac54b0003000
.quad 0x31a8000031a8,0x31a8000031a8,0x31a8800031a88000,0x31a8800031a88000,0xac54b13a0000b1a8,0xb13aac54b000b000,0xb13a2c54b1a88000,0xac54313ab0003000
.quad 0x30003000000031a8,0x3000b00031a80000,0x3000b00031a88000,0xb000b0000000b1a8,0xb13aac540000b1a8,0x2c54313ab0003000,0xac54313ab1a88000,0x313aac5430003000
.quad 0x31a80000000031a8,0xb1a880000000b1a8,0xb1a831a88000,0x800031a8b1a88000,0xb13a2c540000b1a8,0x2c54b13a30003000,0x2c54313ab1a88000,0xb13aac543000b000
.quad 0x3000b000000031a8,0x30003000b1a88000,0xb000b00031a88000,0x3000b000800031a8,0xac54313a0000b1a8,0xb13a2c543000b000,0x313a2c54b1a88000,0x2c54313ab000b000
.quad 0x31a8000031a8,0x31a8000031a8,0x31a8800031a88000,0x31a8800031a88000,0xb13a2c54b1a88000,0xac54313ab0003000,0x2c54313a800031a8,0x313a2c5430003000
.quad 0xb000b0000000b1a8,0xb0003000b1a88000,0xb0003000b1a88000,0x30003000800031a8,0x2c54b13a31a80000,0xb13a2c54b000b000,0xb13aac540000b1a8,0x2c54313ab0003000
.quad 0x31a80000000031a8,0xb1a880000000b1a8,0xb1a831a88000,0x800031a8b1a88000,0x2c54313ab1a88000,0xb13aac543000b000,0x313aac54800031a8,0xac54313ab000b000
.quad 0xb00030000000b1a8,0xb000b00031a80000,0x30003000b1a88000,0xb00030000000b1a8,0xb13aac5431a80000,0xac54b13a30003000,0xac54313a0000b1a8,0xb13a2c543000b000
.quad 0x31a8000031a8,0x31a8000031a8,0x31a8800031a88000,0x31a8800031a88000,0x2e4930b4286a318c,0x318c286a30b42e49,0x30b4ae49318ca86a,0x286ab18c2e49b0b4
.quad 0x313a2c542c54313a,0x2c54b13a313aac54,0x2c54b13a313aac54,0xb13aac54ac54b13a,0x318ca86a2e4930b4,0xb0b4ae49286ab18c,0xa86ab18c30b4ae49,0xae4930b4b18ca86a
.quad 0x3000b00030003000,0xb0003000b000b000,0xb000b0003000b000,0x30003000b0003000,0x286ab18c30b42e49,0x2e4930b4b18c286a,0xb18ca86a2e49b0b4,0x30b4ae49286a318c
.quad 0xac54b13a313a2c54,0x313aac54ac54313a,0xb13a2c542c54b13a,0xac54b13a313a2c54,0xb0b4ae49318c286a,0xa86ab18c2e4930b4,0xae4930b4286ab18c,0xb18c286a30b4ae49
.quad 0x31a8000031a8,0x31a8000031a8,0x31a8800031a88000,0x31a8800031a88000,0x30b4ae49318ca86a,0x286ab18c2e49b0b4,0xae49b0b4a86ab18c,0xb18ca86ab0b4ae49
.quad 0xb13aac54ac54b13a,0xac54313ab13a2c54,0xac54313ab13a2c54,0x313a2c542c54313a,0x286a318cb0b42e49,0x2e49b0b4318c286a,0x318ca86a2e4930b4,0xb0b4ae49286ab18c
.quad 0x3000b00030003000,0xb0003000b000b000,0xb000b0003000b000,0x30003000b0003000,0xb18ca86a2e49b0b4,0x30b4ae49286a318c,0xa86a318cb0b4ae49,0xae49b0b4318ca86a
.quad 0x2c54313ab13aac54,0xb13a2c542c54b13a,0x313aac54ac54313a,0x2c54313ab13aac54,0x2e49b0b4a86a318c,0x318ca86ab0b42e49,0xb0b4ae49318c286a,0xa86ab18c2e4930b4
.quad 0x31a8000031a8,0x31a8000031a8,0x31a8800031a88000,0x31a8800031a88000,0xae49b0b4a86ab18c,0xb18ca86ab0b4ae49,0xb0b42e49b18c286a,0xa86a318cae4930b4
.quad 0x313a2c542c54313a,0x2c54b13a313aac54,0x2c54b13a313aac54,0xb13aac54ac54b13a,0xb18c286aae49b0b4,0x30b42e49a86a318c,0x286a318cb0b42e49,0x2e49b0b4318c286a
.quad 0x3000b00030003000,0xb0003000b000b000,0xb000b0003000b000,0x30003000b0003000,0xa86a318cb0b4ae49,0xae49b0b4318ca86a,0x318c286aae4930b4,0xb0b42e49a86ab18c
.quad 0xac54b13a313a2c54,0x313aac54ac54313a,0xb13a2c542c54b13a,0xac54b13a313a2c54,0x30b42e49b18ca86a,0x286a318cae49b0b4,0x2e49b0b4a86a318c,0x318ca86ab0b42e49
.quad 0x31a8000031a8,0x31a8000031a8,0x31a8800031a88000,0x31a8800031a88000,0xb0b42e49b18c286a,0xa86a318cae4930b4,0x2e4930b4286a318c,0x318c286a30b42e49
.quad 0xb13aac54ac54b13a,0xac54313ab13a2c54,0xac54313ab13a2c54,0x313a2c542c54313a,0xa86ab18c30b4ae49,0xae4930b4b18ca86a,0xb18c286aae49b0b4,0x30b42e49a86a318c
.quad 0x3000b00030003000,0xb0003000b000b000,0xb000b0003000b000,0x30003000b0003000,0x318c286aae4930b4,0xb0b42e49a86ab18c,0x286ab18c30b42e49,0x2e4930b4b18c286a
.quad 0x2c54313ab13aac54,0xb13a2c542c54b13a,0x313aac54ac54313a,0x2c54313ab13aac54,0xae4930b4286ab18c,0xb18c286a30b4ae49,0x30b42e49b18ca86a,0x286a318cae49b0b4
.quad 0xb1a8000031a8,0xb1a8000031a8,0xb1a8800031a88000,0xb1a8800031a88000,0xac54b13a000031a8,0xb13aac5430003000,0xb13a2c5431a88000,0xac54313a3000b000
.quad 0xb000b000000031a8,0xb000300031a80000,0xb000300031a88000,0x300030000000b1a8,0xb13aac54000031a8,0x2c54313a3000b000,0xac54313a31a88000,0x313aac54b000b000
.quad 0xb1a88000000031a8,0x31a800000000b1a8,0x800031a831a88000,0xb1a8b1a88000,0xb13a2c54000031a8,0x2c54b13ab000b000,0x2c54313a31a88000,0xb13aac54b0003000
.quad 0xb0003000000031a8,0xb000b000b1a88000,0x3000300031a88000,0xb0003000800031a8,0xac54313a000031a8,0xb13a2c54b0003000,0x313a2c5431a88000,0x2c54313a30003000
.quad 0xb1a8000031a8,0xb1a8000031a8,0xb1a8800031a88000,0xb1a8800031a88000,0xb13a2c5431a80000,0xac54313a3000b000,0x2c54313a0000b1a8,0x313a2c54b000b000
.quad 0x300030000000b1a8,0x3000b000b1a88000,0x3000b000b1a88000,0xb000b000800031a8,0x2c54b13ab1a88000,0xb13a2c5430003000,0xb13aac54800031a8,0x2c54313a3000b000
.quad 0xb1a88000000031a8,0x31a800000000b1a8,0x800031a831a88000,0xb1a8b1a88000,0x2c54313a31a80000,0xb13aac54b0003000,0x313aac540000b1a8,0xac54313a30003000
.quad 0x3000b0000000b1a8,0x3000300031a80000,0xb000b000b1a88000,0x3000b0000000b1a8,0xb13aac54b1a88000,0xac54b13ab000b000,0xac54313a800031a8,0xb13a2c54b0003000
.quad 0xb1a8000031a8,0xb1a8000031a8,0xb1a8800031a88000,0xb1a8800031a88000,0x2c54313a0000b1a8,0x313a2c54b000b000,0x313aac54b1a88000,0x2c54b13ab0003000
.quad 0xb000b000000031a8,0xb000300031a80000,0xb000300031a88000,0x300030000000b1a8,0x313a2c540000b1a8,0xac54b13ab0003000,0x2c54b13ab1a88000,0xb13a2c5430003000
.quad 0xb1a88000000031a8,0x31a800000000b1a8,0x800031a831a88000,0xb1a8b1a88000,0x313aac540000b1a8,0xac54313a30003000,0xac54b13ab1a88000,0x313a2c543000b000
.quad 0xb0003000000031a8,0xb000b000b1a88000,0x3000300031a88000,0xb0003000800031a8,0x2c54b13a0000b1a8,0x313aac543000b000,0xb13aac54b1a88000,0xac54b13ab000b000
.quad 0xb1a8000031a8,0xb1a8000031a8,0xb1a8800031a88000,0xb1a8800031a88000,0x313aac54b1a88000,0x2c54b13ab0003000,0xac54b13a800031a8,0xb13aac5430003000
.quad 0x300030000000b1a8,0x3000b000b1a88000,0x3000b000b1a88000,0xb000b000800031a8,0xac54313a31a80000,0x313aac54b000b000,0x313a2c540000b1a8,0xac54b13ab0003000
.quad 0xb1a88000000031a8,0x31a800000000b1a8,0x800031a831a88000,0xb1a8b1a88000,0xac54b13ab1a88000,0x313a2c543000b000,0xb13a2c54800031a8,0x2c54b13ab000b000
.quad 0x3000b0000000b1a8,0x3000300031a80000,0xb000b000b1a88000,0x3000b0000000b1a8,0x313a2c5431a80000,0x2c54313a30003000,0x2c54b13a0000b1a8,0x313aac543000b000
.quad 0xb1a8800031a80000,0xb1a8800031a80000,0x800031a80000b1a8,0x800031a80000b1a8,0xb0b42e49318ca86a,0xa86a318c2e49b0b4,0x2e4930b4a86ab18c,0x318c286ab0b4ae49
.quad 0xac54313a313aac54,0x313a2c54ac54b13a,0x313a2c54ac54b13a,0x2c54b13ab13a2c54,0x286a318c30b4ae49,0x2e49b0b4b18ca86a,0x318ca86aae49b0b4,0xb0b4ae49a86a318c
.quad 0x300030003000b000,0xb000b000b0003000,0x3000b000b000b000,0xb000300030003000,0x318c286a2e49b0b4,0xb0b42e49286a318c,0x286ab18cb0b4ae49,0x2e4930b4318ca86a
.quad 0x313aac542c54b13a,0x2c54313a313a2c54,0xac54b13ab13aac54,0x313aac542c54b13a,0x2e49b0b4286ab18c,0x318ca86a30b4ae49,0xb0b4ae49b18ca86a,0xa86ab18cae49b0b4
.quad 0xb1a8800031a80000,0xb1a8800031a80000,0x800031a80000b1a8,0x800031a80000b1a8,0x2e4930b4a86ab18c,0x318c286ab0b4ae49,0x30b4ae49b18c286a,0x286ab18cae4930b4
.quad 0x2c54b13ab13a2c54,0xb13aac542c54313a,0xb13aac542c54313a,0xac54313a313aac54,0xb18c286a2e4930b4,0x30b42e49286ab18c,0x286a318c30b4ae49,0x2e49b0b4b18ca86a
.quad 0x300030003000b000,0xb000b000b0003000,0x3000b000b000b000,0xb000300030003000,0x286ab18cb0b4ae49,0x2e4930b4318ca86a,0xb18ca86aae4930b4,0x30b4ae49a86ab18c
.quad 0xb13a2c54ac54313a,0xac54b13ab13aac54,0x2c54313a313a2c54,0xb13a2c54ac54313a,0x30b42e49318c286a,0x286a318c2e4930b4,0x2e49b0b4286ab18c,0x318ca86a30b4ae49
.quad 0xb1a8800031a80000,0xb1a8800031a80000,0x800031a80000b1a8,0x800031a80000b1a8,0x30b4ae49b18c286a,0x286ab18cae4930b4,0xae49b0b4286a318c,0xb18ca86a30b42e49
.quad 0xac54313a313aac54,0x313a2c54ac54b13a,0x313a2c54ac54b13a,0x2c54b13ab13a2c54,0xa86ab18cb0b42e49,0xae4930b4318c286a,0xb18c286a2e4930b4,0x30b42e49286ab18c
.quad 0x300030003000b000,0xb000b000b0003000,0x3000b000b000b000,0xb000300030003000,0xb18ca86aae4930b4,0x30b4ae49a86ab18c,0xa86a318c30b42e49,0xae49b0b4b18c286a
.quad 0x313aac542c54b13a,0x2c54313a313a2c54,0xac54b13ab13aac54,0x313aac542c54b13a,0xae4930b4a86a318c,0xb18c286ab0b42e49,0x30b42e49318c286a,0x286a318c2e4930b4
.quad 0xb1a8800031a80000,0xb1a8800031a80000,0x800031a80000b1a8,0x800031a80000b1a8,0xae49b0b4286a318c,0xb18ca86a30b42e49,0xb0b42e49318ca86a,0xa86a318c2e49b0b4
.quad 0x2c54b13ab13a2c54,0xb13aac542c54313a,0xb13aac542c54313a,0xac54313a313aac54,0x318ca86aae49b0b4,0xb0b4ae49a86a318c,0xa86ab18cb0b42e49,0xae4930b4318c286a
.quad 0x300030003000b000,0xb000b000b0003000,0x3000b000b000b000,0xb000300030003000,0xa86a318c30b42e49,0xae49b0b4b18c286a,0x318c286a2e49b0b4,0xb0b42e49286a318c
.quad 0xb13a2c54ac54313a,0xac54b13ab13aac54,0x2c54313a313a2c54,0xb13a2c54ac54313a,0xb0b4ae49b18ca86a,0xa86ab18cae49b0b4,0xae4930b4a86a318c,0xb18c286ab0b42e49
.quad 0x31a8000031a8,0x31a8000031a8,0xb1a80000b1a80000,0xb1a80000b1a80000,0x2c54313a000031a8,0x313a2c5430003000,0xb13a2c54b1a80000,0xac54313ab0003000
.quad 0x30003000000031a8,0x3000b00031a80000,0xb0003000b1a80000,0x30003000800031a8,0x313a2c54000031a8,0xac54b13a3000b000,0xac54313ab1a80000,0x313aac5430003000
.quad 0x31a80000000031a8,0xb1a880000000b1a8,0x800031a8b1a80000,0xb1a831a80000,0x313aac54000031a8,0xac54313ab000b000,0x2c54313ab1a80000,0xb13aac543000b000
.quad 0x3000b000000031a8,0x30003000b1a88000,0x30003000b1a80000,0xb00030000000b1a8,0x2c54b13a000031a8,0x313aac54b0003000,0x313a2c54b1a80000,0x2c54313ab000b000
.quad 0x31a8000031a8,0x31a8000031a8,0xb1a80000b1a80000,0xb1a80000b1a80000,0x313aac5431a80000,0x2c54b13a3000b000,0x2c54313a800031a8,0x313a2c5430003000
.quad 0xb000b0000000b1a8,0xb0003000b1a88000,0x3000b00031a80000,0xb000b0000000b1a8,0xac54313ab1a88000,0x313aac5430003000,0xb13aac540000b1a8,0x2c54313ab0003000
.quad 0x31a80000000031a8,0xb1a880000000b1a8,0x800031a8b1a80000,0xb1a831a80000,0xac54b13a31a80000,0x313a2c54b0003000,0x313aac54800031a8,0xac54313ab000b000
.quad 0xb00030000000b1a8,0xb000b00031a80000,0xb000b00031a80000,0x3000b000800031a8,0x313a2c54b1a88000,0x2c54313ab000b000,0xac54313a0000b1a8,0xb13a2c543000b000
.quad 0x31a8000031a8,0x31a8000031a8,0xb1a80000b1a80000,0xb1a80000b1a80000,0xac54b13a0000b1a8,0xb13aac54b000b000,0x313aac5431a80000,0x2c54b13a3000b000
.quad 0x30003000000031a8,0x3000b00031a80000,0xb0003000b1a80000,0x30003000800031a8,0xb13aac540000b1a8,0x2c54313ab0003000,0x2c54b13a31a80000,0xb13a2c54b000b000
.quad 0x31a80000000031a8,0xb1a880000000b1a8,0x800031a8b1a80000,0xb1a831a80000,0xb13a2c540000b1a8,0x2c54b13a30003000,0xac54b13a31a80000,0x313a2c54b0003000
.quad 0x3000b000000031a8,0x30003000b1a88000,0x30003000b1a80000,0xb00030000000b1a8,0xac54313a0000b1a8,0xb13a2c543000b000,0xb13aac5431a80000,0xac54b13a30003000
.quad 0x31a8000031a8,0x31a8000031a8,0xb1a80000b1a80000,0xb1a80000b1a80000,0xb13a2c54b1a88000,0xac54313ab0003000,0xac54b13a0000b1a8,0xb13aac54b000b000
.quad 0xb000b0000000b1a8,0xb0003000b1a88000,0x3000b00031a80000,0xb000b0000000b1a8,0x2c54b13a31a80000,0xb13a2c54b000b000,0x313a2c54800031a8,0xac54b13a3000b000
.quad 0x31a80000000031a8,0xb1a880000000b1a8,0x800031a8b1a80000,0xb1a831a80000,0x2c54313ab1a88000,0xb13aac543000b000,0xb13a2c540000b1a8,0x2c54b13a30003000
.quad 0xb00030000000b1a8,0xb000b00031a80000,0xb000b00031a80000,0x3000b000800031a8,0xb13aac5431a80000,0xac54b13a30003000,0x2c54b13a800031a8,0x313aac54b0003000
.quad 0xb1a80000b1a8,0xb1a80000b1a8,0x31a8000031a80000,0x31a8000031a80000,0xae49b0b4a86ab18c,0xb18ca86ab0b4ae49,0x30b4ae49318ca86a,0x286ab18c2e49b0b4
.quad 0xb13aac54ac54b13a,0xac54313ab13a2c54,0x2c54b13a313aac54,0xb13aac54ac54b13a,0xb18c286aae49b0b4,0x30b42e49a86a318c,0xa86ab18c30b4ae49,0xae4930b4b18ca86a
.quad 0xb0003000b000b000,0x3000b00030003000,0xb000b0003000b000,0x30003000b0003000,0xa86a318cb0b4ae49,0xae49b0b4318ca86a,0xb18ca86a2e49b0b4,0x30b4ae49286a318c
.quad 0x2c54313ab13aac54,0xb13a2c542c54b13a,0xb13a2c542c54b13a,0xac54b13a313a2c54,0x30b42e49b18ca86a,0x286a318cae49b0b4,0xae4930b4286ab18c,0xb18c286a30b4ae49
.quad 0xb1a80000b1a8,0xb1a80000b1a8,0x31a8000031a80000,0x31a8000031a80000,0xb0b42e49b18c286a,0xa86a318cae4930b4,0xae49b0b4a86ab18c,0xb18ca86ab0b4ae49
.quad 0x313a2c542c54313a,0x2c54b13a313aac54,0xac54313ab13a2c54,0x313a2c542c54313a,0xa86ab18c30b4ae49,0xae4930b4b18ca86a,0x318ca86a2e4930b4,0xb0b4ae49286ab18c
.quad 0xb0003000b000b000,0x3000b00030003000,0xb000b0003000b000,0x30003000b0003000,0x318c286aae4930b4,0xb0b42e49a86ab18c,0xa86a318cb0b4ae49,0xae49b0b4318ca86a
.quad 0xac54b13a313a2c54,0x313aac54ac54313a,0x313aac54ac54313a,0x2c54313ab13aac54,0xae4930b4286ab18c,0xb18c286a30b4ae49,0xb0b4ae49318c286a,0xa86ab18c2e4930b4
.quad 0xb1a80000b1a8,0xb1a80000b1a8,0x31a8000031a80000,0x31a8000031a80000,0x2e4930b4286a318c,0x318c286a30b42e49,0xb0b42e49b18c286a,0xa86a318cae4930b4
.quad 0xb13aac54ac54b13a,0xac54313ab13a2c54,0x2c54b13a313aac54,0xb13aac54ac54b13a,0x318ca86a2e4930b4,0xb0b4ae49286ab18c,0x286a318cb0b42e49,0x2e49b0b4318c286a
.quad 0xb0003000b000b000,0x3000b00030003000,0xb000b0003000b000,0x30003000b0003000,0x286ab18c30b42e49,0x2e4930b4b18c286a,0x318c286aae4930b4,0xb0b42e49a86ab18c
.quad 0x2c54313ab13aac54,0xb13a2c542c54b13a,0xb13a2c542c54b13a,0xac54b13a313a2c54,0xb0b4ae49318c286a,0xa86ab18c2e4930b4,0x2e49b0b4a86a318c,0x318ca86ab0b42e49
.quad 0xb1a80000b1a8,0xb1a80000b1a8,0x31a8000031a80000,0x31a8000031a80000,0x30b4ae49318ca86a,0x286ab18c2e49b0b4,0x2e4930b4286a318c,0x318c286a30b42e49
.quad 0x313a2c542c54313a,0x2c54b13a313aac54,0xac54313ab13a2c54,0x313a2c542c54313a,0x286a318cb0b42e49,0x2e49b0b4318c286a,0xb18c286aae49b0b4,0x30b42e49a86a318c
.quad 0xb0003000b000b000,0x3000b00030003000,0xb000b0003000b000,0x30003000b0003000,0xb18ca86a2e49b0b4,0x30b4ae49286a318c,0x286ab18c30b42e49,0x2e4930b4b18c286a
.quad 0xac54b13a313a2c54,0x313aac54ac54313a,0x313aac54ac54313a,0x2c54313ab13aac54,0x2e49b0b4a86a318c,0x318ca86ab0b42e49,0x30b42e49b18ca86a,0x286a318cae49b0b4
.quad 0xb1a8000031a8,0xb1a8000031a8,0x31a80000b1a80000,0x31a80000b1a80000,0xac54b13a000031a8,0xb13aac5430003000,0x313aac54b1a80000,0x2c54b13ab0003000
.quad 0xb000b000000031a8,0xb000300031a80000,0x3000b000b1a80000,0xb000b000800031a8,0xb13aac54000031a8,0x2c54313a3000b000,0x2c54b13ab1a80000,0xb13a2c5430003000
.quad 0xb1a88000000031a8,0x31a800000000b1a8,0xb1a8b1a80000,0x800031a831a80000,0xb13a2c54000031a8,0x2c54b13ab000b000,0xac54b13ab1a80000,0x313a2c543000b000
.quad 0xb0003000000031a8,0xb000b000b1a88000,0xb000b000b1a80000,0x3000b0000000b1a8,0xac54313a000031a8,0xb13a2c54b0003000,0xb13aac54b1a80000,0xac54b13ab000b000
.quad 0xb1a8000031a8,0xb1a8000031a8,0x31a80000b1a80000,0x31a80000b1a80000,0xb13a2c5431a80000,0xac54313a3000b000,0xac54b13a800031a8,0xb13aac5430003000
.quad 0x300030000000b1a8,0x3000b000b1a88000,0xb000300031a80000,0x300030000000b1a8,0x2c54b13ab1a88000,0xb13a2c5430003000,0x313a2c540000b1a8,0xac54b13ab0003000
.quad 0xb1a88000000031a8,0x31a800000000b1a8,0xb1a8b1a80000,0x800031a831a80000,0x2c54313a31a80000,0xb13aac54b0003000,0xb13a2c54800031a8,0x2c54b13ab000b000
.quad 0x3000b0000000b1a8,0x3000300031a80000,0x3000300031a80000,0xb0003000800031a8,0xb13aac54b1a88000,0xac54b13ab000b000,0x2c54b13a0000b1a8,0x313aac543000b000
.quad 0xb1a8000031a8,0xb1a8000031a8,0x31a80000b1a80000,0x31a80000b1a80000,0x2c54313a0000b1a8,0x313a2c54b000b000,0xb13a2c5431a80000,0xac54313a3000b000
.quad 0xb000b000000031a8,0xb000300031a80000,0x3000b000b1a80000,0xb000b000800031a8,0x313a2c540000b1a8,0xac54b13ab0003000,0xac54313a31a80000,0x313aac54b000b000
.quad 0xb1a88000000031a8,0x31a800000000b1a8,0xb1a8b1a80000,0x800031a831a80000,0x313aac540000b1a8,0xac54313a30003000,0x2c54313a31a80000,0xb13aac54b0003000
.quad 0xb0003000000031a8,0xb000b000b1a88000,0xb000b000b1a80000,0x3000b0000000b1a8,0x2c54b13a0000b1a8,0x313aac543000b000,0x313a2c5431a80000,0x2c54313a30003000
.quad 0xb1a8000031a8,0xb1a8000031a8,0x31a80000b1a80000,0x31a80000b1a80000,0x313aac54b1a88000,0x2c54b13ab0003000,0x2c54313a0000b1a8,0x313a2c54b000b000
.quad 0x300030000000b1a8,0x3000b000b1a88000,0xb000300031a80000,0x300030000000b1a8,0xac54313a31a80000,0x313aac54b000b000,0xb13aac54800031a8,0x2c54313a3000b000
.quad 0xb1a88000000031a8,0x31a800000000b1a8,0xb1a8b1a80000,0x800031a831a80000,0xac54b13ab1a88000,0x313a2c543000b000,0x313aac540000b1a8,0xac54313a30003000
.quad 0x3000b0000000b1a8,0x3000300031a80000,0x3000300031a80000,0xb0003000800031a8,0x313a2c5431a80000,0x2c54313a30003000,0xac54313a800031a8,0xb13a2c54b0003000
.quad 0x31a80000b1a88000,0x31a80000b1a88000,0x800031a80000b1a8,0x800031a80000b1a8,0x30b4ae49b18c286a,0x286ab18cae4930b4,0x2e4930b4a86ab18c,0x318c286ab0b4ae49
.quad 0x2c54b13ab13a2c54,0xb13aac542c54313a,0x313a2c54ac54b13a,0x2c54b13ab13a2c54,0xa86ab18cb0b42e49,0xae4930b4318c286a,0x318ca86aae49b0b4,0xb0b4ae49a86a318c
.quad 0xb000b000b0003000,0x300030003000b000,0x3000b000b000b000,0xb000300030003000,0xb18ca86aae4930b4,0x30b4ae49a86ab18c,0x286ab18cb0b4ae49,0x2e4930b4318ca86a
.quad 0xb13a2c54ac54313a,0xac54b13ab13aac54,0xac54b13ab13aac54,0x313aac542c54b13a,0xae4930b4a86a318c,0xb18c286ab0b42e49,0xb0b4ae49b18ca86a,0xa86ab18cae49b0b4
.quad 0x31a80000b1a88000,0x31a80000b1a88000,0x800031a80000b1a8,0x800031a80000b1a8,0xae49b0b4286a318c,0xb18ca86a30b42e49,0x30b4ae49b18c286a,0x286ab18cae4930b4
.quad 0xac54313a313aac54,0x313a2c54ac54b13a,0xb13aac542c54313a,0xac54313a313aac54,0x318ca86aae49b0b4,0xb0b4ae49a86a318c,0x286a318c30b4ae49,0x2e49b0b4b18ca86a
.quad 0xb000b000b0003000,0x300030003000b000,0x3000b000b000b000,0xb000300030003000,0xa86a318c30b42e49,0xae49b0b4b18c286a,0xb18ca86aae4930b4,0x30b4ae49a86ab18c
.quad 0x313aac542c54b13a,0x2c54313a313a2c54,0x2c54313a313a2c54,0xb13a2c54ac54313a,0xb0b4ae49b18ca86a,0xa86ab18cae49b0b4,0x2e49b0b4286ab18c,0x318ca86a30b4ae49
.quad 0x31a80000b1a88000,0x31a80000b1a88000,0x800031a80000b1a8,0x800031a80000b1a8,0xb0b42e49318ca86a,0xa86a318c2e49b0b4,0xae49b0b4286a318c,0xb18ca86a30b42e49
.quad 0x2c54b13ab13a2c54,0xb13aac542c54313a,0x313a2c54ac54b13a,0x2c54b13ab13a2c54,0x286a318c30b4ae49,0x2e49b0b4b18ca86a,0xb18c286a2e4930b4,0x30b42e49286ab18c
.quad 0xb000b000b0003000,0x300030003000b000,0x3000b000b000b000,0xb000300030003000,0x318c286a2e49b0b4,0xb0b42e49286a318c,0xa86a318c30b42e49,0xae49b0b4b18c286a
.quad 0xb13a2c54ac54313a,0xac54b13ab13aac54,0xac54b13ab13aac54,0x313aac542c54b13a,0x2e49b0b4286ab18c,0x318ca86a30b4ae49,0x30b42e49318c286a,0x286a318c2e4930b4
.quad 0x31a80000b1a88000,0x31a80000b1a88000,0x800031a80000b1a8,0x800031a80000b1a8,0x2e4930b4a86ab18c,0x318c286ab0b4ae49,0xb0b42e49318ca86a,0xa86a318c2e49b0b4
.quad 0xac54313a313aac54,0x313a2c54ac54b13a,0xb13aac542c54313a,0xac54313a313aac54,0xb18c286a2e4930b4,0x30b42e49286ab18c,0xa86ab18cb0b42e49,0xae4930b4318c286a
.quad 0xb000b000b0003000,0x300030003000b000,0x3000b000b000b000,0xb000300030003000,0x286ab18cb0b4ae49,0x2e4930b4318ca86a,0x318c286a2e49b0b4,0xb0b42e49286a318c
.quad 0x313aac542c54b13a,0x2c54313a313a2c54,0x2c54313a313a2c54,0xb13a2c54ac54313a,0x30b42e49318c286a,0x286a318c2e4930b4,0xae4930b4a86a318c,0xb18c286ab0b42e49
.quad 0x400000000,0x28400000280,0xc00000008,0x28c00000288,0x1400000010,0x29400000290,0x1c00000018,0x29c00000298
.quad 0x2400000020,0x2a4000002a0,0x2c00000028,0x2ac000002a8,0x3400000030,0x2b4000002b0,0x3c00000038,0x2bc000002b8
.quad 0x4400000040,0x2c4000002c0,0x4c00000048,0x2cc000002c8,0x5400000050,0x2d4000002d0,0x50400000504,0x50400000504
.quad 0x50400000504,0x50400000504,0x50400000504,0x50400000504,0x50400000504,0x50400000504,0x50400000504,0x50400000504
.quad 0xa4000000a0,0x32400000320,0xac000000a8,0x32c00000328,0xb4000000b0,0x33400000330,0xbc000000b8,0x33c00000338
.quad 0xc4000000c0,0x34400000340,0xcc000000c8,0x34c00000348,0xd4000000d0,0x35400000350,0xdc000000d8,0x35c00000358
.quad 0xe4000000e0,0x36400000360,0xec000000e8,0x36c00000368,0xf4000000f0,0x37400000370,0x50400000504,0x50400000504
.quad 0x50400000504,0x50400000504,0x50400000504,0x50400000504,0x50400000504,0x50400000504,0x50400000504,0x50400000504
.quad 0x14400000140,0x3c4000003c0,0x14c00000148,0x3cc000003c8,0x15400000150,0x3d4000003d0,0x15c00000158,0x3dc000003d8
.quad 0x16400000160,0x3e4000003e0,0x16c00000168,0x3ec000003e8,0x17400000170,0x3f4000003f0,0x17c00000178,0x3fc000003f8
.quad 0x18400000180,0x40400000400,0x18c00000188,0x40c00000408,0x19400000190,0x41400000410,0x50400000504,0x50400000504
.quad 0x50400000504,0x50400000504,0x50400000504,0x50400000504,0x50400000504,0x50400000504,0x50400000504,0x50400000504
.quad 0x1e4000001e0,0x46400000460,0x1ec000001e8,0x46c00000468,0x1f4000001f0,0x47400000470,0x1fc000001f8,0x47c00000478
.quad 0x20400000200,0x48400000480,0x20c00000208,0x48c00000488,0x21400000210,0x49400000490,0x21c00000218,0x49c00000498
.quad 0x22400000220,0x4a4000004a0,0x22c00000228,0x4ac000004a8,0x23400000230,0x4b4000004b0,0x50400000504,0x50400000504
.quad 0x50400000504,0x50400000504,0x50400000504,0x50400000504,0x50400000504,0x50400000504,0x50400000504,0x50400000504
.quad 0x50400000500,0x50400000504,0x4f8000004fc,0x2780000027c,0x4f0000004f4,0x27000000274,0x4e8000004ec,0x2680000026c
.quad 0x4e0000004e4,0x26000000264,0x4d8000004dc,0x2580000025c,0x4d0000004d4,0x25000000254,0x4c8000004cc,0x2480000024c
.quad 0x4c0000004c4,0x24000000244,0x4b8000004bc,0x2380000023c,0x50400000504,0x50400000504,0x50400000504,0x50400000504
.quad 0x50400000504,0x50400000504,0x50400000504,0x50400000504,0x50400000504,0x50400000504,0x50400000504,0x50400000504
.quad 0x50400000504,0x50400000504,0x4580000045c,0x1d8000001dc,0x45000000454,0x1d0000001d4,0x4480000044c,0x1c8000001cc
.quad 0x44000000444,0x1c0000001c4,0x4380000043c,0x1b8000001bc,0x43000000434,0x1b0000001b4,0x4280000042c,0x1a8000001ac
.quad 0x42000000424,0x1a0000001a4,0x4180000041c,0x1980000019c,0x50400000504,0x50400000504,0x50400000504,0x50400000504
.quad 0x50400000504,0x50400000504,0x50400000504,0x50400000504,0x50400000504,0x50400000504,0x50400000504,0x50400000504
.quad 0x50400000504,0x50400000504,0x3b8000003bc,0x1380000013c,0x3b0000003b4,0x13000000134,0x3a8000003ac,0x1280000012c
.quad 0x3a0000003a4,0x12000000124,0x3980000039c,0x1180000011c,0x39000000394,0x11000000114,0x3880000038c,0x1080000010c
.quad 0x38000000384,0x10000000104,0x3780000037c,0xf8000000fc,0x50400000504,0x50400000504,0x50400000504,0x50400000504
.quad 0x50400000504,0x50400000504,0x50400000504,0x50400000504,0x50400000504,0x50400000504,0x50400000504,0x50400000504
.quad 0x50400000504,0x50400000504,0x3180000031c,0x980000009c,0x31000000314,0x9000000094,0x3080000030c,0x880000008c
.quad 0x30000000304,0x8000000084,0x2f8000002fc,0x780000007c,0x2f0000002f4,0x7000000074,0x2e8000002ec,0x680000006c
.quad 0x2e0000002e4,0x6000000064,0x2d8000002dc,0x580000005c,0x50400000504,0x50400000504,0x50400000504,0x50400000504
.quad 0x50400000504,0x50400000504,0x50400000504,0x50400000504,0x50400000504,0x50400000504,0x50400000504,0x50400000504
.quad 0x800031a8800031a8,0x800031a8800031a8,0xac54313a800031a8,0xb13a2c54b0003000,0xb0003000800031a8,0xb000b000b1a80000,0xb13a2c54800031a8,0x2c54b13ab000b000
.quad 0xb1a80000800031a8,0x31a880008000b1a8,0xb13aac54800031a8,0x2c54313a3000b000,0xb000b000800031a8,0xb000300031a88000,0xac54b13a800031a8,0xb13aac5430003000
.quad 0x8000b1a8800031a8,0x8000b1a8800031a8,0x2c54b13a800031a8,0x313aac54b0003000,0x3000b000800031a8,0x30003000b1a80000,0x313aac54800031a8,0xac54313ab000b000
.quad 0x31a88000800031a8,0xb1a800008000b1a8,0x313a2c54800031a8,0xac54b13a3000b000,0x30003000800031a8,0x3000b00031a88000,0x2c54313a800031a8,0x313a2c5430003000
.quad 0x800031a8800031a8,0x800031a8800031a8,0xb13aac54b1a80000,0xac54b13ab000b000,0x3000b0008000b1a8,0x3000300031a88000,0x2c54313a31a88000,0xb13aac54b0003000
.quad 0xb1a80000800031a8,0x31a880008000b1a8,0x2c54b13ab1a80000,0xb13a2c5430003000,0x300030008000b1a8,0x3000b000b1a80000,0xb13a2c5431a88000,0xac54313a3000b000
.quad 0x8000b1a8800031a8,0x8000b1a8800031a8,0x313a2c54b1a80000,0x2c54313ab000b000,0xb00030008000b1a8,0xb000b00031a88000,0xac54b13a31a88000,0x313a2c54b0003000
.quad 0x31a88000800031a8,0xb1a800008000b1a8,0xac54313ab1a80000,0x313aac5430003000,0xb000b0008000b1a8,0xb0003000b1a80000,0x313aac5431a88000,0x2c54b13a3000b000
.quad 0x800031a8800031a8,0x800031a8800031a8,0x2c54b13a8000b1a8,0x313aac543000b000,0xb0003000800031a8,0xb000b000b1a80000,0x313aac548000b1a8,0xac54313a30003000
.quad 0xb1a80000800031a8,0x31a880008000b1a8,0x313a2c548000b1a8,0xac54b13ab0003000,0xb000b000800031a8,0xb000300031a88000,0x2c54313a8000b1a8,0x313a2c54b000b000
.quad 0x8000b1a8800031a8,0x8000b1a8800031a8,0xac54313a8000b1a8,0xb13a2c543000b000,0x3000b000800031a8,0x30003000b1a80000,0xb13a2c548000b1a8,0x2c54b13a30003000
.quad 0x31a88000800031a8,0xb1a800008000b1a8,0xb13aac548000b1a8,0x2c54313ab0003000,0x30003000800031a8,0x3000b00031a88000,0xac54b13a8000b1a8,0xb13aac54b000b000
.quad 0x800031a8800031a8,0x800031a8800031a8,0x313a2c5431a88000,0x2c54313a30003000,0x3000b0008000b1a8,0x3000300031a88000,0xac54b13ab1a80000,0x313a2c543000b000
.quad 0xb1a80000800031a8,0x31a880008000b1a8,0xac54313a31a88000,0x313aac54b000b000,0x300030008000b1a8,0x3000b000b1a80000,0x313aac54b1a80000,0x2c54b13ab0003000
.quad 0x8000b1a8800031a8,0x8000b1a8800031a8,0xb13aac5431a88000,0xac54b13a30003000,0xb00030008000b1a8,0xb000b00031a88000,0x2c54313ab1a80000,0xb13aac543000b000
.quad 0x31a88000800031a8,0xb1a800008000b1a8,0x2c54b13a31a88000,0xb13a2c54b000b000,0xb000b0008000b1a8,0xb0003000b1a80000,0xb13a2c54b1a80000,0xac54313ab0003000
.quad 0x31a8000031a80000,0x31a8000031a80000,0x313a2c5431a80000,0x2c54313a30003000,0x3000300031a80000,0xb0003000000031a8,0x2c54313a31a80000,0xb13aac54b0003000
.quad 0x31a831a80000,0x8000b1a8b1a80000,0xac54313a31a80000,0x313aac54b000b000,0xb000300031a80000,0x300030008000b1a8,0xb13a2c5431a80000,0xac54313a3000b000
.quad 0xb1a8000031a80000,0xb1a8000031a80000,0xb13aac5431a80000,0xac54b13a30003000,0xb000b00031a80000,0x3000b000000031a8,0xac54b13a31a80000,0x313a2c54b0003000
.quad 0x8000b1a831a80000,0x31a8b1a80000,0x2c54b13a31a80000,0xb13a2c54b000b000,0x3000b00031a80000,0xb000b0008000b1a8,0x313aac5431a80000,0x2c54b13a3000b000
.quad 0x31a8000031a80000,0x31a8000031a80000,0xac54313a000031a8,0xb13a2c54b0003000,0xb000b000b1a80000,0x3000b0008000b1a8,0x313aac548000b1a8,0xac54313a30003000
.quad 0x31a831a80000,0x8000b1a8b1a80000,0xb13aac54000031a8,0x2c54313a3000b000,0x3000b000b1a80000,0xb000b000000031a8,0x2c54313a8000b1a8,0x313a2c54b000b000
.quad 0xb1a8000031a80000,0xb1a8000031a80000,0x2c54b13a000031a8,0x313aac54b0003000,0x30003000b1a80000,0xb00030008000b1a8,0xb13a2c548000b1a8,0x2c54b13a30003000
.quad 0x8000b1a831a80000,0x31a8b1a80000,0x313a2c54000031a8,0xac54b13a3000b000,0xb0003000b1a80000,0x30003000000031a8,0xac54b13a8000b1a8,0xb13aac54b000b000
.quad 0x31a8000031a80000,0x31a8000031a80000,0xb13aac54b1a80000,0xac54b13ab000b000,0x3000300031a80000,0xb0003000000031a8,0xac54b13ab1a80000,0x313a2c543000b000
.quad 0x31a831a80000,0x8000b1a8b1a80000,0x2c54b13ab1a80000,0xb13a2c5430003000,0xb000300031a80000,0x300030008000b1a8,0x313aac54b1a80000,0x2c54b13ab0003000
.quad 0xb1a8000031a80000,0xb1a8000031a80000,0x313a2c54b1a80000,0x2c54313ab000b000,0xb000b00031a80000,0x3000b000000031a8,0x2c54313ab1a80000,0xb13aac543000b000
.quad 0x8000b1a831a80000,0x31a8b1a80000,0xac54313ab1a80000,0x313aac5430003000,0x3000b00031a80000,0xb000b0008000b1a8,0xb13a2c54b1a80000,0xac54313ab0003000
.quad 0x31a8000031a80000,0x31a8000031a80000,0x2c54b13a8000b1a8,0x313aac543000b000,0xb000b000b1a80000,0x3000b0008000b1a8,0xb13a2c54000031a8,0x2c54b13ab000b000
.quad 0x31a831a80000,0x8000b1a8b1a80000,0x313a2c548000b1a8,0xac54b13ab0003000,0x3000b000b1a80000,0xb000b000000031a8,0xac54b13a000031a8,0xb13aac5430003000
.quad 0xb1a8000031a80000,0xb1a8000031a80000,0xac54313a8000b1a8,0xb13a2c543000b000,0x30003000b1a80000,0xb00030008000b1a8,0x313aac54000031a8,0xac54313ab000b000
.quad 0x8000b1a831a80000,0x31a8b1a80000,0xb13aac548000b1a8,0x2c54313ab0003000,0xb0003000b1a80000,0x30003000000031a8,0x2c54313a000031a8,0x313a2c5430003000
.quad 0xa86a318c800031a8,0xae4930b4ac54313a,0xae4930b4800031a8,0xb18ca86ab13a2c54,0xb0b42e49800031a8,0xa86ab18cb13aac54,0xb18c286a800031a8,0x30b4ae49ac54b13a
.quad 0xb18ca86a800031a8,0x30b42e492c54b13a,0xb0b4ae49800031a8,0xa86a318c313aac54,0xae49b0b4800031a8,0xb18c286a313a2c54,0xa86ab18c800031a8,0xae49b0b42c54313a
.quad 0x286ab18c800031a8,0x2e49b0b4ac54313a,0x2e49b0b4800031a8,0x318c286ab13a2c54,0x30b4ae49800031a8,0x286a318cb13aac54,0x318ca86a800031a8,0xb0b42e49ac54b13a
.quad 0x318c286a800031a8,0xb0b4ae492c54b13a,0x30b42e49800031a8,0x286ab18c313aac54,0x2e4930b4800031a8,0x318ca86a313a2c54,0x286a318c800031a8,0x2e4930b42c54313a
.quad 0xb0b42e49b0003000,0xb18c286ab13a2c54,0xa86ab18cb000b000,0x30b4ae492c54b13a,0x318c286a3000b000,0xae4930b42c54313a,0xae4930b430003000,0x286ab18cb13aac54
.quad 0xae49b0b4b0003000,0x286a318c313aac54,0x318ca86ab000b000,0xae49b0b4ac54313a,0xa86a318c3000b000,0x30b42e49ac54b13a,0xb0b4ae4930003000,0xb18ca86a313a2c54
.quad 0x30b4ae49b0003000,0x318ca86ab13a2c54,0x286a318cb000b000,0xb0b42e492c54b13a,0xb18ca86a3000b000,0x2e49b0b42c54313a,0x2e49b0b430003000,0xa86a318cb13aac54
.quad 0x2e4930b4b0003000,0xa86ab18c313aac54,0xb18c286ab000b000,0x2e4930b4ac54313a,0x286ab18c3000b000,0xb0b4ae49ac54b13a,0x30b42e4930003000,0x318c286a313a2c54
.quad 0xb18ca86ab1a80000,0xb0b4ae49b13aac54,0x30b42e4931a88000,0xa86a318c2c54313a,0xae49b0b4b1a80000,0x318ca86a2c54b13a,0x286a318c31a88000,0xae49b0b4b13a2c54
.quad 0x286ab18cb1a80000,0xae4930b4313a2c54,0xae4930b431a88000,0x318c286aac54b13a,0x30b4ae49b1a80000,0xa86ab18cac54313a,0xb18c286a31a88000,0xb0b42e49313aac54
.quad 0x318c286ab1a80000,0x30b42e49b13aac54,0xb0b4ae4931a88000,0x286ab18c2c54313a,0x2e4930b4b1a80000,0xb18c286a2c54b13a,0xa86ab18c31a88000,0x2e4930b4b13a2c54
.quad 0xa86a318cb1a80000,0x2e49b0b4313a2c54,0x2e49b0b431a88000,0xb18ca86aac54b13a,0xb0b42e49b1a80000,0x286a318cac54313a,0x318ca86a31a88000,0x30b4ae49313aac54
.quad 0xae49b0b4b000b000,0xa86ab18cac54b13a,0xb18c286ab0003000,0xae49b0b4b13aac54,0xa86a318c30003000,0xb0b4ae49b13a2c54,0x30b42e493000b000,0xb18ca86aac54313a
.quad 0x30b4ae49b000b000,0xb18c286a2c54313a,0xa86ab18cb0003000,0xb0b42e49313a2c54,0xb18ca86a30003000,0xae4930b4313aac54,0xae4930b43000b000,0xa86a318c2c54b13a
.quad 0x2e4930b4b000b000,0x286a318cac54b13a,0x318ca86ab0003000,0x2e4930b4b13aac54,0x286ab18c30003000,0x30b42e49b13a2c54,0xb0b4ae493000b000,0x318c286aac54313a
.quad 0xb0b42e49b000b000,0x318ca86a2c54313a,0x286a318cb0003000,0x30b4ae49313a2c54,0x318c286a30003000,0x2e49b0b4313aac54,0x2e49b0b43000b000,0x286ab18c2c54b13a
.quad 0x318c286a31a80000,0x30b42e49313a2c54,0x30b42e4931a80000,0xa86a318c2c54313a,0x2e4930b431a80000,0xb18c286aac54313a,0x286a318c31a80000,0xae49b0b4b13a2c54
.quad 0xa86a318c31a80000,0x2e49b0b4b13aac54,0xae4930b431a80000,0x318c286aac54b13a,0xb0b42e4931a80000,0x286a318c2c54b13a,0xb18c286a31a80000,0xb0b42e49313aac54
.quad 0xb18ca86a31a80000,0xb0b4ae49313a2c54,0xb0b4ae4931a80000,0x286ab18c2c54313a,0xae49b0b431a80000,0x318ca86aac54313a,0xa86ab18c31a80000,0x2e4930b4b13a2c54
.quad 0x286ab18c31a80000,0xae4930b4b13aac54,0x2e49b0b431a80000,0xb18ca86aac54b13a,0x30b4ae4931a80000,0xa86ab18c2c54b13a,0x318ca86a31a80000,0x30b4ae49313aac54
.quad 0x2e4930b430003000,0x286a318c2c54313a,0xb18c286ab0003000,0xae49b0b4b13aac54,0x286ab18cb000b000,0x30b42e49313aac54,0x30b42e493000b000,0xb18ca86aac54313a
.quad 0xb0b42e4930003000,0x318ca86aac54b13a,0xa86ab18cb0003000,0xb0b42e49313a2c54,0x318c286ab000b000,0x2e49b0b4b13a2c54,0xae4930b43000b000,0xa86a318c2c54b13a
.quad 0xae49b0b430003000,0xa86ab18c2c54313a,0x318ca86ab0003000,0x2e4930b4b13aac54,0xa86a318cb000b000,0xb0b4ae49313aac54,0xb0b4ae493000b000,0x318c286aac54313a
.quad 0x30b4ae4930003000,0xb18c286aac54b13a,0x286a318cb0003000,0x30b4ae49313a2c54,0xb18ca86ab000b000,0xae4930b4b13a2c54,0x2e49b0b43000b000,0x286ab18c2c54b13a
.quad 0xa86a318c000031a8,0xae4930b4ac54313a,0x2e49b0b48000b1a8,0x318c286a313aac54,0xb0b42e49000031a8,0xa86ab18cb13aac54,0x318ca86a8000b1a8,0xb0b42e492c54313a
.quad 0xb18ca86a000031a8,0x30b42e492c54b13a,0x30b42e498000b1a8,0x286ab18cb13a2c54,0xae49b0b4000031a8,0xb18c286a313a2c54,0x286a318c8000b1a8,0x2e4930b4ac54b13a
.quad 0x286ab18c000031a8,0x2e49b0b4ac54313a,0xae4930b48000b1a8,0xb18ca86a313aac54,0x30b4ae49000031a8,0x286a318cb13aac54,0xb18c286a8000b1a8,0x30b4ae492c54313a
.quad 0x318c286a000031a8,0xb0b4ae492c54b13a,0xb0b4ae498000b1a8,0xa86a318cb13a2c54,0x2e4930b4000031a8,0x318ca86a313a2c54,0xa86ab18c8000b1a8,0xae49b0b4ac54b13a
.quad 0xb0b42e49b0003000,0xb18c286ab13a2c54,0x286a318c30003000,0xb0b42e49ac54313a,0x318c286a3000b000,0xae4930b42c54313a,0x2e49b0b4b000b000,0xa86a318c313a2c54
.quad 0xae49b0b4b0003000,0x286a318c313aac54,0xb18c286a30003000,0x2e4930b42c54b13a,0xa86a318c3000b000,0x30b42e49ac54b13a,0x30b42e49b000b000,0x318c286ab13aac54
.quad 0x30b4ae49b0003000,0x318ca86ab13a2c54,0xa86ab18c30003000,0x30b4ae49ac54313a,0xb18ca86a3000b000,0x2e49b0b42c54313a,0xae4930b4b000b000,0x286ab18c313a2c54
.quad 0x2e4930b4b0003000,0xa86ab18c313aac54,0x318ca86a30003000,0xae49b0b42c54b13a,0x286ab18c3000b000,0xb0b4ae49ac54b13a,0xb0b4ae49b000b000,0xb18ca86ab13aac54
.quad 0x31a8000031a8,0x31a8000031a8,0x2c54313a000031a8,0x313a2c5430003000,0x30003000000031a8,0x3000b00031a80000,0x313a2c54000031a8,0xac54b13a3000b000
.quad 0x31a80000000031a8,0xb1a880000000b1a8,0x313aac54000031a8,0xac54313ab000b000,0x3000b000000031a8,0x30003000b1a88000,0x2c54b13a000031a8,0x313aac54b0003000
.quad 0xb1a8000031a8,0xb1a8000031a8,0xac54b13a000031a8,0xb13aac5430003000,0xb000b000000031a8,0xb000300031a80000,0xb13aac54000031a8,0x2c54313a3000b000
.quad 0xb1a88000000031a8,0x31a800000000b1a8,0xb13a2c54000031a8,0x2c54b13ab000b000,0xb0003000000031a8,0xb000b000b1a88000,0xac54313a000031a8,0xb13a2c54b0003000
.quad 0x31a8000031a8,0x31a8000031a8,0x313aac5431a80000,0x2c54b13a3000b000,0xb000b0000000b1a8,0xb0003000b1a88000,0xac54313ab1a88000,0x313aac5430003000
.quad 0x31a80000000031a8,0xb1a880000000b1a8,0xac54b13a31a80000,0x313a2c54b0003000,0xb00030000000b1a8,0xb000b00031a80000,0x313a2c54b1a88000,0x2c54313ab000b000
.quad 0xb1a8000031a8,0xb1a8000031a8,0xb13a2c5431a80000,0xac54313a3000b000,0x300030000000b1a8,0x3000b000b1a88000,0x2c54b13ab1a88000,0xb13a2c5430003000
.quad 0xb1a88000000031a8,0x31a800000000b1a8,0x2c54313a31a80000,0xb13aac54b0003000,0x3000b0000000b1a8,0x3000300031a80000,0xb13aac54b1a88000,0xac54b13ab000b000
.quad 0x31a8000031a8,0x31a8000031a8,0xac54b13a0000b1a8,0xb13aac54b000b000,0x30003000000031a8,0x3000b00031a80000,0xb13aac540000b1a8,0x2c54313ab0003000
.quad 0x31a80000000031a8,0xb1a880000000b1a8,0xb13a2c540000b1a8,0x2c54b13a30003000,0x3000b000000031a8,0x30003000b1a88000,0xac54313a0000b1a8,0xb13a2c543000b000
.quad 0xb1a8000031a8,0xb1a8000031a8,0x2c54313a0000b1a8,0x313a2c54b000b000,0xb000b000000031a8,0xb000300031a80000,0x313a2c540000b1a8,0xac54b13ab0003000
.quad 0xb1a88000000031a8,0x31a800000000b1a8,0x313aac540000b1a8,0xac54313a30003000,0xb0003000000031a8,0xb000b000b1a88000,0x2c54b13a0000b1a8,0x313aac543000b000
.quad 0x31a8000031a8,0x31a8000031a8,0xb13a2c54b1a88000,0xac54313ab0003000,0xb000b0000000b1a8,0xb0003000b1a88000,0x2c54b13a31a80000,0xb13a2c54b000b000
.quad 0x31a80000000031a8,0xb1a880000000b1a8,0x2c54313ab1a88000,0xb13aac543000b000,0xb00030000000b1a8,0xb000b00031a80000,0xb13aac5431a80000,0xac54b13a30003000
.quad 0xb1a8000031a8,0xb1a8000031a8,0x313aac54b1a88000,0x2c54b13ab0003000,0x300030000000b1a8,0x3000b000b1a88000,0xac54313a31a80000,0x313aac54b000b000
.quad 0xb1a88000000031a8,0x31a800000000b1a8,0xac54b13ab1a88000,0x313a2c543000b000,0x3000b0000000b1a8,0x3000300031a80000,0x313a2c5431a80000,0x2c54313a30003000
.quad 0xb1a80000b1a80000,0xb1a80000b1a80000,0xb13a2c54b1a80000,0xac54313ab0003000,0xb0003000b1a80000,0x30003000800031a8,0xac54313ab1a80000,0x313aac5430003000
.quad 0x800031a8b1a80000,0xb1a831a80000,0x2c54313ab1a80000,0xb13aac543000b000,0x30003000b1a80000,0xb00030000000b1a8,0x313a2c54b1a80000,0x2c54313ab000b000
.quad 0x31a80000b1a80000,0x31a80000b1a80000,0x313aac54b1a80000,0x2c54b13ab0003000,0x3000b000b1a80000,0xb000b000800031a8,0x2c54b13ab1a80000,0xb13a2c5430003000
.quad 0xb1a8b1a80000,0x800031a831a80000,0xac54b13ab1a80000,0x313a2c543000b000,0xb000b000b1a80000,0x3000b0000000b1a8,0xb13aac54b1a80000,0xac54b13ab000b000
.quad 0xb1a80000b1a80000,0xb1a80000b1a80000,0x2c54313a800031a8,0x313a2c5430003000,0x3000b00031a80000,0xb000b0000000b1a8,0xb13aac540000b1a8,0x2c54313ab0003000
.quad 0x800031a8b1a80000,0xb1a831a80000,0x313aac54800031a8,0xac54313ab000b000,0xb000b00031a80000,0x3000b000800031a8,0xac54313a0000b1a8,0xb13a2c543000b000
.quad 0x31a80000b1a80000,0x31a80000b1a80000,0xac54b13a800031a8,0xb13aac5430003000,0xb000300031a80000,0x300030000000b1a8,0x313a2c540000b1a8,0xac54b13ab0003000
.quad 0xb1a8b1a80000,0x800031a831a80000,0xb13a2c54800031a8,0x2c54b13ab000b000,0x3000300031a80000,0xb0003000800031a8,0x2c54b13a0000b1a8,0x313aac543000b000
.quad 0xb1a80000b1a80000,0xb1a80000b1a80000,0x313aac5431a80000,0x2c54b13a3000b000,0xb0003000b1a80000,0x30003000800031a8,0x2c54b13a31a80000,0xb13a2c54b000b000
.quad 0x800031a8b1a80000,0xb1a831a80000,0xac54b13a31a80000,0x313a2c54b0003000,0x30003000b1a80000,0xb00030000000b1a8,0xb13aac5431a80000,0xac54b13a30003000
.quad 0x31a80000b1a80000,0x31a80000b1a80000,0xb13a2c5431a80000,0xac54313a3000b000,0x3000b000b1a80000,0xb000b000800031a8,0xac54313a31a80000,0x313aac54b000b000
.quad 0xb1a8b1a80000,0x800031a831a80000,0x2c54313a31a80000,0xb13aac54b0003000,0xb000b000b1a80000,0x3000b0000000b1a8,0x313a2c5431a80000,0x2c54313a30003000
.quad 0xb1a80000b1a80000,0xb1a80000b1a80000,0xac54b13a0000b1a8,0xb13aac54b000b000,0x3000b00031a80000,0xb000b0000000b1a8,0x313a2c54800031a8,0xac54b13a3000b000
.quad 0x800031a8b1a80000,0xb1a831a80000,0xb13a2c540000b1a8,0x2c54b13a30003000,0xb000b00031a80000,0x3000b000800031a8,0x2c54b13a800031a8,0x313aac54b0003000
.quad 0x31a80000b1a80000,0x31a80000b1a80000,0x2c54313a0000b1a8,0x313a2c54b000b000,0xb000300031a80000,0x300030000000b1a8,0xb13aac54800031a8,0x2c54313a3000b000
.quad 0xb1a8b1a80000,0x800031a831a80000,0x313aac540000b1a8,0xac54313a30003000,0x3000300031a80000,0xb0003000800031a8,0xac54313a800031a8,0xb13a2c54b0003000
.quad 0xa86ab18c0000b1a8,0xae49b0b4ac54b13a,0xae49b0b40000b1a8,0xb18c286ab13aac54,0xb0b4ae490000b1a8,0xa86a318cb13a2c54,0xb18ca86a0000b1a8,0x30b42e49ac54313a
.quad 0xb18c286a0000b1a8,0x30b4ae492c54313a,0xb0b42e490000b1a8,0xa86ab18c313a2c54,0xae4930b40000b1a8,0xb18ca86a313aac54,0xa86a318c0000b1a8,0xae4930b42c54b13a
.quad 0x286a318c0000b1a8,0x2e4930b4ac54b13a,0x2e4930b40000b1a8,0x318ca86ab13aac54,0x30b42e490000b1a8,0x286ab18cb13a2c54,0x318c286a0000b1a8,0xb0b4ae49ac54313a
.quad 0x318ca86a0000b1a8,0xb0b42e492c54313a,0x30b4ae490000b1a8,0x286a318c313a2c54,0x2e49b0b40000b1a8,0x318c286a313aac54,0x286ab18c0000b1a8,0x2e49b0b42c54b13a
.quad 0xb0b4ae49b000b000,0xb18ca86ab13aac54,0xa86a318cb0003000,0x30b42e492c54313a,0x318ca86a30003000,0xae49b0b42c54b13a,0xae49b0b43000b000,0x286a318cb13a2c54
.quad 0xae4930b4b000b000,0x286ab18c313a2c54,0x318c286ab0003000,0xae4930b4ac54b13a,0xa86ab18c30003000,0x30b4ae49ac54313a,0xb0b42e493000b000,0xb18c286a313aac54
.quad 0x30b42e49b000b000,0x318c286ab13aac54,0x286ab18cb0003000,0xb0b4ae492c54313a,0xb18c286a30003000,0x2e4930b42c54b13a,0x2e4930b43000b000,0xa86ab18cb13a2c54
.quad 0x2e49b0b4b000b000,0xa86a318c313a2c54,0xb18ca86ab0003000,0x2e49b0b4ac54b13a,0x286a318c30003000,0xb0b42e49ac54313a,0x30b4ae493000b000,0x318ca86a313aac54
.quad 0xb18c286ab1a88000,0xb0b42e49b13a2c54,0x30b4ae4931a80000,0xa86ab18c2c54b13a,0xae4930b4b1a88000,0x318c286a2c54313a,0x286ab18c31a80000,0xae4930b4b13aac54
.quad 0x286a318cb1a88000,0xae49b0b4313aac54,0xae49b0b431a80000,0x318ca86aac54313a,0x30b42e49b1a88000,0xa86a318cac54b13a,0xb18ca86a31a80000,0xb0b4ae49313a2c54
.quad 0x318ca86ab1a88000,0x30b4ae49b13a2c54,0xb0b42e4931a80000,0x286a318c2c54b13a,0x2e49b0b4b1a88000,0xb18ca86a2c54313a,0xa86a318c31a80000,0x2e49b0b4b13aac54
.quad 0xa86ab18cb1a88000,0x2e4930b4313aac54,0x2e4930b431a80000,0xb18c286aac54313a,0xb0b4ae49b1a88000,0x286ab18cac54b13a,0x318c286a31a80000,0x30b42e49313a2c54
.quad 0xae4930b4b0003000,0xa86a318cac54313a,0xb18ca86ab000b000,0xae4930b4b13a2c54,0xa86ab18c3000b000,0xb0b42e49b13aac54,0x30b4ae4930003000,0xb18c286aac54b13a
.quad 0x30b42e49b0003000,0xb18ca86a2c54b13a,0xa86a318cb000b000,0xb0b4ae49313aac54,0xb18c286a3000b000,0xae49b0b4313a2c54,0xae49b0b430003000,0xa86ab18c2c54313a
.quad 0x2e49b0b4b0003000,0x286ab18cac54313a,0x318c286ab000b000,0x2e49b0b4b13a2c54,0x286a318c3000b000,0x30b4ae49b13aac54,0xb0b42e4930003000,0x318ca86aac54b13a
.quad 0xb0b4ae49b0003000,0x318c286a2c54b13a,0x286ab18cb000b000,0x30b42e49313aac54,0x318ca86a3000b000,0x2e4930b4313a2c54,0x2e4930b430003000,0x286a318c2c54313a
.quad 0x318ca86a31a80000,0x30b4ae49313aac54,0x30b4ae4931a80000,0xa86ab18c2c54b13a,0x2e49b0b431a80000,0xb18ca86aac54b13a,0x286ab18c31a80000,0xae4930b4b13aac54
.quad 0xa86ab18c31a80000,0x2e4930b4b13a2c54,0xae49b0b431a80000,0x318ca86aac54313a,0xb0b4ae4931a80000,0x286ab18c2c54313a,0xb18ca86a31a80000,0xb0b4ae49313a2c54
.quad 0xb18c286a31a80000,0xb0b42e49313aac54,0xb0b42e4931a80000,0x286a318c2c54b13a,0xae4930b431a80000,0x318c286aac54b13a,0xa86a318c31a80000,0x2e49b0b4b13aac54
.quad 0x286a318c31a80000,0xae49b0b4b13a2c54,0x2e4930b431a80000,0xb18c286aac54313a,0x30b42e4931a80000,0xa86a318c2c54313a,0x318c286a31a80000,0x30b42e49313a2c54
.quad 0x2e49b0b43000b000,0x286ab18c2c54b13a,0xb18ca86ab000b000,0xae4930b4b13a2c54,0x286a318cb0003000,0x30b4ae49313a2c54,0x30b4ae4930003000,0xb18c286aac54b13a
.quad 0xb0b4ae493000b000,0x318c286aac54313a,0xa86a318cb000b000,0xb0b4ae49313aac54,0x318ca86ab0003000,0x2e4930b4b13aac54,0xae49b0b430003000,0xa86ab18c2c54313a
.quad 0xae4930b43000b000,0xa86a318c2c54b13a,0x318c286ab000b000,0x2e49b0b4b13a2c54,0xa86ab18cb0003000,0xb0b42e49313a2c54,0xb0b42e4930003000,0x318ca86aac54b13a
.quad 0x30b42e493000b000,0xb18ca86aac54313a,0x286ab18cb000b000,0x30b42e49313aac54,0xb18c286ab0003000,0xae49b0b4b13aac54,0x2e4930b430003000,0x286a318c2c54313a
.quad 0xa86ab18c0000b1a8,0xae49b0b4ac54b13a,0x2e4930b4800031a8,0x318ca86a313a2c54,0xb0b4ae490000b1a8,0xa86a318cb13a2c54,0x318c286a800031a8,0xb0b4ae492c54b13a
.quad 0xb18c286a0000b1a8,0x30b4ae492c54313a,0x30b4ae49800031a8,0x286a318cb13aac54,0xae4930b40000b1a8,0xb18ca86a313aac54,0x286ab18c800031a8,0x2e49b0b4ac54313a
.quad 0x286a318c0000b1a8,0x2e4930b4ac54b13a,0xae49b0b4800031a8,0xb18c286a313a2c54,0x30b42e490000b1a8,0x286ab18cb13a2c54,0xb18ca86a800031a8,0x30b42e492c54b13a
.quad 0x318ca86a0000b1a8,0xb0b42e492c54313a,0xb0b42e49800031a8,0xa86ab18cb13aac54,0x2e49b0b40000b1a8,0x318c286a313aac54,0xa86a318c800031a8,0xae4930b4ac54313a
.quad 0xb0b4ae49b000b000,0xb18ca86ab13aac54,0x286ab18c3000b000,0xb0b4ae49ac54b13a,0x318ca86a30003000,0xae49b0b42c54b13a,0x2e4930b4b0003000,0xa86ab18c313aac54
.quad 0xae4930b4b000b000,0x286ab18c313a2c54,0xb18ca86a3000b000,0x2e49b0b42c54313a,0xa86ab18c30003000,0x30b4ae49ac54313a,0x30b4ae49b0003000,0x318ca86ab13a2c54
.quad 0x30b42e49b000b000,0x318c286ab13aac54,0xa86a318c3000b000,0x30b42e49ac54b13a,0xb18c286a30003000,0x2e4930b42c54b13a,0xae49b0b4b0003000,0x286a318c313aac54
.quad 0x2e49b0b4b000b000,0xa86a318c313a2c54,0x318c286a3000b000,0xae4930b42c54313a,0x286a318c30003000,0xb0b42e49ac54313a,0xb0b42e49b0003000,0xb18c286ab13a2c54
.quad 0x3f800000,0x40000000,0x3f800000,0x3d20d6d63ffff35e,0x3f800000,0x3da0cee73fffcd79,0x3f800000,0x3df122833fff8e56
.quad 0x3f800000,0x3e20af2a3fff35f9,0x3f800000,0x3e48bd363ffec46d,0x3f800000,0x3e70b7723ffe39bc,0x3f800000,0x3e8c4cf73ffd95f4
.quad 0x3f800000,0x3ea0305b3ffcd925,0x3f800000,0x3eb403f13ffc0361,0x3f800000,0x3ec7c5c23ffb14be,0x3f800000,0x3edb73dc3ffa0d54
.quad 0x3f800000,0x3eef0c4d3ff8ed3c,0x3f800000,0x3f0146933ff7b493,0x3f800000,0x3f0afa3e3ff66377,0x3f800000,0x3f14a0313ff4fa0b
.quad 0x40000000,0x40000000,0x3e20af2a3fff35f9,0x3e48bd363ffec46d,0x3ea0305b3ffcd925,0x3ec7c5c23ffb14be,0x3eef0c4d3ff8ed3c,0x3f14a0313ff4fa0b
.quad 0x3f1e377a3ff37871,0x3f43ef153fec835e,0x3f43ef153fec835e,0x3f715aea3fe1c598,0x3f6871713fe41901,0x3f8e39da3fd4db31,0x3f85c2773fda46a0,0x3fa267993fc5e403
.quad 0x3f9679183fcf1bbd,0x3fb504f33fb504f3,0x3fa6423a3fc2a9f7,0x3fc5e4033fa26799,0x3fb504f33fb504f3,0x3fd4db313f8e39da,0x3fc2a9f73fa6423a,0x3fe1c5983f715aea
.quad 0x3fcf1bbd3f967918,0x3fec835e3f43ef15,0x3fda46a03f85c277,0x3ff4fa0b3f14a031,0x3fe419013f687171,0x3ffb14be3ec7c5c2,0x3fec835e3f43ef15,0x3ffec46d3e48bd36
.quad 0x40000000,0x40000000,0x3ea0305b3ffcd925,0x3eb403f13ffc0361,0x3f1e377a3ff37871,0x3f3136413ff02d4f,0x3f6871713fe41901,0x3f8172c33fdcdc29
.quad 0x3f9679183fcf1bbd,0x3fa6423a3fc2a9f7,0x3fb504f33fb504f3,0x3fc5e4033fa26799,0x3fcf1bbd3f967918,0x3fdf5be63f7a2c90,0x3fe419013f687171,0x3ff1decf3f27bf25
.quad 0x3ff378713f1e377a,0x3ffcd9253ea0305b,0x3ffcd9253ea0305b,0x3ffff35ebd20d6d6,0x40000000250d3132,0x3ffb14bebec7c5c2,0x3ffcd925bea0305b,0x3fee641abf3a9be1
.quad 0x3ff37871bf1e377a,0x3fda46a0bf85c277,0x3fe41901bf687171,0x3fbf5cb5bfaa0c73,0x3fcf1bbdbf967918,0x3f9e7cf1bfc90a88,0x3fb504f3bfb504f3,0x3f715aeabfe1c598
.quad 0x0,0x0,0x0,0x0,0x0,0x0,0x0,0x0
.quad 0x0,0x0,0x0,0x0,0x0,0x0,0x80000000,0x80000000
.quad 0x80000000,0x80000000,0x80000000,0x80000000,0x80000000,0x80000000,0x80000000,0x80000000
.quad 0x80000000,0x80000000,0x80000000,0x8000000080000000,0x8000000080000000,0x8000000080000000,0x8000000080000000,0x8000000080000000
.quad 0x40000000,0x40000000,0x3da0cee73fffcd79,0x3df122833fff8e56,0x3e20af2a3fff35f9,0x3e70b7723ffe39bc,0x3e70b7723ffe39bc,0x3eb403f13ffc0361
.quad 0x3ea0305b3ffcd925,0x3eef0c4d3ff8ed3c,0x3ec7c5c23ffb14be,0x3f14a0313ff4fa0b,0x3eef0c4d3ff8ed3c,0x3f3136413ff02d4f,0x3f0afa3e3ff66377,0x3f4d2ef33fea8b4b
.quad 0x3f1e377a3ff37871,0x3f6871713fe41901,0x3f3136413ff02d4f,0x3f8172c33fdcdc29,0x3f43ef153fec835e,0x3f8e39da3fd4db31,0x3f565a923fe87c12,0x3f9a82a43fcc1d35
.quad 0x3f6871713fe41901,0x3fa6423a3fc2a9f7,0x3f7a2c903fdf5be6,0x3fb16e2c3fb889dc,0x3f85c2773fda46a0,0x3fbbfc8f3fadc5e3,0x3f8e39da3fd4db31,0x3fc5e4033fa26799
.quad 0x40000000,0x40000000,0x3e70b7723ffe39bc,0x3e8c4cf73ffd95f4,0x3eef0c4d3ff8ed3c,0x3f0afa3e3ff66377,0x3f3136413ff02d4f,0x3f4d2ef33fea8b4b
.quad 0x3f6871713fe41901,0x3f85c2773fda46a0,0x3f8e39da3fd4db31,0x3fa267993fc5e403,0x3fa6423a3fc2a9f7,0x3fbbfc8f3fadc5e3,0x3fbbfc8f3fadc5e3,0x3fd205d43f9260b2
.quad 0x3fcf1bbd3f967918,0x3fe419013f687171,0x3fdf5be63f7a2c90,0x3ff1decf3f27bf25,0x3fec835e3f43ef15,0x3ffb14be3ec7c5c2,0x3ff663773f0afa3e,0x3fff8e563df12283
.quad 0x3ffcd9253ea0305b,0x3fff35f9be20af2a,0x3fffcd793da0cee7,0x3ffa0d54bedb73dc,0x3fff35f9be20af2a,0x3ff02d4fbf313641,0x3ffb14bebec7c5c2,0x3fe1c598bf715aea
.quad 0x3f800000,0x0,0x3e47c5c23f7b14be,0x0,0x3ec3ef153f6c835e,0x0,0x3f0e39da3f54db31,0x0
.quad 0x3f3504f33f3504f3,0x0,0x3f54db313f0e39da,0x0,0x3f6c835e3ec3ef15,0x0,0x3f7b14be3e47c5c2,0x0
.quad 0x3f800000248d3132,0x80000000,0x3f7b14bebe47c5c2,0x80000000,0x3f6c835ebec3ef15,0x80000000,0x3f54db31bf0e39da,0x80000000
.quad 0x3f3504f3bf3504f3,0x80000000,0x3f0e39dabf54db31,0x80000000,0x3ec3ef15bf6c835e,0x80000000,0x3e47c5c2bf7b14be,0x8000000080000000
.quad 0x0,0x0,0x0,0x0,0x0,0x0,0x0,0x0
.quad 0x0,0x0,0x0,0x0,0x80000000,0x80000000,0x80000000,0x80000000
.quad 0x80000000,0x80000000,0x80000000,0x80000000,0x80000000,0x80000000,0x80000000,0x8000000080000000
.quad 0x8000000080000000,0x8000000080000000,0x8000000080000000,0x8000000080000000,0x8000000080000000,0x8000000080000000,0x8000000080000000,0x8000000080000000
.quad 0x3f800000,0x3ca0d8d23ffffcd7,0x3f800000,0x3d713d4c3fffe394,0x3f800000,0x3dc8fb303fffb10f,0x3f800000,0x3e0ca1f23fff654e
.quad 0x3f800000,0x3e34b86a3fff0059,0x3f800000,0x3e5cbd0d3ffe8238,0x3f800000,0x3e8255f43ffdeafa,0x3f800000,0x3e9640833ffd3aac
.quad 0x3f800000,0x3eaa1c3f3ffc7160,0x3f800000,0x3ebde7313ffb8f2a,0x3f800000,0x3ed19f653ffa9421,0x3f800000,0x3ee542e93ff9805c
.quad 0x3f800000,0x3ef8cfcc3ff853f8,0x3f800000,0x3f0622103ff70f11,0x3f800000,0x3f0fcefe3ff5b1c9,0x3f800000,0x3f196dba3ff43c41
.quad 0x3da0cee73fffcd79,0x3dc8fb303fffb10f,0x3e70b7723ffe39bc,0x3e9640833ffd3aac,0x3ec7c5c23ffb14be,0x3ef8cfcc3ff853f8,0x3f0afa3e3ff66377,0x3f2c7cd43ff10908
.quad 0x3f3136413ff02d4f,0x3f5ae8803fe76bd8,0x3f565a923fe87c12,0x3f839c3d3fdb941a,0x3f7a2c903fdf5be6,0x3f987fc03fcd9f02,0x3f8e39da3fd4db31,0x3fabeb4a3fbdaef9
.quad 0x3f9e7cf13fc90a88,0x3fbdaef93fabeb4a,0x3fadc5e33fbbfc8f,0x3fcd9f023f987fc0,0x3fbbfc8f3fadc5e3,0x3fdb941a3f839c3d,0x3fc90a883f9e7cf1,0x3fe76bd83f5ae880
.quad 0x3fd4db313f8e39da,0x3ff109083f2c7cd4,0x3fdf5be63f7a2c90,0x3ff853f83ef8cfcc,0x3fe87c123f565a92,0x3ffd3aac3e964083,0x3ff02d4f3f313641,0x3fffb10f3dc8fb30
.quad 0x3e20af2a3fff35f9,0x3e34b86a3fff0059,0x3eef0c4d3ff8ed3c,0x3f0622103ff70f11,0x3f43ef153fec835e,0x3f5ae8803fe76bd8,0x3f85c2773fda46a0,0x3f946eba3fd0935b
.quad 0x3fa6423a3fc2a9f7,0x3fb6c9a93fb33bc6,0x3fc2a9f73fa6423a,0x3fd3731f3f904f0e,0x3fda46a03f85c277,0x3fe986903f51c759,0x3fec835e3f43ef15,0x3ff853f83ef8cfcc
.quad 0x3ff8ed3c3eef0c4d,0x3fff654e3e0ca1f2,0x3fff35f93e20af2a,0x3ffe8238be5cbd0d,0x3fff35f9be20af2a,0x3ff5b1c9bf0fcefe,0x3ff8ed3cbeef0c4d,0x3fe53a48bf63f40d
.quad 0x3fec835ebf43ef15,0x3fcd9f02bf987fc0,0x3fda46a0bf85c277,0x3faf9c32bfba4582,0x3fc2a9f7bfa6423a,0x3f8c2124bfd63e03,0x3fa6423abfc2a9f7,0x3f48917ebfeb8a3d
.quad 0x0,0x0,0x0,0x0,0x0,0x0,0x0,0x0
.quad 0x0,0x0,0x0,0x0,0x0,0x80000000,0x80000000,0x80000000
.quad 0x80000000,0x80000000,0x80000000,0x80000000,0x80000000,0x80000000,0x80000000,0x80000000
.quad 0x80000000,0x8000000080000000,0x8000000080000000,0x8000000080000000,0x8000000080000000,0x8000000080000000,0x8000000080000000,0x8000000080000000
.quad 0x3d20d6d63ffff35e,0x3d713d4c3fffe394,0x3df122833fff8e56,0x3e34b86a3fff0059,0x3e48bd363ffec46d,0x3e9640833ffd3aac,0x3e8c4cf73ffd95f4,0x3ed19f653ffa9421
.quad 0x3eb403f13ffc0361,0x3f0622103ff70f11,0x3edb73dc3ffa0d54,0x3f22fd523ff2ae9e,0x3f0146933ff7b493,0x3f3f47d73fed76aa,0x3f14a0313ff4fa0b,0x3f5ae8803fe76bd8
.quad 0x3f27bf253ff1decf,0x3f75c6c53fe09384,0x3f3a9be13fee641a,0x3f87e5653fd8f3c4,0x3f4d2ef33fea8b4b,0x3f946eba3fd0935b,0x3f5f71083fe655e7,0x3fa074403fc779bc
.quad 0x3f715aea3fe1c598,0x3fabeb4a3fbdaef9,0x3f8172c33fdcdc29,0x3fb6c9a93fb33bc6,0x3f8a04f83fd79b8c,0x3fc105b83fa8296a,0x3f9260b23fd205d4,0x3fca965e3f9c81b9
.quad 0x3df122833fff8e56,0x3e0ca1f23fff654e,0x3eb403f13ffc0361,0x3ed19f653ffa9421,0x3f14a0313ff4fa0b,0x3f2c7cd43ff10908,0x3f4d2ef33fea8b4b,0x3f6ce91a3fe2f219
.quad 0x3f8172c33fdcdc29,0x3f946eba3fd0935b,0x3f9a82a43fcc1d35,0x3faf9c323fba4582,0x3fb16e2c3fb889dc,0x3fc779bc3fa07440,0x3fc5e4033fa26799,0x3fdb941a3f839c3d
.quad 0x3fd79b8c3f8a04f8,0x3feb8a3d3f48917e,0x3fe655e73f5f7108,0x3ff70f113f062210,0x3ff1decf3f27bf25,0x3ffdeafa3e8255f4,0x3ffa0d543edb73dc,0x3ffffcd7bca0d8d2
.quad 0x3ffec46d3e48bd36,0x3ffd3aacbe964083,0x3ffff35ebd20d6d6,0x3ff5b1c9bf0fcefe,0x3ffd95f4be8c4cf7,0x3fe98690bf51c759,0x3ff7b493bf014693,0x3fd8f3c4bf87e565
.quad 0x3dc8bd363f7ec46d,0x0,0x3e94a0313f74fa0b,0x0,0x3ef15aea3f61c598,0x0,0x3f2267993f45e403,0x0
.quad 0x3f45e4033f226799,0x0,0x3f61c5983ef15aea,0x0,0x3f74fa0b3e94a031,0x0,0x3f7ec46d3dc8bd36,0x80000000
.quad 0x3f7ec46dbdc8bd36,0x80000000,0x3f74fa0bbe94a031,0x80000000,0x3f61c598bef15aea,0x80000000,0x3f45e403bf226799,0x80000000
.quad 0x3f226799bf45e403,0x80000000,0x3ef15aeabf61c598,0x80000000,0x3e94a031bf74fa0b,0x80000000,0x3dc8bd36bf7ec46d,0x8000000080000000
.quad 0x0,0x0,0x0,0x0,0x0,0x0,0x0,0x0
.quad 0x0,0x0,0x0,0x80000000,0x80000000,0x80000000,0x80000000,0x80000000
.quad 0x80000000,0x80000000,0x80000000,0x80000000,0x80000000,0x80000000,0x8000000080000000,0x8000000080000000
.quad 0x8000000080000000,0x8000000080000000,0x8000000080000000,0x8000000080000000,0x8000000080000000,0x8000000080000000,0x8000000080000000,0x8000000080000000
.quad 0x8000332880003328,0x8000332880003328,0xac6c32ce80003328,0xb1ca3035b03531ca,0xb03531ca80003328,0xb2ceac6cb2ce2c6c,0xb1ca303580003328,0xac6cb2ceb2ceac6c
.quad 0xb328000080003328,0x332880008000b328,0xb2ceac6c80003328,0x303531ca3035b1ca,0xb1cab03580003328,0xac6c32ce32ceac6c,0xb035b1ca80003328,0xb2ce2c6c32ce2c6c
.quad 0x8000b32880003328,0x8000b32880003328,0x2c6cb2ce80003328,0x31cab035b03531ca,0x3035b1ca80003328,0x32ce2c6cb2ce2c6c,0x31cab03580003328,0x2c6c32ceb2ceac6c
.quad 0x3328800080003328,0xb32800008000b328,0x32ce2c6c80003328,0xb035b1ca3035b1ca,0x31ca303580003328,0x2c6cb2ce32ceac6c,0x303531ca80003328,0x32ceac6c32ce2c6c
.quad 0x8000332880003328,0x8000332880003328,0xb3280000b2ce2c6c,0xb1cab035b2ceac6c,0x8000b328b035b1ca,0x32ceac6c3035b1ca,0x332880003035b1ca,0xac6c32ce303531ca
.quad 0xb328000080003328,0x332880008000b328,0x8000b328b2ce2c6c,0xb03531ca32ce2c6c,0x33288000b035b1ca,0xac6cb2ceb03531ca,0x800033283035b1ca,0x32ce2c6cb035b1ca
.quad 0x8000b32880003328,0x8000b32880003328,0x33288000b2ce2c6c,0x31ca3035b2ceac6c,0x80003328b035b1ca,0xb2ce2c6c3035b1ca,0xb32800003035b1ca,0x2c6cb2ce303531ca
.quad 0x3328800080003328,0xb32800008000b328,0x80003328b2ce2c6c,0x3035b1ca32ce2c6c,0xb3280000b035b1ca,0x2c6c32ceb03531ca,0x8000b3283035b1ca,0xb2ceac6cb035b1ca
.quad 0x8000332880003328,0x80003328,0xac6cb2ceb035b1ca,0x8000b328,0x303531ca32ce2c6c,0x80003328,0xb1cab035b2ce2c6c,0x8000b328
.quad 0xb328000080003328,0x8000b328,0x32ceac6cb035b1ca,0x80003328,0xb1ca303532ce2c6c,0x8000b328,0x3035b1cab2ce2c6c,0x80003328
.quad 0x8000b32880003328,0x80003328,0x2c6c32ceb035b1ca,0x8000b328,0xb035b1ca32ce2c6c,0x80003328,0x31ca3035b2ce2c6c,0x8000b328
.quad 0x3328800080003328,0x8000b328,0xb2ce2c6cb035b1ca,0x80003328,0x31cab03532ce2c6c,0x8000b328,0xb03531cab2ce2c6c,0x80003328
.quad 0x0,0x0,0x0,0x0,0x0,0x0,0x0,0x0
.quad 0x0,0x0,0x0,0x0,0x0,0x0,0x0,0x0
.quad 0x0,0x0,0x0,0x0,0x0,0x0,0x0,0x0
.quad 0x0,0x0,0x0,0x0,0x0,0x0,0x0,0x0
.quad 0xb2ce2c6c80003328,0x3035b1cab035b1ca,0x0,0x0,0x0,0x0,0x0,0x0
.quad 0xac6cb2ce80003328,0xb1cab035303531ca,0x0,0x0,0x0,0x0,0x0,0x0
.quad 0x32ceac6c80003328,0xb03531cab035b1ca,0x0,0x0,0x0,0x0,0x0,0x0
.quad 0x2c6c32ce80003328,0x31ca3035303531ca,0x0,0x0,0x0,0x0,0x0,0x0
.quad 0x8000332832ce2c6c,0xb035b1cab2ce2c6c,0x0,0x0,0x0,0x0,0x0,0x0
.quad 0xb328000032ce2c6c,0xb1ca303532ceac6c,0x0,0x0,0x0,0x0,0x0,0x0
.quad 0x8000b32832ce2c6c,0x303531cab2ce2c6c,0x0,0x0,0x0,0x0,0x0,0x0
.quad 0x3328800032ce2c6c,0x31cab03532ceac6c,0x0,0x0,0x0,0x0,0x0,0x0
.quad 0x32ce2c6c3035b1ca,0x80003328,0x0,0x0,0x0,0x0,0x0,0x0
.quad 0xac6c32ce3035b1ca,0x8000b328,0x0,0x0,0x0,0x0,0x0,0x0
.quad 0xb2ceac6c3035b1ca,0x80003328,0x0,0x0,0x0,0x0,0x0,0x0
.quad 0x2c6cb2ce3035b1ca,0x8000b328,0x0,0x0,0x0,0x0,0x0,0x0
.quad 0x0,0x0,0x0,0x0,0x0,0x0,0x0,0x0
.quad 0x0,0x0,0x0,0x0,0x0,0x0,0x0,0x0
.quad 0x0,0x0,0x0,0x0,0x0,0x0,0x0,0x0
.quad 0x0,0x0,0x0,0x0,0x0,0x0,0x0,0x0
.quad 0x861084000200000,0x1622c080,0x861084000200000,0x1622c080,0x861084000200000,0x1622c080,0x861084000200000,0x1622c080
.quad 0xa61484102204001,0x1c438c81,0xa61484102204001,0x1c438c81,0xa61484102204001,0x1c438c81,0xa61484102204001,0x1c438c81
.quad 0x8e1184200a01002,0x16a2d082,0x8e1184200a01002,0x16a2d082,0x8e1184200a01002,0x16a2d082,0x8e1184200a01002,0x16a2d082
.quad 0xae1584302a05003,0x1bc37c83,0xae1584302a05003,0x1bc37c83,0xae1584302a05003,0x1bc37c83,0xae1584302a05003,0x1bc37c83
.quad 0x961284401202004,0x1722e084,0x961284401202004,0x1722e084,0x961284401202004,0x1722e084,0x961284401202004,0x1722e084
.quad 0xb61684503206005,0x1b436c85,0xb61684503206005,0x1b436c85,0xb61684503206005,0x1b436c85,0xb61684503206005,0x1b436c85
.quad 0x9e1384601a03006,0x1cc39c86,0x9e1384601a03006,0x1cc39c86,0x9e1384601a03006,0x1cc39c86,0x9e1384601a03006,0x1cc39c86
.quad 0x2885144703a07007,0x1ac35c87,0x2885144703a07007,0x1ac35c87,0x2885144703a07007,0x1ac35c87,0x2885144703a07007,0x1ac35c87
.quad 0x2805044804208008,0x1a434c88,0x2805044804208008,0x1a434c88,0x2805044804208008,0x1a434c88,0x2805044804208008,0x1a434c88
.quad 0x2604c4492e45cc09,0x12624889,0x2604c4492e45cc09,0x12624889,0x2604c4492e45cc09,0x12624889,0x2604c4492e45cc09,0x12624889
.quad 0x2784f44a04a0900a,0x19c33c8a,0x2784f44a04a0900a,0x19c33c8a,0x2784f44a04a0900a,0x19c33c8a,0x2784f44a04a0900a,0x19c33c8a
.quad 0x2584b44b2dc5bc0b,0x12e2588b,0x2584b44b2dc5bc0b,0x12e2588b,0x2584b44b2dc5bc0b,0x12e2588b,0x2584b44b2dc5bc0b,0x12e2588b
.quad 0x2704e44c0520a00c,0x19432c8c,0x2704e44c0520a00c,0x19432c8c,0x2704e44c0520a00c,0x19432c8c,0x2704e44c0520a00c,0x19432c8c
.quad 0x2504a44d2d45ac0d,0x1362688d,0x2504a44d2d45ac0d,0x1362688d,0x2504a44d2d45ac0d,0x1362688d,0x2504a44d2d45ac0d,0x1362688d
.quad 0x2684d44e2ec5dc0e,0x18c31c8e,0x2684d44e2ec5dc0e,0x18c31c8e,0x2684d44e2ec5dc0e,0x18c31c8e,0x2684d44e2ec5dc0e,0x18c31c8e
.quad 0x2484944f2cc59c0f,0x13e2788f,0x2484944f2cc59c0f,0x13e2788f,0x2484944f2cc59c0f,0x13e2788f,0x2484944f2cc59c0f,0x13e2788f
.quad 0xc2180502c458c10,0x14628890,0xc2180502c458c10,0x14628890,0xc2180502c458c10,0x14628890,0xc2180502c458c10,0x14628890
.quad 0xe21c05100600811,0x1662c891,0xe21c05100600811,0x1662c891,0xe21c05100600811,0x1662c891,0xe21c05100600811,0x1662c891
.quad 0xca190522bc57c12,0x14e29892,0xca190522bc57c12,0x14e29892,0xca190522bc57c12,0x14e29892,0xca190522bc57c12,0x14e29892
.quad 0xea1d05300e01813,0x16e2d893,0xea1d05300e01813,0x16e2d893,0xea1d05300e01813,0x16e2d893,0xea1d05300e01813,0x16e2d893
.quad 0xd21a0542b456c14,0x1562a894,0xd21a0542b456c14,0x1562a894,0xd21a0542b456c14,0x1562a894,0xd21a0542b456c14,0x1562a894
.quad 0xf21e05501602815,0x1762e895,0xf21e05501602815,0x1762e895,0xf21e05501602815,0x1762e895,0xf21e05501602815,0x1762e895
.quad 0xda1b0562ac55c16,0x15e2b896,0xda1b0562ac55c16,0x15e2b896,0xda1b0562ac55c16,0x15e2b896,0xda1b0562ac55c16,0x15e2b896
.quad 0xfa1f05701e03817,0x1c839497,0xfa1f05701e03817,0x1c839497,0xfa1f05701e03817,0x1c839497,0xfa1f05701e03817,0x1c839497
.quad 0x1022005802604818,0x1c038498,0x1022005802604818,0x1c038498,0x1022005802604818,0x1c038498,0x1022005802604818,0x1c038498
.quad 0x22444c5904608819,0x1a034499,0x22444c5904608819,0x1a034499,0x22444c5904608819,0x1a034499,0x22444c5904608819,0x1a034499
.quad 0x10a2105a02e0581a,0x1b83749a,0x10a2105a02e0581a,0x1b83749a,0x10a2105a02e0581a,0x1b83749a,0x10a2105a02e0581a,0x1b83749a
.quad 0x21c43c5b04e0981b,0x1983349b,0x21c43c5b04e0981b,0x1983349b,0x21c43c5b04e0981b,0x1983349b,0x21c43c5b04e0981b,0x1983349b
.quad 0x1122205c0360681c,0x1b03649c,0x1122205c0360681c,0x1b03649c,0x1122205c0360681c,0x1b03649c,0x1122205c0360681c,0x1b03649c
.quad 0x21442c5d0560a81d,0x1903249d,0x21442c5d0560a81d,0x1903249d,0x21442c5d0560a81d,0x1903249d,0x21442c5d0560a81d,0x1903249d
.quad 0x22c45c5e03e0781e,0x1a83549e,0x22c45c5e03e0781e,0x1a83549e,0x22c45c5e03e0781e,0x1a83549e,0x22c45c5e03e0781e,0x1a83549e
.quad 0x20c41c5f2e85d41f,0x1883149f,0x20c41c5f2e85d41f,0x1883149f,0x20c41c5f2e85d41f,0x1883149f,0x20c41c5f2e85d41f,0x1883149f
.quad 0x20440c602e05c420,0x300300a0,0x20440c602e05c420,0x300300a0,0x20440c602e05c420,0x300300a0,0x20440c602e05c420,0x300300a0
.quad 0xc6188612c058421,0x2a254811,0xc6188612c058421,0x2a254811,0xc6188612c058421,0x2a254811,0xc6188612c058421,0x2a254811
.quad 0x1fc3fc622d85b422,0x2a660000,0x1fc3fc622d85b422,0x2a660000,0x1fc3fc622d85b422,0x2a660000,0x1fc3fc622d85b422,0x2a660000
.quad 0xce198632b857423,0x2f05e41d,0xce198632b857423,0x2f05e41d,0xce198632b857423,0x2f05e41d,0xce198632b857423,0x2f05e41d
.quad 0x1f43ec642d05a424,0x2f45ec0c,0x1f43ec642d05a424,0x2f45ec0c,0x1f43ec642d05a424,0x2f45ec0c,0x1f43ec642d05a424,0x2f45ec0c
.quad 0xd61a8652b056425,0x24248839,0xd61a8652b056425,0x24248839,0xd61a8652b056425,0x24248839,0xd61a8652b056425,0x24248839
.quad 0x1ec3dc662c859426,0x24654028,0x1ec3dc662c859426,0x24654028,0x1ec3dc662c859426,0x24654028,0x1ec3dc662c859426,0x24654028
.quad 0xde1b8672a855427,0x29052445,0xde1b8672a855427,0x29052445,0xde1b8672a855427,0x29052445,0xde1b8672a855427,0x29052445
.quad 0xe61c8680620c028,0x29452c34,0xe61c8680620c028,0x29452c34,0xe61c8680620c028,0x29452c34,0xe61c8680620c028,0x29452c34
.quad 0x1062086908210029,0x1e23c861,0x1062086908210029,0x1e23c861,0x1062086908210029,0x1e23c861,0x1062086908210029,0x1e23c861
.quad 0xee1d86a06a0d02a,0x1e648050,0xee1d86a06a0d02a,0x1e648050,0xee1d86a06a0d02a,0x1e648050,0xee1d86a06a0d02a,0x1e648050
.quad 0x10e2186b08a1102b,0x2304646d,0x10e2186b08a1102b,0x2304646d,0x10e2186b08a1102b,0x2304646d,0x10e2186b08a1102b,0x2304646d
.quad 0xf61e86c0720e02c,0x23446c5c,0xf61e86c0720e02c,0x23446c5c,0xf61e86c0720e02c,0x23446c5c,0xf61e86c0720e02c,0x23446c5c
.quad 0x1162286d0921202d,0x18230889,0x1162286d0921202d,0x18230889,0x1162286d0921202d,0x18230889,0x1162286d0921202d,0x18230889
.quad 0xfe1f86e07a0f02e,0x1863c078,0xfe1f86e07a0f02e,0x1863c078,0xfe1f86e07a0f02e,0x1863c078,0xfe1f86e07a0f02e,0x1863c078
.quad 0x2284546f09a1302f,0x1d03a495,0x2284546f09a1302f,0x1d03a495,0x2284546f09a1302f,0x1d03a495,0x2284546f09a1302f,0x1d03a495
.quad 0x220444700a214030,0x1d43ac84,0x220444700a214030,0x1d43ac84,0x220444700a214030,0x1d43ac84,0x220444700a214030,0x1d43ac84
.quad 0x2004047128450c31,0x30060095,0x2004047128450c31,0x30060095,0x2004047128450c31,0x30060095,0x2004047128450c31,0x30060095
.quad 0x218434720aa15032,0x30060084,0x218434720aa15032,0x30060084,0x218434720aa15032,0x30060084,0x218434720aa15032,0x30060084
.quad 0x1f83f47327c4fc33,0x30060095,0x1f83f47327c4fc33,0x30060095,0x1f83f47327c4fc33,0x30060095,0x1f83f47327c4fc33,0x30060095
.quad 0x210424740b216034,0x30060084,0x210424740b216034,0x30060084,0x210424740b216034,0x30060084,0x210424740b216034,0x30060084
.quad 0x1f03e4752744ec35,0x30060095,0x1f03e4752744ec35,0x30060095,0x1f03e4752744ec35,0x30060095,0x1f03e4752744ec35,0x30060095
.quad 0x2084147628c51c36,0x30060084,0x2084147628c51c36,0x30060084,0x2084147628c51c36,0x30060084,0x2084147628c51c36,0x30060084
.quad 0x1e83d47726c4dc37,0x30060095,0x1e83d47726c4dc37,0x30060095,0x1e83d47726c4dc37,0x30060095,0x1e83d47726c4dc37,0x30060095
.quad 0x122240782644cc38,0x30060084,0x122240782644cc38,0x30060084,0x122240782644cc38,0x30060084,0x122240782644cc38,0x30060084
.quad 0x142280790660c839,0x30060095,0x142280790660c839,0x30060095,0x142280790660c839,0x30060095,0x142280790660c839,0x30060095
.quad 0x12a2507a25c4bc3a,0x30060084,0x12a2507a25c4bc3a,0x30060084,0x12a2507a25c4bc3a,0x30060084,0x12a2507a25c4bc3a,0x30060084
.quad 0x14a2907b06e0d83b,0x30060095,0x14a2907b06e0d83b,0x30060095,0x14a2907b06e0d83b,0x30060095,0x14a2907b06e0d83b,0x30060095
.quad 0x1322607c2544ac3c,0x30060084,0x1322607c2544ac3c,0x30060084,0x1322607c2544ac3c,0x30060084,0x1322607c2544ac3c,0x30060084
.quad 0x1522a07d0760e83d,0x30060095,0x1522a07d0760e83d,0x30060095,0x1522a07d0760e83d,0x30060095,0x1522a07d0760e83d,0x30060095
.quad 0x13a2707e24c49c3e,0x30060084,0x13a2707e24c49c3e,0x30060084,0x13a2707e24c49c3e,0x30060084,0x13a2707e24c49c3e,0x30060084
.quad 0x15a2b07f07e0f83f,0x30060095,0x15a2b07f07e0f83f,0x30060095,0x15a2b07f07e0f83f,0x30060095,0x15a2b07f07e0f83f,0x30060095
.quad 0xe00060000006c0,0x32001a230160,0xe00060000006c0,0x32001b230160,0x26001e000000580,0x2c001c0302e0,0x26001e000000580,0x2c001d0302e0
.quad 0x3e0036000000600,0x30001e030460,0x3e0036000000600,0x30001f030460,0x20000000000700,0x200430040,0xa0008000000780,0x6024300c0
.quad 0x120010000000800,0xa04430140,0x1a0018000000880,0xe064301c0,0x220020000000900,0x1208430240,0x2a0028000000980,0x160a4302c0
.quad 0x320030000000a00,0x1a0c430340,0x3a0038000000a80,0x1e0e4303c0,0x420040000000b00,0x2210430440,0x4a0048000000b80,0x26124204a0
.quad 0x4e004c000000c00,0x2a144204e0,0x520050000000c80,0x2e16420520,0x560054000000d00,0x3218420560,0x20000000000700,0x201430040
.quad 0xa0008000000780,0x6034300c0,0x120010000000800,0xa05430140,0x1a0018000000880,0xe074301c0,0x220020000000900,0x1209430240
.quad 0x2a0028000000980,0x160b4302c0,0x320030000000a00,0x1a0d430340,0x3a0038000000a80,0x1e0f4303c0,0x420040000000b00,0x2211430440
.quad 0x4a0048000000b80,0x26134204a0,0x4e004c000000c00,0x2a154204e0,0x520050000000c80,0x2e17420520,0x560054000000d00,0x3219420560
.size tbl, 37376
.globl pk_kernel
.p2align 8
.type pk_kernel,@function
pk_kernel:
    s_load_dwordx16 s[48:63], s[0:1], 0
    s_load_dwordx4 s[64:67], s[0:1], 64
    s_load_dwordx2 s[68:69], s[0:1], 80
    s_cmp_ge_u32 s2, 256
    s_cbranch_scc1 pk_end0
    v_and_b32 v1, 63, v0
    v_lshrrev_b32 v2, 6, v0
    v_lshlrev_b32 v3, 4, v1
    v_readfirstlane_b32 s32, v2
    s_getpc_b64 s[20:21]
pk_pc:
    s_sub_u32 s20, s20, pk_pc-tbl
    s_subb_u32 s21, s21, 0
    s_mov_b32 s22, pk_textend-tbl
    s_mov_b32 s23, 0x20000
    v_lshrrev_b32 v4, 4, v1
    v_lshlrev_b32 v62, 5, v0
    s_mov_b32 s44, ((pk_pc-tbl+768)&0xffff80)
    buffer_load_dword a255, v62, s[20:23], s44 offen
    s_lshl_b32 s38, s32, 12
    s_add_u32 m0, s38, 81920
    s_lshl_b32 s44, s32, 9
    buffer_load_dwordx4 v3, s[20:23], s38 offen offset:0 lds
    buffer_load_dwordx4 v3, s[20:23], s38 offen offset:1024 lds
    buffer_load_dwordx4 v3, s[20:23], s38 offen offset:2048 lds
    buffer_load_dwordx4 v3, s[20:23], s38 offen offset:3072 lds
    s_add_u32 s44, s44, 16384
    s_add_u32 m0, s44, 81920
    s_mov_b32 exec_hi, 0
    buffer_load_dwordx4 v3, s[20:23], s44 offen lds
    s_mov_b32 exec_hi, -1
    v_mul_u32_u24 v2, 320, v4
    v_and_b32 v5, 15, v1
    v_lshl_add_u32 v2, v5, 2, v2
    s_lshr_b32 s33, s2, 4
    s_lshl_b32 s33, s33, 7
    s_and_b32 s34, s2, 15
    s_lshl_b32 s35, s34, 1
    s_add_u32 s35, s35, s33
    s_lshl_b32 s36, s32, 5
    s_add_u32 s35, s35, s36
    s_mul_i32 s35, s35, 1280
    s_lshl_b32 s36, s34, 2
    s_add_u32 s36, s36, s33
    s_and_b32 s37, s32, 1
    s_lshl_b32 s37, s37, 6
    s_add_u32 s36, s36, s37
    s_mul_i32 s36, s36, 642
    s_and_b32 s37, s36, 8
    s_andn2_b32 s36, s36, 15
    s_add_u32 s37, s37, 16384
    s_mul_i32 s43, s32, 3072
    v_mov_b32 v146, -1
    v_mov_b32 v147, -1
    v_mov_b32 v148, -1
    v_mov_b32 v149, -1
    v_lshrrev_b32 v9, 2, v0
    v_and_b32 v10, 3, v0
    v_min_u32 v7, 40, v9
    v_mul_u32_u24 v8, 205, v7
    v_lshrrev_b32 v8, 10, v8
    v_mul_u32_u24 v8, 40, v8
    v_lshl_add_u32 v8, v7, 3, v8
    v_min_u32 v8, 634, v8
    v_mul_u32_u24 v11, 642, v10
    v_add3_u32 v8, v8, v11, s37
    v_and_b32 v10, 7, v0
    v_lshrrev_b32 v9, 3, v0
    v_lshlrev_b32 v10, 4, v10
    v_lshl_add_u32 v6, v9, 17, v10
    v_lshl_add_u32 v9, v9, 15, v10
    v_add_u32 v7, 2523136, v10
    v_mov_b32 v10, 0x7f000000
    v_cmp_gt_u32 vcc, 168, v0
    s_nop 1
    v_cndmask_b32 v7, v10, v7, vcc
    v_cmp_gt_u32 vcc, 160, v0
    s_nop 1
    v_cndmask_b32 v7, v7, v6, vcc
    v_cndmask_b32 v6, v10, v6, vcc
    s_lshl_b32 s42, s2, 2
    s_add_u32 s42, s42, 0x288000
    v_mov_b32 v11, s42
    v_cmp_eq_u32 vcc, 255, v0
    s_nop 1
    v_cndmask_b32 v63, v10, v11, vcc
    v_cmp_gt_u32 vcc, 136, v0
    s_nop 1
    v_cndmask_b32 v10, v10, v9, vcc
    s_lshr_b32 s33, s2, 7
    s_lshl_b32 s33, s33, 14
    s_bfe_u32 s34, s2, 0x30002
    s_lshl_b32 s34, s34, 11
    s_add_u32 s33, s33, s34
    s_bfe_u32 s34, s2, 0x20005
    s_lshl_b32 s34, s34, 9
    s_add_u32 s33, s33, s34
    s_and_b32 s34, s2, 3
    s_lshl_b32 s34, s34, 7
    s_add_u32 s94, s33, s34
    s_lshr_b32 s33, s2, 6
    s_lshl_b32 s33, s33, 13
    s_bfe_u32 s34, s2, 0x10003
    s_lshl_b32 s34, s34, 12
    s_add_u32 s33, s33, s34
    s_and_b32 s34, s2, 1
    s_lshl_b32 s34, s34, 11
    s_add_u32 s33, s33, s34
    s_bfe_u32 s34, s2, 0x20004
    s_lshl_b32 s34, s34, 9
    s_add_u32 s33, s33, s34
    s_bfe_u32 s34, s2, 0x20001
    s_lshl_b32 s34, s34, 7
    s_add_u32 s95, s33, s34
    v_accvgpr_write_b32 a250, v63
    s_lshl_b32 s42, s2, 7
    s_add_u32 s42, s42, 0x289000
    s_lshl_b32 s33, s2, 2
    s_add_u32 s33, s33, 0x288400
    s_cmp_lt_u32 s2, 95
    s_cselect_b32 s42, s33, s42
    v_mov_b32 v11, s42
    v_cmp_eq_u32 vcc, 254, v0
    s_nop 1
    v_cndmask_b32 v63, v63, v11, vcc
    s_cmp_lt_u32 s32, 2
    s_waitcnt lgkmcnt(0)
    s_cselect_b64 s[8:9], s[50:51], s[52:53]
    s_mov_b64 s[16:17], s[68:69]
    s_mov_b32 s18, 0x2200000
    s_mov_b32 s19, 0x20000
    s_mov_b64 s[4:5], s[48:49]
    s_mov_b32 s6, 0x280000
    s_mov_b32 s7, 0x20000
    buffer_load_dword v12, v2, s[4:7], s35 offen offset:0
    buffer_load_dword v13, v2, s[4:7], s35 offen offset:64
    buffer_load_dword v14, v2, s[4:7], s35 offen offset:128
    buffer_load_dword v15, v2, s[4:7], s35 offen offset:192
    buffer_load_dword v16, v2, s[4:7], s35 offen offset:256
    buffer_load_dword v17, v2, s[4:7], s35 offen offset:1280
    buffer_load_dword v18, v2, s[4:7], s35 offen offset:1344
    buffer_load_dword v19, v2, s[4:7], s35 offen offset:1408
    buffer_load_dword v20, v2, s[4:7], s35 offen offset:1472
    buffer_load_dword v21, v2, s[4:7], s35 offen offset:1536
    buffer_store_dwordx4 v[146:149], v9, s[16:19], s95 offen sc1
    s_add_u32 s40, s95, 0x100000
    buffer_store_dwordx4 v[146:149], v9, s[16:19], s40 offen sc1
    s_add_u32 s40, s95, 0x200000
    buffer_store_dwordx4 v[146:149], v10, s[16:19], s40 offen sc1
    buffer_store_dword v146, v63, s[16:19], 0 offen sc1
    s_mov_b64 s[28:29], s[66:67]
    s_mov_b32 s30, 0x100
    s_mov_b32 s31, 0x20000
    s_lshr_b32 s44, s2, 3
    s_lshl_b32 s44, s44, 4
    s_load_dwordx2 s[66:67], s[20:21], s44 offset:36864
    s_load_dwordx2 s[68:69], s[20:21], s44 offset:36872
    s_mov_b32 s10, 0x141000
    s_mov_b32 s11, 0x20000
    s_add_u32 m0, s43, 16384
    s_nop 0
    buffer_load_dwordx4 v3, s[8:11], s36 offen offset:0 lds
    buffer_load_dwordx4 v3, s[8:11], s36 offen offset:1024 lds
    buffer_load_dwordx4 v3, s[8:11], s36 offen offset:2048 lds
    s_mov_b64 s[24:25], s[58:59]
    s_mov_b32 s26, 0x800000
    s_mov_b32 s27, 0x20000
    s_lshr_b32 s44, s2, 3
    s_lshl_b32 s44, s44, 2
    s_add_u32 s44, s44, s32
    s_lshl_b32 s44, s44, 11
    s_add_u32 s44, s44, 18432
    v_lshlrev_b32 v62, 7, v1
    s_mov_b64 exec, 0xffff
    buffer_load_dword a255, v62, s[20:23], s44 offen
    s_mov_b64 exec, -1
    s_mov_b64 s[8:9], s[56:57]
    s_mov_b32 s10, 0x21c000
    s_mov_b32 s11, 0x20000
    s_mul_i32 s39, s32, 8192
    s_andn2_b32 s33, 7, s2
    s_lshl_b32 s33, s33, 2
    s_lshr_b32 s47, s2, 6
    s_bfe_u32 s34, s2, 0x30003
    s_add_u32 s33, s33, s47
    v_lshrrev_b32 v62, 3, v1
    v_lshrrev_b32 v66, 1, v62
    v_and_b32 v150, 7, v1
    v_xor_b32 v150, v150, v66
    v_lshlrev_b32 v150, 4, v150
    v_lshrrev_b32 v66, 2, v62
    v_and_b32 v62, 3, v62
    v_lshl_add_u32 v62, v66, 5, v62
    v_lshl_add_u32 v150, v62, 12, v150
    s_lshl_b32 s33, s33, 18
    s_lshl_b32 s35, s32, 10
    s_add_u32 s33, s33, s35
    v_add_u32 v150, s33, v150
    v_xor_b32 v151, 64, v150
    v_add_u32 v151, 32768, v151
    s_lshr_b32 s3, s32, 1
    s_lshl_b32 s3, s3, 16
    s_and_b32 s35, s32, 1
    s_lshl_b32 s35, s35, 14
    s_or_b32 s3, s3, s35
    s_bfe_u32 s33, s2, 0x30003
    s_lshl_b32 s59, s33, 11
    s_and_b32 s34, s33, 1
    s_mul_i32 s34, s34, 55296
    s_sub_u32 s35, 55296, s34
    s_lshr_b32 s33, s33, 1
    s_xor_b32 s36, s33, 0
    s_mul_i32 s36, s36, 552960
    s_add_u32 s48, s36, s34
    s_add_u32 s49, s36, s35
    s_xor_b32 s36, s33, 1
    s_mul_i32 s36, s36, 552960
    s_add_u32 s50, s36, s34
    s_add_u32 s51, s36, s35
    s_xor_b32 s36, s33, 2
    s_mul_i32 s36, s36, 552960
    s_add_u32 s52, s36, s34
    s_add_u32 s56, s36, s35
    s_xor_b32 s36, s33, 3
    s_mul_i32 s36, s36, 552960
    s_add_u32 s57, s36, s34
    s_add_u32 s58, s36, s35
    v_lshrrev_b32 v64, 3, v1
    s_lshr_b32 s35, s32, 1
    s_and_b32 s36, s32, 1
    s_lshl_b32 s37, s35, 1
    s_lshl_b32 s38, s36, 5
    s_add_u32 s37, s37, s38
    s_lshl_b32 s38, s35, 3
    s_lshl_b32 s40, s36, 1
    s_add_u32 s38, s38, s40
    v_lshrrev_b32 v66, 2, v64
    v_bfe_u32 v65, v64, 1, 1
    v_and_b32 v64, 1, v64
    v_lshl_add_u32 v156, v66, 6, v64
    v_lshl_add_u32 v156, v65, 2, v156
    v_lshl_add_u32 v157, v66, 2, v64
    v_lshl_add_u32 v157, v65, 4, v157
    v_add_u32 v156, s37, v156
    v_add_u32 v157, s38, v157
    v_mul_u32_u24 v156, 3456, v156
    v_mul_u32_u24 v157, 3456, v157
    s_lshl_b32 s37, s35, 6
    s_lshl_b32 s38, s36, 2
    s_add_u32 s37, s37, s38
    s_lshl_b32 s38, s35, 2
    s_lshl_b32 s40, s36, 4
    s_add_u32 s38, s38, s40
    v_mul_u32_u24 v64, 43, v1
    v_lshrrev_b32 v64, 8, v64
    v_and_b32 v64, 7, v64
    v_lshrrev_b32 v66, 2, v64
    v_and_b32 v158, 1, v64
    v_lshl_add_u32 v158, v66, 1, v158
    v_and_b32 v159, 3, v64
    v_lshl_add_u32 v159, v66, 3, v159
    v_bfe_u32 v66, v64, 1, 1
    v_lshl_add_u32 v158, v66, 5, v158
    v_add_u32 v158, s37, v158
    v_add_u32 v159, s38, v159
    v_mul_u32_u24 v158, 3456, v158
    v_mul_u32_u24 v159, 3456, v159
    s_lshl_b32 s45, s2, 2
    s_add_u32 s45, s45, s32
    s_mul_i32 s45, s45, 2176
    v_lshlrev_b32 v97, 7, v1
    v_add_u32 v97, s45, v97
    v_add_u32 v2, 81920, v3
    v_mov_b32 v62, 0x7f000000
    v_cmp_gt_u32 vcc, 132, v0
    s_nop 1
    v_cndmask_b32 v10, v62, v10, vcc
    s_lshl_b32 s45, s32, 4
    v_add_u32 v122, s45, v5
    v_cvt_f32_u32 v122, v122
    v_cvt_f32_u32 v123, v4
    v_mul_f32 v122, 0x3c800000, v122
    v_mul_f32 v123, 4.0, v123
    v_mul_f32 v123, v123, v122
    v_add_f32 v124, -1.0, v122
    v_cvt_f32_u32 v125, v4
    v_mul_f32 v124, 0x3d000000, v124
    v_mul_f32 v125, 4.0, v125
    v_mul_f32 v125, v125, v124
    v_mov_b32 v114, v123
    v_fmamk_f32 v116, v122, 0x3f800000, v123
    v_fmamk_f32 v118, v122, 0x40000000, v123
    v_fmamk_f32 v120, v122, 0x40400000, v123
    v_sin_f32 v115, v114
    v_cos_f32 v114, v114
    v_sin_f32 v117, v116
    v_cos_f32 v116, v116
    v_sin_f32 v119, v118
    v_cos_f32 v118, v118
    v_sin_f32 v121, v120
    v_cos_f32 v120, v120
    v_cvt_pk_f16_f32 v160, v114, v115
    v_cvt_pk_f16_f32 v164, -v115, v114
    v_cvt_pk_f16_f32 v161, v116, v117
    v_cvt_pk_f16_f32 v165, -v117, v116
    v_cvt_pk_f16_f32 v162, v118, v119
    v_cvt_pk_f16_f32 v166, -v119, v118
    v_cvt_pk_f16_f32 v163, v120, v121
    v_cvt_pk_f16_f32 v167, -v121, v120
    v_fmamk_f32 v114, v122, 0x41800000, v123
    v_fmamk_f32 v116, v122, 0x41880000, v123
    v_fmamk_f32 v118, v122, 0x41900000, v123
    v_fmamk_f32 v120, v122, 0x41980000, v123
    v_sin_f32 v115, v114
    v_cos_f32 v114, v114
    v_sin_f32 v117, v116
    v_cos_f32 v116, v116
    v_sin_f32 v119, v118
    v_cos_f32 v118, v118
    v_sin_f32 v121, v120
    v_cos_f32 v120, v120
    v_cvt_pk_f16_f32 v168, v114, v115
    v_cvt_pk_f16_f32 v172, -v115, v114
    v_cvt_pk_f16_f32 v169, v116, v117
    v_cvt_pk_f16_f32 v173, -v117, v116
    v_cvt_pk_f16_f32 v170, v118, v119
    v_cvt_pk_f16_f32 v174, -v119, v118
    v_cvt_pk_f16_f32 v171, v120, v121
    v_cvt_pk_f16_f32 v175, -v121, v120
    v_fmamk_f32 v114, v122, 0x42000000, v123
    v_fmamk_f32 v116, v122, 0x42040000, v123
    v_fmamk_f32 v118, v122, 0x42080000, v123
    v_fmamk_f32 v120, v122, 0x420c0000, v123
    v_sin_f32 v115, v114
    v_cos_f32 v114, v114
    v_sin_f32 v117, v116
    v_cos_f32 v116, v116
    v_sin_f32 v119, v118
    v_cos_f32 v118, v118
    v_sin_f32 v121, v120
    v_cos_f32 v120, v120
    v_cvt_pk_f16_f32 v176, v114, v115
    v_cvt_pk_f16_f32 v180, -v115, v114
    v_cvt_pk_f16_f32 v177, v116, v117
    v_cvt_pk_f16_f32 v181, -v117, v116
    v_cvt_pk_f16_f32 v178, v118, v119
    v_cvt_pk_f16_f32 v182, -v119, v118
    v_cvt_pk_f16_f32 v179, v120, v121
    v_cvt_pk_f16_f32 v183, -v121, v120
    v_fmamk_f32 v114, v122, 0x42400000, v123
    v_fmamk_f32 v116, v122, 0x42440000, v123
    v_fmamk_f32 v118, v122, 0x42480000, v123
    v_fmamk_f32 v120, v122, 0x424c0000, v123
    v_sin_f32 v115, v114
    v_cos_f32 v114, v114
    v_sin_f32 v117, v116
    v_cos_f32 v116, v116
    v_sin_f32 v119, v118
    v_cos_f32 v118, v118
    v_sin_f32 v121, v120
    v_cos_f32 v120, v120
    v_cvt_pk_f16_f32 v184, v114, v115
    v_cvt_pk_f16_f32 v188, -v115, v114
    v_cvt_pk_f16_f32 v185, v116, v117
    v_cvt_pk_f16_f32 v189, -v117, v116
    v_cvt_pk_f16_f32 v186, v118, v119
    v_cvt_pk_f16_f32 v190, -v119, v118
    v_cvt_pk_f16_f32 v187, v120, v121
    v_cvt_pk_f16_f32 v191, -v121, v120
    v_mov_b32 v114, v125
    v_fmamk_f32 v116, v124, 0x3f800000, v125
    v_fmamk_f32 v118, v124, 0x40000000, v125
    v_fmamk_f32 v120, v124, 0x40400000, v125
    v_sin_f32 v115, v114
    v_cos_f32 v114, v114
    v_sin_f32 v117, v116
    v_cos_f32 v116, v116
    v_sin_f32 v119, v118
    v_cos_f32 v118, v118
    v_sin_f32 v121, v120
    v_cos_f32 v120, v120
    v_mul_f32 v224, 0x3cb504f3, v114
    v_mul_f32 v225, 0xbcb504f3, v115
    v_mul_f32 v226, 0x3cb504f3, v116
    v_mul_f32 v227, 0xbcb504f3, v117
    v_mul_f32 v228, 0x3cb504f3, v118
    v_mul_f32 v229, 0xbcb504f3, v119
    v_mul_f32 v230, 0x3cb504f3, v120
    v_mul_f32 v231, 0xbcb504f3, v121
    v_fmamk_f32 v114, v124, 0x41800000, v125
    v_fmamk_f32 v116, v124, 0x41880000, v125
    v_fmamk_f32 v118, v124, 0x41900000, v125
    v_fmamk_f32 v120, v124, 0x41980000, v125
    v_sin_f32 v115, v114
    v_cos_f32 v114, v114
    v_sin_f32 v117, v116
    v_cos_f32 v116, v116
    v_sin_f32 v119, v118
    v_cos_f32 v118, v118
    v_sin_f32 v121, v120
    v_cos_f32 v120, v120
    v_mul_f32 v232, 0x3cb504f3, v114
    v_mul_f32 v233, 0xbcb504f3, v115
    v_mul_f32 v234, 0x3cb504f3, v116
    v_mul_f32 v235, 0xbcb504f3, v117
    v_mul_f32 v236, 0x3cb504f3, v118
    v_mul_f32 v237, 0xbcb504f3, v119
    v_mul_f32 v238, 0x3cb504f3, v120
    v_mul_f32 v239, 0xbcb504f3, v121
    s_waitcnt vmcnt(8)
    s_mov_b32 s46, 0x3f803f80
    v_dot2_f32_bf16 v91, v12, s46, 0
    v_dot2_f32_bf16 v92, v17, s46, 0
    v_dot2_f32_bf16 v93, v12, v12, 0
    v_dot2_f32_bf16 v94, v17, v17, 0
    v_dot2_f32_bf16 v91, v13, s46, v91
    v_dot2_f32_bf16 v92, v18, s46, v92
    v_dot2_f32_bf16 v93, v13, v13, v93
    v_dot2_f32_bf16 v94, v18, v18, v94
    v_dot2_f32_bf16 v91, v14, s46, v91
    v_dot2_f32_bf16 v92, v19, s46, v92
    v_dot2_f32_bf16 v93, v14, v14, v93
    v_dot2_f32_bf16 v94, v19, v19, v94
    v_dot2_f32_bf16 v91, v15, s46, v91
    v_dot2_f32_bf16 v92, v20, s46, v92
    v_dot2_f32_bf16 v93, v15, v15, v93
    v_dot2_f32_bf16 v94, v20, v20, v94
    v_dot2_f32_bf16 v91, v16, s46, v91
    v_dot2_f32_bf16 v92, v21, s46, v92
    v_dot2_f32_bf16 v93, v16, v16, v93
    v_dot2_f32_bf16 v94, v21, v21, v94
    v_lshlrev_b32 v70, 16, v12
    v_permlane32_swap_b32 v91, v92
    v_and_b32 v71, 0xffff0000, v12
    v_permlane32_swap_b32 v93, v94
    v_add_f32 v91, v91, v92
    v_add_f32 v93, v93, v94
    v_lshlrev_b32 v72, 16, v13
    v_and_b32 v73, 0xffff0000, v13
    v_permlane16_swap_b32 v91, v93
    v_add_f32 v91, v91, v93
    v_lshlrev_b32 v74, 16, v14
    v_and_b32 v75, 0xffff0000, v14
    v_add_f32 v91, v91, v91 row_ror:1
    v_lshlrev_b32 v76, 16, v15
    v_and_b32 v77, 0xffff0000, v15
    v_add_f32 v91, v91, v91 row_ror:2
    v_lshlrev_b32 v78, 16, v16
    v_and_b32 v79, 0xffff0000, v16
    v_add_f32 v91, v91, v91 row_ror:4
    v_lshlrev_b32 v80, 16, v17
    v_and_b32 v81, 0xffff0000, v17
    v_add_f32 v93, v91, v91 row_ror:8
    v_add_f32 v91, v91, v91 row_ror:8
    v_lshlrev_b32 v82, 16, v18
    v_and_b32 v83, 0xffff0000, v18
    v_permlane16_swap_b32 v91, v93
    v_lshlrev_b32 v84, 16, v19
    v_and_b32 v85, 0xffff0000, v19
    v_lshlrev_b32 v86, 16, v20
    v_and_b32 v87, 0xffff0000, v20
    v_lshlrev_b32 v88, 16, v21
    v_and_b32 v89, 0xffff0000, v21
    v_mul_f32 v95, 0x3acccccd, v91
    v_mul_f32 v96, 0x3acccccd, v93
    v_fma_f32 v96, -v95, v95, v96
    v_max_f32 v96, 0, v96
    v_cvt_pk_bf16_f32 v95, v95, v96
    v_and_b32 v96, 0xffff0000, v95
    v_lshlrev_b32 v95, 16, v95
    v_add_f32 v96, 0x3727c5ac, v96
    v_readlane_b32 s42, v95, 0
    v_cvt_pk_bf16_f32 v96, v96, v96
    v_readlane_b32 s44, v95, 32
    v_lshlrev_b32 v96, 16, v96
    v_sqrt_f32 v96, v96
    v_pk_add_f32 v[70:71], v[70:71], s[42:43] op_sel_hi:[1,0] neg_lo:[0,1] neg_hi:[0,1]
    v_pk_add_f32 v[72:73], v[72:73], s[42:43] op_sel_hi:[1,0] neg_lo:[0,1] neg_hi:[0,1]
    v_cvt_pk_bf16_f32 v91, v70, v71
    v_lshlrev_b32 v70, 16, v91
    v_and_b32 v71, 0xffff0000, v91
    v_cvt_pk_bf16_f32 v96, v96, v96
    v_pk_add_f32 v[74:75], v[74:75], s[42:43] op_sel_hi:[1,0] neg_lo:[0,1] neg_hi:[0,1]
    v_cvt_pk_bf16_f32 v92, v72, v73
    v_lshlrev_b32 v72, 16, v92
    v_and_b32 v73, 0xffff0000, v92
    v_lshlrev_b32 v96, 16, v96
    v_pk_add_f32 v[76:77], v[76:77], s[42:43] op_sel_hi:[1,0] neg_lo:[0,1] neg_hi:[0,1]
    v_cvt_pk_bf16_f32 v93, v74, v75
    v_lshlrev_b32 v74, 16, v93
    v_and_b32 v75, 0xffff0000, v93
    v_rcp_f32 v96, v96
    v_pk_add_f32 v[78:79], v[78:79], s[42:43] op_sel_hi:[1,0] neg_lo:[0,1] neg_hi:[0,1]
    v_cvt_pk_bf16_f32 v94, v76, v77
    v_lshlrev_b32 v76, 16, v94
    v_and_b32 v77, 0xffff0000, v94
    v_pk_add_f32 v[80:81], v[80:81], s[44:45] op_sel_hi:[1,0] neg_lo:[0,1] neg_hi:[0,1]
    v_cvt_pk_bf16_f32 v91, v78, v79
    v_lshlrev_b32 v78, 16, v91
    v_and_b32 v79, 0xffff0000, v91
    v_readlane_b32 s43, v96, 0
    v_pk_add_f32 v[82:83], v[82:83], s[44:45] op_sel_hi:[1,0] neg_lo:[0,1] neg_hi:[0,1]
    v_cvt_pk_bf16_f32 v91, v80, v81
    v_lshlrev_b32 v80, 16, v91
    v_and_b32 v81, 0xffff0000, v91
    v_readlane_b32 s45, v96, 32
    s_nop 1
    v_pk_add_f32 v[84:85], v[84:85], s[44:45] op_sel_hi:[1,0] neg_lo:[0,1] neg_hi:[0,1]
    v_cvt_pk_bf16_f32 v92, v82, v83
    v_lshlrev_b32 v82, 16, v92
    v_and_b32 v83, 0xffff0000, v92
    v_pk_add_f32 v[86:87], v[86:87], s[44:45] op_sel_hi:[1,0] neg_lo:[0,1] neg_hi:[0,1]
    v_cvt_pk_bf16_f32 v93, v84, v85
    v_lshlrev_b32 v84, 16, v93
    v_and_b32 v85, 0xffff0000, v93
    v_pk_add_f32 v[88:89], v[88:89], s[44:45] op_sel_hi:[1,0] neg_lo:[0,1] neg_hi:[0,1]
    v_cvt_pk_bf16_f32 v94, v86, v87
    v_lshlrev_b32 v86, 16, v94
    v_and_b32 v87, 0xffff0000, v94
    v_cvt_pk_bf16_f32 v91, v88, v89
    v_lshlrev_b32 v88, 16, v91
    v_and_b32 v89, 0xffff0000, v91
    v_pk_mul_f32 v[70:71], v[70:71], s[42:43] op_sel:[0,1]
    v_pk_mul_f32 v[72:73], v[72:73], s[42:43] op_sel:[0,1]
    v_pk_mul_f32 v[74:75], v[74:75], s[42:43] op_sel:[0,1]
    v_pk_mul_f32 v[76:77], v[76:77], s[42:43] op_sel:[0,1]
    v_pk_mul_f32 v[78:79], v[78:79], s[42:43] op_sel:[0,1]
    v_pk_mul_f32 v[80:81], v[80:81], s[44:45] op_sel:[0,1]
    v_pk_mul_f32 v[82:83], v[82:83], s[44:45] op_sel:[0,1]
    v_pk_mul_f32 v[84:85], v[84:85], s[44:45] op_sel:[0,1]
    v_pk_mul_f32 v[86:87], v[86:87], s[44:45] op_sel:[0,1]
    v_pk_mul_f32 v[88:89], v[88:89], s[44:45] op_sel:[0,1]
    v_and_b32 v11, -4, v8
    s_mov_b32 s92, 0x05040100
    s_mov_b32 s93, 0x07060302
    s_waitcnt vmcnt(18)
    s_waitcnt vmcnt(1)
    s_barrier
    s_getreg_b32 s45, hwreg(HW_REG_XCC_ID, 0, 4)
    s_mul_i32 s0, s45, s45
    s_lshl_b32 s0, s0, 10
    s_add_u32 s0, s0, s45
    s_lshl_b32 s0, s0, 8
    s_add_u32 s0, s0, 1
    s_and_b32 s45, s2, 7
    s_lshl_b32 s45, s45, 5
    v_mov_b32 v90, s45
    v_mov_b32 v91, s0
    s_cmp_eq_u32 s32, 0
    s_cselect_b64 exec, 1, 0
    buffer_atomic_add v91, v90, s[28:31], 0 offen sc1
    s_mov_b64 exec, -1
    s_lshl_b32 s0, s0, 5
    s_lshl_b32 s38, s32, 12
    s_add_u32 m0, s38, 131072
    s_add_u32 s38, s38, 18432
    buffer_load_dwordx4 v3, s[20:23], s38 offen offset:0 lds
    buffer_load_dwordx4 v3, s[20:23], s38 offen offset:1024 lds
    buffer_load_dwordx4 v3, s[20:23], s38 offen offset:2048 lds
    buffer_load_dwordx4 v3, s[20:23], s38 offen offset:3072 lds
    v_lshlrev_b32 v92, 4, v0
    s_mov_b32 s38, 32768
    buffer_load_dwordx4 v[152:155], v92, s[20:23], s38 offen
    s_mov_b64 exec, 0x1ffff
    buffer_load_dword a255, v97, s[8:11], 0 offen
    s_mov_b64 exec, -1
    ds_read_b128 a[0:3], v2 offset:0
    ds_read_b128 a[4:7], v2 offset:1024
    ds_read_b128 a[8:11], v2 offset:2048
    ds_read_b128 a[12:15], v2 offset:3072
    ds_read2_b32 v[46:47], v11 offset0:0 offset1:1
    ds_read2_b32 v[48:49], v11 offset0:2 offset1:10
    ds_read2_b32 v[50:51], v11 offset0:11 offset1:12
    v_add_u32 v11, 3072, v11
    ds_read2_b32 v[52:53], v11 offset0:0 offset1:1
    ds_read2_b32 v[54:55], v11 offset0:2 offset1:10
    ds_read2_b32 v[56:57], v11 offset0:11 offset1:12
    v_add_u32 v11, 3072, v11
    ds_read2_b32 v[58:59], v11 offset0:0 offset1:1
    ds_read2_b32 v[60:61], v11 offset0:2 offset1:10
    ds_read2_b32 v[62:63], v11 offset0:11 offset1:12
    v_add_u32 v11, 3072, v11
    ds_read2_b32 v[64:65], v11 offset0:0 offset1:1
    ds_read2_b32 v[66:67], v11 offset0:2 offset1:10
    ds_read2_b32 v[68:69], v11 offset0:11 offset1:12
    v_cvt_pk_bf16_f32 v98, v70, v72
    v_cvt_pk_bf16_f32 v99, v74, v76
    v_cvt_pk_bf16_f32 v100, v78, 0
    v_mov_b32 v101, 0
    v_cvt_pk_bf16_f32 v102, v71, v73
    v_cvt_pk_bf16_f32 v103, v75, v77
    v_cvt_pk_bf16_f32 v104, v79, 0
    v_mov_b32 v105, 0
    v_cvt_pk_bf16_f32 v106, v80, v82
    v_cvt_pk_bf16_f32 v107, v84, v86
    v_cvt_pk_bf16_f32 v108, v88, 0
    v_mov_b32 v109, 0
    v_cvt_pk_bf16_f32 v110, v81, v83
    v_cvt_pk_bf16_f32 v111, v85, v87
    v_cvt_pk_bf16_f32 v112, v89, 0
    v_mov_b32 v113, 0
    s_waitcnt lgkmcnt(12)
    ds_read_b128 v[22:25], v2 offset:4096
    ds_read_b128 v[26:29], v2 offset:5120
    ds_read_b128 v[30:33], v2 offset:6144
    ds_read_b128 v[34:37], v2 offset:7168
    v_mfma_f32_16x16x32_bf16 v[114:117], v[98:101], a[4:7], 0
    v_mfma_f32_16x16x32_bf16 v[118:121], v[98:101], a[12:15], 0
    v_mfma_f32_16x16x32_bf16 v[114:117], v[98:101], a[0:3], v[114:117]
    v_mfma_f32_16x16x32_bf16 v[118:121], v[98:101], a[8:11], v[118:121]
    s_waitcnt lgkmcnt(4)
    ds_read_b128 a[16:19], v2 offset:8192
    ds_read_b128 a[20:23], v2 offset:9216
    ds_read_b128 a[24:27], v2 offset:10240
    ds_read_b128 a[28:31], v2 offset:11264
    ds_read_b128 a[32:35], v2 offset:12288
    ds_read_b128 a[36:39], v2 offset:13312
    ds_read_b128 a[40:43], v2 offset:14336
    ds_read_b128 a[44:47], v2 offset:15360
    ds_read_b128 v[38:41], v2 offset:16384
    ds_read_b128 v[42:45], v2 offset:17408
    v_mfma_f32_16x16x32_bf16 v[122:125], v[102:105], a[4:7], 0
    v_mfma_f32_16x16x32_bf16 v[126:129], v[102:105], a[12:15], 0
    v_mfma_f32_16x16x32_bf16 v[122:125], v[102:105], a[0:3], v[122:125]
    v_mfma_f32_16x16x32_bf16 v[126:129], v[102:105], a[8:11], v[126:129]
    v_mfma_f32_16x16x32_bf16 v[130:133], v[106:109], a[4:7], 0
    v_alignbyte_b32 v46, v47, v46, v8
    v_alignbyte_b32 v47, v48, v47, v8
    v_mfma_f32_16x16x32_bf16 v[134:137], v[106:109], a[12:15], 0
    v_alignbyte_b32 v49, v50, v49, v8
    v_alignbyte_b32 v50, v51, v50, v8
    v_mfma_f32_16x16x32_bf16 v[130:133], v[106:109], a[0:3], v[130:133]
    v_alignbyte_b32 v52, v53, v52, v8
    v_alignbyte_b32 v53, v54, v53, v8
    v_mfma_f32_16x16x32_bf16 v[134:137], v[106:109], a[8:11], v[134:137]
    v_alignbyte_b32 v55, v56, v55, v8
    v_alignbyte_b32 v56, v57, v56, v8
    v_mfma_f32_16x16x32_bf16 v[138:141], v[110:113], a[4:7], 0
    v_alignbyte_b32 v58, v59, v58, v8
    v_alignbyte_b32 v59, v60, v59, v8
    v_mfma_f32_16x16x32_bf16 v[142:145], v[110:113], a[12:15], 0
    v_alignbyte_b32 v61, v62, v61, v8
    v_alignbyte_b32 v62, v63, v62, v8
    v_mfma_f32_16x16x32_bf16 v[138:141], v[110:113], a[0:3], v[138:141]
    v_alignbyte_b32 v64, v65, v64, v8
    v_alignbyte_b32 v65, v66, v65, v8
    v_mfma_f32_16x16x32_bf16 v[142:145], v[110:113], a[8:11], v[142:145]
    v_alignbyte_b32 v67, v68, v67, v8
    v_alignbyte_b32 v68, v69, v68, v8
    v_perm_b32 v70, v58, v46, s92
    v_perm_b32 v71, v64, v52, s92
    v_perm_b32 v72, v61, v49, s92
    v_perm_b32 v73, v67, v55, s92
    s_add_u32 s40, s94, 0x300000
    buffer_store_dwordx4 v[70:73], v6, s[16:19], s40 offen sc1
    v_perm_b32 v74, v58, v46, s93
    v_perm_b32 v75, v64, v52, s93
    v_perm_b32 v76, v61, v49, s93
    v_perm_b32 v77, v67, v55, s93
    s_add_u32 s40, s94, 0x308000
    buffer_store_dwordx4 v[74:77], v6, s[16:19], s40 offen sc1
    v_perm_b32 v78, v59, v47, s92
    v_perm_b32 v79, v65, v53, s92
    v_perm_b32 v80, v62, v50, s92
    v_perm_b32 v81, v68, v56, s92
    s_add_u32 s40, s94, 0x310000
    buffer_store_dwordx4 v[78:81], v6, s[16:19], s40 offen sc1
    v_perm_b32 v82, v59, v47, s93
    v_perm_b32 v83, v65, v53, s93
    v_perm_b32 v84, v62, v50, s93
    v_perm_b32 v85, v68, v56, s93
    s_add_u32 s40, s94, 0x318000
    buffer_store_dwordx4 v[82:85], v7, s[16:19], s40 offen sc1
    s_mul_i32 s42, s32, 1536
    s_waitcnt lgkmcnt(0)
    v_and_b32 v14, 7, v1
    v_lshlrev_b32 v14, 4, v14
    v_mul_u32_u24 v16, 43, v1
    v_lshrrev_b32 v16, 8, v16
    v_mul_u32_u24 v17, 6, v16
    v_sub_u32 v17, v1, v17
    v_lshlrev_b32 v15, 4, v17
    v_xor_b32 v14, s66, v14
    s_and_b32 s35, s67, 0xffff
    s_lshr_b32 s36, s67, 16
    s_and_b32 s37, s68, 0xffff
    v_mov_b32 v18, s35
    v_mov_b32 v16, s36
    v_cmp_le_u32 vcc, 32, v15
    s_nop 1
    v_cndmask_b32 v18, v18, v16, vcc
    v_mov_b32 v16, s37
    v_cmp_le_u32 vcc, 64, v15
    s_nop 1
    v_cndmask_b32 v18, v18, v16, vcc
    v_and_b32 v15, 16, v15
    v_add_u32 v15, v15, v18
    v_add_u32 v156, v156, v14
    v_add_u32 v157, v157, v14
    v_add_u32 v158, v158, v15
    v_add_u32 v159, v159, v15
    s_mul_i32 s88, s32, 1056
    s_add_u32 s88, s88, 17920
    s_mul_i32 s89, s32, 768
    s_add_u32 s89, s89, 102400
    v_mul_f32 v86, v118, v23
    v_mul_f32 v87, v118, v22
    v_mul_f32 v88, v119, v25
    v_mul_f32 v89, v119, v24
    v_mul_f32 v90, v120, v27
    v_mul_f32 v91, v120, v26
    v_mul_f32 v92, v121, v29
    v_mul_f32 v93, v121, v28
    v_fma_mixlo_f16 v98, v114, v22, -v86
    v_fma_mixlo_f16 v99, v115, v24, -v88
    v_fma_mixlo_f16 v100, v116, v26, -v90
    v_fma_mixlo_f16 v101, v117, v28, -v92
    v_fma_mixhi_f16 v98, v114, v23, v87
    v_fma_mixhi_f16 v99, v115, v25, v89
    v_fma_mixhi_f16 v100, v116, v27, v91
    v_fma_mixhi_f16 v101, v117, v29, v93
    v_mul_f32 v86, v126, v31
    v_mul_f32 v87, v126, v30
    v_mul_f32 v88, v127, v33
    v_mul_f32 v89, v127, v32
    v_mul_f32 v90, v128, v35
    v_mul_f32 v91, v128, v34
    v_mul_f32 v92, v129, v37
    v_mul_f32 v93, v129, v36
    v_fma_mixlo_f16 v102, v122, v30, -v86
    s_add_u32 m0, s88, 12672
    s_add_u32 s90, s49, 27648
    buffer_load_dwordx4 v156, s[8:11], s90 offen lds
    v_fma_mixlo_f16 v103, v123, v32, -v88
    v_fma_mixlo_f16 v104, v124, v34, -v90
    v_fma_mixlo_f16 v105, v125, v36, -v92
    v_fma_mixhi_f16 v102, v122, v31, v87
    v_fma_mixhi_f16 v103, v123, v33, v89
    v_fma_mixhi_f16 v104, v124, v35, v91
    v_fma_mixhi_f16 v105, v125, v37, v93
    v_mul_f32 v86, v134, v23
    v_mul_f32 v87, v134, v22
    v_mul_f32 v88, v135, v25
    v_mul_f32 v89, v135, v24
    v_mul_f32 v90, v136, v27
    v_mul_f32 v91, v136, v26
    v_mul_f32 v92, v137, v29
    v_mul_f32 v93, v137, v28
    v_fma_mixlo_f16 v106, v130, v22, -v86
    v_fma_mixlo_f16 v107, v131, v24, -v88
    v_fma_mixlo_f16 v108, v132, v26, -v90
    v_fma_mixlo_f16 v109, v133, v28, -v92
    v_fma_mixhi_f16 v106, v130, v23, v87
    v_fma_mixhi_f16 v107, v131, v25, v89
    v_fma_mixhi_f16 v108, v132, v27, v91
    v_fma_mixhi_f16 v109, v133, v29, v93
    v_mul_f32 v86, v142, v31
    v_mul_f32 v87, v142, v30
    s_add_u32 m0, s88, 16896
    s_nop 0
    buffer_load_dwordx4 v156, s[8:11], s50 offen lds
    v_mul_f32 v88, v143, v33
    v_mul_f32 v89, v143, v32
    v_mul_f32 v90, v144, v35
    v_mul_f32 v91, v144, v34
    v_mul_f32 v92, v145, v37
    v_mul_f32 v93, v145, v36
    v_fma_mixlo_f16 v110, v138, v30, -v86
    v_fma_mixlo_f16 v111, v139, v32, -v88
    v_fma_mixlo_f16 v112, v140, v34, -v90
    v_fma_mixlo_f16 v113, v141, v36, -v92
    v_fma_mixhi_f16 v110, v138, v31, v87
    v_fma_mixhi_f16 v111, v139, v33, v89
    v_fma_mixhi_f16 v112, v140, v35, v91
    v_fma_mixhi_f16 v113, v141, v37, v93
    s_movk_i32 s43, 6208
    v_mfma_f32_16x16x32_f16 v[114:117], a[16:19], v[98:101], 0
    v_add_u32 v38, s42, v38
    v_add_u32 v39, s42, v39
    v_add_u32 v40, s42, v40
    v_mfma_f32_16x16x32_f16 v[114:117], a[20:23], v[102:105], v[114:117]
    s_add_u32 m0, s88, 21120
    s_add_u32 s90, s50, 27648
    buffer_load_dwordx4 v156, s[8:11], s90 offen lds
    v_add_u32 v41, s42, v41
    v_add_u32 v42, s42, v42
    v_mfma_f32_16x16x32_f16 v[118:121], a[24:27], v[98:101], 0
    v_add_u32 v43, s42, v43
    v_add_u32 v44, s42, v44
    v_mfma_f32_16x16x32_f16 v[118:121], a[28:31], v[102:105], v[118:121]
    v_add_u32 v45, s42, v45
    v_lshrrev_b32 v12, 5, v0
    v_mfma_f32_16x16x32_f16 v[122:125], a[32:35], v[98:101], 0
    v_and_b32 v13, 24, v0
    v_lshl_add_u32 v12, v12, 6, v13
    v_mfma_f32_16x16x32_f16 v[122:125], a[36:39], v[102:105], v[122:125]
    v_and_b32 v13, 4, v0
    s_add_u32 m0, s88, 25344
    s_nop 0
    buffer_load_dwordx4 v156, s[8:11], s51 offen lds
    v_lshl_add_u32 v12, v13, 3, v12
    v_mfma_f32_16x16x32_f16 v[126:129], a[40:43], v[98:101], 0
    v_and_b32 v13, 1, v0
    v_lshl_add_u32 v12, v13, 2, v12
    v_mfma_f32_16x16x32_f16 v[126:129], a[44:47], v[102:105], v[126:129]
    v_bfe_u32 v13, v0, 1, 1
    v_mad_u32_u24 v12, v13, s43, v12
    v_mfma_f32_16x16x32_f16 v[130:133], a[16:19], v[106:109], 0
    v_and_b32 v46, 0x7fff7fff, v46
    v_and_b32 v47, 0x7fff7fff, v47
    v_mfma_f32_16x16x32_f16 v[130:133], a[20:23], v[110:113], v[130:133]
    v_and_b32 v49, 0x7fff7fff, v49
    v_and_b32 v50, 0x7fff7fff, v50
    s_add_u32 m0, s88, 29568
    s_add_u32 s90, s51, 27648
    buffer_load_dwordx4 v156, s[8:11], s90 offen lds
    v_mfma_f32_16x16x32_f16 v[134:137], a[24:27], v[106:109], 0
    v_and_b32 v52, 0x7fff7fff, v52
    v_and_b32 v53, 0x7fff7fff, v53
    v_mfma_f32_16x16x32_f16 v[134:137], a[28:31], v[110:113], v[134:137]
    v_and_b32 v55, 0x7fff7fff, v55
    v_and_b32 v56, 0x7fff7fff, v56
    v_mfma_f32_16x16x32_f16 v[138:141], a[32:35], v[106:109], 0
    v_and_b32 v58, 0x7fff7fff, v58
    v_and_b32 v59, 0x7fff7fff, v59
    v_mfma_f32_16x16x32_f16 v[138:141], a[36:39], v[110:113], v[138:141]
    v_and_b32 v61, 0x7fff7fff, v61
    v_and_b32 v62, 0x7fff7fff, v62
    v_mfma_f32_16x16x32_f16 v[142:145], a[40:43], v[106:109], 0
    s_add_u32 m0, s88, 33792
    s_nop 0
    buffer_load_dwordx4 v156, s[8:11], s52 offen lds
    v_and_b32 v64, 0x7fff7fff, v64
    v_and_b32 v65, 0x7fff7fff, v65
    v_mfma_f32_16x16x32_f16 v[142:145], a[44:47], v[110:113], v[142:145]
    v_and_b32 v67, 0x7fff7fff, v67
    v_and_b32 v68, 0x7fff7fff, v68
    v_cvt_pk_f16_f32 v22, v114, v115
    ds_write_b32 v38, v22 offset:0
    v_cvt_pk_f16_f32 v23, v116, v117
    ds_write_b32 v39, v23 offset:0
    v_cvt_pk_f16_f32 v24, v118, v119
    ds_write_b32 v40, v24 offset:0
    v_cvt_pk_f16_f32 v25, v120, v121
    ds_write_b32 v41, v25 offset:0
    v_cvt_pk_f16_f32 v26, v122, v123
    ds_write_b32 v42, v26 offset:0
    v_cvt_pk_f16_f32 v27, v124, v125
    ds_write_b32 v43, v27 offset:0
    v_cvt_pk_f16_f32 v28, v126, v127
    ds_write_b32 v44, v28 offset:0
    v_cvt_pk_f16_f32 v29, v128, v129
    ds_write_b32 v45, v29 offset:0
    v_cvt_pk_f16_f32 v30, v130, v131
    ds_write_b32 v38, v30 offset:6208
    v_cvt_pk_f16_f32 v31, v132, v133
    ds_write_b32 v39, v31 offset:6208
    v_cvt_pk_f16_f32 v32, v134, v135
    ds_write_b32 v40, v32 offset:6208
    v_cvt_pk_f16_f32 v33, v136, v137
    ds_write_b32 v41, v33 offset:6208
    v_cvt_pk_f16_f32 v34, v138, v139
    ds_write_b32 v42, v34 offset:6208
    v_cvt_pk_f16_f32 v35, v140, v141
    ds_write_b32 v43, v35 offset:6208
    v_cvt_pk_f16_f32 v36, v142, v143
    ds_write_b32 v44, v36 offset:6208
    v_cvt_pk_f16_f32 v37, v144, v145
    ds_write_b32 v45, v37 offset:6208
    s_lshr_b32 s37, s2, 4
    s_sub_u32 s37, s37, 6
    s_lshl_b32 s37, s37, 3
    s_and_b32 s33, s2, 7
    s_add_u32 s37, s37, s33
    s_lshl_b32 s37, s37, 15
    s_and_b32 s33, s2, 8
    s_lshl_b32 s33, s33, 3
    s_add_u32 s37, s37, s33
    s_cmp_eq_u32 s2, 95
    s_cselect_b32 s37, 2621440, s37
    s_lshl_b32 s33, s32, 13
    s_add_u32 s92, s37, s33
    s_lshl_b32 s33, s32, 11
    s_add_u32 s93, s37, s33
    s_add_u32 s93, s93, 0x300000
    v_and_b32 v144, 0x3c0, v3
    v_add_u32 v144, v144, v3
    v_add_u32 v145, 4096, v144
    v_pk_max_u16 v46, v46, v58
    v_pk_max_u16 v47, v47, v59
    v_pk_max_u16 v49, v49, v61
    v_pk_max_u16 v50, v50, v62
    v_pk_max_u16 v52, v52, v64
    v_pk_max_u16 v53, v53, v65
    v_pk_max_u16 v55, v55, v67
    v_pk_max_u16 v56, v56, v68
    v_pk_max_u16 v46, v46, v52
    v_pk_max_u16 v47, v47, v53
    v_pk_max_u16 v49, v49, v55
    v_pk_max_u16 v50, v50, v56
    s_waitcnt vmcnt(6)
    s_waitcnt lgkmcnt(0)
    s_barrier
    ds_read2st64_b32 v[98:99], v12 offset0:0 offset1:6
    ds_read2st64_b32 v[100:101], v12 offset0:12 offset1:18
    ds_read2st64_b32 v[102:103], v12 offset0:2 offset1:8
    ds_read2st64_b32 v[104:105], v12 offset0:14 offset1:20
    ds_read2st64_b32 v[106:107], v12 offset0:4 offset1:10
    ds_read2st64_b32 v[108:109], v12 offset0:16 offset1:22
    v_pk_max_u16 v46, v46, v49
    v_pk_max_u16 v47, v47, v50
    v_pk_max_u16 v46, v46, v47
    v_lshrrev_b32 v47, 16, v46
    v_and_b32 v46, 0xffff, v46
    v_max_u32 v62, v46, v47
    s_waitcnt lgkmcnt(4)
    v_and_b32 v98, -2, v98
    buffer_store_dwordx4 v[98:101], v9, s[16:19], s95 offen sc1
    s_waitcnt lgkmcnt(2)
    v_and_b32 v102, -2, v102
    s_add_u32 s40, s95, 0x100000
    buffer_store_dwordx4 v[102:105], v9, s[16:19], s40 offen sc1
    s_waitcnt lgkmcnt(0)
    v_and_b32 v106, -2, v106
    s_add_u32 s40, s95, 0x200000
    buffer_store_dwordx4 v[106:109], v10, s[16:19], s40 offen sc1
    v_and_b32 v91, 7, v1
    v_lshlrev_b32 v91, 5, v91
    buffer_load_dword v90, v91, s[28:31], 0 offen sc1
    v_max_u32 v62, v62, v62 row_shr:1
    s_nop 1
    v_max_u32 v62, v62, v62 row_shr:2
    s_nop 1
    v_max_u32 v62, v62, v62 row_shr:4
    s_nop 1
    v_max_u32 v62, v62, v62 row_shr:8
    s_nop 1
    v_max_u32 v62, v62, v62 row_bcast:15 row_mask:0xa
    s_nop 1
    v_max_u32 v62, v62, v62 row_bcast:31 row_mask:0xc
    s_lshl_b32 s42, s32, 2
    v_mov_b32 v63, s42
    s_mov_b32 exec_lo, 0
    s_mov_b32 exec_hi, 0x80000000
    ds_write_b32 v63, v62 offset:12416
    s_mov_b64 exec, -1
    v_mov_b32 v8, 0
    v_accvgpr_read_b32 v96, a250
    s_waitcnt lgkmcnt(0)
    s_barrier
    ds_read_b128 v[92:95], v8 offset:12416
    v_add_u32 v6, 8192, v3
    s_waitcnt lgkmcnt(0)
    v_max3_u32 v92, v92, v93, v94
    v_max_u32 v92, v92, v95
    buffer_store_dword v92, v96, s[16:19], 0 offen sc1
    v_add_u32 v8, 131072, v3
    ds_read_b128 a[128:131], v8 offset:0
    ds_read_b128 a[132:135], v8 offset:1024
    ds_read_b128 a[136:139], v8 offset:2048
    ds_read_b128 a[140:143], v8 offset:3072
    ds_read_b128 a[144:147], v8 offset:4096
    ds_read_b128 a[148:151], v8 offset:5120
    ds_read_b128 a[152:155], v8 offset:6144
    ds_read_b128 a[156:159], v8 offset:7168
    ds_read_b128 a[160:163], v8 offset:8192
    ds_read_b128 a[164:167], v8 offset:9216
    ds_read_b128 a[168:171], v8 offset:10240
    ds_read_b128 a[172:175], v8 offset:11264
    ds_read_b128 a[176:179], v8 offset:12288
    ds_read_b128 a[180:183], v8 offset:13312
    s_cmp_lt_u32 s2, 95
    s_cbranch_scc1 pk_idle
    v_cvt_f32_u32 v78, v5
    v_cvt_f32_u32 v70, v4
    v_add_f32 v78, 1.0, v78
    v_mul_f32 v78, 0x3d000000, v78
    v_add_f32 v79, 0.5, v78
    v_mul_f32 v70, 4.0, v70
    s_lshl_b32 s45, s32, 4
    v_cvt_f32_u32 v71, s45
    v_add_f32 v71, v71, v70
    v_mul_f32 v80, v70, v78
    v_mul_f32 v82, 0xbc800000, v78
    v_mul_f32 v84, v71, v82
    v_mul_f32 v81, v70, v79
    v_mul_f32 v83, 0xbc800000, v79
    v_mul_f32 v85, v71, v83
    v_mov_b32 v70, v80
    v_fmamk_f32 v72, v78, 0x3f800000, v80
    v_fmamk_f32 v74, v78, 0x40000000, v80
    v_fmamk_f32 v76, v78, 0x40400000, v80
    v_sin_f32 v71, v70
    s_add_u32 m0, s88, 38016
    s_add_u32 s90, s52, 27648
    buffer_load_dwordx4 v156, s[8:11], s90 offen lds
    v_cos_f32 v70, v70
    v_sin_f32 v73, v72
    v_cos_f32 v72, v72
    v_sin_f32 v75, v74
    v_cos_f32 v74, v74
    s_add_u32 m0, s88, 42240
    s_nop 0
    buffer_load_dwordx4 v156, s[8:11], s56 offen lds
    v_sin_f32 v77, v76
    v_cos_f32 v76, v76
    v_cvt_pk_f16_f32 v192, v70, v71
    v_cvt_pk_f16_f32 v196, -v71, v70
    v_cvt_pk_f16_f32 v193, v72, v73
    v_cvt_pk_f16_f32 v197, -v73, v72
    v_cvt_pk_f16_f32 v194, v74, v75
    v_cvt_pk_f16_f32 v198, -v75, v74
    v_cvt_pk_f16_f32 v195, v76, v77
    v_cvt_pk_f16_f32 v199, -v77, v76
    v_mov_b32 v70, v81
    v_fmamk_f32 v72, v79, 0x3f800000, v81
    v_fmamk_f32 v74, v79, 0x40000000, v81
    v_fmamk_f32 v76, v79, 0x40400000, v81
    s_add_u32 m0, s88, 46464
    s_add_u32 s90, s56, 27648
    buffer_load_dwordx4 v156, s[8:11], s90 offen lds
    v_sin_f32 v71, v70
    v_cos_f32 v70, v70
    v_sin_f32 v73, v72
    v_cos_f32 v72, v72
    v_sin_f32 v75, v74
    s_add_u32 m0, s88, 50688
    s_nop 0
    buffer_load_dwordx4 v156, s[8:11], s57 offen lds
    v_cos_f32 v74, v74
    v_sin_f32 v77, v76
    v_cos_f32 v76, v76
    v_cvt_pk_f16_f32 v200, v70, v71
    v_cvt_pk_f16_f32 v204, -v71, v70
    v_cvt_pk_f16_f32 v201, v72, v73
    v_cvt_pk_f16_f32 v205, -v73, v72
    v_cvt_pk_f16_f32 v202, v74, v75
    v_cvt_pk_f16_f32 v206, -v75, v74
    v_cvt_pk_f16_f32 v203, v76, v77
    v_cvt_pk_f16_f32 v207, -v77, v76
    s_add_u32 m0, s88, 54912
    s_add_u32 s90, s57, 27648
    buffer_load_dwordx4 v156, s[8:11], s90 offen lds
    v_fmamk_f32 v70, v78, 0x41800000, v80
    v_fmamk_f32 v72, v78, 0x41880000, v80
    v_fmamk_f32 v74, v78, 0x41900000, v80
    v_fmamk_f32 v76, v78, 0x41980000, v80
    v_sin_f32 v71, v70
    v_cos_f32 v70, v70
    v_sin_f32 v73, v72
    v_cos_f32 v72, v72
    s_add_u32 m0, s88, 59136
    s_nop 0
    buffer_load_dwordx4 v156, s[8:11], s58 offen lds
    v_sin_f32 v75, v74
    v_cos_f32 v74, v74
    v_sin_f32 v77, v76
    v_cos_f32 v76, v76
    v_cvt_pk_f16_f32 v208, v70, v71
    v_cvt_pk_f16_f32 v212, -v71, v70
    v_cvt_pk_f16_f32 v209, v72, v73
    v_cvt_pk_f16_f32 v213, -v73, v72
    v_cvt_pk_f16_f32 v210, v74, v75
    v_cvt_pk_f16_f32 v214, -v75, v74
    v_cvt_pk_f16_f32 v211, v76, v77
    v_cvt_pk_f16_f32 v215, -v77, v76
    v_fmamk_f32 v70, v79, 0x41800000, v81
    v_fmamk_f32 v72, v79, 0x41880000, v81
    v_fmamk_f32 v74, v79, 0x41900000, v81
    v_fmamk_f32 v76, v79, 0x41980000, v81
    v_sin_f32 v71, v70
    v_cos_f32 v70, v70
    v_sin_f32 v73, v72
    v_cos_f32 v72, v72
    v_sin_f32 v75, v74
    v_cos_f32 v74, v74
    v_sin_f32 v77, v76
    v_cos_f32 v76, v76
    v_cvt_pk_f16_f32 v216, v70, v71
    v_cvt_pk_f16_f32 v220, -v71, v70
    v_cvt_pk_f16_f32 v217, v72, v73
    v_cvt_pk_f16_f32 v221, -v73, v72
    v_cvt_pk_f16_f32 v218, v74, v75
    v_cvt_pk_f16_f32 v222, -v75, v74
    v_cvt_pk_f16_f32 v219, v76, v77
    v_cvt_pk_f16_f32 v223, -v77, v76
    v_mov_b32 v70, v84
    v_fmamk_f32 v72, v82, 0x3f800000, v84
    v_fmamk_f32 v74, v82, 0x40000000, v84
    v_fmamk_f32 v76, v82, 0x40400000, v84
    v_sin_f32 v71, v70
    v_cos_f32 v70, v70
    v_sin_f32 v73, v72
    v_cos_f32 v72, v72
    v_sin_f32 v75, v74
    v_cos_f32 v74, v74
    v_sin_f32 v77, v76
    v_cos_f32 v76, v76
    v_mul_f32 v240, 0x3cb504f3, v70
    v_mul_f32 v241, 0x3cb504f3, v71
    v_mul_f32 v242, 0x3cb504f3, v72
    v_mul_f32 v243, 0x3cb504f3, v73
    v_mul_f32 v244, 0x3cb504f3, v74
    v_mul_f32 v245, 0x3cb504f3, v75
    v_mul_f32 v246, 0x3cb504f3, v76
    v_mul_f32 v247, 0x3cb504f3, v77
    v_mov_b32 v70, v85
    v_fmamk_f32 v72, v83, 0x3f800000, v85
    v_fmamk_f32 v74, v83, 0x40000000, v85
    v_fmamk_f32 v76, v83, 0x40400000, v85
    v_sin_f32 v71, v70
    v_cos_f32 v70, v70
    v_sin_f32 v73, v72
    v_cos_f32 v72, v72
    v_sin_f32 v75, v74
    v_cos_f32 v74, v74
    v_sin_f32 v77, v76
    v_cos_f32 v76, v76
    v_mul_f32 v248, 0x3cb504f3, v70
    v_mul_f32 v249, 0x3cb504f3, v71
    v_mul_f32 v250, 0x3cb504f3, v72
    v_mul_f32 v251, 0x3cb504f3, v73
    v_mul_f32 v252, 0x3cb504f3, v74
    v_mul_f32 v253, 0x3cb504f3, v75
    v_mul_f32 v254, 0x3cb504f3, v76
    v_mul_f32 v255, 0x3cb504f3, v77
    s_waitcnt vmcnt(7)
    v_and_b32 v89, 0xff, v90
    v_cmp_ne_u32 vcc, 32, v89
    s_cmp_lg_u64 vcc, 0
    s_cbranch_scc1 pk_n1_s
pk_n1_r:
    s_and_b32 s45, s2, 7
    v_readlane_b32 s45, v90, s45
    s_cmp_eq_u32 s45, s0
    s_cselect_b32 s1, 1, 0
    buffer_load_dwordx4 v[112:115], v144, s[16:19], s92 offen offset:0 sc1
    buffer_load_dwordx4 v[116:119], v144, s[16:19], s92 offen offset:2048 sc1
    buffer_load_dwordx4 v[120:123], v145, s[16:19], s92 offen offset:0 sc1
    buffer_load_dwordx4 v[124:127], v145, s[16:19], s92 offen offset:2048 sc1
    s_lshl_b32 s38, s32, 11
    v_add_u32 v7, s38, v3
    v_add_u32 v8, 147456, v3
    s_lshl_b32 s38, s32, 12
    v_add_u32 v2, s38, v8
    s_waitcnt vmcnt(0)
    v_max3_u32 v9, v112, v116, v120
    v_max_u32 v9, v9, v124
    v_cmp_eq_u32 vcc, -1, v9
    s_cbranch_vccz pk_c2_r
pk_c2_s:
    s_nop 7
    s_nop 7
    s_mov_b32 s47, 0
pk_c2_l:
    s_mov_b64 exec, vcc
    buffer_load_dwordx4 v[112:115], v144, s[16:19], s92 offen offset:0 sc1
    buffer_load_dwordx4 v[116:119], v144, s[16:19], s92 offen offset:2048 sc1
    buffer_load_dwordx4 v[120:123], v145, s[16:19], s92 offen offset:0 sc1
    buffer_load_dwordx4 v[124:127], v145, s[16:19], s92 offen offset:2048 sc1
    s_add_u32 s47, s47, 1
    s_waitcnt vmcnt(0)
    v_max3_u32 v9, v112, v116, v120
    v_max_u32 v9, v9, v124
    v_cmp_eq_u32 vcc, -1, v9
    s_cmp_eq_u64 vcc, 0
    s_cbranch_scc1 pk_c2_x
    s_cmp_lt_u32 s47, 0x2000
    s_cbranch_scc1 pk_c2_l
pk_c2_x:
    s_mov_b64 exec, -1
    s_nop 4
pk_c2_r:
    ds_write_b128 v2, v[112:115] offset:0
    ds_write_b128 v2, v[116:119] offset:1024
    ds_write_b128 v2, v[120:123] offset:2048
    ds_write_b128 v2, v[124:127] offset:3072
    s_waitcnt lgkmcnt(0)
    s_barrier
    ds_read_b128 v[16:19], v8 offset:0
    ds_read_b128 v[20:23], v8 offset:1024
    ds_read_b128 v[24:27], v8 offset:2048
    ds_read_b128 v[28:31], v8 offset:3072
    ds_read_b128 v[32:35], v8 offset:4096
    ds_read_b128 v[36:39], v8 offset:5120
    ds_read_b128 v[40:43], v8 offset:6144
    ds_read_b128 v[44:47], v8 offset:7168
    ds_read_b128 v[48:51], v8 offset:8192
    ds_read_b128 v[52:55], v8 offset:9216
    ds_read_b128 v[56:59], v8 offset:10240
    ds_read_b128 v[60:63], v8 offset:11264
    ds_read_b128 v[64:67], v8 offset:12288
    ds_read_b128 v[68:71], v8 offset:13312
    ds_read_b128 v[72:75], v8 offset:14336
    ds_read_b128 v[76:79], v8 offset:15360
    s_lshl_b32 s41, s2, 7
    s_add_u32 s41, s41, 0x289000
    s_xor_b32 s54, s41, 1024
    s_cmp_eq_u32 s2, 95
    s_cselect_b32 s54, s41, s54
    v_mov_b32 v9, 0
    s_cmp_eq_u32 s32, 0
    s_cselect_b64 exec, 1, 0
    s_cmp_lg_u32 s1, 0
    s_cbranch_scc0 pk_w3_s
    buffer_store_dword v9, v9, s[16:19], s41 offen
pk_w3_r:
    s_mov_b64 exec, -1
    s_and_b32 s41, s92, 64
    s_andn2_b32 s92, s92, 0x7fff
    s_lshl_b32 s41, s41, 8
    s_add_u32 s92, s92, s41
    s_lshl_b32 s41, s32, 12
    s_add_u32 s92, s92, s41
    s_mov_b32 s40, 0x288000
    buffer_load_dwordx4 v[12:15], v3, s[16:19], s40 offen sc1
    buffer_load_dwordx4 v[128:131], v144, s[16:19], s93 offen sc1
    s_add_u32 s93, s93, 8192
    buffer_load_dwordx4 v[132:135], v144, s[16:19], s93 offen sc1
    s_add_u32 s93, s93, 8192
    buffer_load_dwordx4 v[136:139], v144, s[16:19], s93 offen sc1
    s_add_u32 s93, s93, 8192
    buffer_load_dwordx4 v[140:143], v144, s[16:19], s93 offen sc1
    s_lshl_b32 s41, s2, 2
    s_add_u32 s41, s41, s32
    s_sub_u32 s41, s41, 380
    s_mul_i32 s41, s41, 10112
    s_add_u32 s41, s41, 0x1600000
    s_add_u32 s42, s41, 4096
    s_mov_b32 s53, s41
    s_mov_b32 s55, s42
    s_andn2_b32 s44, 7, s2
    s_lshl_b32 s44, s44, 5
    s_lshr_b32 s45, s2, 3
    s_add_u32 s44, s44, s45
    s_lshl_b32 s44, s44, 2
    s_add_u32 s44, s44, s32
    s_lshl_b32 s44, s44, 13
    s_mov_b32 s45, 3
    s_bitcmp1_b32 s45, s32
    s_cselect_b32 s44, s44, 0x7f000000
    v_lshlrev_b32 v10, 7, v1
    v_add_u32 v10, s44, v10
    s_waitcnt lgkmcnt(12)
    v_mfma_f32_16x16x32_f16 v[80:83], v[16:19], v[160:163], 0
    v_mfma_f32_16x16x32_f16 v[84:87], v[16:19], v[164:167], 0
    v_mfma_f32_16x16x32_f16 v[88:91], v[20:23], v[160:163], 0
    v_mfma_f32_16x16x32_f16 v[92:95], v[20:23], v[164:167], 0
    v_mfma_f32_16x16x32_f16 v[96:99], v[24:27], v[160:163], 0
    s_add_u32 m0, s88, 63360
    s_add_u32 s90, s58, 27648
    buffer_load_dwordx4 v156, s[8:11], s90 offen lds
    v_mfma_f32_16x16x32_f16 v[100:103], v[24:27], v[164:167], 0
    v_mfma_f32_16x16x32_f16 v[104:107], v[28:31], v[160:163], 0
    v_mfma_f32_16x16x32_f16 v[108:111], v[28:31], v[164:167], 0
    s_waitcnt lgkmcnt(8)
    v_mfma_f32_16x16x32_f16 v[80:83], v[32:35], v[168:171], v[80:83]
    v_mfma_f32_16x16x32_f16 v[84:87], v[32:35], v[172:175], v[84:87]
    s_add_u32 m0, s88, 67584
    s_mov_b32 s90, 442368
    buffer_load_dwordx4 v157, s[8:11], s90 offen lds
    v_mfma_f32_16x16x32_f16 v[88:91], v[36:39], v[168:171], v[88:91]
    v_mfma_f32_16x16x32_f16 v[92:95], v[36:39], v[172:175], v[92:95]
    v_mfma_f32_16x16x32_f16 v[96:99], v[40:43], v[168:171], v[96:99]
    v_mfma_f32_16x16x32_f16 v[100:103], v[40:43], v[172:175], v[100:103]
    v_mfma_f32_16x16x32_f16 v[104:107], v[44:47], v[168:171], v[104:107]
    s_add_u32 m0, s88, 71808
    s_mov_b32 s90, 995328
    buffer_load_dwordx4 v157, s[8:11], s90 offen lds
    v_mfma_f32_16x16x32_f16 v[108:111], v[44:47], v[172:175], v[108:111]
    s_waitcnt lgkmcnt(4)
    v_mfma_f32_16x16x32_f16 v[80:83], v[48:51], v[176:179], v[80:83]
    v_mfma_f32_16x16x32_f16 v[84:87], v[48:51], v[180:183], v[84:87]
    v_mfma_f32_16x16x32_f16 v[88:91], v[52:55], v[176:179], v[88:91]
    v_mfma_f32_16x16x32_f16 v[92:95], v[52:55], v[180:183], v[92:95]
    s_add_u32 m0, s88, 76032
    s_mov_b32 s90, 1548288
    buffer_load_dwordx4 v157, s[8:11], s90 offen lds
    v_mfma_f32_16x16x32_f16 v[96:99], v[56:59], v[176:179], v[96:99]
    v_mfma_f32_16x16x32_f16 v[100:103], v[56:59], v[180:183], v[100:103]
    v_mfma_f32_16x16x32_f16 v[104:107], v[60:63], v[176:179], v[104:107]
    v_mfma_f32_16x16x32_f16 v[108:111], v[60:63], v[180:183], v[108:111]
    s_waitcnt lgkmcnt(0)
    v_mfma_f32_16x16x32_f16 v[80:83], v[64:67], v[184:187], v[80:83]
    s_add_u32 m0, s88, 80256
    s_mov_b32 s90, 2101248
    buffer_load_dwordx4 v157, s[8:11], s90 offen lds
    v_mfma_f32_16x16x32_f16 v[84:87], v[64:67], v[188:191], v[84:87]
    v_mfma_f32_16x16x32_f16 v[88:91], v[68:71], v[184:187], v[88:91]
    v_mfma_f32_16x16x32_f16 v[92:95], v[68:71], v[188:191], v[92:95]
    v_mfma_f32_16x16x32_f16 v[96:99], v[72:75], v[184:187], v[96:99]
    v_mfma_f32_16x16x32_f16 v[100:103], v[72:75], v[188:191], v[100:103]
    s_add_u32 m0, s88, 0
    s_nop 0
    buffer_load_dwordx4 v156, s[8:11], s48 offen lds
    v_mfma_f32_16x16x32_f16 v[104:107], v[76:79], v[184:187], v[104:107]
    v_mfma_f32_16x16x32_f16 v[108:111], v[76:79], v[188:191], v[108:111]
    v_mul_f32 v16, v84, v225
    v_mul_f32 v17, v84, v224
    v_mul_f32 v18, v86, v227
    v_mul_f32 v19, v86, v226
    v_mul_f32 v20, v92, v229
    v_mul_f32 v21, v92, v228
    v_mul_f32 v22, v94, v231
    v_mul_f32 v23, v94, v230
    v_fma_mixlo_f16 v112, v80, v224, -v16
    v_fma_mixlo_f16 v113, v82, v226, -v18
    s_add_u32 m0, s88, 4224
    s_add_u32 s90, s48, 27648
    buffer_load_dwordx4 v156, s[8:11], s90 offen lds
    v_fma_mixlo_f16 v114, v88, v228, -v20
    v_fma_mixlo_f16 v115, v90, v230, -v22
    v_fma_mixhi_f16 v112, v80, v225, v17
    v_fma_mixhi_f16 v113, v82, v227, v19
    v_fma_mixhi_f16 v114, v88, v229, v21
    v_fma_mixhi_f16 v115, v90, v231, v23
    v_mul_f32 v16, v100, v233
    v_mul_f32 v17, v100, v232
    v_mul_f32 v18, v102, v235
    v_mul_f32 v19, v102, v234
    v_mul_f32 v20, v108, v237
    v_mul_f32 v21, v108, v236
    v_mul_f32 v22, v110, v239
    v_mul_f32 v23, v110, v238
    v_fma_mixlo_f16 v116, v96, v232, -v16
    v_fma_mixlo_f16 v117, v98, v234, -v18
    v_fma_mixlo_f16 v118, v104, v236, -v20
    v_fma_mixlo_f16 v119, v106, v238, -v22
    s_add_u32 m0, s88, 8448
    s_nop 0
    buffer_load_dwordx4 v156, s[8:11], s49 offen lds
    v_fma_mixhi_f16 v116, v96, v233, v17
    v_fma_mixhi_f16 v117, v98, v235, v19
    v_fma_mixhi_f16 v118, v104, v237, v21
    v_fma_mixhi_f16 v119, v106, v239, v23
    v_mul_f32 v16, v85, v225
    v_mul_f32 v17, v85, v224
    v_mul_f32 v18, v87, v227
    v_mul_f32 v19, v87, v226
    v_mul_f32 v20, v93, v229
    v_mul_f32 v21, v93, v228
    v_mul_f32 v22, v95, v231
    v_mul_f32 v23, v95, v230
    v_fma_mixlo_f16 v120, v81, v224, -v16
    v_fma_mixlo_f16 v121, v83, v226, -v18
    v_fma_mixlo_f16 v122, v89, v228, -v20
    v_fma_mixlo_f16 v123, v91, v230, -v22
    v_fma_mixhi_f16 v120, v81, v225, v17
    v_fma_mixhi_f16 v121, v83, v227, v19
    s_add_u32 m0, s89, 0
    s_mov_b32 exec_hi, 0xffff
    buffer_load_dwordx4 v158, s[8:11], s48 offen lds
    s_mov_b32 exec_hi, -1
    v_fma_mixhi_f16 v122, v89, v229, v21
    v_fma_mixhi_f16 v123, v91, v231, v23
    v_mul_f32 v16, v101, v233
    v_mul_f32 v17, v101, v232
    v_mul_f32 v18, v103, v235
    v_mul_f32 v19, v103, v234
    v_mul_f32 v20, v109, v237
    v_mul_f32 v21, v109, v236
    v_mul_f32 v22, v111, v239
    v_mul_f32 v23, v111, v238
    v_fma_mixlo_f16 v124, v97, v232, -v16
    v_fma_mixlo_f16 v125, v99, v234, -v18
    v_fma_mixlo_f16 v126, v105, v236, -v20
    v_fma_mixlo_f16 v127, v107, v238, -v22
    v_fma_mixhi_f16 v124, v97, v233, v17
    v_fma_mixhi_f16 v125, v99, v235, v19
    v_fma_mixhi_f16 v126, v105, v237, v21
    v_fma_mixhi_f16 v127, v107, v239, v23
    s_add_u32 m0, s89, 3072
    s_mov_b32 exec_hi, 0xffff
    s_add_u32 s90, s48, 27648
    buffer_load_dwordx4 v158, s[8:11], s90 offen lds
    s_mov_b32 exec_hi, -1
    v_mfma_f32_16x16x32_f16 v[80:83], v[192:195], v[112:115], 0
    v_mfma_f32_16x16x32_f16 v[80:83], v[208:211], v[116:119], v[80:83]
    v_mfma_f32_16x16x32_f16 v[84:87], v[196:199], v[112:115], 0
    v_mfma_f32_16x16x32_f16 v[84:87], v[212:215], v[116:119], v[84:87]
    v_mfma_f32_16x16x32_f16 v[88:91], v[200:203], v[112:115], 0
    buffer_load_dword a255, v10, s[24:27], 0 offen
    v_mfma_f32_16x16x32_f16 v[88:91], v[216:219], v[116:119], v[88:91]
    v_mfma_f32_16x16x32_f16 v[92:95], v[204:207], v[112:115], 0
    v_mfma_f32_16x16x32_f16 v[92:95], v[220:223], v[116:119], v[92:95]
    v_mfma_f32_16x16x32_f16 v[96:99], v[192:195], v[120:123], 0
    v_mfma_f32_16x16x32_f16 v[96:99], v[208:211], v[124:127], v[96:99]
    s_waitcnt vmcnt(15)
    v_max3_u32 v9, v12, v13, v14
    v_max_u32 v9, v9, v15
    v_cmp_eq_u32 vcc, -1, v9
    s_cbranch_vccnz pk_c4_s
pk_c4_r:
    v_mfma_f32_16x16x32_f16 v[100:103], v[196:199], v[120:123], 0
    v_mfma_f32_16x16x32_f16 v[100:103], v[212:215], v[124:127], v[100:103]
    v_max_u32 v9, v9, v9 row_shr:1
    s_nop 1
    v_max_u32 v9, v9, v9 row_shr:2
    s_nop 1
    v_max_u32 v9, v9, v9 row_shr:4
    s_nop 1
    v_max_u32 v9, v9, v9 row_shr:8
    s_nop 1
    v_max_u32 v9, v9, v9 row_bcast:15 row_mask:0xa
    s_nop 1
    v_max_u32 v9, v9, v9 row_bcast:31 row_mask:0xc
    s_nop 0
    v_readlane_b32 s41, v9, 63
    s_lshr_b32 s41, s41, 7
    s_sub_i32 s41, 253, s41
    s_max_i32 s41, s41, 1
    s_lshl_b32 s42, s41, 7
    s_lshl_b32 s43, s41, 23
    s_mov_b32 s101, s41
    v_mfma_f32_16x16x32_f16 v[104:107], v[200:203], v[120:123], 0
    v_mfma_f32_16x16x32_f16 v[104:107], v[216:219], v[124:127], v[104:107]
    v_mfma_f32_16x16x32_f16 v[108:111], v[204:207], v[120:123], 0
    v_mfma_f32_16x16x32_f16 v[108:111], v[220:223], v[124:127], v[108:111]
    s_waitcnt vmcnt(11)
    buffer_load_dword v11, off, s[16:19], s54 sc1
    v_dot2_f32_bf16 v32, v128, s42, 0
    v_dot2_f32_bf16 v33, v128, s43, 0
    v_dot2_f32_bf16 v34, v129, s42, 0
    v_dot2_f32_bf16 v35, v129, s43, 0
    v_dot2_f32_bf16 v36, v132, s42, 0
    v_dot2_f32_bf16 v37, v132, s43, 0
    v_dot2_f32_bf16 v38, v133, s42, 0
    v_dot2_f32_bf16 v39, v133, s43, 0
    v_dot2_f32_bf16 v40, v136, s42, 0
    v_dot2_f32_bf16 v41, v136, s43, 0
    v_dot2_f32_bf16 v42, v137, s42, 0
    v_dot2_f32_bf16 v43, v137, s43, 0
    v_dot2_f32_bf16 v44, v140, s42, 0
    v_dot2_f32_bf16 v45, v140, s43, 0
    v_dot2_f32_bf16 v46, v141, s42, 0
    v_dot2_f32_bf16 v47, v141, s43, 0
    v_mul_f32 v16, v84, v33
    v_mul_f32 v17, v84, v32
    v_mul_f32 v18, v85, v35
    v_mul_f32 v19, v85, v34
    v_mul_f32 v20, v86, v37
    v_mul_f32 v21, v86, v36
    v_mul_f32 v22, v87, v39
    v_mul_f32 v23, v87, v38
    v_mul_f32 v24, v92, v41
    v_mul_f32 v25, v92, v40
    v_mul_f32 v26, v93, v43
    v_mul_f32 v27, v93, v42
    v_mul_f32 v28, v94, v45
    v_mul_f32 v29, v94, v44
    v_mul_f32 v30, v95, v47
    v_mul_f32 v31, v95, v46
    v_fma_mixlo_f16 v112, v80, v32, -v16
    v_fma_mixlo_f16 v113, v81, v34, -v18
    v_fma_mixlo_f16 v114, v82, v36, -v20
    v_fma_mixlo_f16 v115, v83, v38, -v22
    v_fma_mixlo_f16 v116, v88, v40, -v24
    v_fma_mixlo_f16 v117, v89, v42, -v26
    v_fma_mixlo_f16 v118, v90, v44, -v28
    v_fma_mixlo_f16 v119, v91, v46, -v30
    v_fma_mixhi_f16 v112, v80, v33, v17
    v_fma_mixhi_f16 v113, v81, v35, v19
    v_fma_mixhi_f16 v114, v82, v37, v21
    v_fma_mixhi_f16 v115, v83, v39, v23
    v_fma_mixhi_f16 v116, v88, v41, v25
    v_fma_mixhi_f16 v117, v89, v43, v27
    v_fma_mixhi_f16 v118, v90, v45, v29
    v_fma_mixhi_f16 v119, v91, v47, v31
    v_dot2_f32_bf16 v32, v130, s42, 0
    v_dot2_f32_bf16 v33, v130, s43, 0
    v_dot2_f32_bf16 v34, v131, s42, 0
    v_dot2_f32_bf16 v35, v131, s43, 0
    v_dot2_f32_bf16 v36, v134, s42, 0
    v_dot2_f32_bf16 v37, v134, s43, 0
    v_dot2_f32_bf16 v38, v135, s42, 0
    v_dot2_f32_bf16 v39, v135, s43, 0
    v_dot2_f32_bf16 v40, v138, s42, 0
    v_dot2_f32_bf16 v41, v138, s43, 0
    v_dot2_f32_bf16 v42, v139, s42, 0
    v_dot2_f32_bf16 v43, v139, s43, 0
    v_dot2_f32_bf16 v44, v142, s42, 0
    v_dot2_f32_bf16 v45, v142, s43, 0
    v_dot2_f32_bf16 v46, v143, s42, 0
    v_dot2_f32_bf16 v47, v143, s43, 0
    v_mul_f32 v16, v100, v33
    v_mul_f32 v17, v100, v32
    v_mul_f32 v18, v101, v35
    v_mul_f32 v19, v101, v34
    v_mul_f32 v20, v102, v37
    v_mul_f32 v21, v102, v36
    v_mul_f32 v22, v103, v39
    v_mul_f32 v23, v103, v38
    v_mul_f32 v24, v108, v41
    v_mul_f32 v25, v108, v40
    v_mul_f32 v26, v109, v43
    v_mul_f32 v27, v109, v42
    v_mul_f32 v28, v110, v45
    v_mul_f32 v29, v110, v44
    v_mul_f32 v30, v111, v47
    v_mul_f32 v31, v111, v46
    v_fma_mixlo_f16 v120, v96, v32, -v16
    v_fma_mixlo_f16 v121, v97, v34, -v18
    v_fma_mixlo_f16 v122, v98, v36, -v20
    v_fma_mixlo_f16 v123, v99, v38, -v22
    v_fma_mixlo_f16 v124, v104, v40, -v24
    v_fma_mixlo_f16 v125, v105, v42, -v26
    v_fma_mixlo_f16 v126, v106, v44, -v28
    v_fma_mixlo_f16 v127, v107, v46, -v30
    v_fma_mixhi_f16 v120, v96, v33, v17
    v_fma_mixhi_f16 v121, v97, v35, v19
    v_fma_mixhi_f16 v122, v98, v37, v21
    v_fma_mixhi_f16 v123, v99, v39, v23
    v_fma_mixhi_f16 v124, v104, v41, v25
    v_fma_mixhi_f16 v125, v105, v43, v27
    v_fma_mixhi_f16 v126, v106, v45, v29
    v_fma_mixhi_f16 v127, v107, v47, v31
    v_mfma_f32_16x16x32_f16 v[80:83], v[112:115], v[192:195], 0
    v_mfma_f32_16x16x32_f16 v[80:83], v[116:119], v[208:211], v[80:83]
    v_mfma_f32_16x16x32_f16 v[84:87], v[112:115], v[196:199], 0
    v_mfma_f32_16x16x32_f16 v[84:87], v[116:119], v[212:215], v[84:87]
    v_mfma_f32_16x16x32_f16 v[88:91], v[112:115], v[200:203], 0
    v_mfma_f32_16x16x32_f16 v[88:91], v[116:119], v[216:219], v[88:91]
    v_mfma_f32_16x16x32_f16 v[92:95], v[112:115], v[204:207], 0
    v_mfma_f32_16x16x32_f16 v[92:95], v[116:119], v[220:223], v[92:95]
    v_mfma_f32_16x16x32_f16 v[96:99], v[120:123], v[192:195], 0
    v_mfma_f32_16x16x32_f16 v[96:99], v[124:127], v[208:211], v[96:99]
    v_mfma_f32_16x16x32_f16 v[100:103], v[120:123], v[196:199], 0
    v_mfma_f32_16x16x32_f16 v[100:103], v[124:127], v[212:215], v[100:103]
    v_mfma_f32_16x16x32_f16 v[104:107], v[120:123], v[200:203], 0
    v_mfma_f32_16x16x32_f16 v[104:107], v[124:127], v[216:219], v[104:107]
    v_mfma_f32_16x16x32_f16 v[108:111], v[120:123], v[204:207], 0
    v_mfma_f32_16x16x32_f16 v[108:111], v[124:127], v[220:223], v[108:111]
    v_mul_f32 v16, v84, v241
    v_mul_f32 v17, v84, v240
    v_mul_f32 v18, v85, v243
    v_mul_f32 v19, v85, v242
    v_mul_f32 v20, v86, v245
    v_mul_f32 v21, v86, v244
    v_mul_f32 v22, v87, v247
    v_mul_f32 v23, v87, v246
    v_fma_mixlo_f16 v112, v80, v240, -v16
    v_fma_mixlo_f16 v113, v81, v242, -v18
    v_fma_mixlo_f16 v114, v82, v244, -v20
    v_fma_mixlo_f16 v115, v83, v246, -v22
    v_fma_mixhi_f16 v112, v80, v241, v17
    v_fma_mixhi_f16 v113, v81, v243, v19
    v_fma_mixhi_f16 v114, v82, v245, v21
    v_fma_mixhi_f16 v115, v83, v247, v23
    ds_write_b128 v7, v[112:115] offset:0
    v_mul_f32 v16, v92, v249
    v_mul_f32 v17, v92, v248
    v_mul_f32 v18, v93, v251
    v_mul_f32 v19, v93, v250
    v_mul_f32 v20, v94, v253
    v_mul_f32 v21, v94, v252
    v_mul_f32 v22, v95, v255
    v_mul_f32 v23, v95, v254
    v_fma_mixlo_f16 v116, v88, v248, -v16
    v_fma_mixlo_f16 v117, v89, v250, -v18
    v_fma_mixlo_f16 v118, v90, v252, -v20
    v_fma_mixlo_f16 v119, v91, v254, -v22
    v_fma_mixhi_f16 v116, v88, v249, v17
    v_fma_mixhi_f16 v117, v89, v251, v19
    v_fma_mixhi_f16 v118, v90, v253, v21
    v_fma_mixhi_f16 v119, v91, v255, v23
    ds_write_b128 v7, v[116:119] offset:1024
    v_mul_f32 v16, v100, v241
    v_mul_f32 v17, v100, v240
    v_mul_f32 v18, v101, v243
    v_mul_f32 v19, v101, v242
    v_mul_f32 v20, v102, v245
    v_mul_f32 v21, v102, v244
    v_mul_f32 v22, v103, v247
    v_mul_f32 v23, v103, v246
    v_fma_mixlo_f16 v120, v96, v240, -v16
    v_fma_mixlo_f16 v121, v97, v242, -v18
    v_fma_mixlo_f16 v122, v98, v244, -v20
    v_fma_mixlo_f16 v123, v99, v246, -v22
    v_fma_mixhi_f16 v120, v96, v241, v17
    v_fma_mixhi_f16 v121, v97, v243, v19
    v_fma_mixhi_f16 v122, v98, v245, v21
    v_fma_mixhi_f16 v123, v99, v247, v23
    ds_write_b128 v7, v[120:123] offset:8192
    v_mul_f32 v16, v108, v249
    v_mul_f32 v17, v108, v248
    v_mul_f32 v18, v109, v251
    v_mul_f32 v19, v109, v250
    v_mul_f32 v20, v110, v253
    v_mul_f32 v21, v110, v252
    v_mul_f32 v22, v111, v255
    v_mul_f32 v23, v111, v254
    v_fma_mixlo_f16 v124, v104, v248, -v16
    v_fma_mixlo_f16 v125, v105, v250, -v18
    v_fma_mixlo_f16 v126, v106, v252, -v20
    v_fma_mixlo_f16 v127, v107, v254, -v22
    v_fma_mixhi_f16 v124, v104, v249, v17
    v_fma_mixhi_f16 v125, v105, v251, v19
    v_fma_mixhi_f16 v126, v106, v253, v21
    v_fma_mixhi_f16 v127, v107, v255, v23
    ds_write_b128 v7, v[124:127] offset:9216
    s_waitcnt lgkmcnt(0)
    s_barrier
    ds_read_b128 v[16:19], v3 offset:0
    ds_read_b128 v[20:23], v3 offset:2048
    ds_read_b128 v[24:27], v3 offset:4096
    ds_read_b128 v[28:31], v3 offset:6144
    ds_read_b128 v[32:35], v3 offset:8192
    ds_read_b128 v[36:39], v3 offset:10240
    ds_read_b128 v[40:43], v3 offset:12288
    ds_read_b128 v[44:47], v3 offset:14336
    ds_read_b128 v[48:51], v3 offset:1024
    ds_read_b128 v[52:55], v3 offset:3072
    ds_read_b128 v[56:59], v3 offset:5120
    ds_read_b128 v[60:63], v3 offset:7168
    ds_read_b128 v[64:67], v3 offset:9216
    ds_read_b128 v[68:71], v3 offset:11264
    ds_read_b128 v[72:75], v3 offset:13312
    ds_read_b128 v[76:79], v3 offset:15360
    s_waitcnt lgkmcnt(12)
    v_mfma_f32_16x16x32_f16 v[80:83], v[160:163], v[16:19], 0
    v_mfma_f32_16x16x32_f16 v[84:87], v[164:167], v[16:19], 0
    v_mfma_f32_16x16x32_f16 v[80:83], v[168:171], v[20:23], v[80:83]
    v_mfma_f32_16x16x32_f16 v[84:87], v[172:175], v[20:23], v[84:87]
    v_mfma_f32_16x16x32_f16 v[80:83], v[176:179], v[24:27], v[80:83]
    v_mfma_f32_16x16x32_f16 v[84:87], v[180:183], v[24:27], v[84:87]
    v_mfma_f32_16x16x32_f16 v[80:83], v[184:187], v[28:31], v[80:83]
    v_mfma_f32_16x16x32_f16 v[84:87], v[188:191], v[28:31], v[84:87]
    s_waitcnt lgkmcnt(8)
    v_mfma_f32_16x16x32_f16 v[96:99], v[160:163], v[32:35], 0
    v_mfma_f32_16x16x32_f16 v[100:103], v[164:167], v[32:35], 0
    v_mfma_f32_16x16x32_f16 v[96:99], v[168:171], v[36:39], v[96:99]
    v_mfma_f32_16x16x32_f16 v[100:103], v[172:175], v[36:39], v[100:103]
    v_mfma_f32_16x16x32_f16 v[96:99], v[176:179], v[40:43], v[96:99]
    v_mfma_f32_16x16x32_f16 v[100:103], v[180:183], v[40:43], v[100:103]
    v_mfma_f32_16x16x32_f16 v[96:99], v[184:187], v[44:47], v[96:99]
    v_mfma_f32_16x16x32_f16 v[100:103], v[188:191], v[44:47], v[100:103]
    s_waitcnt lgkmcnt(4)
    v_mfma_f32_16x16x32_f16 v[88:91], v[160:163], v[48:51], 0
    v_mfma_f32_16x16x32_f16 v[92:95], v[164:167], v[48:51], 0
    v_mfma_f32_16x16x32_f16 v[88:91], v[168:171], v[52:55], v[88:91]
    v_mfma_f32_16x16x32_f16 v[92:95], v[172:175], v[52:55], v[92:95]
    v_mfma_f32_16x16x32_f16 v[88:91], v[176:179], v[56:59], v[88:91]
    v_mfma_f32_16x16x32_f16 v[92:95], v[180:183], v[56:59], v[92:95]
    v_mfma_f32_16x16x32_f16 v[88:91], v[184:187], v[60:63], v[88:91]
    v_mfma_f32_16x16x32_f16 v[92:95], v[188:191], v[60:63], v[92:95]
    s_waitcnt lgkmcnt(0)
    v_mfma_f32_16x16x32_f16 v[104:107], v[160:163], v[64:67], 0
    v_mfma_f32_16x16x32_f16 v[108:111], v[164:167], v[64:67], 0
    v_mfma_f32_16x16x32_f16 v[104:107], v[168:171], v[68:71], v[104:107]
    v_mfma_f32_16x16x32_f16 v[108:111], v[172:175], v[68:71], v[108:111]
    v_mfma_f32_16x16x32_f16 v[104:107], v[176:179], v[72:75], v[104:107]
    v_mfma_f32_16x16x32_f16 v[108:111], v[180:183], v[72:75], v[108:111]
    v_mfma_f32_16x16x32_f16 v[104:107], v[184:187], v[76:79], v[104:107]
    v_mfma_f32_16x16x32_f16 v[108:111], v[188:191], v[76:79], v[108:111]
    s_waitcnt vmcnt(0)
    v_cmp_eq_u32 vcc, -1, v11
    s_cbranch_vccnz pk_c5_s
pk_c5_r:
    v_cvt_pk_f16_f32 v112, v80, v84
    v_cvt_pk_f16_f32 v113, v81, v85
    v_cvt_pk_f16_f32 v114, v96, v100
    v_cvt_pk_f16_f32 v115, v97, v101
    v_or_b32 v112, 1, v112
    buffer_store_dwordx4 v[112:115], v3, s[16:19], s92 offen offset:0 sc1
    v_cvt_pk_f16_f32 v116, v82, v86
    v_cvt_pk_f16_f32 v117, v83, v87
    v_cvt_pk_f16_f32 v118, v98, v102
    v_cvt_pk_f16_f32 v119, v99, v103
    v_or_b32 v116, 1, v116
    buffer_store_dwordx4 v[116:119], v3, s[16:19], s92 offen offset:1024 sc1
    v_cvt_pk_f16_f32 v120, v88, v92
    v_cvt_pk_f16_f32 v121, v89, v93
    v_cvt_pk_f16_f32 v122, v104, v108
    v_cvt_pk_f16_f32 v123, v105, v109
    v_or_b32 v120, 1, v120
    buffer_store_dwordx4 v[120:123], v3, s[16:19], s92 offen offset:2048 sc1
    v_cvt_pk_f16_f32 v124, v90, v94
    v_cvt_pk_f16_f32 v125, v91, v95
    v_cvt_pk_f16_f32 v126, v106, v110
    v_cvt_pk_f16_f32 v127, v107, v111
    v_or_b32 v124, 1, v124
    buffer_store_dwordx4 v[124:127], v3, s[16:19], s92 offen offset:3072 sc1
    s_add_u32 m0, s89, 6144
    s_mov_b32 exec_hi, 0xffff
    buffer_load_dwordx4 v158, s[8:11], s49 offen lds
    s_mov_b32 exec_hi, -1
    s_add_u32 m0, s89, 9216
    s_mov_b32 exec_hi, 0xffff
    s_add_u32 s90, s49, 27648
    buffer_load_dwordx4 v158, s[8:11], s90 offen lds
    s_mov_b32 exec_hi, -1
    s_add_u32 m0, s89, 12288
    s_mov_b32 exec_hi, 0xffff
    buffer_load_dwordx4 v158, s[8:11], s50 offen lds
    s_mov_b32 exec_hi, -1
    s_add_u32 m0, s89, 15360
    s_mov_b32 exec_hi, 0xffff
    s_add_u32 s90, s50, 27648
    buffer_load_dwordx4 v158, s[8:11], s90 offen lds
    s_mov_b32 exec_hi, -1
    s_branch pk_c
pk_idle:
    s_lshl2_add_u32 s41, s2, s32
    s_mul_i32 s41, s41, 17152
    s_min_u32 s41, s41, 6470912
    s_add_u32 s41, s41, 0x1600000
    s_add_u32 s42, s41, 0
    buffer_store_dwordx4 v[146:149], v3, s[16:19], s42 offen offset:0 sc1
    buffer_store_dwordx4 v[146:149], v3, s[16:19], s42 offen offset:1024 sc1
    buffer_store_dwordx4 v[146:149], v3, s[16:19], s42 offen offset:2048 sc1
    buffer_store_dwordx4 v[146:149], v3, s[16:19], s42 offen offset:3072 sc1
    s_add_u32 s42, s41, 4096
    buffer_store_dwordx4 v[146:149], v3, s[16:19], s42 offen offset:0 sc1
    buffer_store_dwordx4 v[146:149], v3, s[16:19], s42 offen offset:1024 sc1
    buffer_store_dwordx4 v[146:149], v3, s[16:19], s42 offen offset:2048 sc1
    buffer_store_dwordx4 v[146:149], v3, s[16:19], s42 offen offset:3072 sc1
    s_add_u32 s42, s41, 8192
    buffer_store_dwordx4 v[146:149], v3, s[16:19], s42 offen offset:0 sc1
    buffer_store_dwordx4 v[146:149], v3, s[16:19], s42 offen offset:1024 sc1
    buffer_store_dwordx4 v[146:149], v3, s[16:19], s42 offen offset:2048 sc1
    buffer_store_dwordx4 v[146:149], v3, s[16:19], s42 offen offset:3072 sc1
    s_add_u32 s42, s41, 12288
    buffer_store_dwordx4 v[146:149], v3, s[16:19], s42 offen offset:0 sc1
    buffer_store_dwordx4 v[146:149], v3, s[16:19], s42 offen offset:1024 sc1
    buffer_store_dwordx4 v[146:149], v3, s[16:19], s42 offen offset:2048 sc1
    buffer_store_dwordx4 v[146:149], v3, s[16:19], s42 offen offset:3072 sc1
    s_add_u32 s42, s41, 12288
    buffer_store_dwordx4 v[146:149], v3, s[16:19], s42 offen offset:3840 sc1
    s_lshr_b32 s33, s2, 3
    s_lshl_b32 s33, s33, 2
    s_add_u32 s33, s33, s32
    s_lshl_b32 s33, s33, 1
    s_lshr_b32 s44, s2, 3
    s_lshl_b32 s44, s44, 1
    s_and_b32 s92, s2, 1
    s_add_u32 s44, s44, s92
    s_mul_i32 s44, s44, 3
    s_add_u32 s44, s44, s32
    s_mul_i32 s92, s44, 37
    s_lshr_b32 s92, s92, 8
    s_bfe_u32 s94, s2, 0x20001
    s_xor_b32 s94, s94, 3
    s_sub_u32 s94, s94, s92
    s_mul_i32 s94, s94, 7
    s_add_u32 s94, s94, s44
    s_cmp_lt_u32 s94, 27
    s_cselect_b32 s44, s44, 99
    s_cmp_lt_u32 s32, 3
    s_cselect_b32 s44, s44, 99
    s_cmp_lt_u32 s44, 56
    s_cselect_b32 s44, 0, 0x7f000000
    s_mov_b32 s53, s44
    s_waitcnt lgkmcnt(0)
    s_barrier
    s_cmp_lg_u32 s44, 0
    s_cbranch_scc1 pk_i1
    s_mov_b64 s[88:89], s[62:63]
    s_mov_b32 s90, 0x10e000
    s_mov_b32 s91, 0x20000
    s_mul_i32 s92, s92, 160
    s_add_u32 s92, s92, s44
    s_mul_i32 s93, s94, 171
    s_lshr_b32 s93, s93, 9
    s_lshl_b32 s95, s94, 1
    s_min_u32 s93, s93, 6
    s_add_u32 s95, s95, s93
    s_mul_i32 s93, s94, 14
    s_sub_u32 s93, s93, 330
    s_cmp_lt_u32 s94, 24
    s_cselect_b32 s95, s95, s93
    s_cselect_b32 s93, 0, 122880
    s_mul_i32 s95, s95, 20480
    s_add_u32 s95, s95, s92
    v_mov_b32 v68, s93
    s_mul_i32 s45, s32, 5120
    v_add_u32 v66, 0, v1
    v_mul_u32_u24 v67, 6554, v66
    v_lshrrev_b32 v67, 16, v67
    v_mul_u32_u24 v69, 1120, v67
    v_lshl_add_u32 v69, v66, 4, v69
    v_cmp_le_u32 vcc, 16, v67
    s_nop 1
    v_cndmask_b32 v67, 0, v68, vcc
    v_add_u32 v69, v69, v67
    s_add_u32 m0, s45, 0
    s_nop 0
    buffer_load_dwordx4 v69, s[88:91], s95 offen lds
    v_add_u32 v66, 64, v1
    v_mul_u32_u24 v67, 6554, v66
    v_lshrrev_b32 v67, 16, v67
    v_mul_u32_u24 v69, 1120, v67
    v_lshl_add_u32 v69, v66, 4, v69
    v_cmp_le_u32 vcc, 16, v67
    s_nop 1
    v_cndmask_b32 v67, 0, v68, vcc
    v_add_u32 v69, v69, v67
    s_add_u32 m0, s45, 1024
    s_nop 0
    buffer_load_dwordx4 v69, s[88:91], s95 offen lds
    v_add_u32 v66, 128, v1
    v_mul_u32_u24 v67, 6554, v66
    v_lshrrev_b32 v67, 16, v67
    v_mul_u32_u24 v69, 1120, v67
    v_lshl_add_u32 v69, v66, 4, v69
    v_cmp_le_u32 vcc, 16, v67
    s_nop 1
    v_cndmask_b32 v67, 0, v68, vcc
    v_add_u32 v69, v69, v67
    s_add_u32 m0, s45, 2048
    s_nop 0
    buffer_load_dwordx4 v69, s[88:91], s95 offen lds
    v_add_u32 v66, 192, v1
    v_mul_u32_u24 v67, 6554, v66
    v_lshrrev_b32 v67, 16, v67
    v_mul_u32_u24 v69, 1120, v67
    v_lshl_add_u32 v69, v66, 4, v69
    v_cmp_le_u32 vcc, 16, v67
    s_nop 1
    v_cndmask_b32 v67, 0, v68, vcc
    v_add_u32 v69, v69, v67
    s_add_u32 m0, s45, 3072
    s_nop 0
    buffer_load_dwordx4 v69, s[88:91], s95 offen lds
    v_add_u32 v66, 256, v1
    v_mul_u32_u24 v67, 6554, v66
    v_lshrrev_b32 v67, 16, v67
    v_mul_u32_u24 v69, 1120, v67
    v_lshl_add_u32 v69, v66, 4, v69
    v_cmp_le_u32 vcc, 16, v67
    s_nop 1
    v_cndmask_b32 v67, 0, v68, vcc
    v_add_u32 v69, v69, v67
    s_add_u32 m0, s45, 4096
    s_nop 0
    buffer_load_dwordx4 v69, s[88:91], s95 offen lds
pk_i1:
    s_mul_i32 s88, s32, 1056
    s_add_u32 s88, s88, 17920
    s_mul_i32 s89, s32, 768
    s_add_u32 s89, s89, 102400
    s_add_u32 m0, s88, 38016
    s_add_u32 s90, s52, 27648
    buffer_load_dwordx4 v156, s[8:11], s90 offen lds
    s_add_u32 m0, s88, 42240
    s_nop 0
    buffer_load_dwordx4 v156, s[8:11], s56 offen lds
    s_add_u32 m0, s88, 46464
    s_add_u32 s90, s56, 27648
    buffer_load_dwordx4 v156, s[8:11], s90 offen lds
    s_add_u32 m0, s88, 50688
    s_nop 0
    buffer_load_dwordx4 v156, s[8:11], s57 offen lds
    s_waitcnt vmcnt(4)
    s_barrier
    s_lshl_b32 s41, s2, 2
    s_add_u32 s41, s41, 0x288400
    v_mov_b32 v9, 0
    s_cmp_eq_u32 s32, 3
    s_cselect_b64 exec, 1, 0
    buffer_store_dword v9, off, s[16:19], s41 sc1
    s_mov_b64 exec, -1
    s_waitcnt vmcnt(23)
    v_and_b32 v89, 0xff, v90
    v_cmp_ne_u32 vcc, 32, v89
    s_cmp_lg_u64 vcc, 0
    s_cbranch_scc1 pk_n6_s
pk_n6_r:
    s_and_b32 s45, s2, 7
    v_readlane_b32 s45, v90, s45
    s_cmp_eq_u32 s45, s0
    s_cselect_b32 s1, 1, 0
    s_mov_b32 s40, 0x288000
    buffer_load_dwordx4 v[12:15], v3, s[16:19], s40 offen sc1
    s_add_u32 m0, s88, 54912
    s_add_u32 s90, s57, 27648
    buffer_load_dwordx4 v156, s[8:11], s90 offen lds
    s_add_u32 m0, s88, 59136
    s_nop 0
    buffer_load_dwordx4 v156, s[8:11], s58 offen lds
    s_add_u32 m0, s88, 63360
    s_add_u32 s90, s58, 27648
    buffer_load_dwordx4 v156, s[8:11], s90 offen lds
    s_add_u32 m0, s88, 67584
    s_mov_b32 s90, 442368
    buffer_load_dwordx4 v157, s[8:11], s90 offen lds
    s_add_u32 m0, s88, 71808
    s_mov_b32 s90, 995328
    buffer_load_dwordx4 v157, s[8:11], s90 offen lds
    s_add_u32 m0, s88, 76032
    s_mov_b32 s90, 1548288
    buffer_load_dwordx4 v157, s[8:11], s90 offen lds
    s_add_u32 m0, s88, 80256
    s_mov_b32 s90, 2101248
    buffer_load_dwordx4 v157, s[8:11], s90 offen lds
    s_add_u32 m0, s88, 0
    s_nop 0
    buffer_load_dwordx4 v156, s[8:11], s48 offen lds
    s_add_u32 m0, s88, 4224
    s_add_u32 s90, s48, 27648
    buffer_load_dwordx4 v156, s[8:11], s90 offen lds
    s_add_u32 m0, s88, 8448
    s_nop 0
    buffer_load_dwordx4 v156, s[8:11], s49 offen lds
    s_cmp_lg_u32 s53, 0
    s_cbranch_scc1 pk_i2
    s_waitcnt vmcnt(16)
    v_lshrrev_b32 v8, 2, v1
    v_mul_u32_u24 v8, 160, v8
    v_and_b32 v9, 3, v1
    s_mul_i32 s44, s32, 5120
    v_add_u32 v8, s44, v8
    v_lshl_add_u32 v16, v9, 3, v8
    v_lshl_add_u32 v8, v9, 4, v8
    v_mov_b32 v9, v16
    ds_read_b64_tr_b16 v[16:17], v8 offset:0
    ds_read_b64_tr_b16 v[18:19], v8 offset:2560
    ds_read_b64_tr_b16 v[20:21], v8 offset:8
    ds_read_b64_tr_b16 v[22:23], v8 offset:2568
    ds_read_b64_tr_b16 v[24:25], v8 offset:64
    ds_read_b64_tr_b16 v[26:27], v8 offset:2624
    ds_read_b64_tr_b16 v[28:29], v8 offset:72
    ds_read_b64_tr_b16 v[30:31], v8 offset:2632
    ds_read_b64_tr_b16 v[32:33], v9 offset:128
    ds_read_b64_tr_b16 v[34:35], v9 offset:2688
    s_lshr_b32 s44, s2, 3
    s_lshl_b32 s44, s44, 1
    s_and_b32 s92, s2, 1
    s_add_u32 s44, s44, s92
    s_mul_i32 s44, s44, 3
    s_add_u32 s44, s44, s32
    s_mul_i32 s92, s44, 37
    s_lshr_b32 s92, s92, 8
    s_bfe_u32 s94, s2, 0x20001
    s_xor_b32 s94, s94, 3
    s_sub_u32 s94, s94, s92
    s_mul_i32 s94, s94, 7
    s_add_u32 s94, s94, s44
    s_cmp_lt_u32 s94, 27
    s_cselect_b32 s44, s44, 99
    s_cmp_lt_u32 s32, 3
    s_cselect_b32 s44, s44, 99
    s_cmp_lt_u32 s44, 56
    s_cselect_b32 s44, 0, 0x7f000000
    s_mul_i32 s92, s92, 27
    s_add_u32 s92, s92, s94
    s_mul_i32 s92, s92, 5120
    s_add_u32 s44, s44, s92
    s_add_u32 s44, s44, 0x1000000
    s_add_u32 s45, s44, 4096
    s_waitcnt lgkmcnt(0)
    buffer_store_dwordx4 v[16:19], v3, s[16:19], s44 offen offset:0 sc1
    buffer_store_dwordx4 v[20:23], v3, s[16:19], s44 offen offset:1024 sc1
    buffer_store_dwordx4 v[24:27], v3, s[16:19], s44 offen offset:2048 sc1
    buffer_store_dwordx4 v[28:31], v3, s[16:19], s44 offen offset:3072 sc1
    buffer_store_dwordx4 v[32:35], v3, s[16:19], s45 offen offset:0 sc1
    s_nop 1
pk_i2:
    s_andn2_b32 s44, 7, s2
    s_lshl_b32 s44, s44, 5
    s_lshr_b32 s45, s2, 3
    s_add_u32 s44, s44, s45
    s_lshl_b32 s44, s44, 2
    s_add_u32 s44, s44, s32
    s_lshl_b32 s44, s44, 13
    s_mov_b32 s45, 3
    s_bitcmp1_b32 s45, s32
    s_cselect_b32 s44, s44, 0x7f000000
    v_lshlrev_b32 v8, 7, v1
    v_add_u32 v8, s44, v8
    buffer_load_dword a255, v8, s[24:27], 0 offen
    s_add_u32 m0, s89, 0
    s_mov_b32 exec_hi, 0xffff
    buffer_load_dwordx4 v158, s[8:11], s48 offen lds
    s_mov_b32 exec_hi, -1
    s_add_u32 m0, s89, 3072
    s_mov_b32 exec_hi, 0xffff
    s_add_u32 s90, s48, 27648
    buffer_load_dwordx4 v158, s[8:11], s90 offen lds
    s_mov_b32 exec_hi, -1
    s_add_u32 m0, s89, 6144
    s_mov_b32 exec_hi, 0xffff
    buffer_load_dwordx4 v158, s[8:11], s49 offen lds
    s_mov_b32 exec_hi, -1
    s_add_u32 m0, s89, 9216
    s_mov_b32 exec_hi, 0xffff
    s_add_u32 s90, s49, 27648
    buffer_load_dwordx4 v158, s[8:11], s90 offen lds
    s_mov_b32 exec_hi, -1
    s_add_u32 m0, s89, 12288
    s_mov_b32 exec_hi, 0xffff
    buffer_load_dwordx4 v158, s[8:11], s50 offen lds
    s_mov_b32 exec_hi, -1
    s_add_u32 m0, s89, 15360
    s_mov_b32 exec_hi, 0xffff
    s_add_u32 s90, s50, 27648
    buffer_load_dwordx4 v158, s[8:11], s90 offen lds
    s_mov_b32 exec_hi, -1
    s_waitcnt vmcnt(17)
    s_barrier
    v_max3_u32 v9, v12, v13, v14
    v_max_u32 v9, v9, v15
    v_cmp_eq_u32 vcc, -1, v9
    s_cbranch_vccnz pk_c7_s
pk_c7_r:
    v_max_u32 v9, v9, v9 row_shr:1
    s_nop 1
    v_max_u32 v9, v9, v9 row_shr:2
    s_nop 1
    v_max_u32 v9, v9, v9 row_shr:4
    s_nop 1
    v_max_u32 v9, v9, v9 row_shr:8
    s_nop 1
    v_max_u32 v9, v9, v9 row_bcast:15 row_mask:0xa
    s_nop 1
    v_max_u32 v9, v9, v9 row_bcast:31 row_mask:0xc
    s_nop 0
    v_readlane_b32 s101, v9, 63
    s_lshr_b32 s101, s101, 7
    s_sub_i32 s101, 253, s101
    s_max_i32 s101, s101, 1
    s_sleep 32
pk_c:
    s_and_b32 s94, s2, 7
    s_lshl_b32 s94, s94, 5
    s_lshr_b32 s34, s2, 3
    s_or_b32 s94, s94, s34
    s_and_b32 s34, s94, 7
    s_lshl_b32 s34, s34, 2
    s_add_u32 s34, s34, s32
    s_sub_u32 s34, 31, s34
    s_bfe_u32 s44, s34, 0x10002
    s_lshr_b32 s45, s34, 4
    s_lshl1_add_u32 s44, s45, s44
    s_lshr_b32 s33, s94, 3
    s_sub_u32 s45, 31, s33
    s_lshl2_add_u32 s44, s45, s44
    s_mul_i32 s44, s44, 80
    s_add_u32 s44, s44, s32
    s_lshl_b32 s44, s44, 8
    s_and_b32 s45, s34, 8
    s_lshl4_add_u32 s44, s45, s44
    s_add_u32 s36, s44, 0x1600000
    s_mul_i32 s45, s34, 1280
    s_lshl_b32 s33, s33, 1
    s_sub_u32 s34, 62, s33
    s_mul_i32 s34, s34, 40960
    s_add_u32 s34, s45, s34
    s_add_u32 s33, s34, 40960
    s_lshr_b32 s35, s94, 6
    s_lshl_b32 s35, s35, 13
    s_bfe_u32 s45, s94, 0x10002
    s_lshl_b32 s45, s45, 12
    s_add_u32 s35, s35, s45
    s_bfe_u32 s45, s94, 0x10003
    s_lshl_b32 s45, s45, 11
    s_add_u32 s35, s35, s45
    s_bfe_u32 s45, s94, 0x20004
    s_lshl_b32 s45, s45, 9
    s_add_u32 s35, s35, s45
    s_and_b32 s45, s94, 3
    s_lshl_b32 s45, s45, 7
    s_add_u32 s35, s35, s45
    s_lshr_b32 s35, s35, 1
    v_mul_u32_u24 v2, 320, v4
    v_lshl_add_u32 v2, v5, 2, v2
    buffer_load_dword v240, v2, s[4:7], s33 offen offset:0
    buffer_load_dword v241, v2, s[4:7], s33 offen offset:64
    buffer_load_dword v242, v2, s[4:7], s33 offen offset:128
    buffer_load_dword v243, v2, s[4:7], s33 offen offset:192
    buffer_load_dword v244, v2, s[4:7], s33 offen offset:256
    buffer_load_dword v245, v2, s[4:7], s34 offen offset:0
    buffer_load_dword v246, v2, s[4:7], s34 offen offset:64
    buffer_load_dword v247, v2, s[4:7], s34 offen offset:128
    buffer_load_dword v248, v2, s[4:7], s34 offen offset:192
    buffer_load_dword v249, v2, s[4:7], s34 offen offset:256
    s_cmp_eq_u32 s32, 0
    s_cselect_b32 s45, 0x288400, 0x288400
    s_cselect_b32 s44, 0, 0x7f000000
    s_add_u32 s45, s45, s44
    v_lshlrev_b32 v25, 2, v1
    v_min_u32 v27, 120, v25
    v_add_u32 v25, s45, v25
    s_add_u32 s45, s45, 256
    v_add_u32 v27, s45, v27
    buffer_load_dword v253, v25, s[16:19], 0 offen sc1
    buffer_load_dword v254, v27, s[16:19], 0 offen sc1
    v_and_b32 v8, 3, v0
    v_and_b32 v9, 0x30, v3
    v_mul_u32_u24 v8, 3104, v8
    v_and_b32 v16, 0xff, v152
    v_lshl_add_u32 v16, v16, 14, v9
    v_bfe_u32 v19, v152, 10, 11
    v_lshl_add_u32 v19, v19, 2, v8
    v_lshrrev_b32 v22, 21, v152
    v_lshl_add_u32 v22, v22, 2, v8
    v_and_b32 v17, 0xff, v153
    v_lshl_add_u32 v17, v17, 14, v9
    v_bfe_u32 v20, v153, 10, 11
    v_lshl_add_u32 v20, v20, 2, v8
    v_lshrrev_b32 v23, 21, v153
    v_lshl_add_u32 v23, v23, 2, v8
    v_and_b32 v18, 0xff, v154
    v_lshl_add_u32 v18, v18, 14, v9
    v_bfe_u32 v21, v154, 10, 11
    v_lshl_add_u32 v21, v21, 2, v8
    v_lshrrev_b32 v24, 21, v154
    v_lshl_add_u32 v24, v24, 2, v8
    buffer_load_dwordx4 v[28:31], v16, s[16:19], s35 offen sc1
    buffer_load_dwordx4 v[32:35], v17, s[16:19], s35 offen sc1
    buffer_load_dwordx4 v[36:39], v18, s[16:19], s35 offen sc1
    v_accvgpr_read_b32 v224, a160
    v_accvgpr_read_b32 v225, a161
    v_accvgpr_read_b32 v226, a162
    v_accvgpr_read_b32 v227, a163
    v_accvgpr_read_b32 v228, a164
    v_accvgpr_read_b32 v229, a165
    v_accvgpr_read_b32 v230, a166
    v_accvgpr_read_b32 v231, a167
    v_accvgpr_read_b32 v232, a168
    v_accvgpr_read_b32 v233, a169
    v_accvgpr_read_b32 v234, a170
    v_accvgpr_read_b32 v235, a171
    v_accvgpr_read_b32 v236, a172
    v_accvgpr_read_b32 v237, a173
    v_accvgpr_read_b32 v238, a174
    v_accvgpr_read_b32 v239, a175
    v_min_u32 v8, 10, v5
    v_mad_u32_u24 v8, v4, 12, v8
    v_lshlrev_b32 v8, 4, v8
    s_mul_i32 s38, s32, 3104
    v_add_u32 v8, s38, v8
    v_add_u32 v11, s38, v2
    v_add_u32 v12, s38, v3
    v_lshlrev_b32 v13, 4, v5
    v_add_u32 v13, 1024, v13
    v_mov_b32 v14, s33
    v_mov_b32 v10, s34
    v_and_b32 v7, 1, v4
    v_cmp_eq_u32 vcc, 1, v7
    s_nop 1
    v_cndmask_b32 v14, v14, v10, vcc
    v_add_u32 v14, v14, v13
    v_add_u32 v14, 0xa00000, v14
    v_mul_u32_u24 v7, 1280, v7
    v_add3_u32 v13, v13, v7, s38
    s_sub_u32 s45, 7, s32
    v_xor_b32 v6, s45, v1
    v_and_b32 v6, 7, v6
    v_lshlrev_b32 v6, 4, v6
    v_lshl_add_u32 v6, v1, 7, v6
    v_lshrrev_b32 v10, 2, v1
    v_xor_b32 v7, s45, v10
    v_and_b32 v7, 7, v7
    v_lshlrev_b32 v7, 4, v7
    v_lshl_add_u32 v7, v10, 7, v7
    v_and_b32 v10, 3, v1
    v_lshl_add_u32 v7, v10, 2, v7
    v_xor_b32 v250, 64, v6
    v_xor_b32 v251, 64, v7
    v_lshrrev_b32 v10, 3, v1
    v_lshl_add_u32 v10, v10, 2, s32
    v_xor_b32 v15, v10, v1
    v_and_b32 v15, 7, v15
    v_lshlrev_b32 v15, 4, v15
    v_lshl_add_u32 v15, v10, 7, v15
    v_lshrrev_b32 v10, 3, v1
    v_and_b32 v252, 0x70, v3
    v_lshl_add_u32 v252, v10, 10, v252
    s_add_u32 s37, s36, 8192
    s_add_u32 s38, s36, 16384
    s_bfe_u32 s44, s68, 0x30014
    s_cmp_eq_u32 s44, 2
    s_cbranch_scc1 pk_wu2
    s_cmp_eq_u32 s44, 0
    s_cbranch_scc1 pk_wu0
pk_wur:
    s_waitcnt vmcnt(0)
    v_max_u32 v9, v253, v254
    v_cmp_eq_u32 vcc, -1, v9
    s_cbranch_vccnz pk_c8_s
pk_c8_r:
    v_and_b32 v26, v28, v32
    v_and_b32 v26, v26, v36
    v_and_b32 v26, 1, v26
    v_add_u32 v26, -1, v26
    v_max3_u32 v9, v28, v32, v36
    v_max_u32 v9, v9, v26
    v_cmp_eq_u32 vcc, -1, v9
    s_cbranch_vccz pk_c9_r
pk_c9_s:
    s_nop 7
    s_nop 7
    s_mov_b32 s47, 0
pk_c9_l:
    s_mov_b64 exec, vcc
    buffer_load_dwordx4 v[28:31], v16, s[16:19], s35 offen sc1
    buffer_load_dwordx4 v[32:35], v17, s[16:19], s35 offen sc1
    buffer_load_dwordx4 v[36:39], v18, s[16:19], s35 offen sc1
    s_add_u32 s47, s47, 1
    s_waitcnt vmcnt(0)
    v_and_b32 v26, v28, v32
    v_and_b32 v26, v26, v36
    v_and_b32 v26, 1, v26
    v_add_u32 v26, -1, v26
    v_max3_u32 v9, v28, v32, v36
    v_max_u32 v9, v9, v26
    v_cmp_eq_u32 vcc, -1, v9
    s_cmp_eq_u64 vcc, 0
    s_cbranch_scc1 pk_c9_x
    s_cmp_lt_u32 s47, 0x2000
    s_cbranch_scc1 pk_c9_l
pk_c9_x:
    s_mov_b64 exec, -1
    s_nop 4
pk_c9_r:
    ds_write_b32 v19, v28 offset:0
    ds_write_b32 v19, v29 offset:1552
    ds_write_b32 v22, v30 offset:0
    ds_write_b32 v22, v31 offset:1552
    ds_write_b32 v20, v32 offset:0
    ds_write_b32 v20, v33 offset:1552
    ds_write_b32 v23, v34 offset:0
    ds_write_b32 v23, v35 offset:1552
    ds_write_b32 v21, v36 offset:0
    ds_write_b32 v21, v37 offset:1552
    ds_write_b32 v24, v38 offset:0
    ds_write_b32 v24, v39 offset:1552
    s_waitcnt lgkmcnt(0)
    s_barrier
    ds_read_b128 v[40:43], v8 offset:0
    ds_read_b128 v[44:47], v8 offset:768
    ds_read_b128 v[48:51], v8 offset:1552
    ds_read_b128 v[52:55], v8 offset:2320
    s_andn2_b32 s44, 7, s2
    s_lshl_b32 s44, s44, 5
    s_lshr_b32 s45, s2, 3
    s_add_u32 s44, s44, s45
    s_lshl_b32 s44, s44, 2
    s_add_u32 s44, s44, s32
    s_lshl_b32 s44, s44, 13
    s_mov_b32 s45, 4
    s_bitcmp1_b32 s45, s32
    s_cselect_b32 s44, s44, 0x7f000000
    v_lshlrev_b32 v9, 7, v1
    v_add_u32 v9, s44, v9
    s_waitcnt lgkmcnt(2)
    v_mfma_f32_16x16x32_f16 v[56:59], v[40:43], a[128:131], 0
    v_mfma_f32_16x16x32_f16 v[60:63], v[40:43], a[132:135], 0
    v_mfma_f32_16x16x32_f16 v[64:67], v[40:43], a[136:139], 0
    v_mfma_f32_16x16x32_f16 v[68:71], v[40:43], a[140:143], 0
    s_add_u32 m0, s89, 18432
    s_mov_b32 exec_hi, 0xffff
    buffer_load_dwordx4 v158, s[8:11], s51 offen lds
    s_mov_b32 exec_hi, -1
    v_mfma_f32_16x16x32_f16 v[56:59], v[44:47], a[144:147], v[56:59]
    v_mfma_f32_16x16x32_f16 v[60:63], v[44:47], a[148:151], v[60:63]
    v_mfma_f32_16x16x32_f16 v[64:67], v[44:47], a[152:155], v[64:67]
    v_mfma_f32_16x16x32_f16 v[68:71], v[44:47], a[156:159], v[68:71]
    s_add_u32 m0, s89, 21504
    s_mov_b32 exec_hi, 0xffff
    s_add_u32 s90, s51, 27648
    buffer_load_dwordx4 v158, s[8:11], s90 offen lds
    s_mov_b32 exec_hi, -1
    s_waitcnt lgkmcnt(0)
    v_mfma_f32_16x16x32_f16 v[72:75], v[48:51], a[128:131], 0
    v_mfma_f32_16x16x32_f16 v[76:79], v[48:51], a[132:135], 0
    v_mfma_f32_16x16x32_f16 v[80:83], v[48:51], a[136:139], 0
    v_mfma_f32_16x16x32_f16 v[84:87], v[48:51], a[140:143], 0
    s_add_u32 m0, s89, 24576
    s_mov_b32 exec_hi, 0xffff
    buffer_load_dwordx4 v158, s[8:11], s52 offen lds
    s_mov_b32 exec_hi, -1
    v_mfma_f32_16x16x32_f16 v[72:75], v[52:55], a[144:147], v[72:75]
    v_mfma_f32_16x16x32_f16 v[76:79], v[52:55], a[148:151], v[76:79]
    v_mfma_f32_16x16x32_f16 v[80:83], v[52:55], a[152:155], v[80:83]
    v_mfma_f32_16x16x32_f16 v[84:87], v[52:55], a[156:159], v[84:87]
    s_add_u32 m0, s89, 27648
    s_mov_b32 exec_hi, 0xffff
    s_add_u32 s90, s52, 27648
    buffer_load_dwordx4 v158, s[8:11], s90 offen lds
    s_mov_b32 exec_hi, -1
    v_mul_f32 v104, v60, v225
    v_mul_f32 v105, v60, v224
    v_mul_f32 v106, v61, v227
    v_mul_f32 v107, v61, v226
    v_mul_f32 v108, v62, v229
    v_mul_f32 v109, v62, v228
    v_mul_f32 v110, v63, v231
    v_mul_f32 v111, v63, v230
    v_fma_mixlo_f16 v88, v56, v224, -v104
    v_fma_mixlo_f16 v89, v57, v226, -v106
    v_fma_mixlo_f16 v90, v58, v228, -v108
    v_fma_mixlo_f16 v91, v59, v230, -v110
    v_fma_mixhi_f16 v88, v56, v225, v105
    v_fma_mixhi_f16 v89, v57, v227, v107
    v_fma_mixhi_f16 v90, v58, v229, v109
    s_add_u32 m0, s89, 30720
    s_mov_b32 exec_hi, 0xffff
    buffer_load_dwordx4 v158, s[8:11], s56 offen lds
    s_mov_b32 exec_hi, -1
    v_fma_mixhi_f16 v91, v59, v231, v111
    v_mul_f32 v104, v68, v233
    v_mul_f32 v105, v68, v232
    v_mul_f32 v106, v69, v235
    v_mul_f32 v107, v69, v234
    v_mul_f32 v108, v70, v237
    v_mul_f32 v109, v70, v236
    v_mul_f32 v110, v71, v239
    v_mul_f32 v111, v71, v238
    v_fma_mixlo_f16 v92, v64, v232, -v104
    v_fma_mixlo_f16 v93, v65, v234, -v106
    v_fma_mixlo_f16 v94, v66, v236, -v108
    v_fma_mixlo_f16 v95, v67, v238, -v110
    v_fma_mixhi_f16 v92, v64, v233, v105
    v_fma_mixhi_f16 v93, v65, v235, v107
    s_add_u32 m0, s89, 33792
    s_mov_b32 exec_hi, 0xffff
    s_add_u32 s90, s56, 27648
    buffer_load_dwordx4 v158, s[8:11], s90 offen lds
    s_mov_b32 exec_hi, -1
    v_fma_mixhi_f16 v94, v66, v237, v109
    v_fma_mixhi_f16 v95, v67, v239, v111
    v_mul_f32 v104, v76, v225
    v_mul_f32 v105, v76, v224
    v_mul_f32 v106, v77, v227
    v_mul_f32 v107, v77, v226
    v_mul_f32 v108, v78, v229
    v_mul_f32 v109, v78, v228
    v_mul_f32 v110, v79, v231
    v_mul_f32 v111, v79, v230
    v_fma_mixlo_f16 v96, v72, v224, -v104
    v_fma_mixlo_f16 v97, v73, v226, -v106
    v_fma_mixlo_f16 v98, v74, v228, -v108
    v_fma_mixlo_f16 v99, v75, v230, -v110
    v_fma_mixhi_f16 v96, v72, v225, v105
    s_add_u32 m0, s89, 36864
    s_mov_b32 exec_hi, 0xffff
    buffer_load_dwordx4 v158, s[8:11], s57 offen lds
    s_mov_b32 exec_hi, -1
    v_fma_mixhi_f16 v97, v73, v227, v107
    v_fma_mixhi_f16 v98, v74, v229, v109
    v_fma_mixhi_f16 v99, v75, v231, v111
    v_mul_f32 v104, v84, v233
    v_mul_f32 v105, v84, v232
    v_mul_f32 v106, v85, v235
    v_mul_f32 v107, v85, v234
    v_mul_f32 v108, v86, v237
    v_mul_f32 v109, v86, v236
    v_mul_f32 v110, v87, v239
    v_mul_f32 v111, v87, v238
    v_fma_mixlo_f16 v100, v80, v232, -v104
    v_fma_mixlo_f16 v101, v81, v234, -v106
    v_fma_mixlo_f16 v102, v82, v236, -v108
    v_fma_mixlo_f16 v103, v83, v238, -v110
    s_add_u32 m0, s89, 39936
    s_mov_b32 exec_hi, 0xffff
    s_add_u32 s90, s57, 27648
    buffer_load_dwordx4 v158, s[8:11], s90 offen lds
    s_mov_b32 exec_hi, -1
    v_fma_mixhi_f16 v100, v80, v233, v105
    v_fma_mixhi_f16 v101, v81, v235, v107
    v_fma_mixhi_f16 v102, v82, v237, v109
    v_fma_mixhi_f16 v103, v83, v239, v111
    v_mfma_f32_16x16x32_f16 v[192:195], a[176:179], v[88:91], 0
    v_mfma_f32_16x16x32_f16 v[196:199], a[180:183], v[88:91], 0
    v_mfma_f32_16x16x32_f16 v[200:203], a[176:179], v[92:95], 0
    s_add_u32 m0, s89, 43008
    s_mov_b32 exec_hi, 0xffff
    buffer_load_dwordx4 v158, s[8:11], s58 offen lds
    s_mov_b32 exec_hi, -1
    v_mfma_f32_16x16x32_f16 v[204:207], a[180:183], v[92:95], 0
    v_mfma_f32_16x16x32_f16 v[208:211], a[176:179], v[96:99], 0
    v_mfma_f32_16x16x32_f16 v[212:215], a[180:183], v[96:99], 0
    v_mfma_f32_16x16x32_f16 v[216:219], a[176:179], v[100:103], 0
    s_add_u32 m0, s89, 46080
    s_mov_b32 exec_hi, 0xffff
    s_add_u32 s90, s58, 27648
    buffer_load_dwordx4 v158, s[8:11], s90 offen lds
    s_mov_b32 exec_hi, -1
    v_mfma_f32_16x16x32_f16 v[220:223], a[180:183], v[100:103], 0
    s_sub_i32 s41, 254, s101
    s_lshl_b32 s41, s41, 23
    v_mul_f32 v56, s41, v192
    v_mul_f32 v57, s41, v200
    v_cvt_pk_bf16_f32 v104, v56, v57
    v_lshlrev_b32 v56, 16, v104
    v_and_b32 v57, 0xffff0000, v104
    v_lshlrev_b32 v105, 16, v240
    v_and_b32 v106, 0xffff0000, v240
    v_add_f32 v56, v56, v105
    v_add_f32 v57, v57, v106
    s_add_u32 m0, s89, 49152
    s_mov_b32 exec_hi, 0xffff
    s_mov_b32 s90, 442368
    buffer_load_dwordx4 v159, s[8:11], s90 offen lds
    s_mov_b32 exec_hi, -1
    v_cvt_pk_bf16_f32 v28, v56, v57
    v_lshlrev_b32 v56, 16, v28
    v_and_b32 v57, 0xffff0000, v28
    ds_write_b32 v11, v28 offset:0
    v_mul_f32 v58, s41, v193
    v_mul_f32 v59, s41, v201
    v_cvt_pk_bf16_f32 v104, v58, v59
    v_lshlrev_b32 v58, 16, v104
    v_and_b32 v59, 0xffff0000, v104
    v_lshlrev_b32 v105, 16, v241
    v_and_b32 v106, 0xffff0000, v241
    v_add_f32 v58, v58, v105
    v_add_f32 v59, v59, v106
    v_cvt_pk_bf16_f32 v29, v58, v59
    v_lshlrev_b32 v58, 16, v29
    s_add_u32 m0, s89, 52224
    s_mov_b32 exec_hi, 0xffff
    s_mov_b32 s90, 995328
    buffer_load_dwordx4 v159, s[8:11], s90 offen lds
    s_mov_b32 exec_hi, -1
    v_and_b32 v59, 0xffff0000, v29
    ds_write_b32 v11, v29 offset:64
    v_mul_f32 v60, s41, v194
    v_mul_f32 v61, s41, v202
    v_cvt_pk_bf16_f32 v104, v60, v61
    v_lshlrev_b32 v60, 16, v104
    v_and_b32 v61, 0xffff0000, v104
    v_lshlrev_b32 v105, 16, v242
    v_and_b32 v106, 0xffff0000, v242
    v_add_f32 v60, v60, v105
    v_add_f32 v61, v61, v106
    v_cvt_pk_bf16_f32 v30, v60, v61
    v_lshlrev_b32 v60, 16, v30
    v_and_b32 v61, 0xffff0000, v30
    ds_write_b32 v11, v30 offset:128
    s_add_u32 m0, s89, 55296
    s_mov_b32 exec_hi, 0xffff
    s_mov_b32 s90, 1548288
    buffer_load_dwordx4 v159, s[8:11], s90 offen lds
    s_mov_b32 exec_hi, -1
    v_mul_f32 v62, s41, v195
    v_mul_f32 v63, s41, v203
    v_cvt_pk_bf16_f32 v104, v62, v63
    v_lshlrev_b32 v62, 16, v104
    v_and_b32 v63, 0xffff0000, v104
    v_lshlrev_b32 v105, 16, v243
    v_and_b32 v106, 0xffff0000, v243
    v_add_f32 v62, v62, v105
    v_add_f32 v63, v63, v106
    v_cvt_pk_bf16_f32 v31, v62, v63
    v_lshlrev_b32 v62, 16, v31
    v_and_b32 v63, 0xffff0000, v31
    ds_write_b32 v11, v31 offset:192
    v_mul_f32 v64, s41, v196
    v_mul_f32 v65, s41, v204
    s_add_u32 m0, s89, 58368
    s_mov_b32 exec_hi, 0xffff
    s_mov_b32 s90, 2101248
    buffer_load_dwordx4 v159, s[8:11], s90 offen lds
    s_mov_b32 exec_hi, -1
    v_cvt_pk_bf16_f32 v104, v64, v65
    v_lshlrev_b32 v64, 16, v104
    v_and_b32 v65, 0xffff0000, v104
    v_lshlrev_b32 v105, 16, v244
    v_and_b32 v106, 0xffff0000, v244
    v_add_f32 v64, v64, v105
    v_add_f32 v65, v65, v106
    v_cvt_pk_bf16_f32 v32, v64, v65
    v_lshlrev_b32 v64, 16, v32
    v_and_b32 v65, 0xffff0000, v32
    ds_write_b32 v11, v32 offset:256
    v_mul_f32 v66, s41, v208
    v_mul_f32 v67, s41, v216
    v_cvt_pk_bf16_f32 v104, v66, v67
    v_lshlrev_b32 v66, 16, v104
    buffer_load_dword a100, v9, s[24:27], 0 offen
    v_and_b32 v67, 0xffff0000, v104
    v_lshlrev_b32 v105, 16, v245
    v_and_b32 v106, 0xffff0000, v245
    v_add_f32 v66, v66, v105
    v_add_f32 v67, v67, v106
    v_cvt_pk_bf16_f32 v33, v66, v67
    v_lshlrev_b32 v66, 16, v33
    v_and_b32 v67, 0xffff0000, v33
    ds_write_b32 v11, v33 offset:1280
    v_mul_f32 v68, s41, v209
    v_mul_f32 v69, s41, v217
    v_cvt_pk_bf16_f32 v104, v68, v69
    v_lshlrev_b32 v68, 16, v104
    v_and_b32 v69, 0xffff0000, v104
    v_lshlrev_b32 v105, 16, v246
    v_and_b32 v106, 0xffff0000, v246
    v_add_f32 v68, v68, v105
    v_add_f32 v69, v69, v106
    v_cvt_pk_bf16_f32 v34, v68, v69
    v_lshlrev_b32 v68, 16, v34
    v_and_b32 v69, 0xffff0000, v34
    ds_write_b32 v11, v34 offset:1344
    v_mul_f32 v70, s41, v210
    v_mul_f32 v71, s41, v218
    v_cvt_pk_bf16_f32 v104, v70, v71
    v_lshlrev_b32 v70, 16, v104
    v_and_b32 v71, 0xffff0000, v104
    v_lshlrev_b32 v105, 16, v247
    v_and_b32 v106, 0xffff0000, v247
    v_add_f32 v70, v70, v105
    v_add_f32 v71, v71, v106
    v_cvt_pk_bf16_f32 v35, v70, v71
    v_lshlrev_b32 v70, 16, v35
    v_and_b32 v71, 0xffff0000, v35
    ds_write_b32 v11, v35 offset:1408
    v_mul_f32 v72, s41, v211
    v_mul_f32 v73, s41, v219
    v_cvt_pk_bf16_f32 v104, v72, v73
    v_lshlrev_b32 v72, 16, v104
    v_and_b32 v73, 0xffff0000, v104
    v_lshlrev_b32 v105, 16, v248
    v_and_b32 v106, 0xffff0000, v248
    v_add_f32 v72, v72, v105
    v_add_f32 v73, v73, v106
    v_cvt_pk_bf16_f32 v36, v72, v73
    v_lshlrev_b32 v72, 16, v36
    v_and_b32 v73, 0xffff0000, v36
    ds_write_b32 v11, v36 offset:1472
    v_mul_f32 v74, s41, v212
    v_mul_f32 v75, s41, v220
    v_cvt_pk_bf16_f32 v104, v74, v75
    v_lshlrev_b32 v74, 16, v104
    v_and_b32 v75, 0xffff0000, v104
    v_lshlrev_b32 v105, 16, v249
    v_and_b32 v106, 0xffff0000, v249
    v_add_f32 v74, v74, v105
    v_add_f32 v75, v75, v106
    v_cvt_pk_bf16_f32 v37, v74, v75
    v_lshlrev_b32 v74, 16, v37
    v_and_b32 v75, 0xffff0000, v37
    ds_write_b32 v11, v37 offset:1536
    ds_read_b128 v[152:155], v12 offset:0
    ds_read_b128 v[156:159], v12 offset:1280
    ds_read_b128 v[160:163], v13
    s_add_u32 s94, s33, 0xa00000
    s_add_u32 s95, s34, 0xa00000
    v_mov_b32 v164, v14
    s_mov_b32 s46, 0x3f803f80
    v_dot2_f32_bf16 v104, v28, s46, 0
    v_dot2_f32_bf16 v105, v33, s46, 0
    v_dot2_f32_bf16 v106, v28, v28, 0
    v_dot2_f32_bf16 v107, v33, v33, 0
    v_dot2_f32_bf16 v104, v29, s46, v104
    v_dot2_f32_bf16 v105, v34, s46, v105
    v_dot2_f32_bf16 v106, v29, v29, v106
    v_dot2_f32_bf16 v107, v34, v34, v107
    v_dot2_f32_bf16 v104, v30, s46, v104
    v_dot2_f32_bf16 v105, v35, s46, v105
    v_dot2_f32_bf16 v106, v30, v30, v106
    v_dot2_f32_bf16 v107, v35, v35, v107
    v_dot2_f32_bf16 v104, v31, s46, v104
    v_dot2_f32_bf16 v105, v36, s46, v105
    v_dot2_f32_bf16 v106, v31, v31, v106
    v_dot2_f32_bf16 v107, v36, v36, v107
    v_dot2_f32_bf16 v104, v32, s46, v104
    v_dot2_f32_bf16 v105, v37, s46, v105
    v_dot2_f32_bf16 v106, v32, v32, v106
    v_dot2_f32_bf16 v107, v37, v37, v107
    s_nop 0
    v_permlane32_swap_b32 v104, v105
    s_nop 0
    v_permlane32_swap_b32 v106, v107
    v_add_f32 v104, v104, v105
    v_add_f32 v106, v106, v107
    s_nop 1
    v_permlane16_swap_b32 v104, v106
    v_add_f32 v104, v104, v106
    s_nop 1
    v_add_f32 v104, v104, v104 row_ror:1
    s_nop 1
    v_add_f32 v104, v104, v104 row_ror:2
    s_nop 1
    v_add_f32 v104, v104, v104 row_ror:4
    s_nop 1
    v_add_f32 v106, v104, v104 row_ror:8
    v_add_f32 v104, v104, v104 row_ror:8
    s_nop 1
    v_permlane16_swap_b32 v104, v106
    s_waitcnt lgkmcnt(0)
    s_barrier
    v_mul_f32 v108, 0x3acccccd, v104
    v_mul_f32 v109, 0x3acccccd, v106
    v_fma_f32 v109, -v108, v108, v109
    v_max_f32 v109, 0, v109
    v_cvt_pk_bf16_f32 v108, v108, v109
    v_and_b32 v109, 0xffff0000, v108
    v_lshlrev_b32 v108, 16, v108
    v_add_f32 v109, 0x3727c5ac, v109
    v_readlane_b32 s42, v108, 0
    v_cvt_pk_bf16_f32 v109, v109, v109
    v_readlane_b32 s44, v108, 32
    v_lshlrev_b32 v109, 16, v109
    v_sqrt_f32 v109, v109
    v_pk_add_f32 v[56:57], v[56:57], s[42:43] op_sel_hi:[1,0] neg_lo:[0,1] neg_hi:[0,1]
    v_pk_add_f32 v[58:59], v[58:59], s[42:43] op_sel_hi:[1,0] neg_lo:[0,1] neg_hi:[0,1]
    v_cvt_pk_bf16_f32 v104, v56, v57
    v_lshlrev_b32 v56, 16, v104
    v_and_b32 v57, 0xffff0000, v104
    v_cvt_pk_bf16_f32 v109, v109, v109
    v_pk_add_f32 v[60:61], v[60:61], s[42:43] op_sel_hi:[1,0] neg_lo:[0,1] neg_hi:[0,1]
    v_cvt_pk_bf16_f32 v105, v58, v59
    v_lshlrev_b32 v58, 16, v105
    v_and_b32 v59, 0xffff0000, v105
    v_lshlrev_b32 v109, 16, v109
    v_pk_add_f32 v[62:63], v[62:63], s[42:43] op_sel_hi:[1,0] neg_lo:[0,1] neg_hi:[0,1]
    v_cvt_pk_bf16_f32 v106, v60, v61
    v_lshlrev_b32 v60, 16, v106
    v_and_b32 v61, 0xffff0000, v106
    v_rcp_f32 v109, v109
    v_pk_add_f32 v[64:65], v[64:65], s[42:43] op_sel_hi:[1,0] neg_lo:[0,1] neg_hi:[0,1]
    v_cvt_pk_bf16_f32 v107, v62, v63
    v_lshlrev_b32 v62, 16, v107
    v_and_b32 v63, 0xffff0000, v107
    v_pk_add_f32 v[66:67], v[66:67], s[44:45] op_sel_hi:[1,0] neg_lo:[0,1] neg_hi:[0,1]
    v_cvt_pk_bf16_f32 v104, v64, v65
    v_lshlrev_b32 v64, 16, v104
    v_and_b32 v65, 0xffff0000, v104
    v_readlane_b32 s43, v109, 0
    v_pk_add_f32 v[68:69], v[68:69], s[44:45] op_sel_hi:[1,0] neg_lo:[0,1] neg_hi:[0,1]
    v_cvt_pk_bf16_f32 v104, v66, v67
    v_lshlrev_b32 v66, 16, v104
    v_and_b32 v67, 0xffff0000, v104
    v_readlane_b32 s45, v109, 32
    s_nop 1
    v_pk_add_f32 v[70:71], v[70:71], s[44:45] op_sel_hi:[1,0] neg_lo:[0,1] neg_hi:[0,1]
    v_cvt_pk_bf16_f32 v105, v68, v69
    v_lshlrev_b32 v68, 16, v105
    v_and_b32 v69, 0xffff0000, v105
    v_pk_add_f32 v[72:73], v[72:73], s[44:45] op_sel_hi:[1,0] neg_lo:[0,1] neg_hi:[0,1]
    v_cvt_pk_bf16_f32 v106, v70, v71
    v_lshlrev_b32 v70, 16, v106
    v_and_b32 v71, 0xffff0000, v106
    v_pk_add_f32 v[74:75], v[74:75], s[44:45] op_sel_hi:[1,0] neg_lo:[0,1] neg_hi:[0,1]
    v_cvt_pk_bf16_f32 v107, v72, v73
    v_lshlrev_b32 v72, 16, v107
    v_and_b32 v73, 0xffff0000, v107
    v_cvt_pk_bf16_f32 v104, v74, v75
    v_lshlrev_b32 v74, 16, v104
    v_and_b32 v75, 0xffff0000, v104
    v_pk_mul_f32 v[56:57], v[56:57], s[42:43] op_sel:[0,1]
    v_pk_mul_f32 v[58:59], v[58:59], s[42:43] op_sel:[0,1]
    v_pk_mul_f32 v[60:61], v[60:61], s[42:43] op_sel:[0,1]
    v_pk_mul_f32 v[62:63], v[62:63], s[42:43] op_sel:[0,1]
    v_pk_mul_f32 v[64:65], v[64:65], s[42:43] op_sel:[0,1]
    v_pk_mul_f32 v[66:67], v[66:67], s[44:45] op_sel:[0,1]
    v_pk_mul_f32 v[68:69], v[68:69], s[44:45] op_sel:[0,1]
    v_pk_mul_f32 v[70:71], v[70:71], s[44:45] op_sel:[0,1]
    v_pk_mul_f32 v[72:73], v[72:73], s[44:45] op_sel:[0,1]
    v_pk_mul_f32 v[74:75], v[74:75], s[44:45] op_sel:[0,1]
    v_cvt_pk_bf16_f32 v196, v64, v65
    ds_write_b32 v7, v196 offset:8192
    v_cvt_pk_bf16_f32 v192, v56, v57
    v_cvt_pk_bf16_f32 v193, v58, v59
    v_cvt_pk_bf16_f32 v194, v60, v61
    v_cvt_pk_bf16_f32 v195, v62, v63
    ds_write_b128 v6, v[192:195]
    v_cvt_pk_bf16_f32 v204, v74, v75
    ds_write_b32 v251, v204 offset:8192
    v_cvt_pk_bf16_f32 v200, v66, v67
    v_cvt_pk_bf16_f32 v201, v68, v69
    v_cvt_pk_bf16_f32 v202, v70, v71
    v_cvt_pk_bf16_f32 v203, v72, v73
    ds_write_b128 v250, v[200:203]
    s_waitcnt lgkmcnt(0)
    s_barrier
    ds_read_b128 v[192:195], v15 offset:0
    ds_read_b128 v[196:199], v15 offset:4096
    ds_read_b128 v[200:203], v15 offset:8192
    s_cmp_lg_u32 s1, 0
    s_cbranch_scc0 pk_w10_s
    s_waitcnt lgkmcnt(2)
    buffer_store_dwordx4 v[192:195], v252, s[16:19], s36 offen
    s_waitcnt lgkmcnt(1)
    buffer_store_dwordx4 v[196:199], v252, s[16:19], s37 offen
    s_mov_b32 exec_hi, 0
    s_waitcnt lgkmcnt(0)
    buffer_store_dwordx4 v[200:203], v252, s[16:19], s38 offen
    s_mov_b32 exec_hi, -1
pk_w10_r:
    s_waitcnt lgkmcnt(0)
    s_andn2_b32 s33, 7, s2
    s_lshl_b32 s33, s33, 1
    s_bfe_u32 s34, s68, 0x10018
    s_add_u32 s33, s33, s34
    s_lshr_b32 s34, s68, 25
    s_bfe_u32 s42, s68, 0x30014
    s_lshl_b32 s38, s33, 2
    s_add_u32 s38, s38, s32
    s_mul_i32 s35, s38, 40960
    s_add_u32 s35, s35, 0x1600000
    s_mov_b32 s36, 16384
    v_lshlrev_b32 v6, 6, v5
    v_lshl_add_u32 v6, v4, 4, v6
    v_add_u32 v6, s35, v3
    v_add_u32 v7, 20480, v6
    buffer_load_dwordx4 a[192:195], v6, s[16:19], s36 offen offset:0 sc1
    buffer_load_dwordx4 v[240:243], v7, s[16:19], s36 offen offset:0 sc1
    buffer_load_dwordx4 a[196:199], v6, s[16:19], s36 offen offset:1024 sc1
    buffer_load_dwordx4 v[244:247], v7, s[16:19], s36 offen offset:1024 sc1
    buffer_load_dwordx4 a[200:203], v6, s[16:19], s36 offen offset:2048 sc1
    buffer_load_dwordx4 v[248:251], v7, s[16:19], s36 offen offset:2048 sc1
    buffer_load_dwordx4 a[204:207], v6, s[16:19], s36 offen offset:3072 sc1
    buffer_load_dwordx4 v[252:255], v7, s[16:19], s36 offen offset:3072 sc1
    s_xor_b32 s40, s59, 0
    buffer_load_dwordx4 a[128:131], v6, s[16:19], s40 offen offset:0 sc1
    buffer_load_dwordx4 v[176:179], v7, s[16:19], s40 offen offset:0 sc1
    s_xor_b32 s40, s59, 0
    buffer_load_dwordx4 a[132:135], v6, s[16:19], s40 offen offset:1024 sc1
    buffer_load_dwordx4 v[180:183], v7, s[16:19], s40 offen offset:1024 sc1
    v_bfe_u32 v8, v1, 3, 2
    v_mul_u32_u24 v15, 1056, v8
    v_lshrrev_b32 v8, 5, v1
    v_lshl_add_u32 v15, v8, 8, v15
    v_bfe_u32 v8, v1, 2, 1
    v_lshl_add_u32 v15, v8, 7, v15
    v_and_b32 v9, 3, v1
    v_lshl_add_u32 v15, v9, 3, v15
    v_lshrrev_b32 v8, 2, v1
    v_mul_u32_u24 v14, 96, v8
    v_lshl_add_u32 v14, v9, 3, v14
    v_add_u32 v14, 102400, v14
    v_add_u32 v8, 17920, v15
    v_add_u32 v9, 42240, v8
    v_mov_b32 v136, 0xc0135761
    v_mov_b32 v137, 0xc0135761
    v_mov_b32 v138, 0xbdd2d3e8
    v_mov_b32 v139, 0xbdd2d3e8
    v_mov_b32 v140, 0x3f800000
    v_mov_b32 v141, 0x3f800000
    ds_read_b64_tr_b16 v[72:73], v9 offset:25344
    ds_read_b64_tr_b16 v[74:75], v9 offset:25856
    ds_read_b64_tr_b16 v[76:77], v9 offset:25376
    ds_read_b64_tr_b16 v[78:79], v9 offset:25888
    ds_read_b64_tr_b16 v[80:81], v9 offset:25408
    ds_read_b64_tr_b16 v[82:83], v9 offset:25920
    ds_read_b64_tr_b16 v[84:85], v9 offset:25440
    ds_read_b64_tr_b16 v[86:87], v9 offset:25952
    ds_read_b64_tr_b16 v[88:89], v9 offset:29568
    ds_read_b64_tr_b16 v[90:91], v9 offset:30080
    ds_read_b64_tr_b16 v[92:93], v9 offset:29600
    ds_read_b64_tr_b16 v[94:95], v9 offset:30112
    ds_read_b64_tr_b16 v[96:97], v9 offset:29632
    ds_read_b64_tr_b16 v[98:99], v9 offset:30144
    ds_read_b64_tr_b16 v[100:101], v9 offset:29664
    ds_read_b64_tr_b16 v[102:103], v9 offset:30176
    ds_read_b64_tr_b16 v[104:105], v9 offset:33792
    ds_read_b64_tr_b16 v[106:107], v9 offset:34304
    ds_read_b64_tr_b16 v[108:109], v9 offset:33824
    ds_read_b64_tr_b16 v[110:111], v9 offset:34336
    ds_read_b64_tr_b16 v[112:113], v9 offset:33856
    ds_read_b64_tr_b16 v[114:115], v9 offset:34368
    ds_read_b64_tr_b16 v[116:117], v9 offset:33888
    ds_read_b64_tr_b16 v[118:119], v9 offset:34400
    ds_read_b64_tr_b16 v[120:121], v9 offset:38016
    ds_read_b64_tr_b16 v[122:123], v9 offset:38528
    ds_read_b64_tr_b16 v[124:125], v9 offset:38048
    ds_read_b64_tr_b16 v[126:127], v9 offset:38560
    ds_read_b64_tr_b16 v[128:129], v9 offset:38080
    ds_read_b64_tr_b16 v[130:131], v9 offset:38592
    ds_read_b64_tr_b16 v[132:133], v9 offset:38112
    ds_read_b64_tr_b16 v[134:135], v9 offset:38624
    ds_read_b64_tr_b16 a[208:209], v8 offset:0
    ds_read_b64_tr_b16 a[210:211], v8 offset:512
    ds_read_b64_tr_b16 a[212:213], v8 offset:32
    ds_read_b64_tr_b16 a[214:215], v8 offset:544
    ds_read_b64_tr_b16 a[216:217], v8 offset:64
    ds_read_b64_tr_b16 a[218:219], v8 offset:576
    ds_read_b64_tr_b16 a[220:221], v8 offset:96
    ds_read_b64_tr_b16 a[222:223], v8 offset:608
    ds_read_b64_tr_b16 a[224:225], v8 offset:4224
    ds_read_b64_tr_b16 a[226:227], v8 offset:4736
    ds_read_b64_tr_b16 a[228:229], v8 offset:4256
    ds_read_b64_tr_b16 a[230:231], v8 offset:4768
    ds_read_b64_tr_b16 a[232:233], v8 offset:4288
    ds_read_b64_tr_b16 a[234:235], v8 offset:4800
    ds_read_b64_tr_b16 a[236:237], v8 offset:4320
    ds_read_b64_tr_b16 a[238:239], v8 offset:4832
    ds_read_b64_tr_b16 a[240:241], v8 offset:8448
    ds_read_b64_tr_b16 a[242:243], v8 offset:8960
    ds_read_b64_tr_b16 a[244:245], v8 offset:8480
    ds_read_b64_tr_b16 a[246:247], v8 offset:8992
    ds_read_b64_tr_b16 a[248:249], v8 offset:8512
    ds_read_b64_tr_b16 a[250:251], v8 offset:9024
    ds_read_b64_tr_b16 a[252:253], v8 offset:8544
    ds_read_b64_tr_b16 a[254:255], v8 offset:9056
    s_andn2_b32 s44, 7, s2
    s_lshl_b32 s44, s44, 5
    s_lshr_b32 s45, s2, 3
    s_add_u32 s44, s44, s45
    s_lshl_b32 s44, s44, 2
    s_add_u32 s44, s44, s32
    s_mul_i32 s44, s44, 3456
    s_add_u32 s44, s44, 0x1c30000
    s_waitcnt vmcnt(10)
    v_accvgpr_read_b32 v12, a192
    v_max_u32 v12, v12, v240
    v_cmp_eq_u32 vcc, -1, v12
    s_cbranch_vccz pk_c11_r
pk_c11_s:
    s_nop 7
    s_nop 7
    s_mov_b32 s47, 0
    s_mov_b64 s[92:93], -1
pk_c11_l:
    buffer_load_dwordx4 a[192:195], v6, s[16:19], s36 offen offset:0 sc1
    buffer_load_dwordx4 v[240:243], v7, s[16:19], s36 offen offset:0 sc1
    buffer_load_dwordx4 a[196:199], v6, s[16:19], s36 offen offset:1024 sc1
    buffer_load_dwordx4 v[244:247], v7, s[16:19], s36 offen offset:1024 sc1
    buffer_load_dwordx4 a[200:203], v6, s[16:19], s36 offen offset:2048 sc1
    buffer_load_dwordx4 v[248:251], v7, s[16:19], s36 offen offset:2048 sc1
    buffer_load_dwordx4 a[204:207], v6, s[16:19], s36 offen offset:3072 sc1
    buffer_load_dwordx4 v[252:255], v7, s[16:19], s36 offen offset:3072 sc1
    s_xor_b32 s40, s59, 0
    buffer_load_dwordx4 a[128:131], v6, s[16:19], s40 offen offset:0 sc1
    buffer_load_dwordx4 v[176:179], v7, s[16:19], s40 offen offset:0 sc1
    s_xor_b32 s40, s59, 0
    buffer_load_dwordx4 a[132:135], v6, s[16:19], s40 offen offset:1024 sc1
    buffer_load_dwordx4 v[180:183], v7, s[16:19], s40 offen offset:1024 sc1
    s_add_u32 s47, s47, 1
    s_waitcnt vmcnt(10)
    v_accvgpr_read_b32 v12, a192
    v_max_u32 v12, v12, v240
    v_cmp_eq_u32 vcc, -1, v12
    s_cmp_eq_u64 vcc, 0
    s_cbranch_scc1 pk_c11_x
    s_cmp_lt_u32 s47, 0x2000
    s_cbranch_scc1 pk_c11_l
pk_c11_x:
    s_mov_b64 exec, s[92:93]
    s_mov_b32 s47, 0x7f000000
    s_mov_b64 exec, -1
    s_nop 4
pk_c11_r:
    s_mul_i32 s43, s38, 55296
    s_add_u32 s43, s43, 0x600000
    s_nop 1
    s_cmp_eq_u32 s42, 0
    s_cbranch_scc1 pk_dn0
    s_cmp_lg_u32 s42, 4
    s_cbranch_scc1 pk_dn2
    s_waitcnt lgkmcnt(15)
    v_mfma_f32_16x16x32_bf16 v[16:19], a[192:195], v[72:75], 0
    s_waitcnt vmcnt(8)
    v_accvgpr_read_b32 v12, a196
    v_mfma_f32_16x16x32_bf16 v[32:35], v[240:243], v[72:75], 0
    ds_read_b64_tr_b16 v[72:73], v8 offset:12672
    ds_read_b64_tr_b16 v[74:75], v8 offset:13184
    v_mfma_f32_16x16x32_bf16 v[20:23], a[192:195], v[76:79], 0
    v_max_u32 v12, v12, v244
    v_mfma_f32_16x16x32_bf16 v[36:39], v[240:243], v[76:79], 0
    ds_read_b64_tr_b16 v[76:77], v8 offset:12704
    ds_read_b64_tr_b16 v[78:79], v8 offset:13216
    v_mfma_f32_16x16x32_bf16 v[24:27], a[192:195], v[80:83], 0
    v_cmp_eq_u32 vcc, -1, v12
    v_mfma_f32_16x16x32_bf16 v[40:43], v[240:243], v[80:83], 0
    ds_read_b64_tr_b16 v[80:81], v8 offset:12736
    ds_read_b64_tr_b16 v[82:83], v8 offset:13248
    s_xor_b32 s40, s59, 2048
    buffer_load_dwordx4 a[136:139], v6, s[16:19], s40 offen offset:0 sc1
    v_mfma_f32_16x16x32_bf16 v[28:31], a[192:195], v[84:87], 0
    s_cbranch_vccnz pk_c12_s
pk_c12_r:
    v_mfma_f32_16x16x32_bf16 v[44:47], v[240:243], v[84:87], 0
    ds_read_b64_tr_b16 v[84:85], v8 offset:12768
    ds_read_b64_tr_b16 v[86:87], v8 offset:13280
    buffer_load_dwordx4 v[184:187], v7, s[16:19], s40 offen offset:0 sc1
    v_mfma_f32_16x16x32_bf16 v[16:19], a[196:199], v[88:91], v[16:19]
    s_waitcnt vmcnt(8)
    v_accvgpr_read_b32 v12, a200
    v_mfma_f32_16x16x32_bf16 v[32:35], v[244:247], v[88:91], v[32:35]
    ds_read_b64_tr_b16 v[88:89], v8 offset:16896
    ds_read_b64_tr_b16 v[90:91], v8 offset:17408
    v_mfma_f32_16x16x32_bf16 v[20:23], a[196:199], v[92:95], v[20:23]
    v_max_u32 v12, v12, v248
    v_mfma_f32_16x16x32_bf16 v[36:39], v[244:247], v[92:95], v[36:39]
    ds_read_b64_tr_b16 v[92:93], v8 offset:16928
    ds_read_b64_tr_b16 v[94:95], v8 offset:17440
    v_mfma_f32_16x16x32_bf16 v[24:27], a[196:199], v[96:99], v[24:27]
    v_cmp_eq_u32 vcc, -1, v12
    v_mfma_f32_16x16x32_bf16 v[40:43], v[244:247], v[96:99], v[40:43]
    ds_read_b64_tr_b16 v[96:97], v8 offset:16960
    ds_read_b64_tr_b16 v[98:99], v8 offset:17472
    s_xor_b32 s40, s59, 2048
    buffer_load_dwordx4 a[140:143], v6, s[16:19], s40 offen offset:1024 sc1
    v_mfma_f32_16x16x32_bf16 v[28:31], a[196:199], v[100:103], v[28:31]
    s_cbranch_vccnz pk_c13_s
pk_c13_r:
    v_mfma_f32_16x16x32_bf16 v[44:47], v[244:247], v[100:103], v[44:47]
    ds_read_b64_tr_b16 v[100:101], v8 offset:16992
    ds_read_b64_tr_b16 v[102:103], v8 offset:17504
    buffer_load_dwordx4 v[188:191], v7, s[16:19], s40 offen offset:1024 sc1
    v_mfma_f32_16x16x32_bf16 v[16:19], a[200:203], v[104:107], v[16:19]
    s_waitcnt vmcnt(8)
    v_accvgpr_read_b32 v12, a204
    v_mfma_f32_16x16x32_bf16 v[32:35], v[248:251], v[104:107], v[32:35]
    ds_read_b64_tr_b16 v[104:105], v8 offset:21120
    ds_read_b64_tr_b16 v[106:107], v8 offset:21632
    v_mfma_f32_16x16x32_bf16 v[20:23], a[200:203], v[108:111], v[20:23]
    v_max_u32 v12, v12, v252
    v_mfma_f32_16x16x32_bf16 v[36:39], v[248:251], v[108:111], v[36:39]
    ds_read_b64_tr_b16 v[108:109], v8 offset:21152
    ds_read_b64_tr_b16 v[110:111], v8 offset:21664
    v_mfma_f32_16x16x32_bf16 v[24:27], a[200:203], v[112:115], v[24:27]
    v_cmp_eq_u32 vcc, -1, v12
    v_mfma_f32_16x16x32_bf16 v[40:43], v[248:251], v[112:115], v[40:43]
    ds_read_b64_tr_b16 v[112:113], v8 offset:21184
    ds_read_b64_tr_b16 v[114:115], v8 offset:21696
    s_xor_b32 s40, s59, 4096
    buffer_load_dwordx4 a[144:147], v6, s[16:19], s40 offen offset:0 sc1
    v_mfma_f32_16x16x32_bf16 v[28:31], a[200:203], v[116:119], v[28:31]
    s_cbranch_vccnz pk_c14_s
pk_c14_r:
    v_mfma_f32_16x16x32_bf16 v[44:47], v[248:251], v[116:119], v[44:47]
    ds_read_b64_tr_b16 v[116:117], v8 offset:21216
    ds_read_b64_tr_b16 v[118:119], v8 offset:21728
    buffer_load_dwordx4 v[192:195], v7, s[16:19], s40 offen offset:0 sc1
    v_mfma_f32_16x16x32_bf16 v[16:19], a[204:207], v[120:123], v[16:19]
    s_waitcnt vmcnt(8)
    v_accvgpr_read_b32 v12, a128
    v_mfma_f32_16x16x32_bf16 v[32:35], v[252:255], v[120:123], v[32:35]
    ds_read_b64_tr_b16 v[120:121], v8 offset:25344
    ds_read_b64_tr_b16 v[122:123], v8 offset:25856
    v_mfma_f32_16x16x32_bf16 v[20:23], a[204:207], v[124:127], v[20:23]
    v_max_u32 v12, v12, v176
    v_mfma_f32_16x16x32_bf16 v[36:39], v[252:255], v[124:127], v[36:39]
    ds_read_b64_tr_b16 v[124:125], v8 offset:25376
    ds_read_b64_tr_b16 v[126:127], v8 offset:25888
    v_mfma_f32_16x16x32_bf16 v[24:27], a[204:207], v[128:131], v[24:27]
    v_cmp_eq_u32 vcc, -1, v12
    v_mfma_f32_16x16x32_bf16 v[40:43], v[252:255], v[128:131], v[40:43]
    ds_read_b64_tr_b16 v[128:129], v8 offset:25408
    ds_read_b64_tr_b16 v[130:131], v8 offset:25920
    s_xor_b32 s40, s59, 4096
    buffer_load_dwordx4 a[148:151], v6, s[16:19], s40 offen offset:1024 sc1
    v_mfma_f32_16x16x32_bf16 v[28:31], a[204:207], v[132:135], v[28:31]
    s_cbranch_vccnz pk_c15_s
pk_c15_r:
    v_mfma_f32_16x16x32_bf16 v[44:47], v[252:255], v[132:135], v[44:47]
    ds_read_b64_tr_b16 v[132:133], v8 offset:25440
    ds_read_b64_tr_b16 v[134:135], v8 offset:25952
    buffer_load_dwordx4 v[196:199], v7, s[16:19], s40 offen offset:1024 sc1
    v_mfma_f32_16x16x32_bf16 v[16:19], a[128:131], a[208:211], v[16:19]
    s_waitcnt vmcnt(8)
    v_accvgpr_read_b32 v12, a132
    v_mfma_f32_16x16x32_bf16 v[32:35], v[176:179], a[208:211], v[32:35]
    ds_read_b64_tr_b16 a[208:209], v8 offset:29568
    ds_read_b64_tr_b16 a[210:211], v8 offset:30080
    v_mfma_f32_16x16x32_bf16 v[20:23], a[128:131], a[212:215], v[20:23]
    v_max_u32 v12, v12, v180
    v_mfma_f32_16x16x32_bf16 v[36:39], v[176:179], a[212:215], v[36:39]
    ds_read_b64_tr_b16 a[212:213], v8 offset:29600
    ds_read_b64_tr_b16 a[214:215], v8 offset:30112
    v_mfma_f32_16x16x32_bf16 v[24:27], a[128:131], a[216:219], v[24:27]
    v_cmp_eq_u32 vcc, -1, v12
    v_mfma_f32_16x16x32_bf16 v[40:43], v[176:179], a[216:219], v[40:43]
    ds_read_b64_tr_b16 a[216:217], v8 offset:29632
    ds_read_b64_tr_b16 a[218:219], v8 offset:30144
    s_xor_b32 s40, s59, 6144
    buffer_load_dwordx4 a[152:155], v6, s[16:19], s40 offen offset:0 sc1
    v_mfma_f32_16x16x32_bf16 v[28:31], a[128:131], a[220:223], v[28:31]
    s_cbranch_vccnz pk_c16_s
pk_c16_r:
    v_mfma_f32_16x16x32_bf16 v[44:47], v[176:179], a[220:223], v[44:47]
    ds_read_b64_tr_b16 a[220:221], v8 offset:29664
    ds_read_b64_tr_b16 a[222:223], v8 offset:30176
    buffer_load_dwordx4 v[200:203], v7, s[16:19], s40 offen offset:0 sc1
    s_waitcnt lgkmcnt(15)
    v_mfma_f32_16x16x32_bf16 v[16:19], a[132:135], a[224:227], v[16:19]
    s_waitcnt vmcnt(8)
    v_accvgpr_read_b32 v12, a136
    v_mfma_f32_16x16x32_bf16 v[32:35], v[180:183], a[224:227], v[32:35]
    ds_read_b64_tr_b16 a[224:225], v8 offset:33792
    ds_read_b64_tr_b16 a[226:227], v8 offset:34304
    v_mfma_f32_16x16x32_bf16 v[20:23], a[132:135], a[228:231], v[20:23]
    v_max_u32 v12, v12, v184
    v_mfma_f32_16x16x32_bf16 v[36:39], v[180:183], a[228:231], v[36:39]
    ds_read_b64_tr_b16 a[228:229], v8 offset:33824
    ds_read_b64_tr_b16 a[230:231], v8 offset:34336
    v_mfma_f32_16x16x32_bf16 v[24:27], a[132:135], a[232:235], v[24:27]
    v_cmp_eq_u32 vcc, -1, v12
    v_mfma_f32_16x16x32_bf16 v[40:43], v[180:183], a[232:235], v[40:43]
    ds_read_b64_tr_b16 a[232:233], v8 offset:33856
    ds_read_b64_tr_b16 a[234:235], v8 offset:34368
    s_xor_b32 s40, s59, 6144
    buffer_load_dwordx4 a[156:159], v6, s[16:19], s40 offen offset:1024 sc1
    v_mfma_f32_16x16x32_bf16 v[28:31], a[132:135], a[236:239], v[28:31]
    s_cbranch_vccnz pk_c17_s
pk_c17_r:
    v_mfma_f32_16x16x32_bf16 v[44:47], v[180:183], a[236:239], v[44:47]
    ds_read_b64_tr_b16 a[236:237], v8 offset:33888
    ds_read_b64_tr_b16 a[238:239], v8 offset:34400
    buffer_load_dwordx4 v[204:207], v7, s[16:19], s40 offen offset:1024 sc1
    v_mfma_f32_16x16x32_bf16 v[16:19], a[136:139], a[240:243], v[16:19]
    s_waitcnt vmcnt(8)
    v_accvgpr_read_b32 v12, a140
    v_mfma_f32_16x16x32_bf16 v[32:35], v[184:187], a[240:243], v[32:35]
    ds_read_b64_tr_b16 a[240:241], v8 offset:38016
    ds_read_b64_tr_b16 a[242:243], v8 offset:38528
    v_mfma_f32_16x16x32_bf16 v[20:23], a[136:139], a[244:247], v[20:23]
    v_max_u32 v12, v12, v188
    v_mfma_f32_16x16x32_bf16 v[36:39], v[184:187], a[244:247], v[36:39]
    ds_read_b64_tr_b16 a[244:245], v8 offset:38048
    ds_read_b64_tr_b16 a[246:247], v8 offset:38560
    v_mfma_f32_16x16x32_bf16 v[24:27], a[136:139], a[248:251], v[24:27]
    v_cmp_eq_u32 vcc, -1, v12
    v_mfma_f32_16x16x32_bf16 v[40:43], v[184:187], a[248:251], v[40:43]
    ds_read_b64_tr_b16 a[248:249], v8 offset:38080
    ds_read_b64_tr_b16 a[250:251], v8 offset:38592
    s_xor_b32 s40, s59, 8192
    buffer_load_dwordx4 a[160:163], v6, s[16:19], s40 offen offset:0 sc1
    v_mfma_f32_16x16x32_bf16 v[28:31], a[136:139], a[252:255], v[28:31]
    s_cbranch_vccnz pk_c18_s
pk_c18_r:
    v_mfma_f32_16x16x32_bf16 v[44:47], v[184:187], a[252:255], v[44:47]
    ds_read_b64_tr_b16 a[252:253], v8 offset:38112
    ds_read_b64_tr_b16 a[254:255], v8 offset:38624
    buffer_load_dwordx4 v[208:211], v7, s[16:19], s40 offen offset:0 sc1
    v_mfma_f32_16x16x32_bf16 v[16:19], a[140:143], v[72:75], v[16:19]
    s_waitcnt vmcnt(8)
    v_accvgpr_read_b32 v12, a144
    v_mfma_f32_16x16x32_bf16 v[32:35], v[188:191], v[72:75], v[32:35]
    ds_read_b64_tr_b16 v[72:73], v9 offset:0
    ds_read_b64_tr_b16 v[74:75], v9 offset:512
    v_mfma_f32_16x16x32_bf16 v[20:23], a[140:143], v[76:79], v[20:23]
    v_max_u32 v12, v12, v192
    v_mfma_f32_16x16x32_bf16 v[36:39], v[188:191], v[76:79], v[36:39]
    ds_read_b64_tr_b16 v[76:77], v9 offset:32
    ds_read_b64_tr_b16 v[78:79], v9 offset:544
    v_mfma_f32_16x16x32_bf16 v[24:27], a[140:143], v[80:83], v[24:27]
    v_cmp_eq_u32 vcc, -1, v12
    v_mfma_f32_16x16x32_bf16 v[40:43], v[188:191], v[80:83], v[40:43]
    ds_read_b64_tr_b16 v[80:81], v9 offset:64
    ds_read_b64_tr_b16 v[82:83], v9 offset:576
    s_xor_b32 s40, s59, 8192
    buffer_load_dwordx4 a[164:167], v6, s[16:19], s40 offen offset:1024 sc1
    v_mfma_f32_16x16x32_bf16 v[28:31], a[140:143], v[84:87], v[28:31]
    s_cbranch_vccnz pk_c19_s
pk_c19_r:
    v_mfma_f32_16x16x32_bf16 v[44:47], v[188:191], v[84:87], v[44:47]
    ds_read_b64_tr_b16 v[84:85], v9 offset:96
    ds_read_b64_tr_b16 v[86:87], v9 offset:608
    buffer_load_dwordx4 v[212:215], v7, s[16:19], s40 offen offset:1024 sc1
    v_mfma_f32_16x16x32_bf16 v[16:19], a[144:147], v[88:91], v[16:19]
    s_waitcnt vmcnt(8)
    v_accvgpr_read_b32 v12, a148
    v_mfma_f32_16x16x32_bf16 v[32:35], v[192:195], v[88:91], v[32:35]
    ds_read_b64_tr_b16 v[88:89], v9 offset:4224
    ds_read_b64_tr_b16 v[90:91], v9 offset:4736
    v_mfma_f32_16x16x32_bf16 v[20:23], a[144:147], v[92:95], v[20:23]
    v_max_u32 v12, v12, v196
    v_mfma_f32_16x16x32_bf16 v[36:39], v[192:195], v[92:95], v[36:39]
    ds_read_b64_tr_b16 v[92:93], v9 offset:4256
    ds_read_b64_tr_b16 v[94:95], v9 offset:4768
    v_mfma_f32_16x16x32_bf16 v[24:27], a[144:147], v[96:99], v[24:27]
    v_cmp_eq_u32 vcc, -1, v12
    v_mfma_f32_16x16x32_bf16 v[40:43], v[192:195], v[96:99], v[40:43]
    ds_read_b64_tr_b16 v[96:97], v9 offset:4288
    ds_read_b64_tr_b16 v[98:99], v9 offset:4800
    s_xor_b32 s40, s59, 10240
    buffer_load_dwordx4 a[168:171], v6, s[16:19], s40 offen offset:0 sc1
    v_mfma_f32_16x16x32_bf16 v[28:31], a[144:147], v[100:103], v[28:31]
    s_cbranch_vccnz pk_c20_s
pk_c20_r:
    v_mfma_f32_16x16x32_bf16 v[44:47], v[192:195], v[100:103], v[44:47]
    ds_read_b64_tr_b16 v[100:101], v9 offset:4320
    ds_read_b64_tr_b16 v[102:103], v9 offset:4832
    buffer_load_dwordx4 v[216:219], v7, s[16:19], s40 offen offset:0 sc1
    v_mfma_f32_16x16x32_bf16 v[16:19], a[148:151], v[104:107], v[16:19]
    s_waitcnt vmcnt(8)
    v_accvgpr_read_b32 v12, a152
    v_mfma_f32_16x16x32_bf16 v[32:35], v[196:199], v[104:107], v[32:35]
    ds_read_b64_tr_b16 v[104:105], v9 offset:8448
    ds_read_b64_tr_b16 v[106:107], v9 offset:8960
    v_mfma_f32_16x16x32_bf16 v[20:23], a[148:151], v[108:111], v[20:23]
    v_max_u32 v12, v12, v200
    v_mfma_f32_16x16x32_bf16 v[36:39], v[196:199], v[108:111], v[36:39]
    ds_read_b64_tr_b16 v[108:109], v9 offset:8480
    ds_read_b64_tr_b16 v[110:111], v9 offset:8992
    v_mfma_f32_16x16x32_bf16 v[24:27], a[148:151], v[112:115], v[24:27]
    v_cmp_eq_u32 vcc, -1, v12
    v_mfma_f32_16x16x32_bf16 v[40:43], v[196:199], v[112:115], v[40:43]
    ds_read_b64_tr_b16 v[112:113], v9 offset:8512
    ds_read_b64_tr_b16 v[114:115], v9 offset:9024
    s_xor_b32 s40, s59, 10240
    buffer_load_dwordx4 a[172:175], v6, s[16:19], s40 offen offset:1024 sc1
    v_mfma_f32_16x16x32_bf16 v[28:31], a[148:151], v[116:119], v[28:31]
    s_cbranch_vccnz pk_c21_s
pk_c21_r:
    v_mfma_f32_16x16x32_bf16 v[44:47], v[196:199], v[116:119], v[44:47]
    ds_read_b64_tr_b16 v[116:117], v9 offset:8544
    ds_read_b64_tr_b16 v[118:119], v9 offset:9056
    buffer_load_dwordx4 v[220:223], v7, s[16:19], s40 offen offset:1024 sc1
    s_waitcnt lgkmcnt(15)
    v_mfma_f32_16x16x32_bf16 v[16:19], a[152:155], v[120:123], v[16:19]
    s_waitcnt vmcnt(8)
    v_accvgpr_read_b32 v12, a156
    v_mfma_f32_16x16x32_bf16 v[32:35], v[200:203], v[120:123], v[32:35]
    ds_read_b64_tr_b16 v[120:121], v9 offset:12672
    ds_read_b64_tr_b16 v[122:123], v9 offset:13184
    v_mfma_f32_16x16x32_bf16 v[20:23], a[152:155], v[124:127], v[20:23]
    v_max_u32 v12, v12, v204
    v_mfma_f32_16x16x32_bf16 v[36:39], v[200:203], v[124:127], v[36:39]
    ds_read_b64_tr_b16 v[124:125], v9 offset:12704
    ds_read_b64_tr_b16 v[126:127], v9 offset:13216
    v_mfma_f32_16x16x32_bf16 v[24:27], a[152:155], v[128:131], v[24:27]
    v_cmp_eq_u32 vcc, -1, v12
    v_mfma_f32_16x16x32_bf16 v[40:43], v[200:203], v[128:131], v[40:43]
    ds_read_b64_tr_b16 v[128:129], v9 offset:12736
    ds_read_b64_tr_b16 v[130:131], v9 offset:13248
    s_xor_b32 s40, s59, 12288
    buffer_load_dwordx4 a[176:179], v6, s[16:19], s40 offen offset:0 sc1
    v_mfma_f32_16x16x32_bf16 v[28:31], a[152:155], v[132:135], v[28:31]
    s_cbranch_vccnz pk_c22_s
pk_c22_r:
    v_mfma_f32_16x16x32_bf16 v[44:47], v[200:203], v[132:135], v[44:47]
    ds_read_b64_tr_b16 v[132:133], v9 offset:12768
    ds_read_b64_tr_b16 v[134:135], v9 offset:13280
    buffer_load_dwordx4 v[224:227], v7, s[16:19], s40 offen offset:0 sc1
    v_mfma_f32_16x16x32_bf16 v[16:19], a[156:159], a[208:211], v[16:19]
    s_waitcnt vmcnt(8)
    v_accvgpr_read_b32 v12, a160
    v_mfma_f32_16x16x32_bf16 v[32:35], v[204:207], a[208:211], v[32:35]
    ds_read_b64_tr_b16 a[208:209], v9 offset:16896
    ds_read_b64_tr_b16 a[210:211], v9 offset:17408
    v_mfma_f32_16x16x32_bf16 v[20:23], a[156:159], a[212:215], v[20:23]
    v_max_u32 v12, v12, v208
    v_mfma_f32_16x16x32_bf16 v[36:39], v[204:207], a[212:215], v[36:39]
    ds_read_b64_tr_b16 a[212:213], v9 offset:16928
    ds_read_b64_tr_b16 a[214:215], v9 offset:17440
    v_mfma_f32_16x16x32_bf16 v[24:27], a[156:159], a[216:219], v[24:27]
    v_cmp_eq_u32 vcc, -1, v12
    v_mfma_f32_16x16x32_bf16 v[40:43], v[204:207], a[216:219], v[40:43]
    ds_read_b64_tr_b16 a[216:217], v9 offset:16960
    ds_read_b64_tr_b16 a[218:219], v9 offset:17472
    s_xor_b32 s40, s59, 12288
    buffer_load_dwordx4 a[180:183], v6, s[16:19], s40 offen offset:1024 sc1
    v_mfma_f32_16x16x32_bf16 v[28:31], a[156:159], a[220:223], v[28:31]
    s_cbranch_vccnz pk_c23_s
pk_c23_r:
    v_mfma_f32_16x16x32_bf16 v[44:47], v[204:207], a[220:223], v[44:47]
    ds_read_b64_tr_b16 a[220:221], v9 offset:16992
    ds_read_b64_tr_b16 a[222:223], v9 offset:17504
    buffer_load_dwordx4 v[228:231], v7, s[16:19], s40 offen offset:1024 sc1
    v_mfma_f32_16x16x32_bf16 v[16:19], a[160:163], a[224:227], v[16:19]
    s_waitcnt vmcnt(8)
    v_accvgpr_read_b32 v12, a164
    v_mfma_f32_16x16x32_bf16 v[32:35], v[208:211], a[224:227], v[32:35]
    ds_read_b64_tr_b16 a[224:225], v9 offset:21120
    ds_read_b64_tr_b16 a[226:227], v9 offset:21632
    v_mfma_f32_16x16x32_bf16 v[20:23], a[160:163], a[228:231], v[20:23]
    v_max_u32 v12, v12, v212
    v_mfma_f32_16x16x32_bf16 v[36:39], v[208:211], a[228:231], v[36:39]
    ds_read_b64_tr_b16 a[228:229], v9 offset:21152
    ds_read_b64_tr_b16 a[230:231], v9 offset:21664
    v_mfma_f32_16x16x32_bf16 v[24:27], a[160:163], a[232:235], v[24:27]
    v_cmp_eq_u32 vcc, -1, v12
    v_mfma_f32_16x16x32_bf16 v[40:43], v[208:211], a[232:235], v[40:43]
    ds_read_b64_tr_b16 a[232:233], v9 offset:21184
    ds_read_b64_tr_b16 a[234:235], v9 offset:21696
    s_xor_b32 s40, s59, 14336
    buffer_load_dwordx4 a[184:187], v6, s[16:19], s40 offen offset:0 sc1
    v_mfma_f32_16x16x32_bf16 v[28:31], a[160:163], a[236:239], v[28:31]
    s_cbranch_vccnz pk_c24_s
pk_c24_r:
    v_mfma_f32_16x16x32_bf16 v[44:47], v[208:211], a[236:239], v[44:47]
    ds_read_b64_tr_b16 a[236:237], v9 offset:21216
    ds_read_b64_tr_b16 a[238:239], v9 offset:21728
    buffer_load_dwordx4 v[232:235], v7, s[16:19], s40 offen offset:0 sc1
    v_mfma_f32_16x16x32_bf16 v[16:19], a[164:167], a[240:243], v[16:19]
    s_waitcnt vmcnt(8)
    v_accvgpr_read_b32 v12, a168
    v_mfma_f32_16x16x32_bf16 v[32:35], v[212:215], a[240:243], v[32:35]
    v_mfma_f32_16x16x32_bf16 v[20:23], a[164:167], a[244:247], v[20:23]
    v_max_u32 v12, v12, v216
    v_mfma_f32_16x16x32_bf16 v[36:39], v[212:215], a[244:247], v[36:39]
    v_mfma_f32_16x16x32_bf16 v[24:27], a[164:167], a[248:251], v[24:27]
    v_cmp_eq_u32 vcc, -1, v12
    v_mfma_f32_16x16x32_bf16 v[40:43], v[212:215], a[248:251], v[40:43]
    s_xor_b32 s40, s59, 14336
    buffer_load_dwordx4 a[188:191], v6, s[16:19], s40 offen offset:1024 sc1
    v_mfma_f32_16x16x32_bf16 v[28:31], a[164:167], a[252:255], v[28:31]
    s_cbranch_vccnz pk_c25_s
pk_c25_r:
    v_mfma_f32_16x16x32_bf16 v[44:47], v[212:215], a[252:255], v[44:47]
    buffer_load_dwordx4 v[236:239], v7, s[16:19], s40 offen offset:1024 sc1
    v_mfma_f32_16x16x32_bf16 v[16:19], a[168:171], v[72:75], v[16:19]
    s_waitcnt vmcnt(8)
    v_accvgpr_read_b32 v12, a172
    v_mfma_f32_16x16x32_bf16 v[32:35], v[216:219], v[72:75], v[32:35]
    v_mfma_f32_16x16x32_bf16 v[20:23], a[168:171], v[76:79], v[20:23]
    v_max_u32 v12, v12, v220
    v_mfma_f32_16x16x32_bf16 v[36:39], v[216:219], v[76:79], v[36:39]
    v_mfma_f32_16x16x32_bf16 v[24:27], a[168:171], v[80:83], v[24:27]
    v_cmp_eq_u32 vcc, -1, v12
    v_mfma_f32_16x16x32_bf16 v[40:43], v[216:219], v[80:83], v[40:43]
    s_andn2_b32 s45, 7, s2
    s_lshl_b32 s45, s45, 5
    s_lshr_b32 s46, s2, 3
    s_add_u32 s45, s45, s46
    s_lshl_b32 s45, s45, 2
    s_add_u32 s45, s45, s32
    s_lshl_b32 s45, s45, 13
    s_mov_b32 s46, 8
    s_bitcmp1_b32 s46, s32
    s_cselect_b32 s45, s45, 0x7f000000
    v_lshlrev_b32 v10, 7, v1
    v_add_u32 v10, s45, v10
    buffer_load_dword v13, v10, s[24:27], 0 offen
    v_mfma_f32_16x16x32_bf16 v[28:31], a[168:171], v[84:87], v[28:31]
    s_cbranch_vccnz pk_c26_s
pk_c26_r:
    v_mfma_f32_16x16x32_bf16 v[44:47], v[216:219], v[84:87], v[44:47]
    buffer_store_dwordx4 v[146:149], v3, s[16:19], s44 offen offset:0 sc1
    s_waitcnt lgkmcnt(15)
    v_mfma_f32_16x16x32_bf16 v[16:19], a[172:175], v[88:91], v[16:19]
    s_waitcnt vmcnt(8)
    v_accvgpr_read_b32 v12, a176
    v_mfma_f32_16x16x32_bf16 v[32:35], v[220:223], v[88:91], v[32:35]
    v_mfma_f32_16x16x32_bf16 v[20:23], a[172:175], v[92:95], v[20:23]
    v_max_u32 v12, v12, v224
    v_mfma_f32_16x16x32_bf16 v[36:39], v[220:223], v[92:95], v[36:39]
    v_mfma_f32_16x16x32_bf16 v[24:27], a[172:175], v[96:99], v[24:27]
    v_cmp_eq_u32 vcc, -1, v12
    v_mfma_f32_16x16x32_bf16 v[40:43], v[220:223], v[96:99], v[40:43]
    buffer_store_dwordx4 v[146:149], v3, s[16:19], s44 offen offset:1024 sc1
    v_mfma_f32_16x16x32_bf16 v[28:31], a[172:175], v[100:103], v[28:31]
    s_cbranch_vccnz pk_c27_s
pk_c27_r:
    v_mfma_f32_16x16x32_bf16 v[44:47], v[220:223], v[100:103], v[44:47]
    buffer_store_dwordx4 v[146:149], v3, s[16:19], s44 offen offset:2048 sc1
    v_mfma_f32_16x16x32_bf16 v[16:19], a[176:179], v[104:107], v[16:19]
    s_waitcnt vmcnt(8)
    v_accvgpr_read_b32 v12, a180
    v_mfma_f32_16x16x32_bf16 v[32:35], v[224:227], v[104:107], v[32:35]
    v_mfma_f32_16x16x32_bf16 v[20:23], a[176:179], v[108:111], v[20:23]
    v_max_u32 v12, v12, v228
    v_mfma_f32_16x16x32_bf16 v[36:39], v[224:227], v[108:111], v[36:39]
    v_mfma_f32_16x16x32_bf16 v[24:27], a[176:179], v[112:115], v[24:27]
    v_cmp_eq_u32 vcc, -1, v12
    v_mfma_f32_16x16x32_bf16 v[40:43], v[224:227], v[112:115], v[40:43]
    buffer_store_dwordx4 v[146:149], v3, s[16:19], s44 offen offset:2432 sc1
    v_mfma_f32_16x16x32_bf16 v[28:31], a[176:179], v[116:119], v[28:31]
    s_cbranch_vccnz pk_c28_s
pk_c28_r:
    v_mfma_f32_16x16x32_bf16 v[44:47], v[224:227], v[116:119], v[44:47]
    v_mfma_f32_16x16x32_bf16 v[16:19], a[180:183], v[120:123], v[16:19]
    s_waitcnt vmcnt(7)
    v_accvgpr_read_b32 v12, a184
    v_mfma_f32_16x16x32_bf16 v[32:35], v[228:231], v[120:123], v[32:35]
    v_mfma_f32_16x16x32_bf16 v[20:23], a[180:183], v[124:127], v[20:23]
    v_max_u32 v12, v12, v232
    v_mfma_f32_16x16x32_bf16 v[36:39], v[228:231], v[124:127], v[36:39]
    v_mfma_f32_16x16x32_bf16 v[24:27], a[180:183], v[128:131], v[24:27]
    v_cmp_eq_u32 vcc, -1, v12
    v_mfma_f32_16x16x32_bf16 v[40:43], v[228:231], v[128:131], v[40:43]
    v_mfma_f32_16x16x32_bf16 v[28:31], a[180:183], v[132:135], v[28:31]
    s_cbranch_vccnz pk_c29_s
pk_c29_r:
    v_mfma_f32_16x16x32_bf16 v[44:47], v[228:231], v[132:135], v[44:47]
    s_waitcnt lgkmcnt(8)
    v_mfma_f32_16x16x32_bf16 v[16:19], a[184:187], a[208:211], v[16:19]
    s_waitcnt vmcnt(5)
    v_accvgpr_read_b32 v12, a188
    v_mfma_f32_16x16x32_bf16 v[32:35], v[232:235], a[208:211], v[32:35]
    v_mfma_f32_16x16x32_bf16 v[20:23], a[184:187], a[212:215], v[20:23]
    v_max_u32 v12, v12, v236
    v_mfma_f32_16x16x32_bf16 v[36:39], v[232:235], a[212:215], v[36:39]
    v_mfma_f32_16x16x32_bf16 v[24:27], a[184:187], a[216:219], v[24:27]
    v_cmp_eq_u32 vcc, -1, v12
    v_mfma_f32_16x16x32_bf16 v[40:43], v[232:235], a[216:219], v[40:43]
    v_mfma_f32_16x16x32_bf16 v[28:31], a[184:187], a[220:223], v[28:31]
    s_cbranch_vccnz pk_c30_s
pk_c30_r:
    v_mfma_f32_16x16x32_bf16 v[44:47], v[232:235], a[220:223], v[44:47]
    s_waitcnt lgkmcnt(0)
    v_mfma_f32_16x16x32_bf16 v[16:19], a[188:191], a[224:227], v[16:19]
    v_mfma_f32_16x16x32_bf16 v[32:35], v[236:239], a[224:227], v[32:35]
    v_mfma_f32_16x16x32_bf16 v[20:23], a[188:191], a[228:231], v[20:23]
    v_mfma_f32_16x16x32_bf16 v[36:39], v[236:239], a[228:231], v[36:39]
    v_mfma_f32_16x16x32_bf16 v[24:27], a[188:191], a[232:235], v[24:27]
    v_mfma_f32_16x16x32_bf16 v[40:43], v[236:239], a[232:235], v[40:43]
    v_mfma_f32_16x16x32_bf16 v[28:31], a[188:191], a[236:239], v[28:31]
    v_mfma_f32_16x16x32_bf16 v[44:47], v[236:239], a[236:239], v[44:47]
    s_barrier
    ds_read_b64_tr_b16 v[72:73], v14 offset:0
    ds_read_b64_tr_b16 v[74:75], v14 offset:1536
    ds_read_b64_tr_b16 v[76:77], v14 offset:32
    ds_read_b64_tr_b16 v[78:79], v14 offset:1568
    ds_read_b64_tr_b16 v[80:81], v14 offset:64
    ds_read_b64_tr_b16 v[82:83], v14 offset:1600
    v_cvt_pk_bf16_f32 v168, v16, v17
    v_cvt_pk_bf16_f32 v170, v18, v19
    v_cvt_pk_bf16_f32 v172, v32, v33
    v_cvt_pk_bf16_f32 v174, v34, v35
    v_lshlrev_b32 v16, 16, v168
    v_and_b32 v17, 0xffff0000, v168
    v_lshlrev_b32 v18, 16, v170
    v_and_b32 v19, 0xffff0000, v170
    v_lshlrev_b32 v32, 16, v172
    s_add_u32 m0, s39, 0
    s_xor_b32 s46, s3, 0
    buffer_load_dwordx4 v150, s[24:27], s46 offen lds
    v_and_b32 v33, 0xffff0000, v172
    v_lshlrev_b32 v34, 16, v174
    v_and_b32 v35, 0xffff0000, v174
    v_pk_mul_f32 v[168:169], v[16:17], v[16:17]
    v_pk_mul_f32 v[170:171], v[18:19], v[18:19]
    v_pk_mul_f32 v[172:173], v[32:33], v[32:33]
    v_pk_mul_f32 v[174:175], v[34:35], v[34:35]
    v_pk_fma_f32 v[168:169], v[168:169], v[138:139], v[136:137]
    v_pk_fma_f32 v[170:171], v[170:171], v[138:139], v[136:137]
    v_pk_fma_f32 v[172:173], v[172:173], v[138:139], v[136:137]
    v_pk_fma_f32 v[174:175], v[174:175], v[138:139], v[136:137]
    v_pk_mul_f32 v[168:169], v[168:169], v[16:17]
    v_pk_mul_f32 v[170:171], v[170:171], v[18:19]
    v_pk_mul_f32 v[172:173], v[172:173], v[32:33]
    v_pk_mul_f32 v[174:175], v[174:175], v[34:35]
    buffer_store_dwordx4 v[152:155], v3, s[16:19], s94 offen sc1
    v_exp_f32 v168, v168
    v_exp_f32 v169, v169
    v_exp_f32 v170, v170
    v_exp_f32 v171, v171
    s_add_u32 m0, s39, 1024
    s_xor_b32 s46, s3, 0
    buffer_load_dwordx4 v151, s[24:27], s46 offen lds
    v_exp_f32 v172, v172
    v_exp_f32 v173, v173
    v_exp_f32 v174, v174
    v_exp_f32 v175, v175
    buffer_store_dwordx4 v[156:159], v3, s[16:19], s95 offen sc1
    v_pk_add_f32 v[168:169], v[168:169], v[140:141]
    v_pk_add_f32 v[170:171], v[170:171], v[140:141]
    v_pk_add_f32 v[172:173], v[172:173], v[140:141]
    v_pk_add_f32 v[174:175], v[174:175], v[140:141]
    v_rcp_f32 v168, v168
    v_rcp_f32 v169, v169
    v_rcp_f32 v170, v170
    s_add_u32 m0, s39, 2048
    s_xor_b32 s46, s3, 16384
    buffer_load_dwordx4 v150, s[24:27], s46 offen lds
    v_rcp_f32 v171, v171
    v_rcp_f32 v172, v172
    v_rcp_f32 v173, v173
    v_rcp_f32 v174, v174
    s_mov_b32 exec_hi, 0
    buffer_store_dwordx4 v[160:163], v164, s[16:19], 0 offen sc1
    s_mov_b32 exec_hi, -1
    v_rcp_f32 v175, v175
    v_pk_mul_f32 v[16:17], v[16:17], v[168:169]
    v_pk_mul_f32 v[18:19], v[18:19], v[170:171]
    v_pk_mul_f32 v[32:33], v[32:33], v[172:173]
    v_pk_mul_f32 v[34:35], v[34:35], v[174:175]
    v_cvt_pk_bf16_f32 v142, v16, v17
    v_cvt_pk_bf16_f32 v143, v18, v19
    v_cvt_pk_bf16_f32 v144, v32, v33
    v_cvt_pk_bf16_f32 v145, v34, v35
    s_nop 1
    v_mov_b32 v152, 0
    v_mov_b32 v153, 0
    s_add_u32 m0, s39, 3072
    s_xor_b32 s46, s3, 16384
    buffer_load_dwordx4 v151, s[24:27], s46 offen lds
    v_mov_b32 v154, 0
    v_mov_b32 v155, 0
    v_mov_b32 v156, 0
    v_mov_b32 v157, 0
    v_mov_b32 v158, 0
    v_mov_b32 v159, 0
    v_mov_b32 v160, 0
    v_mov_b32 v161, 0
    v_mov_b32 v162, 0
    v_mov_b32 v163, 0
    v_mov_b32 v164, 0
    v_mov_b32 v165, 0
    v_mov_b32 v166, 0
    v_mov_b32 v167, 0
    ds_read_b64_tr_b16 v[84:85], v14 offset:3072
    s_add_u32 m0, s39, 4096
    s_xor_b32 s46, s3, 65536
    buffer_load_dwordx4 v150, s[24:27], s46 offen lds
    ds_read_b64_tr_b16 v[86:87], v14 offset:4608
    ds_read_b64_tr_b16 v[88:89], v14 offset:3104
    ds_read_b64_tr_b16 v[90:91], v14 offset:4640
    ds_read_b64_tr_b16 v[92:93], v14 offset:3136
    ds_read_b64_tr_b16 v[94:95], v14 offset:4672
    v_lshlrev_b32 v16, 16, v142
    v_and_b32 v17, 0xffff0000, v142
    v_lshlrev_b32 v18, 16, v143
    v_and_b32 v19, 0xffff0000, v143
    v_lshlrev_b32 v32, 16, v144
    v_and_b32 v33, 0xffff0000, v144
    v_lshlrev_b32 v34, 16, v145
    v_and_b32 v35, 0xffff0000, v145
    v_pk_add_f32 v[152:153], v[152:153], v[16:17]
    v_pk_fma_f32 v[160:161], v[16:17], v[16:17], v[160:161]
    s_add_u32 m0, s39, 5120
    s_xor_b32 s46, s3, 65536
    buffer_load_dwordx4 v151, s[24:27], s46 offen lds
    v_pk_add_f32 v[154:155], v[154:155], v[18:19]
    v_pk_fma_f32 v[162:163], v[18:19], v[18:19], v[162:163]
    v_pk_add_f32 v[156:157], v[156:157], v[32:33]
    v_pk_fma_f32 v[164:165], v[32:33], v[32:33], v[164:165]
    v_pk_add_f32 v[158:159], v[158:159], v[34:35]
    v_pk_fma_f32 v[166:167], v[34:35], v[34:35], v[166:167]
    ds_read_b64_tr_b16 v[96:97], v14 offset:6144
    ds_read_b64_tr_b16 v[98:99], v14 offset:7680
    ds_read_b64_tr_b16 v[100:101], v14 offset:6176
    ds_read_b64_tr_b16 v[102:103], v14 offset:7712
    ds_read_b64_tr_b16 v[104:105], v14 offset:6208
    ds_read_b64_tr_b16 v[106:107], v14 offset:7744
    v_cvt_pk_bf16_f32 v168, v20, v21
    v_cvt_pk_bf16_f32 v170, v22, v23
    v_cvt_pk_bf16_f32 v172, v36, v37
    s_add_u32 m0, s39, 6144
    s_xor_b32 s46, s3, 81920
    buffer_load_dwordx4 v150, s[24:27], s46 offen lds
    v_cvt_pk_bf16_f32 v174, v38, v39
    v_lshlrev_b32 v20, 16, v168
    v_and_b32 v21, 0xffff0000, v168
    v_lshlrev_b32 v22, 16, v170
    v_and_b32 v23, 0xffff0000, v170
    v_lshlrev_b32 v36, 16, v172
    v_and_b32 v37, 0xffff0000, v172
    v_lshlrev_b32 v38, 16, v174
    v_and_b32 v39, 0xffff0000, v174
    v_pk_mul_f32 v[168:169], v[20:21], v[20:21]
    v_pk_mul_f32 v[170:171], v[22:23], v[22:23]
    v_pk_mul_f32 v[172:173], v[36:37], v[36:37]
    v_pk_mul_f32 v[174:175], v[38:39], v[38:39]
    v_pk_fma_f32 v[168:169], v[168:169], v[138:139], v[136:137]
    v_pk_fma_f32 v[170:171], v[170:171], v[138:139], v[136:137]
    s_add_u32 m0, s39, 7168
    s_xor_b32 s46, s3, 81920
    buffer_load_dwordx4 v151, s[24:27], s46 offen lds
    v_pk_fma_f32 v[172:173], v[172:173], v[138:139], v[136:137]
    v_pk_fma_f32 v[174:175], v[174:175], v[138:139], v[136:137]
    v_pk_mul_f32 v[168:169], v[168:169], v[20:21]
    v_pk_mul_f32 v[170:171], v[170:171], v[22:23]
    v_pk_mul_f32 v[172:173], v[172:173], v[36:37]
    v_pk_mul_f32 v[174:175], v[174:175], v[38:39]
    v_exp_f32 v168, v168
    v_exp_f32 v169, v169
    v_exp_f32 v170, v170
    s_add_u32 m0, s39, 32768
    s_xor_b32 s46, s3, 128
    buffer_load_dwordx4 v150, s[24:27], s46 offen lds
    v_exp_f32 v171, v171
    v_exp_f32 v172, v172
    v_exp_f32 v173, v173
    v_exp_f32 v174, v174
    s_add_u32 m0, s39, 33792
    s_xor_b32 s46, s3, 128
    buffer_load_dwordx4 v151, s[24:27], s46 offen lds
    v_exp_f32 v175, v175
    v_pk_add_f32 v[168:169], v[168:169], v[140:141]
    v_pk_add_f32 v[170:171], v[170:171], v[140:141]
    v_pk_add_f32 v[172:173], v[172:173], v[140:141]
    v_pk_add_f32 v[174:175], v[174:175], v[140:141]
    v_rcp_f32 v168, v168
    v_rcp_f32 v169, v169
    s_add_u32 m0, s39, 34816
    s_xor_b32 s46, s3, 16512
    buffer_load_dwordx4 v150, s[24:27], s46 offen lds
    v_rcp_f32 v170, v170
    v_rcp_f32 v171, v171
    v_rcp_f32 v172, v172
    v_rcp_f32 v173, v173
    s_add_u32 m0, s39, 35840
    s_xor_b32 s46, s3, 16512
    buffer_load_dwordx4 v151, s[24:27], s46 offen lds
    v_rcp_f32 v174, v174
    v_rcp_f32 v175, v175
    v_pk_mul_f32 v[20:21], v[20:21], v[168:169]
    v_pk_mul_f32 v[22:23], v[22:23], v[170:171]
    v_pk_mul_f32 v[36:37], v[36:37], v[172:173]
    v_pk_mul_f32 v[38:39], v[38:39], v[174:175]
    v_cvt_pk_bf16_f32 v142, v20, v21
    v_cvt_pk_bf16_f32 v143, v22, v23
    v_cvt_pk_bf16_f32 v144, v36, v37
    s_add_u32 m0, s39, 36864
    s_xor_b32 s46, s3, 65664
    buffer_load_dwordx4 v150, s[24:27], s46 offen lds
    v_cvt_pk_bf16_f32 v145, v38, v39
    ds_read_b64_tr_b16 v[108:109], v14 offset:9216
    ds_read_b64_tr_b16 v[110:111], v14 offset:10752
    ds_read_b64_tr_b16 v[112:113], v14 offset:9248
    ds_read_b64_tr_b16 v[114:115], v14 offset:10784
    ds_read_b64_tr_b16 v[116:117], v14 offset:9280
    ds_read_b64_tr_b16 v[118:119], v14 offset:10816
    v_lshlrev_b32 v20, 16, v142
    v_and_b32 v21, 0xffff0000, v142
    v_lshlrev_b32 v22, 16, v143
    v_and_b32 v23, 0xffff0000, v143
    v_lshlrev_b32 v36, 16, v144
    v_and_b32 v37, 0xffff0000, v144
    v_lshlrev_b32 v38, 16, v145
    v_and_b32 v39, 0xffff0000, v145
    s_add_u32 m0, s39, 37888
    s_xor_b32 s46, s3, 65664
    buffer_load_dwordx4 v151, s[24:27], s46 offen lds
    v_pk_add_f32 v[152:153], v[152:153], v[20:21]
    v_pk_fma_f32 v[160:161], v[20:21], v[20:21], v[160:161]
    v_pk_add_f32 v[154:155], v[154:155], v[22:23]
    v_pk_fma_f32 v[162:163], v[22:23], v[22:23], v[162:163]
    v_pk_add_f32 v[156:157], v[156:157], v[36:37]
    v_pk_fma_f32 v[164:165], v[36:37], v[36:37], v[164:165]
    v_pk_add_f32 v[158:159], v[158:159], v[38:39]
    v_pk_fma_f32 v[166:167], v[38:39], v[38:39], v[166:167]
    ds_read_b64_tr_b16 v[120:121], v14 offset:12288
    ds_read_b64_tr_b16 v[122:123], v14 offset:13824
    ds_read_b64_tr_b16 v[124:125], v14 offset:12320
    ds_read_b64_tr_b16 v[126:127], v14 offset:13856
    ds_read_b64_tr_b16 v[128:129], v14 offset:12352
    ds_read_b64_tr_b16 v[130:131], v14 offset:13888
    v_cvt_pk_bf16_f32 v168, v24, v25
    s_add_u32 m0, s39, 38912
    s_xor_b32 s46, s3, 82048
    buffer_load_dwordx4 v150, s[24:27], s46 offen lds
    v_cvt_pk_bf16_f32 v170, v26, v27
    v_cvt_pk_bf16_f32 v172, v40, v41
    v_cvt_pk_bf16_f32 v174, v42, v43
    v_lshlrev_b32 v24, 16, v168
    v_and_b32 v25, 0xffff0000, v168
    v_lshlrev_b32 v26, 16, v170
    v_and_b32 v27, 0xffff0000, v170
    v_lshlrev_b32 v40, 16, v172
    v_and_b32 v41, 0xffff0000, v172
    v_lshlrev_b32 v42, 16, v174
    v_and_b32 v43, 0xffff0000, v174
    v_pk_mul_f32 v[168:169], v[24:25], v[24:25]
    v_pk_mul_f32 v[170:171], v[26:27], v[26:27]
    v_pk_mul_f32 v[172:173], v[40:41], v[40:41]
    v_pk_mul_f32 v[174:175], v[42:43], v[42:43]
    s_add_u32 m0, s39, 39936
    s_xor_b32 s46, s3, 82048
    buffer_load_dwordx4 v151, s[24:27], s46 offen lds
    v_pk_fma_f32 v[168:169], v[168:169], v[138:139], v[136:137]
    v_pk_fma_f32 v[170:171], v[170:171], v[138:139], v[136:137]
    v_pk_fma_f32 v[172:173], v[172:173], v[138:139], v[136:137]
    v_pk_fma_f32 v[174:175], v[174:175], v[138:139], v[136:137]
    v_pk_mul_f32 v[168:169], v[168:169], v[24:25]
    v_pk_mul_f32 v[170:171], v[170:171], v[26:27]
    v_pk_mul_f32 v[172:173], v[172:173], v[40:41]
    v_pk_mul_f32 v[174:175], v[174:175], v[42:43]
    v_exp_f32 v168, v168
    v_exp_f32 v169, v169
    s_add_u32 m0, s39, 65536
    s_xor_b32 s46, s3, 256
    buffer_load_dwordx4 v150, s[24:27], s46 offen lds
    v_exp_f32 v170, v170
    v_exp_f32 v171, v171
    v_exp_f32 v172, v172
    v_exp_f32 v173, v173
    s_add_u32 m0, s39, 66560
    s_xor_b32 s46, s3, 256
    buffer_load_dwordx4 v151, s[24:27], s46 offen lds
    v_exp_f32 v174, v174
    v_exp_f32 v175, v175
    v_pk_add_f32 v[168:169], v[168:169], v[140:141]
    v_pk_add_f32 v[170:171], v[170:171], v[140:141]
    v_pk_add_f32 v[172:173], v[172:173], v[140:141]
    v_pk_add_f32 v[174:175], v[174:175], v[140:141]
    v_rcp_f32 v168, v168
    s_add_u32 m0, s39, 67584
    s_xor_b32 s46, s3, 16640
    buffer_load_dwordx4 v150, s[24:27], s46 offen lds
    v_rcp_f32 v169, v169
    v_rcp_f32 v170, v170
    v_rcp_f32 v171, v171
    v_rcp_f32 v172, v172
    s_add_u32 m0, s39, 68608
    s_xor_b32 s46, s3, 16640
    buffer_load_dwordx4 v151, s[24:27], s46 offen lds
    v_rcp_f32 v173, v173
    v_rcp_f32 v174, v174
    v_rcp_f32 v175, v175
    v_pk_mul_f32 v[24:25], v[24:25], v[168:169]
    v_pk_mul_f32 v[26:27], v[26:27], v[170:171]
    v_pk_mul_f32 v[40:41], v[40:41], v[172:173]
    s_add_u32 m0, s39, 69632
    s_xor_b32 s46, s3, 65792
    buffer_load_dwordx4 v150, s[24:27], s46 offen lds
    v_pk_mul_f32 v[42:43], v[42:43], v[174:175]
    v_cvt_pk_bf16_f32 v142, v24, v25
    v_cvt_pk_bf16_f32 v143, v26, v27
    v_cvt_pk_bf16_f32 v144, v40, v41
    v_cvt_pk_bf16_f32 v145, v42, v43
    ds_read_b64_tr_b16 a[208:209], v14 offset:15360
    ds_read_b64_tr_b16 a[210:211], v14 offset:16896
    ds_read_b64_tr_b16 a[212:213], v14 offset:15392
    ds_read_b64_tr_b16 a[214:215], v14 offset:16928
    ds_read_b64_tr_b16 a[216:217], v14 offset:15424
    ds_read_b64_tr_b16 a[218:219], v14 offset:16960
    v_lshlrev_b32 v24, 16, v142
    v_and_b32 v25, 0xffff0000, v142
    v_lshlrev_b32 v26, 16, v143
    v_and_b32 v27, 0xffff0000, v143
    s_add_u32 m0, s39, 70656
    s_xor_b32 s46, s3, 65792
    buffer_load_dwordx4 v151, s[24:27], s46 offen lds
    v_lshlrev_b32 v40, 16, v144
    v_and_b32 v41, 0xffff0000, v144
    v_lshlrev_b32 v42, 16, v145
    v_and_b32 v43, 0xffff0000, v145
    v_pk_add_f32 v[152:153], v[152:153], v[24:25]
    v_pk_fma_f32 v[160:161], v[24:25], v[24:25], v[160:161]
    v_pk_add_f32 v[154:155], v[154:155], v[26:27]
    v_pk_fma_f32 v[162:163], v[26:27], v[26:27], v[162:163]
    v_pk_add_f32 v[156:157], v[156:157], v[40:41]
    v_pk_fma_f32 v[164:165], v[40:41], v[40:41], v[164:165]
    v_pk_add_f32 v[158:159], v[158:159], v[42:43]
    v_pk_fma_f32 v[166:167], v[42:43], v[42:43], v[166:167]
    v_cvt_pk_bf16_f32 v168, v28, v29
    v_cvt_pk_bf16_f32 v170, v30, v31
    v_cvt_pk_bf16_f32 v172, v44, v45
    s_add_u32 m0, s39, 71680
    s_xor_b32 s46, s3, 82176
    buffer_load_dwordx4 v150, s[24:27], s46 offen lds
    v_cvt_pk_bf16_f32 v174, v46, v47
    v_lshlrev_b32 v28, 16, v168
    v_and_b32 v29, 0xffff0000, v168
    v_lshlrev_b32 v30, 16, v170
    v_and_b32 v31, 0xffff0000, v170
    v_lshlrev_b32 v44, 16, v172
    v_and_b32 v45, 0xffff0000, v172
    v_lshlrev_b32 v46, 16, v174
    v_and_b32 v47, 0xffff0000, v174
    v_pk_mul_f32 v[168:169], v[28:29], v[28:29]
    v_pk_mul_f32 v[170:171], v[30:31], v[30:31]
    v_pk_mul_f32 v[172:173], v[44:45], v[44:45]
    v_pk_mul_f32 v[174:175], v[46:47], v[46:47]
    v_pk_fma_f32 v[168:169], v[168:169], v[138:139], v[136:137]
    v_pk_fma_f32 v[170:171], v[170:171], v[138:139], v[136:137]
    s_add_u32 m0, s39, 72704
    s_xor_b32 s46, s3, 82176
    buffer_load_dwordx4 v151, s[24:27], s46 offen lds
    v_pk_fma_f32 v[172:173], v[172:173], v[138:139], v[136:137]
    v_pk_fma_f32 v[174:175], v[174:175], v[138:139], v[136:137]
    v_pk_mul_f32 v[168:169], v[168:169], v[28:29]
    v_pk_mul_f32 v[170:171], v[170:171], v[30:31]
    v_pk_mul_f32 v[172:173], v[172:173], v[44:45]
    v_pk_mul_f32 v[174:175], v[174:175], v[46:47]
    v_exp_f32 v168, v168
    v_exp_f32 v169, v169
    v_exp_f32 v170, v170
    v_exp_f32 v171, v171
    v_exp_f32 v172, v172
    v_exp_f32 v173, v173
    v_exp_f32 v174, v174
    v_exp_f32 v175, v175
    v_pk_add_f32 v[168:169], v[168:169], v[140:141]
    v_pk_add_f32 v[170:171], v[170:171], v[140:141]
    v_pk_add_f32 v[172:173], v[172:173], v[140:141]
    v_pk_add_f32 v[174:175], v[174:175], v[140:141]
    v_rcp_f32 v168, v168
    v_rcp_f32 v169, v169
    v_rcp_f32 v170, v170
    v_rcp_f32 v171, v171
    v_rcp_f32 v172, v172
    v_rcp_f32 v173, v173
    v_rcp_f32 v174, v174
    v_rcp_f32 v175, v175
    v_pk_mul_f32 v[28:29], v[28:29], v[168:169]
    v_pk_mul_f32 v[30:31], v[30:31], v[170:171]
    v_pk_mul_f32 v[44:45], v[44:45], v[172:173]
    v_pk_mul_f32 v[46:47], v[46:47], v[174:175]
    v_cvt_pk_bf16_f32 v142, v28, v29
    v_cvt_pk_bf16_f32 v143, v30, v31
    v_cvt_pk_bf16_f32 v144, v44, v45
    v_cvt_pk_bf16_f32 v145, v46, v47
    v_lshlrev_b32 v28, 16, v142
    v_and_b32 v29, 0xffff0000, v142
    v_lshlrev_b32 v30, 16, v143
    v_and_b32 v31, 0xffff0000, v143
    v_lshlrev_b32 v44, 16, v144
    v_and_b32 v45, 0xffff0000, v144
    v_lshlrev_b32 v46, 16, v145
    v_and_b32 v47, 0xffff0000, v145
    v_pk_add_f32 v[152:153], v[152:153], v[28:29]
    v_pk_fma_f32 v[160:161], v[28:29], v[28:29], v[160:161]
    v_pk_add_f32 v[154:155], v[154:155], v[30:31]
    v_pk_fma_f32 v[162:163], v[30:31], v[30:31], v[162:163]
    v_pk_add_f32 v[156:157], v[156:157], v[44:45]
    v_pk_fma_f32 v[164:165], v[44:45], v[44:45], v[164:165]
    v_pk_add_f32 v[158:159], v[158:159], v[46:47]
    v_pk_fma_f32 v[166:167], v[46:47], v[46:47], v[166:167]
    s_nop 1
pk_dz2:
    v_add_f32 v168, v152, v152 row_mirror bank_mask:0x3
    v_add_f32 v169, v153, v153 row_mirror bank_mask:0x3
    v_add_f32 v170, v156, v156 row_mirror bank_mask:0x3
    v_add_f32 v171, v157, v157 row_mirror bank_mask:0x3
    v_add_f32 v172, v160, v160 row_mirror bank_mask:0x3
    v_add_f32 v173, v161, v161 row_mirror bank_mask:0x3
    v_add_f32 v174, v164, v164 row_mirror bank_mask:0x3
    v_add_f32 v175, v165, v165 row_mirror bank_mask:0x3
    v_add_f32 v168, v154, v154 row_mirror bank_mask:0xc
    v_add_f32 v169, v155, v155 row_mirror bank_mask:0xc
    v_add_f32 v170, v158, v158 row_mirror bank_mask:0xc
    v_add_f32 v171, v159, v159 row_mirror bank_mask:0xc
    v_add_f32 v172, v162, v162 row_mirror bank_mask:0xc
    v_add_f32 v173, v163, v163 row_mirror bank_mask:0xc
    v_add_f32 v174, v166, v166 row_mirror bank_mask:0xc
    v_add_f32 v175, v167, v167 row_mirror bank_mask:0xc
    s_lshl_b32 s45, s33, 4
    s_add_u32 s45, s45, s34
    s_lshl_b32 s45, s45, 2
    s_add_u32 s45, s45, s32
    s_lshl_b32 s36, s45, 8
    s_add_u32 s36, s36, 0x1be0000
    v_lshrrev_b32 v10, 2, v1
    v_lshlrev_b32 v10, 4, v10
    v_add_f32 v142, v168, v168 row_half_mirror bank_mask:0x5
    v_add_f32 v143, v170, v170 row_half_mirror bank_mask:0x5
    v_add_f32 v144, v172, v172 row_half_mirror bank_mask:0x5
    v_add_f32 v145, v174, v174 row_half_mirror bank_mask:0x5
    v_add_f32 v142, v169, v169 row_half_mirror bank_mask:0xa
    v_add_f32 v143, v171, v171 row_half_mirror bank_mask:0xa
    v_add_f32 v144, v173, v173 row_half_mirror bank_mask:0xa
    v_add_f32 v145, v175, v175 row_half_mirror bank_mask:0xa
    v_add_f32 v142, v142, v142 quad_perm:[1,0,3,2]
    v_add_f32 v143, v143, v143 quad_perm:[1,0,3,2]
    v_add_f32 v144, v144, v144 quad_perm:[1,0,3,2]
    v_add_f32 v145, v145, v145 quad_perm:[1,0,3,2]
    v_add_f32 v142, v142, v142 quad_perm:[2,3,0,1]
    v_add_f32 v143, v143, v143 quad_perm:[2,3,0,1]
    v_add_f32 v144, v144, v144 quad_perm:[2,3,0,1]
    v_add_f32 v145, v145, v145 quad_perm:[2,3,0,1]
    s_waitcnt vmcnt(27)
    s_cmp_lg_u32 s1, 0
    s_cbranch_scc0 pk_w75_s
    buffer_store_dwordx4 v[142:145], v10, s[16:19], s36 offen
pk_w75_r:
    ds_read_b64_tr_b16 a[220:221], v14 offset:18432
    ds_read_b64_tr_b16 a[222:223], v14 offset:19968
    ds_read_b64_tr_b16 a[224:225], v14 offset:18464
    ds_read_b64_tr_b16 a[226:227], v14 offset:20000
    ds_read_b64_tr_b16 a[228:229], v14 offset:18496
    ds_read_b64_tr_b16 a[230:231], v14 offset:20032
    ds_read_b64_tr_b16 a[232:233], v14 offset:21504
    ds_read_b64_tr_b16 a[234:235], v14 offset:23040
    ds_read_b64_tr_b16 a[236:237], v14 offset:21536
    ds_read_b64_tr_b16 a[238:239], v14 offset:23072
    ds_read_b64_tr_b16 a[240:241], v14 offset:21568
    ds_read_b64_tr_b16 a[242:243], v14 offset:23104
    s_lshl_b32 s37, s45, 6
    s_add_u32 s37, s37, 0x1c20000
    s_lshl_b32 s36, s33, 14
    s_lshl_b32 s45, s32, 8
    s_add_u32 s36, s36, s45
    s_add_u32 s36, s36, 0x1be0000
    v_and_b32 v12, 3, v1
    v_lshl_add_u32 v10, v12, 12, v10
    v_bfe_u32 v2, v1, 4, 1
    v_lshrrev_b32 v6, 5, v1
    v_lshl_add_u32 v2, v2, 2, v6
    v_bfe_u32 v6, v1, 1, 3
    v_xor_b32 v6, v6, v2
    v_lshlrev_b32 v6, 4, v6
    v_and_b32 v2, 15, v1
    v_lshl_add_u32 v6, v2, 7, v6
    v_xor_b32 v7, 32, v6
    v_add_u32 v6, s39, v6
    v_add_u32 v7, s39, v7
    v_add_u32 v8, 0x10000, v6
    v_add_u32 v9, 0x10000, v7
    s_and_b32 s33, s69, 0xff
    s_mul_i32 s33, s33, 1024
    s_mul_i32 s34, s38, 55296
    s_add_u32 s33, s33, s34
    s_waitcnt lgkmcnt(15)
    v_mfma_f32_16x16x32_bf16 v[48:51], v[72:75], a[128:131], 0
    s_waitcnt vmcnt(17)
    ds_read_b128 a[0:3], v6 offset:0
    ds_read_b128 a[4:7], v6 offset:2048
    v_mfma_f32_16x16x32_bf16 v[60:63], v[72:75], v[176:179], 0
    ds_read_b64_tr_b16 v[72:73], v14 offset:24576
    ds_read_b64_tr_b16 v[74:75], v14 offset:26112
    v_mfma_f32_16x16x32_bf16 v[52:55], v[76:79], a[128:131], 0
    ds_read_b128 a[8:11], v6 offset:4096
    v_mfma_f32_16x16x32_bf16 v[64:67], v[76:79], v[176:179], 0
    ds_read_b64_tr_b16 v[76:77], v14 offset:24608
    ds_read_b64_tr_b16 v[78:79], v14 offset:26144
    v_mfma_f32_16x16x32_bf16 v[56:59], v[80:83], a[128:131], 0
    ds_read_b128 a[12:15], v6 offset:6144
    v_mfma_f32_16x16x32_bf16 v[68:71], v[80:83], v[176:179], 0
    ds_read_b64_tr_b16 v[80:81], v14 offset:24640
    ds_read_b64_tr_b16 v[82:83], v14 offset:26176
    v_mfma_f32_16x16x32_bf16 v[48:51], v[84:87], a[132:135], v[48:51]
    ds_read_b128 a[16:19], v7 offset:0
    ds_read_b128 a[20:23], v7 offset:2048
    v_mfma_f32_16x16x32_bf16 v[60:63], v[84:87], v[180:183], v[60:63]
    ds_read_b64_tr_b16 v[84:85], v14 offset:27648
    ds_read_b64_tr_b16 v[86:87], v14 offset:29184
    v_mfma_f32_16x16x32_bf16 v[52:55], v[88:91], a[132:135], v[52:55]
    ds_read_b128 a[24:27], v7 offset:4096
    v_mfma_f32_16x16x32_bf16 v[64:67], v[88:91], v[180:183], v[64:67]
    ds_read_b64_tr_b16 v[88:89], v14 offset:27680
    ds_read_b64_tr_b16 v[90:91], v14 offset:29216
    v_mfma_f32_16x16x32_bf16 v[56:59], v[92:95], a[132:135], v[56:59]
    ds_read_b128 a[28:31], v7 offset:6144
    v_mfma_f32_16x16x32_bf16 v[68:71], v[92:95], v[180:183], v[68:71]
    ds_read_b64_tr_b16 v[92:93], v14 offset:27712
    ds_read_b64_tr_b16 v[94:95], v14 offset:29248
    v_mfma_f32_16x16x32_bf16 v[48:51], v[96:99], a[136:139], v[48:51]
    s_waitcnt vmcnt(9)
    ds_read_b128 a[32:35], v6 offset:32768
    ds_read_b128 a[36:39], v6 offset:34816
    v_mfma_f32_16x16x32_bf16 v[60:63], v[96:99], v[184:187], v[60:63]
    ds_read_b64_tr_b16 v[96:97], v14 offset:30720
    ds_read_b64_tr_b16 v[98:99], v14 offset:32256
    s_waitcnt lgkmcnt(6)
    s_add_u32 m0, s39, 0
    s_xor_b32 s46, s3, 384
    buffer_load_dwordx4 v150, s[24:27], s46 offen lds
    v_mfma_f32_16x16x32_bf16 v[52:55], v[100:103], a[136:139], v[52:55]
    ds_read_b128 a[40:43], v6 offset:36864
    v_mfma_f32_16x16x32_bf16 v[64:67], v[100:103], v[184:187], v[64:67]
    ds_read_b64_tr_b16 v[100:101], v14 offset:30752
    ds_read_b64_tr_b16 v[102:103], v14 offset:32288
    s_add_u32 m0, s39, 1024
    s_xor_b32 s46, s3, 384
    buffer_load_dwordx4 v151, s[24:27], s46 offen lds
    v_mfma_f32_16x16x32_bf16 v[56:59], v[104:107], a[136:139], v[56:59]
    ds_read_b128 a[44:47], v6 offset:38912
    v_mfma_f32_16x16x32_bf16 v[68:71], v[104:107], v[184:187], v[68:71]
    ds_read_b64_tr_b16 v[104:105], v14 offset:30784
    ds_read_b64_tr_b16 v[106:107], v14 offset:32320
    s_add_u32 m0, s39, 2048
    s_xor_b32 s46, s3, 16768
    buffer_load_dwordx4 v150, s[24:27], s46 offen lds
    v_mfma_f32_16x16x32_bf16 v[48:51], v[108:111], a[140:143], v[48:51]
    ds_read_b128 a[48:51], v7 offset:32768
    ds_read_b128 a[52:55], v7 offset:34816
    v_mfma_f32_16x16x32_bf16 v[60:63], v[108:111], v[188:191], v[60:63]
    ds_read_b64_tr_b16 v[108:109], v14 offset:33792
    ds_read_b64_tr_b16 v[110:111], v14 offset:35328
    s_add_u32 m0, s39, 3072
    s_xor_b32 s46, s3, 16768
    buffer_load_dwordx4 v151, s[24:27], s46 offen lds
    v_mfma_f32_16x16x32_bf16 v[52:55], v[112:115], a[140:143], v[52:55]
    ds_read_b128 a[56:59], v7 offset:36864
    v_mfma_f32_16x16x32_bf16 v[64:67], v[112:115], v[188:191], v[64:67]
    ds_read_b64_tr_b16 v[112:113], v14 offset:33824
    ds_read_b64_tr_b16 v[114:115], v14 offset:35360
    s_add_u32 m0, s39, 4096
    s_xor_b32 s46, s3, 65920
    buffer_load_dwordx4 v150, s[24:27], s46 offen lds
    v_mfma_f32_16x16x32_bf16 v[56:59], v[116:119], a[140:143], v[56:59]
    ds_read_b128 a[60:63], v7 offset:38912
    v_mfma_f32_16x16x32_bf16 v[68:71], v[116:119], v[188:191], v[68:71]
    ds_read_b64_tr_b16 v[116:117], v14 offset:33856
    ds_read_b64_tr_b16 v[118:119], v14 offset:35392
    s_add_u32 m0, s39, 5120
    s_xor_b32 s46, s3, 65920
    buffer_load_dwordx4 v151, s[24:27], s46 offen lds
    v_mfma_f32_16x16x32_bf16 v[48:51], v[120:123], a[144:147], v[48:51]
    s_waitcnt vmcnt(7)
    ds_read_b128 a[64:67], v8 offset:0
    ds_read_b128 a[68:71], v8 offset:2048
    v_mfma_f32_16x16x32_bf16 v[60:63], v[120:123], v[192:195], v[60:63]
    ds_read_b64_tr_b16 v[120:121], v14 offset:36864
    ds_read_b64_tr_b16 v[122:123], v14 offset:38400
    s_add_u32 m0, s39, 6144
    s_xor_b32 s46, s3, 82304
    buffer_load_dwordx4 v150, s[24:27], s46 offen lds
    v_mfma_f32_16x16x32_bf16 v[52:55], v[124:127], a[144:147], v[52:55]
    ds_read_b128 a[72:75], v8 offset:4096
    v_mfma_f32_16x16x32_bf16 v[64:67], v[124:127], v[192:195], v[64:67]
    ds_read_b64_tr_b16 v[124:125], v14 offset:36896
    ds_read_b64_tr_b16 v[126:127], v14 offset:38432
    s_add_u32 m0, s39, 7168
    s_xor_b32 s46, s3, 82304
    buffer_load_dwordx4 v151, s[24:27], s46 offen lds
    v_mfma_f32_16x16x32_bf16 v[56:59], v[128:131], a[144:147], v[56:59]
    ds_read_b128 a[76:79], v8 offset:6144
    v_mfma_f32_16x16x32_bf16 v[68:71], v[128:131], v[192:195], v[68:71]
    ds_read_b64_tr_b16 v[128:129], v14 offset:36928
    ds_read_b64_tr_b16 v[130:131], v14 offset:38464
    s_waitcnt lgkmcnt(12)
    s_add_u32 m0, s39, 32768
    s_xor_b32 s46, s3, 512
    buffer_load_dwordx4 v150, s[24:27], s46 offen lds
    v_mfma_f32_16x16x32_bf16 v[48:51], a[208:211], a[148:151], v[48:51]
    ds_read_b128 a[80:83], v9 offset:0
    ds_read_b128 a[84:87], v9 offset:2048
    v_mfma_f32_16x16x32_bf16 v[60:63], a[208:211], v[196:199], v[60:63]
    ds_read_b64_tr_b16 a[208:209], v14 offset:39936
    ds_read_b64_tr_b16 a[210:211], v14 offset:41472
    s_add_u32 m0, s39, 33792
    s_xor_b32 s46, s3, 512
    buffer_load_dwordx4 v151, s[24:27], s46 offen lds
    v_mfma_f32_16x16x32_bf16 v[52:55], a[212:215], a[148:151], v[52:55]
    ds_read_b128 a[88:91], v9 offset:4096
    v_mfma_f32_16x16x32_bf16 v[64:67], a[212:215], v[196:199], v[64:67]
    ds_read_b64_tr_b16 a[212:213], v14 offset:39968
    ds_read_b64_tr_b16 a[214:215], v14 offset:41504
    s_add_u32 m0, s39, 34816
    s_xor_b32 s46, s3, 16896
    buffer_load_dwordx4 v150, s[24:27], s46 offen lds
    v_mfma_f32_16x16x32_bf16 v[56:59], a[216:219], a[148:151], v[56:59]
    ds_read_b128 a[92:95], v9 offset:6144
    v_mfma_f32_16x16x32_bf16 v[68:71], a[216:219], v[196:199], v[68:71]
    ds_read_b64_tr_b16 a[216:217], v14 offset:40000
    ds_read_b64_tr_b16 a[218:219], v14 offset:41536
    s_add_u32 m0, s39, 35840
    s_xor_b32 s46, s3, 16896
    buffer_load_dwordx4 v151, s[24:27], s46 offen lds
    v_mfma_f32_16x16x32_bf16 v[48:51], a[220:223], a[152:155], v[48:51]
    v_mfma_f32_16x16x32_bf16 v[60:63], a[220:223], v[200:203], v[60:63]
    ds_read_b64_tr_b16 a[220:221], v14 offset:43008
    ds_read_b64_tr_b16 a[222:223], v14 offset:44544
    s_add_u32 m0, s39, 36864
    s_xor_b32 s46, s3, 66048
    buffer_load_dwordx4 v150, s[24:27], s46 offen lds
    v_mfma_f32_16x16x32_bf16 v[52:55], a[224:227], a[152:155], v[52:55]
    v_mfma_f32_16x16x32_bf16 v[64:67], a[224:227], v[200:203], v[64:67]
    ds_read_b64_tr_b16 a[224:225], v14 offset:43040
    ds_read_b64_tr_b16 a[226:227], v14 offset:44576
    s_add_u32 m0, s39, 37888
    s_xor_b32 s46, s3, 66048
    buffer_load_dwordx4 v151, s[24:27], s46 offen lds
    v_mfma_f32_16x16x32_bf16 v[56:59], a[228:231], a[152:155], v[56:59]
    v_mfma_f32_16x16x32_bf16 v[68:71], a[228:231], v[200:203], v[68:71]
    ds_read_b64_tr_b16 a[228:229], v14 offset:43072
    ds_read_b64_tr_b16 a[230:231], v14 offset:44608
    s_add_u32 m0, s39, 38912
    s_xor_b32 s46, s3, 82432
    buffer_load_dwordx4 v150, s[24:27], s46 offen lds
    v_mfma_f32_16x16x32_bf16 v[48:51], a[232:235], a[156:159], v[48:51]
    v_mfma_f32_16x16x32_bf16 v[60:63], a[232:235], v[204:207], v[60:63]
    ds_read_b64_tr_b16 a[232:233], v14 offset:46080
    ds_read_b64_tr_b16 a[234:235], v14 offset:47616
    s_add_u32 m0, s39, 39936
    s_xor_b32 s46, s3, 82432
    buffer_load_dwordx4 v151, s[24:27], s46 offen lds
    v_mfma_f32_16x16x32_bf16 v[52:55], a[236:239], a[156:159], v[52:55]
    v_mfma_f32_16x16x32_bf16 v[64:67], a[236:239], v[204:207], v[64:67]
    ds_read_b64_tr_b16 a[236:237], v14 offset:46112
    ds_read_b64_tr_b16 a[238:239], v14 offset:47648
    s_waitcnt lgkmcnt(12)
    s_add_u32 m0, s39, 65536
    s_xor_b32 s46, s3, 640
    buffer_load_dwordx4 v150, s[24:27], s46 offen lds
    v_mfma_f32_16x16x32_bf16 v[56:59], a[240:243], a[156:159], v[56:59]
    v_mfma_f32_16x16x32_bf16 v[68:71], a[240:243], v[204:207], v[68:71]
    ds_read_b64_tr_b16 a[240:241], v14 offset:46144
    ds_read_b64_tr_b16 a[242:243], v14 offset:47680
    s_add_u32 m0, s39, 66560
    s_xor_b32 s46, s3, 640
    buffer_load_dwordx4 v151, s[24:27], s46 offen lds
    v_mfma_f32_16x16x32_bf16 v[48:51], v[72:75], a[160:163], v[48:51]
    v_mfma_f32_16x16x32_bf16 v[60:63], v[72:75], v[208:211], v[60:63]
    ds_read_b64_tr_b16 v[72:73], v14 offset:49152
    ds_read_b64_tr_b16 v[74:75], v14 offset:50688
    s_add_u32 m0, s39, 67584
    s_xor_b32 s46, s3, 17024
    buffer_load_dwordx4 v150, s[24:27], s46 offen lds
    v_mfma_f32_16x16x32_bf16 v[52:55], v[76:79], a[160:163], v[52:55]
    v_mfma_f32_16x16x32_bf16 v[64:67], v[76:79], v[208:211], v[64:67]
    ds_read_b64_tr_b16 v[76:77], v14 offset:49184
    ds_read_b64_tr_b16 v[78:79], v14 offset:50720
    s_add_u32 m0, s39, 68608
    s_xor_b32 s46, s3, 17024
    buffer_load_dwordx4 v151, s[24:27], s46 offen lds
    v_mfma_f32_16x16x32_bf16 v[56:59], v[80:83], a[160:163], v[56:59]
    v_mfma_f32_16x16x32_bf16 v[68:71], v[80:83], v[208:211], v[68:71]
    ds_read_b64_tr_b16 v[80:81], v14 offset:49216
    ds_read_b64_tr_b16 v[82:83], v14 offset:50752
    s_add_u32 m0, s39, 69632
    s_xor_b32 s46, s3, 66176
    buffer_load_dwordx4 v150, s[24:27], s46 offen lds
    buffer_load_dwordx4 v[152:155], v10, s[16:19], s36 offen offset:0 sc1
    buffer_load_dwordx4 v[156:159], v10, s[16:19], s36 offen offset:1024 sc1
    buffer_load_dwordx4 v[160:163], v10, s[16:19], s36 offen offset:2048 sc1
    buffer_load_dwordx4 v[164:167], v10, s[16:19], s36 offen offset:3072 sc1
    v_mfma_f32_16x16x32_bf16 v[48:51], v[84:87], a[164:167], v[48:51]
    v_mfma_f32_16x16x32_bf16 v[60:63], v[84:87], v[212:215], v[60:63]
    ds_read_b64_tr_b16 v[84:85], v14 offset:52224
    ds_read_b64_tr_b16 v[86:87], v14 offset:53760
    s_add_u32 m0, s39, 70656
    s_xor_b32 s46, s3, 66176
    buffer_load_dwordx4 v151, s[24:27], s46 offen lds
    v_mfma_f32_16x16x32_bf16 v[52:55], v[88:91], a[164:167], v[52:55]
    v_mfma_f32_16x16x32_bf16 v[64:67], v[88:91], v[212:215], v[64:67]
    ds_read_b64_tr_b16 v[88:89], v14 offset:52256
    ds_read_b64_tr_b16 v[90:91], v14 offset:53792
    s_add_u32 m0, s39, 71680
    s_xor_b32 s46, s3, 82560
    buffer_load_dwordx4 v150, s[24:27], s46 offen lds
    v_mfma_f32_16x16x32_bf16 v[56:59], v[92:95], a[164:167], v[56:59]
    v_mfma_f32_16x16x32_bf16 v[68:71], v[92:95], v[212:215], v[68:71]
    ds_read_b64_tr_b16 v[92:93], v14 offset:52288
    ds_read_b64_tr_b16 v[94:95], v14 offset:53824
    s_add_u32 m0, s39, 72704
    s_xor_b32 s46, s3, 82560
    buffer_load_dwordx4 v151, s[24:27], s46 offen lds
    v_mfma_f32_16x16x32_bf16 v[48:51], v[96:99], a[168:171], v[48:51]
    v_mfma_f32_16x16x32_bf16 v[60:63], v[96:99], v[216:219], v[60:63]
    ds_read_b64_tr_b16 v[96:97], v14 offset:55296
    ds_read_b64_tr_b16 v[98:99], v14 offset:56832
    v_mfma_f32_16x16x32_bf16 v[52:55], v[100:103], a[168:171], v[52:55]
    v_mfma_f32_16x16x32_bf16 v[64:67], v[100:103], v[216:219], v[64:67]
    ds_read_b64_tr_b16 v[100:101], v14 offset:55328
    ds_read_b64_tr_b16 v[102:103], v14 offset:56864
    v_mfma_f32_16x16x32_bf16 v[56:59], v[104:107], a[168:171], v[56:59]
    v_mfma_f32_16x16x32_bf16 v[68:71], v[104:107], v[216:219], v[68:71]
    ds_read_b64_tr_b16 v[104:105], v14 offset:55360
    ds_read_b64_tr_b16 v[106:107], v14 offset:56896
    v_mfma_f32_16x16x32_bf16 v[48:51], v[108:111], a[172:175], v[48:51]
    v_mfma_f32_16x16x32_bf16 v[60:63], v[108:111], v[220:223], v[60:63]
    ds_read_b64_tr_b16 v[108:109], v14 offset:58368
    ds_read_b64_tr_b16 v[110:111], v14 offset:59904
    v_mfma_f32_16x16x32_bf16 v[52:55], v[112:115], a[172:175], v[52:55]
    v_mfma_f32_16x16x32_bf16 v[64:67], v[112:115], v[220:223], v[64:67]
    ds_read_b64_tr_b16 v[112:113], v14 offset:58400
    ds_read_b64_tr_b16 v[114:115], v14 offset:59936
    v_mfma_f32_16x16x32_bf16 v[56:59], v[116:119], a[172:175], v[56:59]
    v_mfma_f32_16x16x32_bf16 v[68:71], v[116:119], v[220:223], v[68:71]
    ds_read_b64_tr_b16 v[116:117], v14 offset:58432
    ds_read_b64_tr_b16 v[118:119], v14 offset:59968
    v_mfma_f32_16x16x32_bf16 v[48:51], v[120:123], a[176:179], v[48:51]
    v_mfma_f32_16x16x32_bf16 v[60:63], v[120:123], v[224:227], v[60:63]
    v_mfma_f32_16x16x32_bf16 v[52:55], v[124:127], a[176:179], v[52:55]
    v_mfma_f32_16x16x32_bf16 v[64:67], v[124:127], v[224:227], v[64:67]
    v_mfma_f32_16x16x32_bf16 v[56:59], v[128:131], a[176:179], v[56:59]
    v_mfma_f32_16x16x32_bf16 v[68:71], v[128:131], v[224:227], v[68:71]
    s_waitcnt lgkmcnt(15)
    v_mfma_f32_16x16x32_bf16 v[48:51], a[208:211], a[180:183], v[48:51]
    v_mfma_f32_16x16x32_bf16 v[60:63], a[208:211], v[228:231], v[60:63]
    v_mfma_f32_16x16x32_bf16 v[52:55], a[212:215], a[180:183], v[52:55]
    v_mfma_f32_16x16x32_bf16 v[64:67], a[212:215], v[228:231], v[64:67]
    v_mfma_f32_16x16x32_bf16 v[56:59], a[216:219], a[180:183], v[56:59]
    v_mfma_f32_16x16x32_bf16 v[68:71], a[216:219], v[228:231], v[68:71]
    s_waitcnt vmcnt(3)
    v_max3_u32 v12, v152, v156, v160
    v_max_u32 v12, v12, v164
    v_cmp_eq_u32 vcc, -1, v12
    s_cbranch_vccz pk_c76_r
pk_c76_s:
    s_nop 7
    s_nop 7
    s_mov_b32 s47, 0
pk_c76_l:
    s_mov_b64 exec, vcc
    buffer_load_dwordx4 v[152:155], v10, s[16:19], s36 offen offset:0 sc1
    buffer_load_dwordx4 v[156:159], v10, s[16:19], s36 offen offset:1024 sc1
    buffer_load_dwordx4 v[160:163], v10, s[16:19], s36 offen offset:2048 sc1
    buffer_load_dwordx4 v[164:167], v10, s[16:19], s36 offen offset:3072 sc1
    s_add_u32 s47, s47, 1
    s_waitcnt vmcnt(0)
    v_max3_u32 v12, v152, v156, v160
    v_max_u32 v12, v12, v164
    v_cmp_eq_u32 vcc, -1, v12
    s_cmp_eq_u64 vcc, 0
    s_cbranch_scc1 pk_c76_x
    s_cmp_lt_u32 s47, 0x2000
    s_cbranch_scc1 pk_c76_l
pk_c76_x:
    s_mov_b64 exec, -1
    s_nop 4
pk_c76_r:
    v_pk_add_f32 v[152:153], v[152:153], v[156:157]
    v_pk_add_f32 v[154:155], v[154:155], v[158:159]
    v_pk_add_f32 v[152:153], v[152:153], v[160:161]
    v_pk_add_f32 v[154:155], v[154:155], v[162:163]
    v_pk_add_f32 v[152:153], v[152:153], v[164:165]
    v_pk_add_f32 v[154:155], v[154:155], v[166:167]
    s_nop 0
    v_add_f32 v152, v152, v152 quad_perm:[1,0,3,2]
    v_add_f32 v153, v153, v153 quad_perm:[1,0,3,2]
    v_add_f32 v154, v154, v154 quad_perm:[1,0,3,2]
    v_add_f32 v155, v155, v155 quad_perm:[1,0,3,2]
    v_add_f32 v152, v152, v152 quad_perm:[2,3,0,1]
    v_add_f32 v153, v153, v153 quad_perm:[2,3,0,1]
    v_add_f32 v154, v154, v154 quad_perm:[2,3,0,1]
    v_add_f32 v155, v155, v155 quad_perm:[2,3,0,1]
    v_mul_f32 v152, 0x3a97b426, v152
    v_mul_f32 v154, 0x3a97b426, v154
    v_fma_f32 v154, -v152, v152, v154
    v_max_f32 v154, 0, v154
    v_mul_f32 v153, 0x3a97b426, v153
    v_mul_f32 v155, 0x3a97b426, v155
    v_fma_f32 v155, -v153, v153, v155
    v_max_f32 v155, 0, v155
    v_cvt_pk_bf16_f32 v156, v152, v154
    v_cvt_pk_bf16_f32 v157, v153, v155
    v_lshlrev_b32 v152, 16, v156
    v_and_b32 v154, 0xffff0000, v156
    v_add_f32 v154, 0x3727c5ac, v154
    v_cvt_pk_bf16_f32 v154, v154, v154
    v_lshlrev_b32 v154, 16, v154
    v_lshlrev_b32 v153, 16, v157
    v_and_b32 v155, 0xffff0000, v157
    v_add_f32 v155, 0x3727c5ac, v155
    v_cvt_pk_bf16_f32 v155, v155, v155
    v_lshlrev_b32 v155, 16, v155
    v_sqrt_f32 v154, v154
    v_sqrt_f32 v155, v155
    v_cvt_pk_bf16_f32 v154, v154, v154
    v_lshlrev_b32 v154, 16, v154
    v_cvt_pk_bf16_f32 v155, v155, v155
    v_lshlrev_b32 v155, 16, v155
    v_rcp_f32 v154, v154
    v_rcp_f32 v155, v155
    s_cmp_eq_u32 s42, 0
    s_cbranch_scc1 pk_dz3
    v_subrev_f32 v16, v152, v16 row_newbcast:0
    v_subrev_f32 v17, v152, v17 row_newbcast:4
    v_subrev_f32 v18, v152, v18 row_newbcast:8
    v_subrev_f32 v19, v152, v19 row_newbcast:12
    v_subrev_f32 v32, v153, v32 row_newbcast:0
    v_subrev_f32 v33, v153, v33 row_newbcast:4
    v_subrev_f32 v34, v153, v34 row_newbcast:8
    v_subrev_f32 v35, v153, v35 row_newbcast:12
    v_cvt_pk_bf16_f32 v160, v16, v17
    v_lshlrev_b32 v16, 16, v160
    v_and_b32 v17, 0xffff0000, v160
    v_cvt_pk_bf16_f32 v161, v18, v19
    v_lshlrev_b32 v18, 16, v161
    v_and_b32 v19, 0xffff0000, v161
    v_cvt_pk_bf16_f32 v162, v32, v33
    v_lshlrev_b32 v32, 16, v162
    v_and_b32 v33, 0xffff0000, v162
    v_cvt_pk_bf16_f32 v163, v34, v35
    v_lshlrev_b32 v34, 16, v163
    v_and_b32 v35, 0xffff0000, v163
    v_mul_f32 v16, v154, v16 row_newbcast:0
    v_mul_f32 v17, v154, v17 row_newbcast:4
    v_mul_f32 v18, v154, v18 row_newbcast:8
    v_mul_f32 v19, v154, v19 row_newbcast:12
    v_mul_f32 v32, v155, v32 row_newbcast:0
    v_mul_f32 v33, v155, v33 row_newbcast:4
    v_mul_f32 v34, v155, v34 row_newbcast:8
    v_mul_f32 v35, v155, v35 row_newbcast:12
    v_cvt_pk_bf16_f32 v168, v16, v17
    v_cvt_pk_bf16_f32 v169, v18, v19
    v_cvt_pk_bf16_f32 v170, v32, v33
    v_cvt_pk_bf16_f32 v171, v34, v35
    s_add_u32 s40, s33, 0x1880000
    buffer_store_dwordx4 v[168:171], v3, s[16:19], s40 offen sc1
    v_subrev_f32 v20, v152, v20 row_newbcast:0
    v_subrev_f32 v21, v152, v21 row_newbcast:4
    v_subrev_f32 v22, v152, v22 row_newbcast:8
    v_subrev_f32 v23, v152, v23 row_newbcast:12
    v_subrev_f32 v36, v153, v36 row_newbcast:0
    v_subrev_f32 v37, v153, v37 row_newbcast:4
    v_subrev_f32 v38, v153, v38 row_newbcast:8
    v_subrev_f32 v39, v153, v39 row_newbcast:12
    v_cvt_pk_bf16_f32 v160, v20, v21
    v_lshlrev_b32 v20, 16, v160
    v_and_b32 v21, 0xffff0000, v160
    v_cvt_pk_bf16_f32 v161, v22, v23
    v_lshlrev_b32 v22, 16, v161
    v_and_b32 v23, 0xffff0000, v161
    v_cvt_pk_bf16_f32 v162, v36, v37
    v_lshlrev_b32 v36, 16, v162
    v_and_b32 v37, 0xffff0000, v162
    v_cvt_pk_bf16_f32 v163, v38, v39
    v_lshlrev_b32 v38, 16, v163
    v_and_b32 v39, 0xffff0000, v163
    v_mul_f32 v20, v154, v20 row_newbcast:0
    v_mul_f32 v21, v154, v21 row_newbcast:4
    v_mul_f32 v22, v154, v22 row_newbcast:8
    v_mul_f32 v23, v154, v23 row_newbcast:12
    v_mul_f32 v36, v155, v36 row_newbcast:0
    v_mul_f32 v37, v155, v37 row_newbcast:4
    v_mul_f32 v38, v155, v38 row_newbcast:8
    v_mul_f32 v39, v155, v39 row_newbcast:12
    v_cvt_pk_bf16_f32 v172, v20, v21
    v_cvt_pk_bf16_f32 v173, v22, v23
    v_cvt_pk_bf16_f32 v174, v36, v37
    v_cvt_pk_bf16_f32 v175, v38, v39
    buffer_store_dwordx4 v[172:175], v3, s[16:19], s40 offen offset:1024 sc1
    s_cmp_eq_u32 s42, 2
    s_cbranch_scc1 pk_dz3
    v_subrev_f32 v24, v152, v24 row_newbcast:0
    v_subrev_f32 v25, v152, v25 row_newbcast:4
    v_subrev_f32 v26, v152, v26 row_newbcast:8
    v_subrev_f32 v27, v152, v27 row_newbcast:12
    v_subrev_f32 v40, v153, v40 row_newbcast:0
    v_subrev_f32 v41, v153, v41 row_newbcast:4
    v_subrev_f32 v42, v153, v42 row_newbcast:8
    v_subrev_f32 v43, v153, v43 row_newbcast:12
    v_cvt_pk_bf16_f32 v160, v24, v25
    v_lshlrev_b32 v24, 16, v160
    v_and_b32 v25, 0xffff0000, v160
    v_cvt_pk_bf16_f32 v161, v26, v27
    v_lshlrev_b32 v26, 16, v161
    v_and_b32 v27, 0xffff0000, v161
    v_cvt_pk_bf16_f32 v162, v40, v41
    v_lshlrev_b32 v40, 16, v162
    v_and_b32 v41, 0xffff0000, v162
    v_cvt_pk_bf16_f32 v163, v42, v43
    v_lshlrev_b32 v42, 16, v163
    v_and_b32 v43, 0xffff0000, v163
    v_mul_f32 v24, v154, v24 row_newbcast:0
    v_mul_f32 v25, v154, v25 row_newbcast:4
    v_mul_f32 v26, v154, v26 row_newbcast:8
    v_mul_f32 v27, v154, v27 row_newbcast:12
    v_mul_f32 v40, v155, v40 row_newbcast:0
    v_mul_f32 v41, v155, v41 row_newbcast:4
    v_mul_f32 v42, v155, v42 row_newbcast:8
    v_mul_f32 v43, v155, v43 row_newbcast:12
    v_cvt_pk_bf16_f32 v168, v24, v25
    v_cvt_pk_bf16_f32 v169, v26, v27
    v_cvt_pk_bf16_f32 v170, v40, v41
    v_cvt_pk_bf16_f32 v171, v42, v43
    buffer_store_dwordx4 v[168:171], v3, s[16:19], s40 offen offset:2048 sc1
    v_subrev_f32 v28, v152, v28 row_newbcast:0
    v_subrev_f32 v29, v152, v29 row_newbcast:4
    v_subrev_f32 v30, v152, v30 row_newbcast:8
    v_subrev_f32 v31, v152, v31 row_newbcast:12
    v_subrev_f32 v44, v153, v44 row_newbcast:0
    v_subrev_f32 v45, v153, v45 row_newbcast:4
    v_subrev_f32 v46, v153, v46 row_newbcast:8
    v_subrev_f32 v47, v153, v47 row_newbcast:12
    v_cvt_pk_bf16_f32 v160, v28, v29
    v_lshlrev_b32 v28, 16, v160
    v_and_b32 v29, 0xffff0000, v160
    v_cvt_pk_bf16_f32 v161, v30, v31
    v_lshlrev_b32 v30, 16, v161
    v_and_b32 v31, 0xffff0000, v161
    v_cvt_pk_bf16_f32 v162, v44, v45
    v_lshlrev_b32 v44, 16, v162
    v_and_b32 v45, 0xffff0000, v162
    v_cvt_pk_bf16_f32 v163, v46, v47
    v_lshlrev_b32 v46, 16, v163
    v_and_b32 v47, 0xffff0000, v163
    v_mul_f32 v28, v154, v28 row_newbcast:0
    v_mul_f32 v29, v154, v29 row_newbcast:4
    v_mul_f32 v30, v154, v30 row_newbcast:8
    v_mul_f32 v31, v154, v31 row_newbcast:12
    v_mul_f32 v44, v155, v44 row_newbcast:0
    v_mul_f32 v45, v155, v45 row_newbcast:4
    v_mul_f32 v46, v155, v46 row_newbcast:8
    v_mul_f32 v47, v155, v47 row_newbcast:12
    v_cvt_pk_bf16_f32 v172, v28, v29
    v_cvt_pk_bf16_f32 v173, v30, v31
    v_cvt_pk_bf16_f32 v174, v44, v45
    v_cvt_pk_bf16_f32 v175, v46, v47
    buffer_store_dwordx4 v[172:175], v3, s[16:19], s40 offen offset:3072 sc1
    s_nop 1
pk_dz3:
    v_mfma_f32_16x16x32_bf16 v[48:51], a[220:223], a[184:187], v[48:51]
    ds_read_b128 a[96:99], v6 offset:0
    ds_read_b128 a[100:103], v6 offset:2048
    v_mfma_f32_16x16x32_bf16 v[60:63], a[220:223], v[232:235], v[60:63]
    v_mfma_f32_16x16x32_bf16 v[52:55], a[224:227], a[184:187], v[52:55]
    ds_read_b128 a[104:107], v6 offset:4096
    v_mfma_f32_16x16x32_bf16 v[64:67], a[224:227], v[232:235], v[64:67]
    v_mfma_f32_16x16x32_bf16 v[56:59], a[228:231], a[184:187], v[56:59]
    ds_read_b128 a[108:111], v6 offset:6144
    v_mfma_f32_16x16x32_bf16 v[68:71], a[228:231], v[232:235], v[68:71]
    v_mfma_f32_16x16x32_bf16 v[48:51], a[232:235], a[188:191], v[48:51]
    ds_read_b128 a[112:115], v7 offset:0
    ds_read_b128 a[116:119], v7 offset:2048
    v_mfma_f32_16x16x32_bf16 v[60:63], a[232:235], v[236:239], v[60:63]
    v_mfma_f32_16x16x32_bf16 v[52:55], a[236:239], a[188:191], v[52:55]
    ds_read_b128 a[120:123], v7 offset:4096
    v_mfma_f32_16x16x32_bf16 v[64:67], a[236:239], v[236:239], v[64:67]
    v_mfma_f32_16x16x32_bf16 v[56:59], a[240:243], a[188:191], v[56:59]
    ds_read_b128 a[124:127], v7 offset:6144
    v_mfma_f32_16x16x32_bf16 v[68:71], a[240:243], v[236:239], v[68:71]
    v_mfma_f32_16x16x32_bf16 v[48:51], v[72:75], a[192:195], v[48:51]
    v_mfma_f32_16x16x32_bf16 v[60:63], v[72:75], v[240:243], v[60:63]
    s_waitcnt lgkmcnt(0)
    s_add_u32 m0, s39, 0
    s_xor_b32 s46, s3, 768
    buffer_load_dwordx4 v150, s[24:27], s46 offen lds
    v_mfma_f32_16x16x32_bf16 v[52:55], v[76:79], a[192:195], v[52:55]
    v_mfma_f32_16x16x32_bf16 v[64:67], v[76:79], v[240:243], v[64:67]
    s_add_u32 m0, s39, 1024
    s_xor_b32 s46, s3, 768
    buffer_load_dwordx4 v151, s[24:27], s46 offen lds
    v_mfma_f32_16x16x32_bf16 v[56:59], v[80:83], a[192:195], v[56:59]
    v_mfma_f32_16x16x32_bf16 v[68:71], v[80:83], v[240:243], v[68:71]
    s_add_u32 m0, s39, 2048
    s_xor_b32 s46, s3, 17152
    buffer_load_dwordx4 v150, s[24:27], s46 offen lds
    v_mfma_f32_16x16x32_bf16 v[48:51], v[84:87], a[196:199], v[48:51]
    v_mfma_f32_16x16x32_bf16 v[60:63], v[84:87], v[244:247], v[60:63]
    s_add_u32 m0, s39, 3072
    s_xor_b32 s46, s3, 17152
    buffer_load_dwordx4 v151, s[24:27], s46 offen lds
    v_mfma_f32_16x16x32_bf16 v[52:55], v[88:91], a[196:199], v[52:55]
    v_mfma_f32_16x16x32_bf16 v[64:67], v[88:91], v[244:247], v[64:67]
    s_add_u32 m0, s39, 4096
    s_xor_b32 s46, s3, 66304
    buffer_load_dwordx4 v150, s[24:27], s46 offen lds
    v_mfma_f32_16x16x32_bf16 v[56:59], v[92:95], a[196:199], v[56:59]
    v_mfma_f32_16x16x32_bf16 v[68:71], v[92:95], v[244:247], v[68:71]
    s_add_u32 m0, s39, 5120
    s_xor_b32 s46, s3, 66304
    buffer_load_dwordx4 v151, s[24:27], s46 offen lds
    v_mfma_f32_16x16x32_bf16 v[48:51], v[96:99], a[200:203], v[48:51]
    v_mfma_f32_16x16x32_bf16 v[60:63], v[96:99], v[248:251], v[60:63]
    s_add_u32 m0, s39, 6144
    s_xor_b32 s46, s3, 82688
    buffer_load_dwordx4 v150, s[24:27], s46 offen lds
    v_mfma_f32_16x16x32_bf16 v[52:55], v[100:103], a[200:203], v[52:55]
    v_mfma_f32_16x16x32_bf16 v[64:67], v[100:103], v[248:251], v[64:67]
    s_add_u32 m0, s39, 7168
    s_xor_b32 s46, s3, 82688
    buffer_load_dwordx4 v151, s[24:27], s46 offen lds
    v_mfma_f32_16x16x32_bf16 v[56:59], v[104:107], a[200:203], v[56:59]
    v_mfma_f32_16x16x32_bf16 v[68:71], v[104:107], v[248:251], v[68:71]
    v_mfma_f32_16x16x32_bf16 v[48:51], v[108:111], a[204:207], v[48:51]
    v_mfma_f32_16x16x32_bf16 v[60:63], v[108:111], v[252:255], v[60:63]
    v_mfma_f32_16x16x32_bf16 v[52:55], v[112:115], a[204:207], v[52:55]
    v_mfma_f32_16x16x32_bf16 v[64:67], v[112:115], v[252:255], v[64:67]
    v_mfma_f32_16x16x32_bf16 v[56:59], v[116:119], a[204:207], v[56:59]
    v_mfma_f32_16x16x32_bf16 v[68:71], v[116:119], v[252:255], v[68:71]
    v_mov_b32 v72, 0xc0135761
    v_mov_b32 v73, 0xc0135761
    v_mov_b32 v74, 0xbdd2d3e8
    v_mov_b32 v75, 0xbdd2d3e8
    v_mov_b32 v76, 0x3f800000
    v_mov_b32 v77, 0x3f800000
    v_mov_b32 v90, v150
    v_mov_b32 v91, v151
    ds_read_b128 a[128:131], v6 offset:32768
    ds_read_b128 a[132:135], v6 offset:34816
    ds_read_b128 a[136:139], v6 offset:36864
    ds_read_b128 a[140:143], v6 offset:38912
    ds_read_b128 a[144:147], v7 offset:32768
    ds_read_b128 a[148:151], v7 offset:34816
    ds_read_b128 a[152:155], v7 offset:36864
    ds_read_b128 a[156:159], v7 offset:38912
    s_mov_b32 s38, s43
    s_andn2_b32 s33, 7, s2
    s_lshl_b32 s33, s33, 2
    s_lshr_b32 s47, s2, 6
    s_bfe_u32 s34, s2, 0x30003
    s_add_u32 s33, s33, s47
    s_mul_i32 s35, s34, 7
    s_mul_i32 s36, s34, 6
    s_add_u32 s36, s36, 6
    s_cmp_lt_u32 s34, 6
    s_cselect_b32 s41, s35, s36
    s_cselect_b32 s42, 0, 0x7f000000
    s_mul_i32 s35, s41, 1024
    s_mul_i32 s36, s32, 884736
    s_add_u32 s35, s35, s36
    v_add_u32 v11, s35, v3
    v_add_u32 v12, s42, v11
    s_bfe_u32 s45, s68, 0x20010
    v_lshlrev_b32 v93, 3, v1
    s_bfe_u32 s44, s68, 0x100000
    s_lshl_b32 s44, s44, 5
    s_add_u32 s44, s44, s38
    s_cmp_lg_u32 s45, 3
    s_cbranch_scc1 pk_dz4
    v_cvt_pk_bf16_f32 v82, v56, v57
    v_cvt_pk_bf16_f32 v84, v58, v59
    v_cvt_pk_bf16_f32 v86, v68, v69
    v_cvt_pk_bf16_f32 v88, v70, v71
    v_lshlrev_b32 v56, 16, v82
    v_and_b32 v57, 0xffff0000, v82
    v_lshlrev_b32 v58, 16, v84
    v_and_b32 v59, 0xffff0000, v84
    v_lshlrev_b32 v68, 16, v86
    v_and_b32 v69, 0xffff0000, v86
    v_lshlrev_b32 v70, 16, v88
    v_and_b32 v71, 0xffff0000, v88
    v_pk_mul_f32 v[82:83], v[56:57], v[56:57]
    v_pk_mul_f32 v[84:85], v[58:59], v[58:59]
    v_pk_mul_f32 v[86:87], v[68:69], v[68:69]
    v_pk_mul_f32 v[88:89], v[70:71], v[70:71]
    v_pk_fma_f32 v[82:83], v[82:83], v[74:75], v[72:73]
    v_pk_fma_f32 v[84:85], v[84:85], v[74:75], v[72:73]
    v_pk_fma_f32 v[86:87], v[86:87], v[74:75], v[72:73]
    v_pk_fma_f32 v[88:89], v[88:89], v[74:75], v[72:73]
    v_pk_mul_f32 v[82:83], v[82:83], v[56:57]
    v_pk_mul_f32 v[84:85], v[84:85], v[58:59]
    v_pk_mul_f32 v[86:87], v[86:87], v[68:69]
    v_pk_mul_f32 v[88:89], v[88:89], v[70:71]
    v_exp_f32 v82, v82
    v_exp_f32 v83, v83
    v_exp_f32 v84, v84
    v_exp_f32 v85, v85
    v_exp_f32 v86, v86
    v_exp_f32 v87, v87
    v_exp_f32 v88, v88
    v_exp_f32 v89, v89
    v_pk_add_f32 v[82:83], v[82:83], v[76:77]
    v_pk_add_f32 v[84:85], v[84:85], v[76:77]
    v_pk_add_f32 v[86:87], v[86:87], v[76:77]
    v_pk_add_f32 v[88:89], v[88:89], v[76:77]
    v_rcp_f32 v82, v82
    v_rcp_f32 v83, v83
    v_rcp_f32 v84, v84
    v_rcp_f32 v85, v85
    v_rcp_f32 v86, v86
    v_rcp_f32 v87, v87
    v_rcp_f32 v88, v88
    v_rcp_f32 v89, v89
    v_pk_mul_f32 v[56:57], v[56:57], v[82:83]
    v_pk_mul_f32 v[58:59], v[58:59], v[84:85]
    v_pk_mul_f32 v[68:69], v[68:69], v[86:87]
    v_pk_mul_f32 v[70:71], v[70:71], v[88:89]
    v_cvt_pk_bf16_f32 v78, v56, v57
    v_cvt_pk_bf16_f32 v79, v58, v59
    v_cvt_pk_bf16_f32 v80, v68, v69
    v_cvt_pk_bf16_f32 v81, v70, v71
    s_cmp_lg_u32 s1, 0
    s_cbranch_scc0 pk_w77_s
    buffer_store_dwordx2 v[78:79], v93, s[16:19], s44 offen offset:0
    buffer_store_dwordx2 v[80:81], v93, s[16:19], s44 offen offset:512
pk_w77_r:
pk_dz4:
    s_bfe_u32 s44, s67, 0x100000
    s_lshl_b32 s44, s44, 5
    s_add_u32 s44, s44, s38
    v_cvt_pk_bf16_f32 v82, v48, v49
    v_cvt_pk_bf16_f32 v84, v50, v51
    v_cvt_pk_bf16_f32 v86, v60, v61
    v_cvt_pk_bf16_f32 v88, v62, v63
    v_lshlrev_b32 v48, 16, v82
    v_and_b32 v49, 0xffff0000, v82
    s_waitcnt lgkmcnt(0)
    v_lshlrev_b32 v50, 16, v84
    v_and_b32 v51, 0xffff0000, v84
    v_lshlrev_b32 v60, 16, v86
    v_and_b32 v61, 0xffff0000, v86
    v_lshlrev_b32 v62, 16, v88
    v_and_b32 v63, 0xffff0000, v88
    s_add_u32 m0, s39, 32768
    s_xor_b32 s46, s3, 896
    buffer_load_dwordx4 v90, s[24:27], s46 offen lds
    v_pk_mul_f32 v[82:83], v[48:49], v[48:49]
    v_pk_mul_f32 v[84:85], v[50:51], v[50:51]
    v_pk_mul_f32 v[86:87], v[60:61], v[60:61]
    v_pk_mul_f32 v[88:89], v[62:63], v[62:63]
    v_pk_fma_f32 v[82:83], v[82:83], v[74:75], v[72:73]
    v_pk_fma_f32 v[84:85], v[84:85], v[74:75], v[72:73]
    s_add_u32 m0, s39, 33792
    s_xor_b32 s46, s3, 896
    buffer_load_dwordx4 v91, s[24:27], s46 offen lds
    v_pk_fma_f32 v[86:87], v[86:87], v[74:75], v[72:73]
    v_pk_fma_f32 v[88:89], v[88:89], v[74:75], v[72:73]
    v_pk_mul_f32 v[82:83], v[82:83], v[48:49]
    v_pk_mul_f32 v[84:85], v[84:85], v[50:51]
    v_pk_mul_f32 v[86:87], v[86:87], v[60:61]
    v_pk_mul_f32 v[88:89], v[88:89], v[62:63]
    s_waitcnt vmcnt(10)
    ds_read_b128 a[160:163], v8 offset:0
    ds_read_b128 a[164:167], v8 offset:2048
    ds_read_b128 a[168:171], v8 offset:4096
    ds_read_b128 a[172:175], v8 offset:6144
    v_exp_f32 v82, v82
    v_exp_f32 v83, v83
    ds_read_b128 a[176:179], v9 offset:0
    ds_read_b128 a[180:183], v9 offset:2048
    ds_read_b128 a[184:187], v9 offset:4096
    ds_read_b128 a[188:191], v9 offset:6144
    v_exp_f32 v84, v84
    v_exp_f32 v85, v85
    s_add_u32 m0, s39, 34816
    s_xor_b32 s46, s3, 17280
    buffer_load_dwordx4 v90, s[24:27], s46 offen lds
    v_exp_f32 v86, v86
    v_exp_f32 v87, v87
    s_add_u32 m0, s39, 35840
    s_xor_b32 s46, s3, 17280
    buffer_load_dwordx4 v91, s[24:27], s46 offen lds
    v_exp_f32 v88, v88
    v_exp_f32 v89, v89
    s_add_u32 m0, s39, 36864
    s_xor_b32 s46, s3, 66432
    buffer_load_dwordx4 v90, s[24:27], s46 offen lds
    v_pk_add_f32 v[82:83], v[82:83], v[76:77]
    v_pk_add_f32 v[84:85], v[84:85], v[76:77]
    v_pk_add_f32 v[86:87], v[86:87], v[76:77]
    v_pk_add_f32 v[88:89], v[88:89], v[76:77]
    v_rcp_f32 v82, v82
    s_waitcnt vmcnt(5)
    ds_read_b128 a[192:195], v6 offset:0
    ds_read_b128 a[196:199], v6 offset:2048
    ds_read_b128 a[200:203], v6 offset:4096
    ds_read_b128 a[204:207], v6 offset:6144
    v_rcp_f32 v83, v83
    v_rcp_f32 v84, v84
    ds_read_b128 a[208:211], v7 offset:0
    ds_read_b128 a[212:215], v7 offset:2048
    ds_read_b128 a[216:219], v7 offset:4096
    ds_read_b128 a[220:223], v7 offset:6144
    v_rcp_f32 v85, v85
    v_rcp_f32 v86, v86
    s_add_u32 m0, s39, 37888
    s_xor_b32 s46, s3, 66432
    buffer_load_dwordx4 v91, s[24:27], s46 offen lds
    v_rcp_f32 v87, v87
    v_rcp_f32 v88, v88
    s_add_u32 m0, s39, 38912
    s_xor_b32 s46, s3, 82816
    buffer_load_dwordx4 v90, s[24:27], s46 offen lds
    v_rcp_f32 v89, v89
    v_pk_mul_f32 v[48:49], v[48:49], v[82:83]
    v_pk_mul_f32 v[50:51], v[50:51], v[84:85]
    s_add_u32 m0, s39, 39936
    s_xor_b32 s46, s3, 82816
    buffer_load_dwordx4 v91, s[24:27], s46 offen lds
    v_pk_mul_f32 v[60:61], v[60:61], v[86:87]
    v_pk_mul_f32 v[62:63], v[62:63], v[88:89]
    v_cvt_pk_bf16_f32 v78, v48, v49
    v_cvt_pk_bf16_f32 v79, v50, v51
    v_cvt_pk_bf16_f32 v80, v60, v61
    v_cvt_pk_bf16_f32 v81, v62, v63
    s_mov_b32 s46, 0x1880000
    buffer_load_dwordx4 v[128:131], v11, s[16:19], s46 offen sc1
    s_cmp_lg_u32 s1, 0
    s_cbranch_scc0 pk_w78_s
    buffer_store_dwordx2 v[78:79], v93, s[16:19], s44 offen offset:0
    buffer_store_dwordx2 v[80:81], v93, s[16:19], s44 offen offset:512
pk_w78_r:
    s_bfe_u32 s44, s67, 0x100010
    s_lshl_b32 s44, s44, 5
    s_add_u32 s44, s44, s38
    v_cvt_pk_bf16_f32 v82, v52, v53
    v_cvt_pk_bf16_f32 v84, v54, v55
    v_cvt_pk_bf16_f32 v86, v64, v65
    v_cvt_pk_bf16_f32 v88, v66, v67
    v_lshlrev_b32 v52, 16, v82
    v_and_b32 v53, 0xffff0000, v82
    s_mov_b32 s46, 0x1880400
    buffer_load_dwordx4 v[132:135], v11, s[16:19], s46 offen sc1
    v_lshlrev_b32 v54, 16, v84
    v_and_b32 v55, 0xffff0000, v84
    v_lshlrev_b32 v64, 16, v86
    v_and_b32 v65, 0xffff0000, v86
    v_lshlrev_b32 v66, 16, v88
    v_and_b32 v67, 0xffff0000, v88
    s_mov_b32 s46, 0x1880800
    buffer_load_dwordx4 v[136:139], v11, s[16:19], s46 offen sc1
    v_pk_mul_f32 v[82:83], v[52:53], v[52:53]
    v_pk_mul_f32 v[84:85], v[54:55], v[54:55]
    v_pk_mul_f32 v[86:87], v[64:65], v[64:65]
    v_pk_mul_f32 v[88:89], v[66:67], v[66:67]
    v_pk_fma_f32 v[82:83], v[82:83], v[74:75], v[72:73]
    v_pk_fma_f32 v[84:85], v[84:85], v[74:75], v[72:73]
    s_mov_b32 s46, 0x1880c00
    buffer_load_dwordx4 v[140:143], v11, s[16:19], s46 offen sc1
    v_pk_fma_f32 v[86:87], v[86:87], v[74:75], v[72:73]
    v_pk_fma_f32 v[88:89], v[88:89], v[74:75], v[72:73]
    v_pk_mul_f32 v[82:83], v[82:83], v[52:53]
    v_pk_mul_f32 v[84:85], v[84:85], v[54:55]
    v_pk_mul_f32 v[86:87], v[86:87], v[64:65]
    v_pk_mul_f32 v[88:89], v[88:89], v[66:67]
    s_mov_b32 s46, 0x1881000
    buffer_load_dwordx4 v[144:147], v11, s[16:19], s46 offen sc1
    v_exp_f32 v82, v82
    v_exp_f32 v83, v83
    s_mov_b32 s46, 0x1881400
    buffer_load_dwordx4 v[148:151], v11, s[16:19], s46 offen sc1
    v_exp_f32 v84, v84
    v_exp_f32 v85, v85
    s_mov_b32 s46, 0x1881800
    buffer_load_dwordx4 v[152:155], v12, s[16:19], s46 offen sc1
    v_exp_f32 v86, v86
    v_exp_f32 v87, v87
    s_mov_b32 s46, 0x188d800
    buffer_load_dwordx4 v[156:159], v11, s[16:19], s46 offen sc1
    v_exp_f32 v88, v88
    v_exp_f32 v89, v89
    s_mov_b32 s46, 0x188dc00
    buffer_load_dwordx4 v[160:163], v11, s[16:19], s46 offen sc1
    v_pk_add_f32 v[82:83], v[82:83], v[76:77]
    v_pk_add_f32 v[84:85], v[84:85], v[76:77]
    v_pk_add_f32 v[86:87], v[86:87], v[76:77]
    v_pk_add_f32 v[88:89], v[88:89], v[76:77]
    v_rcp_f32 v82, v82
    s_mov_b32 s46, 0x188e000
    buffer_load_dwordx4 v[164:167], v11, s[16:19], s46 offen sc1
    v_rcp_f32 v83, v83
    v_rcp_f32 v84, v84
    s_mov_b32 s46, 0x188e400
    buffer_load_dwordx4 v[168:171], v11, s[16:19], s46 offen sc1
    v_rcp_f32 v85, v85
    v_rcp_f32 v86, v86
    s_mov_b32 s46, 0x188e800
    buffer_load_dwordx4 v[172:175], v11, s[16:19], s46 offen sc1
    v_rcp_f32 v87, v87
    v_rcp_f32 v88, v88
    s_mov_b32 s46, 0x188ec00
    buffer_load_dwordx4 v[176:179], v11, s[16:19], s46 offen sc1
    v_rcp_f32 v89, v89
    v_pk_mul_f32 v[52:53], v[52:53], v[82:83]
    v_pk_mul_f32 v[54:55], v[54:55], v[84:85]
    s_mov_b32 s46, 0x188f000
    buffer_load_dwordx4 v[180:183], v12, s[16:19], s46 offen sc1
    v_pk_mul_f32 v[64:65], v[64:65], v[86:87]
    v_pk_mul_f32 v[66:67], v[66:67], v[88:89]
    v_cvt_pk_bf16_f32 v78, v52, v53
    v_cvt_pk_bf16_f32 v79, v54, v55
    v_cvt_pk_bf16_f32 v80, v64, v65
    v_cvt_pk_bf16_f32 v81, v66, v67
    s_cmp_lg_u32 s1, 0
    s_cbranch_scc0 pk_w79_s
    buffer_store_dwordx2 v[78:79], v93, s[16:19], s44 offen offset:0
    buffer_store_dwordx2 v[80:81], v93, s[16:19], s44 offen offset:512
pk_w79_r:
    s_lshr_b32 s36, s33, 1
    s_lshl_b32 s36, s36, 5
    s_and_b32 s38, s33, 1
    s_add_u32 s36, s36, s38
    s_lshl_b32 s36, s36, 1
    s_lshr_b32 s38, s32, 1
    s_add_u32 s36, s36, s38
    s_lshl_b32 s36, s36, 6
    s_add_u32 s36, s36, 0x1c20000
    v_lshlrev_b32 v14, 8, v5
    s_lshl_b32 s43, s33, 2
    s_add_u32 s43, s43, s32
    s_lshr_b32 s44, s43, 1
    s_mul_i32 s44, s44, 55296
    s_lshl_b32 s45, s41, 10
    s_add_u32 s44, s44, s45
    s_and_b32 s45, s32, 1
    s_lshl_b32 s45, s45, 9
    s_add_u32 s44, s44, s45
    s_add_u32 s44, s44, 0x600000
    v_add_u32 v13, 4096, v3
    v_and_b32 v15, 11, v5
    v_and_b32 v2, 4, v5
    v_lshl_add_u32 v15, v2, 3, v15
    s_lshl_b32 s45, s33, 6
    s_lshr_b32 s38, s3, 12
    s_add_u32 s45, s45, s38
    v_add_u32 v15, s45, v15
    s_mov_b64 s[12:13], s[60:61]
    s_mov_b32 s14, 0x1000
    s_mov_b32 s15, 0x20000
    s_mov_b32 s35, s37
    s_waitcnt vmcnt(9)
    v_max3_u32 v2, v128, v132, v136
    v_max3_u32 v2, v2, v140, v144
    v_max3_u32 v2, v2, v148, v152
    v_cmp_eq_u32 vcc, -1, v2
    s_cbranch_vccnz pk_c80_s
pk_c80_r:
    s_mul_i32 s37, s34, 27
    s_mul_i32 s38, s32, 6
    s_add_u32 s37, s37, s38
    s_mul_i32 s37, s37, 5120
    s_add_u32 s37, s37, 0x1000000
    s_mul_i32 s38, s32, -25600
    s_add_u32 s38, s38, 92160
    s_cmp_eq_u32 s32, 3
    s_cselect_b32 s38, 0x7f000000, s38
    v_add_u32 v10, s38, v3
    v_mfma_f32_16x16x32_bf16 v[16:19], v[128:131], a[0:3], 0
    v_mfma_f32_16x16x32_bf16 v[44:47], v[128:131], a[4:7], 0
    s_mov_b32 s46, 0x189b000
    buffer_load_dwordx4 v[184:187], v11, s[16:19], s46 offen sc1
    v_mfma_f32_16x16x32_bf16 v[72:75], v[128:131], a[8:11], 0
    v_mfma_f32_16x16x32_bf16 v[100:103], v[128:131], a[12:15], 0
    s_mov_b32 s46, 0x189b400
    buffer_load_dwordx4 v[188:191], v11, s[16:19], s46 offen sc1
    v_mfma_f32_16x16x32_bf16 v[20:23], v[132:135], a[0:3], 0
    v_mfma_f32_16x16x32_bf16 v[48:51], v[132:135], a[4:7], 0
    s_mov_b32 s46, 0x189b800
    buffer_load_dwordx4 v[192:195], v11, s[16:19], s46 offen sc1
    v_mfma_f32_16x16x32_bf16 v[76:79], v[132:135], a[8:11], 0
    v_mfma_f32_16x16x32_bf16 v[104:107], v[132:135], a[12:15], 0
    s_mov_b32 s46, 0x189bc00
    buffer_load_dwordx4 v[196:199], v11, s[16:19], s46 offen sc1
    v_mfma_f32_16x16x32_bf16 v[24:27], v[136:139], a[0:3], 0
    v_mfma_f32_16x16x32_bf16 v[52:55], v[136:139], a[4:7], 0
    s_mov_b32 s46, 0x189c000
    buffer_load_dwordx4 v[200:203], v11, s[16:19], s46 offen sc1
    v_mfma_f32_16x16x32_bf16 v[80:83], v[136:139], a[8:11], 0
    v_mfma_f32_16x16x32_bf16 v[108:111], v[136:139], a[12:15], 0
    s_mov_b32 s46, 0x189c400
    buffer_load_dwordx4 v[204:207], v11, s[16:19], s46 offen sc1
    v_mfma_f32_16x16x32_bf16 v[28:31], v[140:143], a[0:3], 0
    v_mfma_f32_16x16x32_bf16 v[56:59], v[140:143], a[4:7], 0
    s_mov_b32 s46, 0x189c800
    buffer_load_dwordx4 v[208:211], v12, s[16:19], s46 offen sc1
    v_mfma_f32_16x16x32_bf16 v[84:87], v[140:143], a[8:11], 0
    v_mfma_f32_16x16x32_bf16 v[112:115], v[140:143], a[12:15], 0
    s_mov_b32 s46, 0x18a8800
    buffer_load_dwordx4 v[212:215], v11, s[16:19], s46 offen sc1
    v_mfma_f32_16x16x32_bf16 v[32:35], v[144:147], a[0:3], 0
    v_mfma_f32_16x16x32_bf16 v[60:63], v[144:147], a[4:7], 0
    v_mfma_f32_16x16x32_bf16 v[88:91], v[144:147], a[8:11], 0
    s_waitcnt vmcnt(10)
    v_max3_u32 v2, v156, v160, v164
    v_mfma_f32_16x16x32_bf16 v[116:119], v[144:147], a[12:15], 0
    s_mov_b32 s46, 0x18a8c00
    buffer_load_dwordx4 v[216:219], v11, s[16:19], s46 offen sc1
    v_max3_u32 v2, v2, v168, v172
    v_mfma_f32_16x16x32_bf16 v[36:39], v[148:151], a[0:3], 0
    v_max3_u32 v2, v2, v176, v180
    v_mfma_f32_16x16x32_bf16 v[64:67], v[148:151], a[4:7], 0
    v_cmp_eq_u32 vcc, -1, v2
    v_mfma_f32_16x16x32_bf16 v[92:95], v[148:151], a[8:11], 0
    v_mfma_f32_16x16x32_bf16 v[120:123], v[148:151], a[12:15], 0
    s_mov_b32 s46, 0x18a9000
    buffer_load_dwordx4 v[220:223], v11, s[16:19], s46 offen sc1
    s_cbranch_vccnz pk_c81_s
pk_c81_r:
    v_mfma_f32_16x16x32_bf16 v[40:43], v[152:155], a[0:3], 0
    v_mfma_f32_16x16x32_bf16 v[68:71], v[152:155], a[4:7], 0
    v_mfma_f32_16x16x32_bf16 v[96:99], v[152:155], a[8:11], 0
    v_mfma_f32_16x16x32_bf16 v[124:127], v[152:155], a[12:15], 0
    s_mov_b32 s46, 0x18a9400
    buffer_load_dwordx4 v[224:227], v11, s[16:19], s46 offen sc1
    v_mfma_f32_16x16x32_bf16 v[16:19], v[156:159], a[16:19], v[16:19]
    v_mfma_f32_16x16x32_bf16 v[44:47], v[156:159], a[20:23], v[44:47]
    v_mfma_f32_16x16x32_bf16 v[72:75], v[156:159], a[24:27], v[72:75]
    v_mfma_f32_16x16x32_bf16 v[100:103], v[156:159], a[28:31], v[100:103]
    s_mov_b32 s46, 0x18a9800
    buffer_load_dwordx4 v[228:231], v11, s[16:19], s46 offen sc1
    v_mfma_f32_16x16x32_bf16 v[20:23], v[160:163], a[16:19], v[20:23]
    v_mfma_f32_16x16x32_bf16 v[48:51], v[160:163], a[20:23], v[48:51]
    v_mfma_f32_16x16x32_bf16 v[76:79], v[160:163], a[24:27], v[76:79]
    v_mfma_f32_16x16x32_bf16 v[104:107], v[160:163], a[28:31], v[104:107]
    s_mov_b32 s46, 0x18a9c00
    buffer_load_dwordx4 v[232:235], v11, s[16:19], s46 offen sc1
    v_mfma_f32_16x16x32_bf16 v[24:27], v[164:167], a[16:19], v[24:27]
    v_mfma_f32_16x16x32_bf16 v[52:55], v[164:167], a[20:23], v[52:55]
    v_mfma_f32_16x16x32_bf16 v[80:83], v[164:167], a[24:27], v[80:83]
    v_mfma_f32_16x16x32_bf16 v[108:111], v[164:167], a[28:31], v[108:111]
    s_mov_b32 s46, 0x18aa000
    buffer_load_dwordx4 v[236:239], v12, s[16:19], s46 offen sc1
    v_mfma_f32_16x16x32_bf16 v[28:31], v[168:171], a[16:19], v[28:31]
    v_mfma_f32_16x16x32_bf16 v[56:59], v[168:171], a[20:23], v[56:59]
    v_mfma_f32_16x16x32_bf16 v[84:87], v[168:171], a[24:27], v[84:87]
    v_mfma_f32_16x16x32_bf16 v[112:115], v[168:171], a[28:31], v[112:115]
    s_mov_b32 s46, 0x18b6000
    buffer_load_dwordx4 v[128:131], v11, s[16:19], s46 offen sc1
    v_mfma_f32_16x16x32_bf16 v[32:35], v[172:175], a[16:19], v[32:35]
    v_mfma_f32_16x16x32_bf16 v[60:63], v[172:175], a[20:23], v[60:63]
    v_mfma_f32_16x16x32_bf16 v[88:91], v[172:175], a[24:27], v[88:91]
    s_waitcnt vmcnt(8)
    v_max3_u32 v2, v184, v188, v192
    v_mfma_f32_16x16x32_bf16 v[116:119], v[172:175], a[28:31], v[116:119]
    s_mov_b32 s46, 0x18b6400
    buffer_load_dwordx4 v[132:135], v11, s[16:19], s46 offen sc1
    v_max3_u32 v2, v2, v196, v200
    v_mfma_f32_16x16x32_bf16 v[36:39], v[176:179], a[16:19], v[36:39]
    v_max3_u32 v2, v2, v204, v208
    v_mfma_f32_16x16x32_bf16 v[64:67], v[176:179], a[20:23], v[64:67]
    v_cmp_eq_u32 vcc, -1, v2
    v_mfma_f32_16x16x32_bf16 v[92:95], v[176:179], a[24:27], v[92:95]
    v_mfma_f32_16x16x32_bf16 v[120:123], v[176:179], a[28:31], v[120:123]
    s_mov_b32 s46, 0x18b6800
    buffer_load_dwordx4 v[136:139], v11, s[16:19], s46 offen sc1
    s_cbranch_vccnz pk_c82_s
pk_c82_r:
    v_mfma_f32_16x16x32_bf16 v[40:43], v[180:183], a[16:19], v[40:43]
    v_mfma_f32_16x16x32_bf16 v[68:71], v[180:183], a[20:23], v[68:71]
    v_mfma_f32_16x16x32_bf16 v[96:99], v[180:183], a[24:27], v[96:99]
    v_mfma_f32_16x16x32_bf16 v[124:127], v[180:183], a[28:31], v[124:127]
    s_mov_b32 s46, 0x18b6c00
    buffer_load_dwordx4 v[140:143], v11, s[16:19], s46 offen sc1
    v_mfma_f32_16x16x32_bf16 v[16:19], v[184:187], a[32:35], v[16:19]
    v_mfma_f32_16x16x32_bf16 v[44:47], v[184:187], a[36:39], v[44:47]
    v_mfma_f32_16x16x32_bf16 v[72:75], v[184:187], a[40:43], v[72:75]
    v_mfma_f32_16x16x32_bf16 v[100:103], v[184:187], a[44:47], v[100:103]
    s_mov_b32 s46, 0x18b7000
    buffer_load_dwordx4 v[144:147], v11, s[16:19], s46 offen sc1
    v_mfma_f32_16x16x32_bf16 v[20:23], v[188:191], a[32:35], v[20:23]
    v_mfma_f32_16x16x32_bf16 v[48:51], v[188:191], a[36:39], v[48:51]
    v_mfma_f32_16x16x32_bf16 v[76:79], v[188:191], a[40:43], v[76:79]
    v_mfma_f32_16x16x32_bf16 v[104:107], v[188:191], a[44:47], v[104:107]
    s_mov_b32 s46, 0x18b7400
    buffer_load_dwordx4 v[148:151], v11, s[16:19], s46 offen sc1
    v_mfma_f32_16x16x32_bf16 v[24:27], v[192:195], a[32:35], v[24:27]
    v_mfma_f32_16x16x32_bf16 v[52:55], v[192:195], a[36:39], v[52:55]
    v_mfma_f32_16x16x32_bf16 v[80:83], v[192:195], a[40:43], v[80:83]
    v_mfma_f32_16x16x32_bf16 v[108:111], v[192:195], a[44:47], v[108:111]
    s_mov_b32 s46, 0x18b7800
    buffer_load_dwordx4 v[152:155], v12, s[16:19], s46 offen sc1
    v_mfma_f32_16x16x32_bf16 v[28:31], v[196:199], a[32:35], v[28:31]
    v_mfma_f32_16x16x32_bf16 v[56:59], v[196:199], a[36:39], v[56:59]
    v_mfma_f32_16x16x32_bf16 v[84:87], v[196:199], a[40:43], v[84:87]
    v_mfma_f32_16x16x32_bf16 v[112:115], v[196:199], a[44:47], v[112:115]
    s_mov_b32 s46, 0x18c3800
    buffer_load_dwordx4 v[156:159], v11, s[16:19], s46 offen sc1
    v_mfma_f32_16x16x32_bf16 v[32:35], v[200:203], a[32:35], v[32:35]
    v_mfma_f32_16x16x32_bf16 v[60:63], v[200:203], a[36:39], v[60:63]
    v_mfma_f32_16x16x32_bf16 v[88:91], v[200:203], a[40:43], v[88:91]
    s_waitcnt vmcnt(8)
    v_max3_u32 v2, v212, v216, v220
    v_mfma_f32_16x16x32_bf16 v[116:119], v[200:203], a[44:47], v[116:119]
    s_mov_b32 s46, 0x18c3c00
    buffer_load_dwordx4 v[160:163], v11, s[16:19], s46 offen sc1
    v_max3_u32 v2, v2, v224, v228
    v_mfma_f32_16x16x32_bf16 v[36:39], v[204:207], a[32:35], v[36:39]
    v_max3_u32 v2, v2, v232, v236
    v_mfma_f32_16x16x32_bf16 v[64:67], v[204:207], a[36:39], v[64:67]
    v_cmp_eq_u32 vcc, -1, v2
    v_mfma_f32_16x16x32_bf16 v[92:95], v[204:207], a[40:43], v[92:95]
    v_mfma_f32_16x16x32_bf16 v[120:123], v[204:207], a[44:47], v[120:123]
    s_mov_b32 s46, 0x18c4000
    buffer_load_dwordx4 v[164:167], v11, s[16:19], s46 offen sc1
    s_cbranch_vccnz pk_c83_s
pk_c83_r:
    v_mfma_f32_16x16x32_bf16 v[40:43], v[208:211], a[32:35], v[40:43]
    v_mfma_f32_16x16x32_bf16 v[68:71], v[208:211], a[36:39], v[68:71]
    v_mfma_f32_16x16x32_bf16 v[96:99], v[208:211], a[40:43], v[96:99]
    v_mfma_f32_16x16x32_bf16 v[124:127], v[208:211], a[44:47], v[124:127]
    s_mov_b32 s46, 0x18c4400
    buffer_load_dwordx4 v[168:171], v11, s[16:19], s46 offen sc1
    v_mfma_f32_16x16x32_bf16 v[16:19], v[212:215], a[48:51], v[16:19]
    v_mfma_f32_16x16x32_bf16 v[44:47], v[212:215], a[52:55], v[44:47]
    v_mfma_f32_16x16x32_bf16 v[72:75], v[212:215], a[56:59], v[72:75]
    v_mov_b32 v2, 0
    s_mov_b64 exec, 1
    s_cmp_lg_u32 s1, 0
    s_cbranch_scc0 pk_w84_s
    buffer_store_dword v2, v2, s[16:19], s35 offen
pk_w84_r:
    s_mov_b64 exec, -1
    v_mfma_f32_16x16x32_bf16 v[100:103], v[212:215], a[60:63], v[100:103]
    s_mov_b32 s46, 0x18c4800
    buffer_load_dwordx4 v[172:175], v11, s[16:19], s46 offen sc1
    v_mfma_f32_16x16x32_bf16 v[20:23], v[216:219], a[48:51], v[20:23]
    v_mfma_f32_16x16x32_bf16 v[48:51], v[216:219], a[52:55], v[48:51]
    v_mfma_f32_16x16x32_bf16 v[76:79], v[216:219], a[56:59], v[76:79]
    v_mfma_f32_16x16x32_bf16 v[104:107], v[216:219], a[60:63], v[104:107]
    s_mov_b32 s46, 0x18c4c00
    buffer_load_dwordx4 v[176:179], v11, s[16:19], s46 offen sc1
    v_mfma_f32_16x16x32_bf16 v[24:27], v[220:223], a[48:51], v[24:27]
    v_mfma_f32_16x16x32_bf16 v[52:55], v[220:223], a[52:55], v[52:55]
    v_mfma_f32_16x16x32_bf16 v[80:83], v[220:223], a[56:59], v[80:83]
    v_mfma_f32_16x16x32_bf16 v[108:111], v[220:223], a[60:63], v[108:111]
    s_mov_b32 s46, 0x18c5000
    buffer_load_dwordx4 v[180:183], v12, s[16:19], s46 offen sc1
    v_mfma_f32_16x16x32_bf16 v[28:31], v[224:227], a[48:51], v[28:31]
    v_mfma_f32_16x16x32_bf16 v[56:59], v[224:227], a[52:55], v[56:59]
    v_mfma_f32_16x16x32_bf16 v[84:87], v[224:227], a[56:59], v[84:87]
    v_mfma_f32_16x16x32_bf16 v[112:115], v[224:227], a[60:63], v[112:115]
    s_mov_b32 s46, 0x18d1000
    buffer_load_dwordx4 v[184:187], v11, s[16:19], s46 offen sc1
    v_mfma_f32_16x16x32_bf16 v[32:35], v[228:231], a[48:51], v[32:35]
    v_mfma_f32_16x16x32_bf16 v[60:63], v[228:231], a[52:55], v[60:63]
    v_mfma_f32_16x16x32_bf16 v[88:91], v[228:231], a[56:59], v[88:91]
    ds_read_b128 a[224:227], v6 offset:32768
    ds_read_b128 a[228:231], v6 offset:34816
    ds_read_b128 a[232:235], v6 offset:36864
    ds_read_b128 a[236:239], v6 offset:38912
    s_waitcnt vmcnt(9)
    v_max3_u32 v2, v128, v132, v136
    v_mfma_f32_16x16x32_bf16 v[116:119], v[228:231], a[60:63], v[116:119]
    s_mov_b32 s46, 0x18d1400
    buffer_load_dwordx4 v[188:191], v11, s[16:19], s46 offen sc1
    v_max3_u32 v2, v2, v140, v144
    v_mfma_f32_16x16x32_bf16 v[36:39], v[232:235], a[48:51], v[36:39]
    v_max3_u32 v2, v2, v148, v152
    v_mfma_f32_16x16x32_bf16 v[64:67], v[232:235], a[52:55], v[64:67]
    v_cmp_eq_u32 vcc, -1, v2
    v_mfma_f32_16x16x32_bf16 v[92:95], v[232:235], a[56:59], v[92:95]
    v_mfma_f32_16x16x32_bf16 v[120:123], v[232:235], a[60:63], v[120:123]
    s_mov_b32 s46, 0x18d1800
    buffer_load_dwordx4 v[192:195], v11, s[16:19], s46 offen sc1
    s_cbranch_vccnz pk_c85_s
pk_c85_r:
    v_mfma_f32_16x16x32_bf16 v[40:43], v[236:239], a[48:51], v[40:43]
    v_mfma_f32_16x16x32_bf16 v[68:71], v[236:239], a[52:55], v[68:71]
    v_mfma_f32_16x16x32_bf16 v[96:99], v[236:239], a[56:59], v[96:99]
    v_mfma_f32_16x16x32_bf16 v[124:127], v[236:239], a[60:63], v[124:127]
    s_mov_b32 s46, 0x18d1c00
    buffer_load_dwordx4 v[196:199], v11, s[16:19], s46 offen sc1
    v_mfma_f32_16x16x32_bf16 v[16:19], v[128:131], a[64:67], v[16:19]
    v_mfma_f32_16x16x32_bf16 v[44:47], v[128:131], a[68:71], v[44:47]
    v_mfma_f32_16x16x32_bf16 v[72:75], v[128:131], a[72:75], v[72:75]
    v_mfma_f32_16x16x32_bf16 v[100:103], v[128:131], a[76:79], v[100:103]
    s_mov_b32 s46, 0x18d2000
    buffer_load_dwordx4 v[200:203], v11, s[16:19], s46 offen sc1
    v_mfma_f32_16x16x32_bf16 v[20:23], v[132:135], a[64:67], v[20:23]
    v_mfma_f32_16x16x32_bf16 v[48:51], v[132:135], a[68:71], v[48:51]
    v_mfma_f32_16x16x32_bf16 v[76:79], v[132:135], a[72:75], v[76:79]
    v_mfma_f32_16x16x32_bf16 v[104:107], v[132:135], a[76:79], v[104:107]
    s_mov_b32 s46, 0x18d2400
    buffer_load_dwordx4 v[204:207], v11, s[16:19], s46 offen sc1
    v_mfma_f32_16x16x32_bf16 v[24:27], v[136:139], a[64:67], v[24:27]
    v_mfma_f32_16x16x32_bf16 v[52:55], v[136:139], a[68:71], v[52:55]
    v_mfma_f32_16x16x32_bf16 v[80:83], v[136:139], a[72:75], v[80:83]
    v_mfma_f32_16x16x32_bf16 v[108:111], v[136:139], a[76:79], v[108:111]
    s_mov_b32 s46, 0x18d2800
    buffer_load_dwordx4 v[208:211], v12, s[16:19], s46 offen sc1
    v_mfma_f32_16x16x32_bf16 v[28:31], v[140:143], a[64:67], v[28:31]
    v_mfma_f32_16x16x32_bf16 v[56:59], v[140:143], a[68:71], v[56:59]
    v_mfma_f32_16x16x32_bf16 v[84:87], v[140:143], a[72:75], v[84:87]
    v_mfma_f32_16x16x32_bf16 v[112:115], v[140:143], a[76:79], v[112:115]
    s_mov_b32 s46, 0x18de800
    buffer_load_dwordx4 v[212:215], v11, s[16:19], s46 offen sc1
    v_mfma_f32_16x16x32_bf16 v[32:35], v[144:147], a[64:67], v[32:35]
    v_mfma_f32_16x16x32_bf16 v[60:63], v[144:147], a[68:71], v[60:63]
    v_mfma_f32_16x16x32_bf16 v[88:91], v[144:147], a[72:75], v[88:91]
    ds_read_b128 a[240:243], v7 offset:32768
    ds_read_b128 a[244:247], v7 offset:34816
    ds_read_b128 a[248:251], v7 offset:36864
    ds_read_b128 a[252:255], v7 offset:38912
    s_waitcnt vmcnt(8)
    v_max3_u32 v2, v156, v160, v164
    v_mfma_f32_16x16x32_bf16 v[116:119], v[144:147], a[76:79], v[116:119]
    s_mov_b32 s46, 0x18dec00
    buffer_load_dwordx4 v[216:219], v11, s[16:19], s46 offen sc1
    v_max3_u32 v2, v2, v168, v172
    v_mfma_f32_16x16x32_bf16 v[36:39], v[148:151], a[64:67], v[36:39]
    v_max3_u32 v2, v2, v176, v180
    v_mfma_f32_16x16x32_bf16 v[64:67], v[148:151], a[68:71], v[64:67]
    v_cmp_eq_u32 vcc, -1, v2
    v_mfma_f32_16x16x32_bf16 v[92:95], v[148:151], a[72:75], v[92:95]
    v_mfma_f32_16x16x32_bf16 v[120:123], v[148:151], a[76:79], v[120:123]
    s_mov_b32 s46, 0x18df000
    buffer_load_dwordx4 v[220:223], v11, s[16:19], s46 offen sc1
    s_cbranch_vccnz pk_c86_s
pk_c86_r:
    v_mfma_f32_16x16x32_bf16 v[40:43], v[152:155], a[64:67], v[40:43]
    v_mfma_f32_16x16x32_bf16 v[68:71], v[152:155], a[68:71], v[68:71]
    v_mfma_f32_16x16x32_bf16 v[96:99], v[152:155], a[72:75], v[96:99]
    v_mfma_f32_16x16x32_bf16 v[124:127], v[152:155], a[76:79], v[124:127]
    s_mov_b32 s46, 0x18df400
    buffer_load_dwordx4 v[224:227], v11, s[16:19], s46 offen sc1
    v_mfma_f32_16x16x32_bf16 v[16:19], v[156:159], a[80:83], v[16:19]
    v_mfma_f32_16x16x32_bf16 v[44:47], v[156:159], a[84:87], v[44:47]
    v_mfma_f32_16x16x32_bf16 v[72:75], v[156:159], a[88:91], v[72:75]
    v_mfma_f32_16x16x32_bf16 v[100:103], v[156:159], a[92:95], v[100:103]
    s_mov_b32 s46, 0x18df800
    buffer_load_dwordx4 v[228:231], v11, s[16:19], s46 offen sc1
    v_mfma_f32_16x16x32_bf16 v[20:23], v[160:163], a[80:83], v[20:23]
    v_mfma_f32_16x16x32_bf16 v[48:51], v[160:163], a[84:87], v[48:51]
    v_mfma_f32_16x16x32_bf16 v[76:79], v[160:163], a[88:91], v[76:79]
    v_mfma_f32_16x16x32_bf16 v[104:107], v[160:163], a[92:95], v[104:107]
    s_mov_b32 s46, 0x18dfc00
    buffer_load_dwordx4 v[232:235], v11, s[16:19], s46 offen sc1
    v_mfma_f32_16x16x32_bf16 v[24:27], v[164:167], a[80:83], v[24:27]
    v_mfma_f32_16x16x32_bf16 v[52:55], v[164:167], a[84:87], v[52:55]
    v_mfma_f32_16x16x32_bf16 v[80:83], v[164:167], a[88:91], v[80:83]
    v_mfma_f32_16x16x32_bf16 v[108:111], v[164:167], a[92:95], v[108:111]
    s_mov_b32 s46, 0x18e0000
    buffer_load_dwordx4 v[236:239], v12, s[16:19], s46 offen sc1
    v_mfma_f32_16x16x32_bf16 v[28:31], v[168:171], a[80:83], v[28:31]
    v_mfma_f32_16x16x32_bf16 v[56:59], v[168:171], a[84:87], v[56:59]
    v_mfma_f32_16x16x32_bf16 v[84:87], v[168:171], a[88:91], v[84:87]
    v_mfma_f32_16x16x32_bf16 v[112:115], v[168:171], a[92:95], v[112:115]
    s_mov_b32 s46, 0x18ec000
    buffer_load_dwordx4 v[128:131], v11, s[16:19], s46 offen sc1
    v_mfma_f32_16x16x32_bf16 v[32:35], v[172:175], a[80:83], v[32:35]
    v_mfma_f32_16x16x32_bf16 v[60:63], v[172:175], a[84:87], v[60:63]
    v_mfma_f32_16x16x32_bf16 v[88:91], v[172:175], a[88:91], v[88:91]
    s_waitcnt vmcnt(8)
    v_max3_u32 v2, v184, v188, v192
    v_mfma_f32_16x16x32_bf16 v[116:119], v[172:175], a[92:95], v[116:119]
    s_mov_b32 s46, 0x18ec400
    buffer_load_dwordx4 v[132:135], v11, s[16:19], s46 offen sc1
    v_max3_u32 v2, v2, v196, v200
    v_mfma_f32_16x16x32_bf16 v[36:39], v[176:179], a[80:83], v[36:39]
    v_max3_u32 v2, v2, v204, v208
    v_mfma_f32_16x16x32_bf16 v[64:67], v[176:179], a[84:87], v[64:67]
    v_cmp_eq_u32 vcc, -1, v2
    v_mfma_f32_16x16x32_bf16 v[92:95], v[176:179], a[88:91], v[92:95]
    v_mfma_f32_16x16x32_bf16 v[120:123], v[176:179], a[92:95], v[120:123]
    s_mov_b32 s46, 0x18ec800
    buffer_load_dwordx4 v[136:139], v11, s[16:19], s46 offen sc1
    s_cbranch_vccnz pk_c87_s
pk_c87_r:
    v_mfma_f32_16x16x32_bf16 v[40:43], v[180:183], a[80:83], v[40:43]
    v_mfma_f32_16x16x32_bf16 v[68:71], v[180:183], a[84:87], v[68:71]
    v_mfma_f32_16x16x32_bf16 v[96:99], v[180:183], a[88:91], v[96:99]
    v_mfma_f32_16x16x32_bf16 v[124:127], v[180:183], a[92:95], v[124:127]
    s_mov_b32 s46, 0x18ecc00
    buffer_load_dwordx4 v[140:143], v11, s[16:19], s46 offen sc1
    v_mfma_f32_16x16x32_bf16 v[16:19], v[184:187], a[96:99], v[16:19]
    v_mfma_f32_16x16x32_bf16 v[44:47], v[184:187], a[100:103], v[44:47]
    v_mfma_f32_16x16x32_bf16 v[72:75], v[184:187], a[104:107], v[72:75]
    v_mfma_f32_16x16x32_bf16 v[100:103], v[184:187], a[108:111], v[100:103]
    s_mov_b32 s46, 0x18ed000
    buffer_load_dwordx4 v[144:147], v11, s[16:19], s46 offen sc1
    v_mfma_f32_16x16x32_bf16 v[20:23], v[188:191], a[96:99], v[20:23]
    v_mfma_f32_16x16x32_bf16 v[48:51], v[188:191], a[100:103], v[48:51]
    v_mfma_f32_16x16x32_bf16 v[76:79], v[188:191], a[104:107], v[76:79]
    v_mfma_f32_16x16x32_bf16 v[104:107], v[188:191], a[108:111], v[104:107]
    s_mov_b32 s46, 0x18ed400
    buffer_load_dwordx4 v[148:151], v11, s[16:19], s46 offen sc1
    v_mfma_f32_16x16x32_bf16 v[24:27], v[192:195], a[96:99], v[24:27]
    v_mfma_f32_16x16x32_bf16 v[52:55], v[192:195], a[100:103], v[52:55]
    v_mfma_f32_16x16x32_bf16 v[80:83], v[192:195], a[104:107], v[80:83]
    v_mfma_f32_16x16x32_bf16 v[108:111], v[192:195], a[108:111], v[108:111]
    s_mov_b32 s46, 0x18ed800
    buffer_load_dwordx4 v[152:155], v12, s[16:19], s46 offen sc1
    v_mfma_f32_16x16x32_bf16 v[28:31], v[196:199], a[96:99], v[28:31]
    v_mfma_f32_16x16x32_bf16 v[56:59], v[196:199], a[100:103], v[56:59]
    v_mfma_f32_16x16x32_bf16 v[84:87], v[196:199], a[104:107], v[84:87]
    v_mfma_f32_16x16x32_bf16 v[112:115], v[196:199], a[108:111], v[112:115]
    s_mov_b32 s46, 0x18f9800
    buffer_load_dwordx4 v[156:159], v11, s[16:19], s46 offen sc1
    v_mfma_f32_16x16x32_bf16 v[32:35], v[200:203], a[96:99], v[32:35]
    v_mfma_f32_16x16x32_bf16 v[60:63], v[200:203], a[100:103], v[60:63]
    v_mfma_f32_16x16x32_bf16 v[88:91], v[200:203], a[104:107], v[88:91]
    s_waitcnt vmcnt(8)
    v_max3_u32 v2, v212, v216, v220
    v_mfma_f32_16x16x32_bf16 v[116:119], v[200:203], a[108:111], v[116:119]
    s_mov_b32 s46, 0x18f9c00
    buffer_load_dwordx4 v[160:163], v11, s[16:19], s46 offen sc1
    v_max3_u32 v2, v2, v224, v228
    v_mfma_f32_16x16x32_bf16 v[36:39], v[204:207], a[96:99], v[36:39]
    v_max3_u32 v2, v2, v232, v236
    v_mfma_f32_16x16x32_bf16 v[64:67], v[204:207], a[100:103], v[64:67]
    v_cmp_eq_u32 vcc, -1, v2
    v_mfma_f32_16x16x32_bf16 v[92:95], v[204:207], a[104:107], v[92:95]
    v_mfma_f32_16x16x32_bf16 v[120:123], v[204:207], a[108:111], v[120:123]
    s_mov_b32 s46, 0x18fa000
    buffer_load_dwordx4 v[164:167], v11, s[16:19], s46 offen sc1
    s_cbranch_vccnz pk_c88_s
pk_c88_r:
    v_mfma_f32_16x16x32_bf16 v[40:43], v[208:211], a[96:99], v[40:43]
    v_mfma_f32_16x16x32_bf16 v[68:71], v[208:211], a[100:103], v[68:71]
    v_mfma_f32_16x16x32_bf16 v[96:99], v[208:211], a[104:107], v[96:99]
    v_mfma_f32_16x16x32_bf16 v[124:127], v[208:211], a[108:111], v[124:127]
    s_mov_b32 s46, 0x18fa400
    buffer_load_dwordx4 v[168:171], v11, s[16:19], s46 offen sc1
    buffer_load_dword v255, v14, s[16:19], s36 offen sc1
    v_mfma_f32_16x16x32_bf16 v[16:19], v[212:215], a[112:115], v[16:19]
    v_mfma_f32_16x16x32_bf16 v[44:47], v[212:215], a[116:119], v[44:47]
    v_mfma_f32_16x16x32_bf16 v[72:75], v[212:215], a[120:123], v[72:75]
    v_mfma_f32_16x16x32_bf16 v[100:103], v[212:215], a[124:127], v[100:103]
    s_mov_b32 s46, 0x18fa800
    buffer_load_dwordx4 v[172:175], v11, s[16:19], s46 offen sc1
    v_mfma_f32_16x16x32_bf16 v[20:23], v[216:219], a[112:115], v[20:23]
    v_mfma_f32_16x16x32_bf16 v[48:51], v[216:219], a[116:119], v[48:51]
    v_mfma_f32_16x16x32_bf16 v[76:79], v[216:219], a[120:123], v[76:79]
    v_mfma_f32_16x16x32_bf16 v[104:107], v[216:219], a[124:127], v[104:107]
    s_mov_b32 s46, 0x18fac00
    buffer_load_dwordx4 v[176:179], v11, s[16:19], s46 offen sc1
    v_mfma_f32_16x16x32_bf16 v[24:27], v[220:223], a[112:115], v[24:27]
    v_mfma_f32_16x16x32_bf16 v[52:55], v[220:223], a[116:119], v[52:55]
    v_mfma_f32_16x16x32_bf16 v[80:83], v[220:223], a[120:123], v[80:83]
    v_mfma_f32_16x16x32_bf16 v[108:111], v[220:223], a[124:127], v[108:111]
    s_mov_b32 s46, 0x18fb000
    buffer_load_dwordx4 v[180:183], v12, s[16:19], s46 offen sc1
    v_mfma_f32_16x16x32_bf16 v[28:31], v[224:227], a[112:115], v[28:31]
    v_mfma_f32_16x16x32_bf16 v[56:59], v[224:227], a[116:119], v[56:59]
    v_mfma_f32_16x16x32_bf16 v[84:87], v[224:227], a[120:123], v[84:87]
    v_mfma_f32_16x16x32_bf16 v[112:115], v[224:227], a[124:127], v[112:115]
    s_mov_b32 s46, 0x1907000
    buffer_load_dwordx4 v[184:187], v11, s[16:19], s46 offen sc1
    v_mfma_f32_16x16x32_bf16 v[32:35], v[228:231], a[112:115], v[32:35]
    v_mfma_f32_16x16x32_bf16 v[60:63], v[228:231], a[116:119], v[60:63]
    v_mfma_f32_16x16x32_bf16 v[88:91], v[228:231], a[120:123], v[88:91]
    s_waitcnt vmcnt(9)
    v_max3_u32 v2, v128, v132, v136
    v_mfma_f32_16x16x32_bf16 v[116:119], v[228:231], a[124:127], v[116:119]
    s_mov_b32 s46, 0x1914800
    buffer_load_dwordx4 v[188:191], v11, s[16:19], s46 offen sc1
    v_max3_u32 v2, v2, v140, v144
    v_mfma_f32_16x16x32_bf16 v[36:39], v[232:235], a[112:115], v[36:39]
    v_max3_u32 v2, v2, v148, v152
    v_mfma_f32_16x16x32_bf16 v[64:67], v[232:235], a[116:119], v[64:67]
    v_cmp_eq_u32 vcc, -1, v2
    v_mfma_f32_16x16x32_bf16 v[92:95], v[232:235], a[120:123], v[92:95]
    v_mfma_f32_16x16x32_bf16 v[120:123], v[232:235], a[124:127], v[120:123]
    s_mov_b32 s46, 0x1922000
    buffer_load_dwordx4 v[192:195], v11, s[16:19], s46 offen sc1
    s_cbranch_vccnz pk_c89_s
pk_c89_r:
    v_mfma_f32_16x16x32_bf16 v[40:43], v[236:239], a[112:115], v[40:43]
    v_mfma_f32_16x16x32_bf16 v[68:71], v[236:239], a[116:119], v[68:71]
    v_mfma_f32_16x16x32_bf16 v[96:99], v[236:239], a[120:123], v[96:99]
    v_mfma_f32_16x16x32_bf16 v[124:127], v[236:239], a[124:127], v[124:127]
    s_mov_b32 s46, 0x192f800
    buffer_load_dwordx4 v[196:199], v11, s[16:19], s46 offen sc1
    s_waitcnt lgkmcnt(0)
    v_add_u32 v6, s39, v3
    v_add_u32 v7, 0x10000, v6
    v_mfma_f32_16x16x32_bf16 v[16:19], v[128:131], a[128:131], v[16:19]
    v_mfma_f32_16x16x32_bf16 v[44:47], v[128:131], a[132:135], v[44:47]
    v_mfma_f32_16x16x32_bf16 v[72:75], v[128:131], a[136:139], v[72:75]
    v_mfma_f32_16x16x32_bf16 v[100:103], v[128:131], a[140:143], v[100:103]
    s_mov_b32 s46, 0x193d000
    buffer_load_dwordx4 v[200:203], v11, s[16:19], s46 offen sc1
    v_mfma_f32_16x16x32_bf16 v[20:23], v[132:135], a[128:131], v[20:23]
    v_mfma_f32_16x16x32_bf16 v[48:51], v[132:135], a[132:135], v[48:51]
    v_mfma_f32_16x16x32_bf16 v[76:79], v[132:135], a[136:139], v[76:79]
    v_mfma_f32_16x16x32_bf16 v[104:107], v[132:135], a[140:143], v[104:107]
    s_mov_b32 s46, 0x194a800
    buffer_load_dwordx4 v[204:207], v11, s[16:19], s46 offen sc1
    v_mfma_f32_16x16x32_bf16 v[24:27], v[136:139], a[128:131], v[24:27]
    v_mfma_f32_16x16x32_bf16 v[52:55], v[136:139], a[132:135], v[52:55]
    v_mfma_f32_16x16x32_bf16 v[80:83], v[136:139], a[136:139], v[80:83]
    v_mfma_f32_16x16x32_bf16 v[108:111], v[136:139], a[140:143], v[108:111]
    s_mov_b32 s46, 0x1907400
    buffer_load_dwordx4 v[208:211], v11, s[16:19], s46 offen sc1
    v_mfma_f32_16x16x32_bf16 v[28:31], v[140:143], a[128:131], v[28:31]
    v_mfma_f32_16x16x32_bf16 v[56:59], v[140:143], a[132:135], v[56:59]
    v_mfma_f32_16x16x32_bf16 v[84:87], v[140:143], a[136:139], v[84:87]
    v_mfma_f32_16x16x32_bf16 v[112:115], v[140:143], a[140:143], v[112:115]
    s_mov_b32 s46, 0x1914c00
    buffer_load_dwordx4 v[212:215], v11, s[16:19], s46 offen sc1
    v_mfma_f32_16x16x32_bf16 v[32:35], v[144:147], a[128:131], v[32:35]
    v_mfma_f32_16x16x32_bf16 v[60:63], v[144:147], a[132:135], v[60:63]
    v_mfma_f32_16x16x32_bf16 v[88:91], v[144:147], a[136:139], v[88:91]
    s_waitcnt vmcnt(8)
    v_max3_u32 v2, v156, v160, v164
    v_mfma_f32_16x16x32_bf16 v[116:119], v[144:147], a[140:143], v[116:119]
    s_mov_b32 s46, 0x1922400
    buffer_load_dwordx4 v[216:219], v11, s[16:19], s46 offen sc1
    v_max3_u32 v2, v2, v168, v172
    v_mfma_f32_16x16x32_bf16 v[36:39], v[148:151], a[128:131], v[36:39]
    v_max3_u32 v2, v2, v176, v180
    v_mfma_f32_16x16x32_bf16 v[64:67], v[148:151], a[132:135], v[64:67]
    v_cmp_eq_u32 vcc, -1, v2
    v_mfma_f32_16x16x32_bf16 v[92:95], v[148:151], a[136:139], v[92:95]
    v_mfma_f32_16x16x32_bf16 v[120:123], v[148:151], a[140:143], v[120:123]
    s_mov_b32 s46, 0x192fc00
    buffer_load_dwordx4 v[220:223], v11, s[16:19], s46 offen sc1
    s_cbranch_vccnz pk_c90_s
pk_c90_r:
    v_mfma_f32_16x16x32_bf16 v[40:43], v[152:155], a[128:131], v[40:43]
    v_mfma_f32_16x16x32_bf16 v[68:71], v[152:155], a[132:135], v[68:71]
    v_mfma_f32_16x16x32_bf16 v[96:99], v[152:155], a[136:139], v[96:99]
    v_mfma_f32_16x16x32_bf16 v[124:127], v[152:155], a[140:143], v[124:127]
    s_mov_b32 s46, 0x193d400
    buffer_load_dwordx4 v[224:227], v11, s[16:19], s46 offen sc1
    v_mfma_f32_16x16x32_bf16 v[16:19], v[156:159], a[144:147], v[16:19]
    v_mfma_f32_16x16x32_bf16 v[44:47], v[156:159], a[148:151], v[44:47]
    v_mfma_f32_16x16x32_bf16 v[72:75], v[156:159], a[152:155], v[72:75]
    v_mfma_f32_16x16x32_bf16 v[100:103], v[156:159], a[156:159], v[100:103]
    s_mov_b32 s46, 0x194ac00
    buffer_load_dwordx4 v[228:231], v11, s[16:19], s46 offen sc1
    v_mfma_f32_16x16x32_bf16 v[20:23], v[160:163], a[144:147], v[20:23]
    v_mfma_f32_16x16x32_bf16 v[48:51], v[160:163], a[148:151], v[48:51]
    v_mfma_f32_16x16x32_bf16 v[76:79], v[160:163], a[152:155], v[76:79]
    v_mfma_f32_16x16x32_bf16 v[104:107], v[160:163], a[156:159], v[104:107]
    s_mov_b32 s46, 0x1907800
    buffer_load_dwordx4 v[232:235], v11, s[16:19], s46 offen sc1
    v_mfma_f32_16x16x32_bf16 v[24:27], v[164:167], a[144:147], v[24:27]
    v_mfma_f32_16x16x32_bf16 v[52:55], v[164:167], a[148:151], v[52:55]
    v_mfma_f32_16x16x32_bf16 v[80:83], v[164:167], a[152:155], v[80:83]
    v_mfma_f32_16x16x32_bf16 v[108:111], v[164:167], a[156:159], v[108:111]
    s_mov_b32 s46, 0x1915000
    buffer_load_dwordx4 v[236:239], v11, s[16:19], s46 offen sc1
    v_mfma_f32_16x16x32_bf16 v[28:31], v[168:171], a[144:147], v[28:31]
    v_mfma_f32_16x16x32_bf16 v[56:59], v[168:171], a[148:151], v[56:59]
    v_mfma_f32_16x16x32_bf16 v[84:87], v[168:171], a[152:155], v[84:87]
    v_mfma_f32_16x16x32_bf16 v[112:115], v[168:171], a[156:159], v[112:115]
    s_mov_b32 s46, 0x1922800
    buffer_load_dwordx4 v[128:131], v11, s[16:19], s46 offen sc1
    v_mfma_f32_16x16x32_bf16 v[32:35], v[172:175], a[144:147], v[32:35]
    v_mfma_f32_16x16x32_bf16 v[60:63], v[172:175], a[148:151], v[60:63]
    v_mfma_f32_16x16x32_bf16 v[88:91], v[172:175], a[152:155], v[88:91]
    s_waitcnt vmcnt(9)
    v_max3_u32 v2, v184, v188, v192
    v_mfma_f32_16x16x32_bf16 v[116:119], v[172:175], a[156:159], v[116:119]
    s_mov_b32 s46, 0x1930000
    buffer_load_dwordx4 v[132:135], v11, s[16:19], s46 offen sc1
    v_max3_u32 v2, v2, v196, v200
    v_mfma_f32_16x16x32_bf16 v[36:39], v[176:179], a[144:147], v[36:39]
    v_max_u32 v2, v2, v204
    v_mfma_f32_16x16x32_bf16 v[64:67], v[176:179], a[148:151], v[64:67]
    v_cmp_eq_u32 vcc, -1, v2
    v_mfma_f32_16x16x32_bf16 v[92:95], v[176:179], a[152:155], v[92:95]
    v_mfma_f32_16x16x32_bf16 v[120:123], v[176:179], a[156:159], v[120:123]
    s_mov_b32 s46, 0x193d800
    buffer_load_dwordx4 v[136:139], v11, s[16:19], s46 offen sc1
    s_cbranch_vccnz pk_c91_s
pk_c91_r:
    v_mfma_f32_16x16x32_bf16 v[40:43], v[180:183], a[144:147], v[40:43]
    v_mfma_f32_16x16x32_bf16 v[68:71], v[180:183], a[148:151], v[68:71]
    v_mfma_f32_16x16x32_bf16 v[96:99], v[180:183], a[152:155], v[96:99]
    v_mfma_f32_16x16x32_bf16 v[124:127], v[180:183], a[156:159], v[124:127]
    s_mov_b32 s46, 0x194b000
    buffer_load_dwordx4 v[140:143], v11, s[16:19], s46 offen sc1
    v_mfma_f32_16x16x32_bf16 v[16:19], v[184:187], a[160:163], v[16:19]
    v_mfma_f32_16x16x32_bf16 v[44:47], v[184:187], a[164:167], v[44:47]
    v_mfma_f32_16x16x32_bf16 v[72:75], v[184:187], a[168:171], v[72:75]
    v_cmp_eq_u32 vcc, -1, v255
    s_cbranch_vccnz pk_c92_s
pk_c92_r:
    v_lshlrev_b32 v8, 3, v1
    v_add_u32 v9, 4096, v8
    buffer_load_dwordx2 v[240:241], v8, s[16:19], s44 offen offset:0 sc1
    v_mfma_f32_16x16x32_bf16 v[100:103], v[184:187], a[172:175], v[100:103]
    s_mov_b32 s46, 0x1907c00
    buffer_load_dwordx4 v[144:147], v11, s[16:19], s46 offen sc1
    v_mfma_f32_16x16x32_bf16 v[16:19], v[188:191], a[176:179], v[16:19]
    buffer_load_dwordx2 v[242:243], v8, s[16:19], s44 offen offset:1024 sc1
    v_mfma_f32_16x16x32_bf16 v[44:47], v[188:191], a[180:183], v[44:47]
    v_mfma_f32_16x16x32_bf16 v[72:75], v[188:191], a[184:187], v[72:75]
    buffer_load_dwordx2 v[244:245], v8, s[16:19], s44 offen offset:2048 sc1
    v_mfma_f32_16x16x32_bf16 v[100:103], v[188:191], a[188:191], v[100:103]
    s_mov_b32 s46, 0x1915400
    buffer_load_dwordx4 v[148:151], v11, s[16:19], s46 offen sc1
    v_mfma_f32_16x16x32_bf16 v[16:19], v[192:195], a[192:195], v[16:19]
    buffer_load_dwordx2 v[246:247], v8, s[16:19], s44 offen offset:3072 sc1
    v_mfma_f32_16x16x32_bf16 v[44:47], v[192:195], a[196:199], v[44:47]
    v_mfma_f32_16x16x32_bf16 v[72:75], v[192:195], a[200:203], v[72:75]
    buffer_load_dwordx2 v[248:249], v9, s[16:19], s44 offen offset:0 sc1
    v_mfma_f32_16x16x32_bf16 v[100:103], v[192:195], a[204:207], v[100:103]
    s_mov_b32 s46, 0x1922c00
    buffer_load_dwordx4 v[152:155], v11, s[16:19], s46 offen sc1
    v_mfma_f32_16x16x32_bf16 v[16:19], v[196:199], a[208:211], v[16:19]
    buffer_load_dwordx2 v[250:251], v9, s[16:19], s44 offen offset:1024 sc1
    v_mfma_f32_16x16x32_bf16 v[44:47], v[196:199], a[212:215], v[44:47]
    v_mfma_f32_16x16x32_bf16 v[72:75], v[196:199], a[216:219], v[72:75]
    buffer_load_dwordx2 v[252:253], v9, s[16:19], s44 offen offset:2048 sc1
    v_mfma_f32_16x16x32_bf16 v[100:103], v[196:199], a[220:223], v[100:103]
    s_mov_b32 s46, 0x1930400
    buffer_load_dwordx4 v[156:159], v11, s[16:19], s46 offen sc1
    v_mfma_f32_16x16x32_bf16 v[16:19], v[200:203], a[224:227], v[16:19]
    v_lshlrev_b32 v255, 1, v15
    buffer_load_ushort v254, v255, s[12:15], 0 offen
    v_mfma_f32_16x16x32_bf16 v[44:47], v[200:203], a[228:231], v[44:47]
    s_waitcnt vmcnt(18)
    v_max3_u32 v2, v208, v212, v216
    v_mfma_f32_16x16x32_bf16 v[72:75], v[200:203], a[232:235], v[72:75]
    v_max3_u32 v2, v2, v220, v224
    s_xor_b32 s45, s32, 1
    v_mfma_f32_16x16x32_bf16 v[100:103], v[200:203], a[236:239], v[100:103]
    s_mov_b32 s46, 0x193dc00
    buffer_load_dwordx4 v[160:163], v11, s[16:19], s46 offen sc1
    v_max_u32 v2, v2, v228
    s_mul_i32 s45, s45, 8192
    s_add_u32 s45, s45, 0
    v_mfma_f32_16x16x32_bf16 v[44:47], v[204:207], a[244:247], v[44:47]
    v_cmp_eq_u32 vcc, -1, v2
    v_add_u32 v8, s45, v3
    s_xor_b32 s45, s32, 2
    v_mfma_f32_16x16x32_bf16 v[72:75], v[204:207], a[248:251], v[72:75]
    s_mul_i32 s45, s45, 8192
    s_add_u32 s45, s45, 32768
    v_mfma_f32_16x16x32_bf16 v[100:103], v[204:207], a[252:255], v[100:103]
    s_cbranch_vccnz pk_c93_s
pk_c93_r:
    v_add_u32 v9, s45, v3
    s_xor_b32 s45, s32, 3
    v_mfma_f32_16x16x32_bf16 v[16:19], v[204:207], a[240:243], v[16:19]
    s_mov_b32 s46, 0x194b400
    buffer_load_dwordx4 v[164:167], v11, s[16:19], s46 offen sc1
    s_mul_i32 s45, s45, 8192
    s_add_u32 s45, s45, 65536
    v_mfma_f32_16x16x32_bf16 v[20:23], v[208:211], a[160:163], v[20:23]
    ds_write_b128 v6, v[44:47] offset:0
    v_mfma_f32_16x16x32_bf16 v[48:51], v[208:211], a[164:167], v[48:51]
    ds_write_b128 v6, v[72:75] offset:32768
    v_mfma_f32_16x16x32_bf16 v[76:79], v[208:211], a[168:171], v[76:79]
    ds_write_b128 v7, v[100:103] offset:0
    v_mfma_f32_16x16x32_bf16 v[104:107], v[208:211], a[172:175], v[104:107]
    s_mov_b32 s46, 0x1908000
    buffer_load_dwordx4 v[168:171], v11, s[16:19], s46 offen sc1
    v_add_u32 v5, s45, v3
    s_mul_i32 s44, s43, 27648
    v_mfma_f32_16x16x32_bf16 v[20:23], v[212:215], a[176:179], v[20:23]
    s_add_u32 s44, s44, 0x1c30000
    s_lshr_b32 s45, s34, 1
    v_mfma_f32_16x16x32_bf16 v[48:51], v[212:215], a[180:183], v[48:51]
    s_lshl_b32 s45, s45, 10
    s_and_b32 s36, s34, 1
    v_mfma_f32_16x16x32_bf16 v[76:79], v[212:215], a[184:187], v[76:79]
    s_lshl_b32 s36, s36, 3
    s_add_u32 s45, s45, s36
    v_mfma_f32_16x16x32_bf16 v[104:107], v[212:215], a[188:191], v[104:107]
    s_mov_b32 s46, 0x1915800
    buffer_load_dwordx4 v[172:175], v11, s[16:19], s46 offen sc1
    s_add_u32 s45, s45, s44
    s_add_u32 s45, s45, 24576
    v_mfma_f32_16x16x32_bf16 v[20:23], v[216:219], a[192:195], v[20:23]
    s_mul_i32 s36, s34, 3072
    s_add_u32 s44, s44, s36
    v_mfma_f32_16x16x32_bf16 v[48:51], v[216:219], a[196:199], v[48:51]
    v_mfma_f32_16x16x32_bf16 v[76:79], v[216:219], a[200:203], v[76:79]
    v_mfma_f32_16x16x32_bf16 v[104:107], v[216:219], a[204:207], v[104:107]
    s_mov_b32 s46, 0x1923000
    buffer_load_dwordx4 v[176:179], v11, s[16:19], s46 offen sc1
    v_mfma_f32_16x16x32_bf16 v[20:23], v[220:223], a[208:211], v[20:23]
    v_mfma_f32_16x16x32_bf16 v[48:51], v[220:223], a[212:215], v[48:51]
    v_mfma_f32_16x16x32_bf16 v[76:79], v[220:223], a[216:219], v[76:79]
    v_mfma_f32_16x16x32_bf16 v[104:107], v[220:223], a[220:223], v[104:107]
    s_mov_b32 s46, 0x1930800
    buffer_load_dwordx4 v[180:183], v11, s[16:19], s46 offen sc1
    v_mfma_f32_16x16x32_bf16 v[20:23], v[224:227], a[224:227], v[20:23]
    v_mfma_f32_16x16x32_bf16 v[48:51], v[224:227], a[228:231], v[48:51]
    s_waitcnt vmcnt(18)
    v_max3_u32 v2, v232, v236, v128
    v_mfma_f32_16x16x32_bf16 v[76:79], v[224:227], a[232:235], v[76:79]
    v_max3_u32 v2, v2, v132, v136
    v_mfma_f32_16x16x32_bf16 v[104:107], v[224:227], a[236:239], v[104:107]
    s_mov_b32 s46, 0x193e000
    buffer_load_dwordx4 v[184:187], v11, s[16:19], s46 offen sc1
    v_max_u32 v2, v2, v140
    v_mfma_f32_16x16x32_bf16 v[48:51], v[228:231], a[244:247], v[48:51]
    v_cmp_eq_u32 vcc, -1, v2
    v_mfma_f32_16x16x32_bf16 v[76:79], v[228:231], a[248:251], v[76:79]
    v_mfma_f32_16x16x32_bf16 v[104:107], v[228:231], a[252:255], v[104:107]
    s_cbranch_vccnz pk_c94_s
pk_c94_r:
    v_mfma_f32_16x16x32_bf16 v[20:23], v[228:231], a[240:243], v[20:23]
    s_mov_b32 s46, 0x194b800
    buffer_load_dwordx4 v[188:191], v11, s[16:19], s46 offen sc1
    v_mfma_f32_16x16x32_bf16 v[24:27], v[232:235], a[160:163], v[24:27]
    ds_write_b128 v6, v[48:51] offset:1024
    v_mfma_f32_16x16x32_bf16 v[52:55], v[232:235], a[164:167], v[52:55]
    ds_write_b128 v6, v[76:79] offset:33792
    v_mfma_f32_16x16x32_bf16 v[80:83], v[232:235], a[168:171], v[80:83]
    ds_write_b128 v7, v[104:107] offset:1024
    v_mfma_f32_16x16x32_bf16 v[108:111], v[232:235], a[172:175], v[108:111]
    s_mov_b32 s46, 0x1908400
    buffer_load_dwordx4 v[192:195], v11, s[16:19], s46 offen sc1
    v_mfma_f32_16x16x32_bf16 v[24:27], v[236:239], a[176:179], v[24:27]
    v_mfma_f32_16x16x32_bf16 v[52:55], v[236:239], a[180:183], v[52:55]
    s_waitcnt lgkmcnt(0)
    s_barrier
    v_mfma_f32_16x16x32_bf16 v[80:83], v[236:239], a[184:187], v[80:83]
    ds_read_b128 v[44:47], v8 offset:0
    ds_read_b128 v[72:75], v9 offset:0
    v_mfma_f32_16x16x32_bf16 v[108:111], v[236:239], a[188:191], v[108:111]
    s_mov_b32 s46, 0x1915c00
    buffer_load_dwordx4 v[196:199], v11, s[16:19], s46 offen sc1
    ds_read_b128 v[100:103], v5 offset:0
    ds_read_b128 v[48:51], v8 offset:1024
    v_mfma_f32_16x16x32_bf16 v[24:27], v[128:131], a[192:195], v[24:27]
    ds_read_b128 v[76:79], v9 offset:1024
    ds_read_b128 v[104:107], v5 offset:1024
    v_mfma_f32_16x16x32_bf16 v[52:55], v[128:131], a[196:199], v[52:55]
    v_mfma_f32_16x16x32_bf16 v[80:83], v[128:131], a[200:203], v[80:83]
    v_mfma_f32_16x16x32_bf16 v[108:111], v[128:131], a[204:207], v[108:111]
    s_mov_b32 s46, 0x1923400
    buffer_load_dwordx4 v[200:203], v11, s[16:19], s46 offen sc1
    v_mfma_f32_16x16x32_bf16 v[24:27], v[132:135], a[208:211], v[24:27]
    v_mfma_f32_16x16x32_bf16 v[52:55], v[132:135], a[212:215], v[52:55]
    s_waitcnt vmcnt(11)
    v_lshlrev_b32 v254, 16, v254
    s_waitcnt lgkmcnt(3)
    v_add_f32 v16, v16, v44
    v_add_f32 v17, v17, v45
    v_mfma_f32_16x16x32_bf16 v[80:83], v[132:135], a[216:219], v[80:83]
    v_add_f32 v18, v18, v46
    v_add_f32 v19, v19, v47
    v_mfma_f32_16x16x32_bf16 v[108:111], v[132:135], a[220:223], v[108:111]
    s_mov_b32 s46, 0x1930c00
    buffer_load_dwordx4 v[204:207], v11, s[16:19], s46 offen sc1
    v_add_f32 v16, v16, v72
    v_add_f32 v17, v17, v73
    v_mfma_f32_16x16x32_bf16 v[24:27], v[136:139], a[224:227], v[24:27]
    v_add_f32 v18, v18, v74
    v_add_f32 v19, v19, v75
    v_mfma_f32_16x16x32_bf16 v[52:55], v[136:139], a[228:231], v[52:55]
    s_waitcnt vmcnt(10)
    v_max3_u32 v2, v144, v148, v152
    v_add_f32 v16, v16, v100
    v_add_f32 v17, v17, v101
    v_mfma_f32_16x16x32_bf16 v[80:83], v[136:139], a[232:235], v[80:83]
    v_max3_u32 v2, v2, v156, v160
    v_add_f32 v18, v18, v102
    v_add_f32 v19, v19, v103
    v_mfma_f32_16x16x32_bf16 v[108:111], v[136:139], a[236:239], v[108:111]
    s_mov_b32 s46, 0x193e400
    buffer_load_dwordx4 v[208:211], v11, s[16:19], s46 offen sc1
    v_max_u32 v2, v2, v164
    v_cvt_pk_bf16_f32 v44, v16, v17
    v_cvt_pk_bf16_f32 v45, v18, v19
    v_mfma_f32_16x16x32_bf16 v[52:55], v[140:143], a[244:247], v[52:55]
    v_cmp_eq_u32 vcc, -1, v2
    v_lshlrev_b32 v72, 16, v240
    v_and_b32 v73, 0xffff0000, v240
    v_mfma_f32_16x16x32_bf16 v[80:83], v[140:143], a[248:251], v[80:83]
    v_lshlrev_b32 v74, 16, v241
    v_and_b32 v75, 0xffff0000, v241
    v_mfma_f32_16x16x32_bf16 v[108:111], v[140:143], a[252:255], v[108:111]
    s_cbranch_vccnz pk_c95_s
pk_c95_r:
    v_lshlrev_b32 v16, 16, v44
    v_and_b32 v17, 0xffff0000, v44
    v_mfma_f32_16x16x32_bf16 v[24:27], v[140:143], a[240:243], v[24:27]
    s_mov_b32 s46, 0x194bc00
    buffer_load_dwordx4 v[212:215], v11, s[16:19], s46 offen sc1
    v_lshlrev_b32 v18, 16, v45
    v_and_b32 v19, 0xffff0000, v45
    v_mfma_f32_16x16x32_bf16 v[28:31], v[144:147], a[160:163], v[28:31]
    ds_write_b128 v6, v[52:55] offset:2048
    v_mfma_f32_16x16x32_bf16 v[56:59], v[144:147], a[164:167], v[56:59]
    ds_write_b128 v6, v[80:83] offset:34816
    v_mfma_f32_16x16x32_bf16 v[84:87], v[144:147], a[168:171], v[84:87]
    ds_write_b128 v7, v[108:111] offset:2048
    v_mfma_f32_16x16x32_bf16 v[112:115], v[144:147], a[172:175], v[112:115]
    s_mov_b32 s46, 0x1908800
    buffer_load_dwordx4 v[216:219], v12, s[16:19], s46 offen sc1
    v_add_f32 v16, v16, v254
    v_add_f32 v17, v17, v254
    v_mfma_f32_16x16x32_bf16 v[28:31], v[148:151], a[176:179], v[28:31]
    v_add_f32 v18, v18, v254
    v_add_f32 v19, v19, v254
    v_mfma_f32_16x16x32_bf16 v[56:59], v[148:151], a[180:183], v[56:59]
    v_cvt_pk_bf16_f32 v44, v16, v17
    v_cvt_pk_bf16_f32 v45, v18, v19
    v_mfma_f32_16x16x32_bf16 v[84:87], v[148:151], a[184:187], v[84:87]
    v_lshlrev_b32 v16, 16, v44
    v_and_b32 v17, 0xffff0000, v44
    v_mfma_f32_16x16x32_bf16 v[112:115], v[148:151], a[188:191], v[112:115]
    s_mov_b32 s46, 0x1916000
    buffer_load_dwordx4 v[220:223], v12, s[16:19], s46 offen sc1
    v_lshlrev_b32 v18, 16, v45
    v_and_b32 v19, 0xffff0000, v45
    v_mfma_f32_16x16x32_bf16 v[28:31], v[152:155], a[192:195], v[28:31]
    v_mul_f32 v16, v16, v72
    v_mul_f32 v17, v17, v73
    v_mfma_f32_16x16x32_bf16 v[56:59], v[152:155], a[196:199], v[56:59]
    v_mul_f32 v18, v18, v74
    v_mul_f32 v19, v19, v75
    v_mfma_f32_16x16x32_bf16 v[84:87], v[152:155], a[200:203], v[84:87]
    v_cvt_pk_bf16_f32 v100, v16, v17
    v_cvt_pk_bf16_f32 v101, v18, v19
    v_mfma_f32_16x16x32_bf16 v[112:115], v[152:155], a[204:207], v[112:115]
    s_mov_b32 s46, 0x1923800
    buffer_load_dwordx4 v[224:227], v12, s[16:19], s46 offen sc1
    s_waitcnt lgkmcnt(0)
    v_add_f32 v20, v20, v48
    v_add_f32 v21, v21, v49
    v_mfma_f32_16x16x32_bf16 v[28:31], v[156:159], a[208:211], v[28:31]
    v_add_f32 v22, v22, v50
    v_add_f32 v23, v23, v51
    v_mfma_f32_16x16x32_bf16 v[56:59], v[156:159], a[212:215], v[56:59]
    buffer_load_dwordx4 a[0:3], v3, s[16:19], s37 offen sc1
    v_add_f32 v20, v20, v76
    v_add_f32 v21, v21, v77
    v_mfma_f32_16x16x32_bf16 v[84:87], v[156:159], a[216:219], v[84:87]
    v_add_f32 v22, v22, v78
    v_add_f32 v23, v23, v79
    v_mfma_f32_16x16x32_bf16 v[112:115], v[156:159], a[220:223], v[112:115]
    s_mov_b32 s46, 0x1931000
    buffer_load_dwordx4 v[228:231], v12, s[16:19], s46 offen sc1
    buffer_load_dwordx4 a[4:7], v3, s[16:19], s37 offen offset:1024 sc1
    v_add_f32 v20, v20, v104
    v_add_f32 v21, v21, v105
    v_mfma_f32_16x16x32_bf16 v[28:31], v[160:163], a[224:227], v[28:31]
    v_add_f32 v22, v22, v106
    v_add_f32 v23, v23, v107
    v_mfma_f32_16x16x32_bf16 v[56:59], v[160:163], a[228:231], v[56:59]
    s_waitcnt vmcnt(12)
    v_max3_u32 v2, v168, v172, v176
    buffer_load_dwordx4 a[8:11], v3, s[16:19], s37 offen offset:2048 sc1
    v_cvt_pk_bf16_f32 v48, v20, v21
    v_cvt_pk_bf16_f32 v49, v22, v23
    v_mfma_f32_16x16x32_bf16 v[84:87], v[160:163], a[232:235], v[84:87]
    v_max3_u32 v2, v2, v180, v184
    v_lshlrev_b32 v76, 16, v242
    v_and_b32 v77, 0xffff0000, v242
    v_mfma_f32_16x16x32_bf16 v[112:115], v[160:163], a[236:239], v[112:115]
    s_mov_b32 s46, 0x193e800
    buffer_load_dwordx4 v[232:235], v12, s[16:19], s46 offen sc1
    v_max_u32 v2, v2, v188
    buffer_load_dwordx4 a[12:15], v3, s[16:19], s37 offen offset:3072 sc1
    v_lshlrev_b32 v78, 16, v243
    v_and_b32 v79, 0xffff0000, v243
    v_mfma_f32_16x16x32_bf16 v[56:59], v[164:167], a[244:247], v[56:59]
    v_cmp_eq_u32 vcc, -1, v2
    v_lshlrev_b32 v20, 16, v48
    v_and_b32 v21, 0xffff0000, v48
    v_mfma_f32_16x16x32_bf16 v[84:87], v[164:167], a[248:251], v[84:87]
    s_add_u32 s40, s37, 0x1000
    buffer_load_dwordx4 a[16:19], v3, s[16:19], s40 offen sc1
    v_lshlrev_b32 v22, 16, v49
    v_and_b32 v23, 0xffff0000, v49
    v_mfma_f32_16x16x32_bf16 v[112:115], v[164:167], a[252:255], v[112:115]
    s_cbranch_vccnz pk_c96_s
pk_c96_r:
    v_add_f32 v20, v20, v254
    v_add_f32 v21, v21, v254
    v_mfma_f32_16x16x32_bf16 v[28:31], v[164:167], a[240:243], v[28:31]
    s_mov_b32 s46, 0x194c000
    buffer_load_dwordx4 v[236:239], v12, s[16:19], s46 offen sc1
    s_add_u32 s40, s37, 0x3000
    buffer_load_dwordx4 a[60:63], v3, s[16:19], s40 offen offset:3072 sc1
    v_add_f32 v22, v22, v254
    v_add_f32 v23, v23, v254
    v_mfma_f32_16x16x32_bf16 v[32:35], v[168:171], a[160:163], v[32:35]
    ds_write_b128 v6, v[56:59] offset:3072
    v_mfma_f32_16x16x32_bf16 v[60:63], v[168:171], a[164:167], v[60:63]
    s_add_u32 s40, s37, 0x4000
    buffer_load_dwordx4 a[64:67], v3, s[16:19], s40 offen sc1
    ds_write_b128 v6, v[84:87] offset:35840
    v_mfma_f32_16x16x32_bf16 v[88:91], v[168:171], a[168:171], v[88:91]
    ds_write_b128 v7, v[112:115] offset:3072
    v_mfma_f32_16x16x32_bf16 v[116:119], v[168:171], a[172:175], v[116:119]
    buffer_load_dwordx4 a[68:71], v3, s[16:19], s40 offen offset:1024 sc1
    v_cvt_pk_bf16_f32 v48, v20, v21
    v_cvt_pk_bf16_f32 v49, v22, v23
    v_mfma_f32_16x16x32_bf16 v[32:35], v[172:175], a[176:179], v[32:35]
    v_lshlrev_b32 v20, 16, v48
    v_and_b32 v21, 0xffff0000, v48
    v_mfma_f32_16x16x32_bf16 v[60:63], v[172:175], a[180:183], v[60:63]
    buffer_load_dwordx4 a[72:75], v3, s[16:19], s40 offen offset:2048 sc1
    s_waitcnt lgkmcnt(0)
    s_barrier
    v_mfma_f32_16x16x32_bf16 v[88:91], v[172:175], a[184:187], v[88:91]
    ds_read_b128 v[52:55], v8 offset:2048
    ds_read_b128 v[80:83], v9 offset:2048
    v_mfma_f32_16x16x32_bf16 v[116:119], v[172:175], a[188:191], v[116:119]
    buffer_load_dwordx4 a[76:79], v3, s[16:19], s40 offen offset:3072 sc1
    ds_read_b128 v[108:111], v5 offset:2048
    ds_read_b128 v[56:59], v8 offset:3072
    v_mfma_f32_16x16x32_bf16 v[32:35], v[176:179], a[192:195], v[32:35]
    ds_read_b128 v[84:87], v9 offset:3072
    ds_read_b128 v[112:115], v5 offset:3072
    v_mfma_f32_16x16x32_bf16 v[60:63], v[176:179], a[196:199], v[60:63]
    s_add_u32 s40, s37, 0x1000
    buffer_load_dwordx4 a[20:23], v3, s[16:19], s40 offen offset:1024 sc1
    v_lshlrev_b32 v22, 16, v49
    v_and_b32 v23, 0xffff0000, v49
    v_mfma_f32_16x16x32_bf16 v[88:91], v[176:179], a[200:203], v[88:91]
    v_mul_f32 v20, v20, v76
    v_mul_f32 v21, v21, v77
    v_mfma_f32_16x16x32_bf16 v[116:119], v[176:179], a[204:207], v[116:119]
    buffer_load_dwordx4 a[24:27], v3, s[16:19], s40 offen offset:2048 sc1
    v_mul_f32 v22, v22, v78
    v_mul_f32 v23, v23, v79
    v_mfma_f32_16x16x32_bf16 v[32:35], v[180:183], a[208:211], v[32:35]
    v_cvt_pk_bf16_f32 v102, v20, v21
    v_cvt_pk_bf16_f32 v103, v22, v23
    v_mfma_f32_16x16x32_bf16 v[60:63], v[180:183], a[212:215], v[60:63]
    buffer_load_dwordx4 a[28:31], v3, s[16:19], s40 offen offset:3072 sc1
    s_cmp_lg_u32 s1, 0
    s_cbranch_scc0 pk_w97_s
    buffer_store_dwordx4 v[100:103], v3, s[16:19], s44 offen offset:0
pk_w97_r:
    s_waitcnt lgkmcnt(3)
    v_add_f32 v24, v24, v52
    v_mfma_f32_16x16x32_bf16 v[88:91], v[180:183], a[216:219], v[88:91]
    v_add_f32 v25, v25, v53
    v_add_f32 v26, v26, v54
    v_mfma_f32_16x16x32_bf16 v[116:119], v[180:183], a[220:223], v[116:119]
    s_add_u32 s40, s37, 0x2000
    buffer_load_dwordx4 a[32:35], v3, s[16:19], s40 offen sc1
    v_add_f32 v27, v27, v55
    v_add_f32 v24, v24, v80
    v_mfma_f32_16x16x32_bf16 v[32:35], v[184:187], a[224:227], v[32:35]
    v_add_f32 v25, v25, v81
    v_add_f32 v26, v26, v82
    v_mfma_f32_16x16x32_bf16 v[60:63], v[184:187], a[228:231], v[60:63]
    s_waitcnt vmcnt(21)
    v_max3_u32 v2, v192, v196, v200
    buffer_load_dwordx4 a[36:39], v3, s[16:19], s40 offen offset:1024 sc1
    v_add_f32 v27, v27, v83
    v_add_f32 v24, v24, v108
    v_mfma_f32_16x16x32_bf16 v[88:91], v[184:187], a[232:235], v[88:91]
    v_max3_u32 v2, v2, v204, v208
    v_add_f32 v25, v25, v109
    v_add_f32 v26, v26, v110
    v_mfma_f32_16x16x32_bf16 v[116:119], v[184:187], a[236:239], v[116:119]
    v_max_u32 v2, v2, v212
    s_add_u32 s40, s37, 0x5000
    buffer_load_dwordx4 a[80:83], v3, s[16:19], s40 offen sc1
    v_add_f32 v27, v27, v111
    v_cvt_pk_bf16_f32 v52, v24, v25
    v_mfma_f32_16x16x32_bf16 v[60:63], v[188:191], a[244:247], v[60:63]
    v_cmp_eq_u32 vcc, -1, v2
    v_cvt_pk_bf16_f32 v53, v26, v27
    v_lshlrev_b32 v80, 16, v244
    v_mfma_f32_16x16x32_bf16 v[88:91], v[188:191], a[248:251], v[88:91]
    buffer_load_dwordx4 a[84:87], v3, s[16:19], s40 offen offset:1024 sc1
    v_and_b32 v81, 0xffff0000, v244
    v_lshlrev_b32 v82, 16, v245
    v_mfma_f32_16x16x32_bf16 v[116:119], v[188:191], a[252:255], v[116:119]
    s_cbranch_vccnz pk_c98_s
pk_c98_r:
    v_and_b32 v83, 0xffff0000, v245
    v_lshlrev_b32 v24, 16, v52
    v_mfma_f32_16x16x32_bf16 v[32:35], v[188:191], a[240:243], v[32:35]
    buffer_load_dwordx4 a[88:91], v3, s[16:19], s40 offen offset:2048 sc1
    v_and_b32 v25, 0xffff0000, v52
    v_lshlrev_b32 v26, 16, v53
    v_mfma_f32_16x16x32_bf16 v[36:39], v[192:195], a[160:163], v[36:39]
    ds_write_b128 v6, v[60:63] offset:4096
    v_mfma_f32_16x16x32_bf16 v[64:67], v[192:195], a[164:167], v[64:67]
    buffer_load_dwordx4 a[92:95], v3, s[16:19], s40 offen offset:3072 sc1
    ds_write_b128 v6, v[88:91] offset:36864
    v_mfma_f32_16x16x32_bf16 v[92:95], v[192:195], a[168:171], v[92:95]
    ds_write_b128 v7, v[116:119] offset:4096
    v_mfma_f32_16x16x32_bf16 v[120:123], v[192:195], a[172:175], v[120:123]
    s_add_u32 s40, s37, 0x6000
    buffer_load_dwordx4 a[96:99], v3, s[16:19], s40 offen sc1
    v_and_b32 v27, 0xffff0000, v53
    v_add_f32 v24, v24, v254
    v_mfma_f32_16x16x32_bf16 v[36:39], v[196:199], a[176:179], v[36:39]
    v_add_f32 v25, v25, v254
    v_add_f32 v26, v26, v254
    v_mfma_f32_16x16x32_bf16 v[64:67], v[196:199], a[180:183], v[64:67]
    s_add_u32 s40, s37, 0x2000
    buffer_load_dwordx4 a[40:43], v3, s[16:19], s40 offen offset:2048 sc1
    v_add_f32 v27, v27, v254
    v_cvt_pk_bf16_f32 v52, v24, v25
    v_mfma_f32_16x16x32_bf16 v[92:95], v[196:199], a[184:187], v[92:95]
    v_cvt_pk_bf16_f32 v53, v26, v27
    v_lshlrev_b32 v24, 16, v52
    v_mfma_f32_16x16x32_bf16 v[120:123], v[196:199], a[188:191], v[120:123]
    buffer_load_dwordx4 a[44:47], v3, s[16:19], s40 offen offset:3072 sc1
    v_and_b32 v25, 0xffff0000, v52
    v_lshlrev_b32 v26, 16, v53
    v_mfma_f32_16x16x32_bf16 v[36:39], v[200:203], a[192:195], v[36:39]
    v_and_b32 v27, 0xffff0000, v53
    v_mul_f32 v24, v24, v80
    v_mfma_f32_16x16x32_bf16 v[64:67], v[200:203], a[196:199], v[64:67]
    s_add_u32 s40, s37, 0x3000
    buffer_load_dwordx4 a[48:51], v3, s[16:19], s40 offen sc1
    v_mul_f32 v25, v25, v81
    v_mul_f32 v26, v26, v82
    v_mfma_f32_16x16x32_bf16 v[92:95], v[200:203], a[200:203], v[92:95]
    v_mul_f32 v27, v27, v83
    v_cvt_pk_bf16_f32 v108, v24, v25
    v_mfma_f32_16x16x32_bf16 v[120:123], v[200:203], a[204:207], v[120:123]
    buffer_load_dwordx4 a[52:55], v3, s[16:19], s40 offen offset:1024 sc1
    v_cvt_pk_bf16_f32 v109, v26, v27
    s_waitcnt lgkmcnt(3)
    v_add_f32 v28, v28, v56
    v_mfma_f32_16x16x32_bf16 v[36:39], v[204:207], a[208:211], v[36:39]
    v_add_f32 v29, v29, v57
    v_add_f32 v30, v30, v58
    v_mfma_f32_16x16x32_bf16 v[64:67], v[204:207], a[212:215], v[64:67]
    buffer_load_dwordx4 a[56:59], v3, s[16:19], s40 offen offset:2048 sc1
    v_add_f32 v31, v31, v59
    v_add_f32 v28, v28, v84
    v_mfma_f32_16x16x32_bf16 v[92:95], v[204:207], a[216:219], v[92:95]
    v_add_f32 v29, v29, v85
    v_add_f32 v30, v30, v86
    v_mfma_f32_16x16x32_bf16 v[120:123], v[204:207], a[220:223], v[120:123]
    s_add_u32 s40, s37, 0x6000
    buffer_load_dwordx4 a[100:103], v3, s[16:19], s40 offen offset:1024 sc1
    v_add_f32 v31, v31, v87
    v_add_f32 v28, v28, v112
    v_mfma_f32_16x16x32_bf16 v[36:39], v[208:211], a[224:227], v[36:39]
    v_add_f32 v29, v29, v113
    v_add_f32 v30, v30, v114
    v_mfma_f32_16x16x32_bf16 v[64:67], v[208:211], a[228:231], v[64:67]
    s_waitcnt vmcnt(22)
    v_max3_u32 v2, v216, v220, v224
    buffer_load_dwordx4 a[104:107], v3, s[16:19], s40 offen offset:2048 sc1
    v_add_f32 v31, v31, v115
    v_cvt_pk_bf16_f32 v56, v28, v29
    v_mfma_f32_16x16x32_bf16 v[92:95], v[208:211], a[232:235], v[92:95]
    v_max3_u32 v2, v2, v228, v232
    v_cvt_pk_bf16_f32 v57, v30, v31
    v_lshlrev_b32 v84, 16, v246
    v_mfma_f32_16x16x32_bf16 v[120:123], v[208:211], a[236:239], v[120:123]
    v_max_u32 v2, v2, v236
    buffer_load_dwordx4 a[108:111], v3, s[16:19], s40 offen offset:3072 sc1
    v_and_b32 v85, 0xffff0000, v246
    v_lshlrev_b32 v86, 16, v247
    v_mfma_f32_16x16x32_bf16 v[64:67], v[212:215], a[244:247], v[64:67]
    v_cmp_eq_u32 vcc, -1, v2
    v_and_b32 v87, 0xffff0000, v247
    v_lshlrev_b32 v28, 16, v56
    v_mfma_f32_16x16x32_bf16 v[92:95], v[212:215], a[248:251], v[92:95]
    s_add_u32 s40, s37, 0x7000
    buffer_load_dwordx4 a[112:115], v3, s[16:19], s40 offen sc1
    v_and_b32 v29, 0xffff0000, v56
    v_lshlrev_b32 v30, 16, v57
    v_mfma_f32_16x16x32_bf16 v[120:123], v[212:215], a[252:255], v[120:123]
    s_cbranch_vccnz pk_c99_s
pk_c99_r:
    v_and_b32 v31, 0xffff0000, v57
    v_add_f32 v28, v28, v254
    v_mfma_f32_16x16x32_bf16 v[36:39], v[212:215], a[240:243], v[36:39]
    buffer_load_dwordx4 a[116:119], v3, s[16:19], s40 offen offset:1024 sc1
    v_add_f32 v29, v29, v254
    v_add_f32 v30, v30, v254
    v_mfma_f32_16x16x32_bf16 v[40:43], v[216:219], a[160:163], v[40:43]
    ds_write_b128 v6, v[64:67] offset:5120
    v_mfma_f32_16x16x32_bf16 v[68:71], v[216:219], a[164:167], v[68:71]
    ds_write_b128 v6, v[92:95] offset:37888
    v_mfma_f32_16x16x32_bf16 v[96:99], v[216:219], a[168:171], v[96:99]
    ds_write_b128 v7, v[120:123] offset:5120
    v_mfma_f32_16x16x32_bf16 v[124:127], v[216:219], a[172:175], v[124:127]
    v_add_f32 v31, v31, v254
    v_cvt_pk_bf16_f32 v56, v28, v29
    v_mfma_f32_16x16x32_bf16 v[40:43], v[220:223], a[176:179], v[40:43]
    v_cvt_pk_bf16_f32 v57, v30, v31
    v_lshlrev_b32 v28, 16, v56
    v_mfma_f32_16x16x32_bf16 v[68:71], v[220:223], a[180:183], v[68:71]
    s_waitcnt lgkmcnt(0)
    s_barrier
    v_mfma_f32_16x16x32_bf16 v[96:99], v[220:223], a[184:187], v[96:99]
    ds_read_b128 v[60:63], v8 offset:4096
    ds_read_b128 v[88:91], v9 offset:4096
    v_mfma_f32_16x16x32_bf16 v[124:127], v[220:223], a[188:191], v[124:127]
    ds_read_b128 v[116:119], v5 offset:4096
    ds_read_b128 v[64:67], v8 offset:5120
    v_mfma_f32_16x16x32_bf16 v[40:43], v[224:227], a[192:195], v[40:43]
    ds_read_b128 v[92:95], v9 offset:5120
    ds_read_b128 v[120:123], v5 offset:5120
    v_mfma_f32_16x16x32_bf16 v[68:71], v[224:227], a[196:199], v[68:71]
    v_and_b32 v29, 0xffff0000, v56
    v_lshlrev_b32 v30, 16, v57
    v_mfma_f32_16x16x32_bf16 v[96:99], v[224:227], a[200:203], v[96:99]
    v_and_b32 v31, 0xffff0000, v57
    v_mul_f32 v28, v28, v84
    v_mfma_f32_16x16x32_bf16 v[124:127], v[224:227], a[204:207], v[124:127]
    v_mul_f32 v29, v29, v85
    v_mul_f32 v30, v30, v86
    v_mfma_f32_16x16x32_bf16 v[40:43], v[228:231], a[208:211], v[40:43]
    v_mul_f32 v31, v31, v87
    v_cvt_pk_bf16_f32 v110, v28, v29
    v_mfma_f32_16x16x32_bf16 v[68:71], v[228:231], a[212:215], v[68:71]
    v_cvt_pk_bf16_f32 v111, v30, v31
    s_cmp_lg_u32 s1, 0
    s_cbranch_scc0 pk_w100_s
    buffer_store_dwordx4 v[108:111], v3, s[16:19], s44 offen offset:1024
pk_w100_r:
    v_mfma_f32_16x16x32_bf16 v[96:99], v[228:231], a[216:219], v[96:99]
    v_mul_u32_u24 v15, 1280, v15
    v_lshl_add_u32 v114, v4, 3, v15
    v_mfma_f32_16x16x32_bf16 v[124:127], v[228:231], a[220:223], v[124:127]
    v_lshl_add_u32 v15, v4, 4, v15
    s_mul_i32 s43, s34, 160
    v_mfma_f32_16x16x32_bf16 v[40:43], v[232:235], a[224:227], v[40:43]
    s_add_u32 s36, s43, 0xa00000
    buffer_load_dwordx4 v[100:103], v15, s[16:19], s36 offen sc1
    v_mfma_f32_16x16x32_bf16 v[68:71], v[232:235], a[228:231], v[68:71]
    buffer_load_dwordx4 v[104:107], v15, s[16:19], s36 offen offset:64 sc1
    buffer_load_dwordx2 v[108:109], v114, s[16:19], s36 offen offset:128 sc1
    v_mfma_f32_16x16x32_bf16 v[96:99], v[232:235], a[232:235], v[96:99]
    s_mul_i32 s35, s33, 110592
    s_mul_i32 s36, s32, 6144
    v_mfma_f32_16x16x32_bf16 v[124:127], v[232:235], a[236:239], v[124:127]
    s_add_u32 s35, s35, s36
    s_add_u32 s35, s35, 0x1c30000
    v_mfma_f32_16x16x32_bf16 v[68:71], v[236:239], a[244:247], v[68:71]
    s_xor_b32 s36, s32, 0
    s_mul_i32 s36, s36, 27648
    v_mfma_f32_16x16x32_bf16 v[96:99], v[236:239], a[248:251], v[96:99]
    s_add_u32 s88, s35, s36
    s_xor_b32 s36, s32, 1
    v_mfma_f32_16x16x32_bf16 v[124:127], v[236:239], a[252:255], v[124:127]
    s_mul_i32 s36, s36, 27648
    s_add_u32 s89, s35, s36
    v_mfma_f32_16x16x32_bf16 v[40:43], v[236:239], a[240:243], v[40:43]
    s_xor_b32 s36, s32, 2
    s_mul_i32 s36, s36, 27648
    s_add_u32 s90, s35, s36
    s_xor_b32 s36, s32, 3
    s_mul_i32 s36, s36, 27648
    s_add_u32 s91, s35, s36
    ds_write_b128 v6, v[68:71] offset:6144
    ds_write_b128 v6, v[96:99] offset:38912
    ds_write_b128 v7, v[124:127] offset:6144
    s_add_u32 s36, s32, 1
    s_lshr_b32 s36, s36, 2
    s_mul_i32 s36, s36, 0x7f000000
    v_add_u32 v14, s36, v13
    s_mul_i32 s36, s32, -5120
    s_add_u32 s36, s36, 18432
    v_add_u32 v14, s36, v14
    s_mov_b64 s[4:5], s[64:65]
    s_mov_b32 s6, 0x280000
    s_mov_b32 s7, 0x20000
    s_mul_i32 s36, s32, 5120
    s_add_u32 s36, s36, 98304
    s_waitcnt lgkmcnt(0)
    s_barrier
    ds_read_b128 v[68:71], v8 offset:6144
    ds_read_b128 v[96:99], v9 offset:6144
    ds_read_b128 v[124:127], v5 offset:6144
    v_add_u32 v113, s36, v3
    s_xor_b32 s36, s32, 1
    s_mul_i32 s36, s36, 5120
    s_add_u32 s36, s36, 98304
    v_add_u32 v110, s36, v3
    s_xor_b32 s36, s32, 2
    s_mul_i32 s36, s36, 5120
    s_add_u32 s36, s36, 118784
    v_add_u32 v111, s36, v3
    s_xor_b32 s36, s32, 3
    s_mul_i32 s36, s36, 5120
    s_add_u32 s36, s36, 139264
    v_add_u32 v112, s36, v3
    v_pk_add_f32 v[32:33], v[32:33], v[60:61]
    v_pk_add_f32 v[34:35], v[34:35], v[62:63]
    v_pk_add_f32 v[32:33], v[32:33], v[88:89]
    v_pk_add_f32 v[34:35], v[34:35], v[90:91]
    v_pk_add_f32 v[32:33], v[32:33], v[116:117]
    v_pk_add_f32 v[34:35], v[34:35], v[118:119]
    v_cvt_pk_bf16_f32 v60, v32, v33
    v_cvt_pk_bf16_f32 v61, v34, v35
    v_lshlrev_b32 v88, 16, v248
    v_and_b32 v89, 0xffff0000, v248
    v_lshlrev_b32 v90, 16, v249
    v_and_b32 v91, 0xffff0000, v249
    v_lshlrev_b32 v32, 16, v60
    v_and_b32 v33, 0xffff0000, v60
    v_lshlrev_b32 v34, 16, v61
    v_and_b32 v35, 0xffff0000, v61
    v_pk_add_f32 v[32:33], v[32:33], v[254:255] op_sel_hi:[1,0]
    v_pk_add_f32 v[34:35], v[34:35], v[254:255] op_sel_hi:[1,0]
    v_cvt_pk_bf16_f32 v60, v32, v33
    v_cvt_pk_bf16_f32 v61, v34, v35
    v_lshlrev_b32 v32, 16, v60
    v_and_b32 v33, 0xffff0000, v60
    v_lshlrev_b32 v34, 16, v61
    v_and_b32 v35, 0xffff0000, v61
    v_pk_mul_f32 v[32:33], v[32:33], v[88:89]
    v_pk_mul_f32 v[34:35], v[34:35], v[90:91]
    v_cvt_pk_bf16_f32 v116, v32, v33
    v_cvt_pk_bf16_f32 v117, v34, v35
    v_pk_add_f32 v[36:37], v[36:37], v[64:65]
    v_pk_add_f32 v[38:39], v[38:39], v[66:67]
    v_pk_add_f32 v[36:37], v[36:37], v[92:93]
    v_pk_add_f32 v[38:39], v[38:39], v[94:95]
    v_pk_add_f32 v[36:37], v[36:37], v[120:121]
    v_pk_add_f32 v[38:39], v[38:39], v[122:123]
    v_cvt_pk_bf16_f32 v64, v36, v37
    v_cvt_pk_bf16_f32 v65, v38, v39
    v_lshlrev_b32 v92, 16, v250
    v_and_b32 v93, 0xffff0000, v250
    v_lshlrev_b32 v94, 16, v251
    v_and_b32 v95, 0xffff0000, v251
    v_lshlrev_b32 v36, 16, v64
    v_and_b32 v37, 0xffff0000, v64
    v_lshlrev_b32 v38, 16, v65
    v_and_b32 v39, 0xffff0000, v65
    v_pk_add_f32 v[36:37], v[36:37], v[254:255] op_sel_hi:[1,0]
    v_pk_add_f32 v[38:39], v[38:39], v[254:255] op_sel_hi:[1,0]
    v_cvt_pk_bf16_f32 v64, v36, v37
    v_cvt_pk_bf16_f32 v65, v38, v39
    v_lshlrev_b32 v36, 16, v64
    v_and_b32 v37, 0xffff0000, v64
    v_lshlrev_b32 v38, 16, v65
    v_and_b32 v39, 0xffff0000, v65
    v_pk_mul_f32 v[36:37], v[36:37], v[92:93]
    v_pk_mul_f32 v[38:39], v[38:39], v[94:95]
    v_cvt_pk_bf16_f32 v118, v36, v37
    v_cvt_pk_bf16_f32 v119, v38, v39
    s_cmp_lg_u32 s1, 0
    s_cbranch_scc0 pk_w101_s
    buffer_store_dwordx4 v[116:119], v3, s[16:19], s44 offen offset:2048
pk_w101_r:
    s_waitcnt lgkmcnt(0)
    v_pk_add_f32 v[40:41], v[40:41], v[68:69]
    v_pk_add_f32 v[42:43], v[42:43], v[70:71]
    v_pk_add_f32 v[40:41], v[40:41], v[96:97]
    v_pk_add_f32 v[42:43], v[42:43], v[98:99]
    v_pk_add_f32 v[40:41], v[40:41], v[124:125]
    v_pk_add_f32 v[42:43], v[42:43], v[126:127]
    v_cvt_pk_bf16_f32 v68, v40, v41
    v_cvt_pk_bf16_f32 v69, v42, v43
    v_lshlrev_b32 v96, 16, v252
    v_and_b32 v97, 0xffff0000, v252
    v_lshlrev_b32 v98, 16, v253
    v_and_b32 v99, 0xffff0000, v253
    v_lshlrev_b32 v40, 16, v68
    v_and_b32 v41, 0xffff0000, v68
    v_lshlrev_b32 v42, 16, v69
    v_and_b32 v43, 0xffff0000, v69
    v_pk_add_f32 v[40:41], v[40:41], v[254:255] op_sel_hi:[1,0]
    v_pk_add_f32 v[42:43], v[42:43], v[254:255] op_sel_hi:[1,0]
    v_cvt_pk_bf16_f32 v68, v40, v41
    v_cvt_pk_bf16_f32 v69, v42, v43
    v_lshlrev_b32 v40, 16, v68
    v_and_b32 v41, 0xffff0000, v68
    v_lshlrev_b32 v42, 16, v69
    v_and_b32 v43, 0xffff0000, v69
    v_pk_mul_f32 v[40:41], v[40:41], v[96:97]
    v_pk_mul_f32 v[42:43], v[42:43], v[98:99]
    v_cvt_pk_bf16_f32 v124, v40, v41
    v_cvt_pk_bf16_f32 v125, v42, v43
    v_add_u32 v12, s42, v3
    s_cmp_lg_u32 s1, 0
    s_cbranch_scc0 pk_w102_s
    buffer_store_dwordx2 v[124:125], v12, s[16:19], s45 offen
pk_w102_r:
    buffer_load_dwordx4 v[128:131], v3, s[16:19], s89 offen offset:0 sc1
    buffer_load_dwordx4 v[132:135], v3, s[16:19], s89 offen offset:3072 sc1
    buffer_load_dwordx4 v[136:139], v3, s[16:19], s90 offen offset:0 sc1
    buffer_load_dwordx4 v[140:143], v3, s[16:19], s90 offen offset:3072 sc1
    buffer_load_dwordx4 v[144:147], v3, s[16:19], s91 offen offset:0 sc1
    buffer_load_dwordx4 v[148:151], v3, s[16:19], s91 offen offset:3072 sc1
    buffer_load_dwordx4 v[152:155], v3, s[16:19], s89 offen offset:1024 sc1
    buffer_load_dwordx4 v[156:159], v13, s[16:19], s89 offen offset:0 sc1
    buffer_load_dwordx4 v[160:163], v3, s[16:19], s90 offen offset:1024 sc1
    buffer_load_dwordx4 v[164:167], v13, s[16:19], s90 offen offset:0 sc1
    s_waitcnt vmcnt(16)
    s_waitcnt vmcnt(6)
    v_max3_u32 v2, v128, v132, v136
    v_max_u32 v2, v2, v140
    v_cmp_eq_u32 vcc, -1, v2
    s_cbranch_vccnz pk_c103_s
pk_c103_r:
    v_mfma_f32_16x16x32_bf16 v[36:39], a[0:3], v[128:131], 0
    buffer_load_dwordx4 v[168:171], v3, s[16:19], s91 offen offset:1024 sc1
    v_mfma_f32_16x16x32_bf16 v[40:43], a[4:7], v[128:131], 0
    buffer_load_dwordx4 a[120:123], v10, s[16:19], s40 offen offset:2048 sc1
    v_mfma_f32_16x16x32_bf16 v[44:47], a[8:11], v[128:131], 0
    v_mfma_f32_16x16x32_bf16 v[48:51], a[12:15], v[128:131], 0
    buffer_load_dwordx4 v[172:175], v13, s[16:19], s91 offen offset:0 sc1
    v_mfma_f32_16x16x32_bf16 v[52:55], a[16:19], v[128:131], 0
    buffer_load_dwordx4 a[124:127], v10, s[16:19], s40 offen offset:3072 sc1
    v_mfma_f32_16x16x32_bf16 v[36:39], a[60:63], v[132:135], v[36:39]
    v_mfma_f32_16x16x32_bf16 v[40:43], a[64:67], v[132:135], v[40:43]
    buffer_load_dwordx4 v[176:179], v3, s[16:19], s89 offen offset:2048 sc1
    v_mfma_f32_16x16x32_bf16 v[44:47], a[68:71], v[132:135], v[44:47]
    s_add_u32 s40, s37, 0x8000
    buffer_load_dwordx4 a[128:131], v10, s[16:19], s40 offen sc1
    v_mfma_f32_16x16x32_bf16 v[48:51], a[72:75], v[132:135], v[48:51]
    v_mfma_f32_16x16x32_bf16 v[52:55], a[76:79], v[132:135], v[52:55]
    buffer_load_dwordx4 v[180:183], v13, s[16:19], s89 offen offset:1024 sc1
    v_mfma_f32_16x16x32_bf16 v[56:59], a[0:3], v[136:139], 0
    buffer_load_dwordx4 a[132:135], v10, s[16:19], s40 offen offset:1024 sc1
    v_mfma_f32_16x16x32_bf16 v[60:63], a[4:7], v[136:139], 0
    v_mfma_f32_16x16x32_bf16 v[64:67], a[8:11], v[136:139], 0
    buffer_load_dwordx4 v[184:187], v14, s[16:19], s89 offen offset:2048 sc1
    s_waitcnt vmcnt(13)
    v_max_u32 v2, v144, v148
    v_mfma_f32_16x16x32_bf16 v[68:71], a[12:15], v[136:139], 0
    buffer_load_dwordx4 a[136:139], v10, s[16:19], s40 offen offset:2048 sc1
    v_cmp_eq_u32 vcc, -1, v2
    v_mfma_f32_16x16x32_bf16 v[72:75], a[16:19], v[136:139], 0
    v_mfma_f32_16x16x32_bf16 v[56:59], a[60:63], v[140:143], v[56:59]
    buffer_load_dwordx4 v[188:191], v3, s[16:19], s90 offen offset:2048 sc1
    s_cbranch_vccnz pk_c104_s
pk_c104_r:
    v_mfma_f32_16x16x32_bf16 v[60:63], a[64:67], v[140:143], v[60:63]
    v_mfma_f32_16x16x32_bf16 v[64:67], a[68:71], v[140:143], v[64:67]
    v_mfma_f32_16x16x32_bf16 v[68:71], a[72:75], v[140:143], v[68:71]
    buffer_load_dwordx4 v[192:195], v13, s[16:19], s90 offen offset:1024 sc1
    v_mfma_f32_16x16x32_bf16 v[72:75], a[76:79], v[140:143], v[72:75]
    v_mfma_f32_16x16x32_bf16 v[76:79], a[0:3], v[144:147], 0
    v_mfma_f32_16x16x32_bf16 v[80:83], a[4:7], v[144:147], 0
    buffer_load_dwordx4 v[196:199], v14, s[16:19], s90 offen offset:2048 sc1
    v_mfma_f32_16x16x32_bf16 v[84:87], a[8:11], v[144:147], 0
    s_waitcnt vmcnt(15)
    v_max_u32 v2, v152, v156
    v_mfma_f32_16x16x32_bf16 v[88:91], a[12:15], v[144:147], 0
    v_cmp_eq_u32 vcc, -1, v2
    v_mfma_f32_16x16x32_bf16 v[92:95], a[16:19], v[144:147], 0
    buffer_load_dwordx4 v[200:203], v3, s[16:19], s91 offen offset:2048 sc1
    v_mfma_f32_16x16x32_bf16 v[76:79], a[60:63], v[148:151], v[76:79]
    s_cbranch_vccnz pk_c105_s
pk_c105_r:
    v_mfma_f32_16x16x32_bf16 v[80:83], a[64:67], v[148:151], v[80:83]
    v_mfma_f32_16x16x32_bf16 v[84:87], a[68:71], v[148:151], v[84:87]
    buffer_load_dwordx4 v[204:207], v13, s[16:19], s91 offen offset:1024 sc1
    v_mfma_f32_16x16x32_bf16 v[88:91], a[72:75], v[148:151], v[88:91]
    v_mfma_f32_16x16x32_bf16 v[92:95], a[76:79], v[148:151], v[92:95]
    v_mfma_f32_16x16x32_bf16 v[36:39], a[20:23], v[152:155], v[36:39]
    buffer_load_dwordx4 v[208:211], v14, s[16:19], s91 offen offset:2048 sc1
    v_mfma_f32_16x16x32_bf16 v[40:43], a[24:27], v[152:155], v[40:43]
    v_mfma_f32_16x16x32_bf16 v[44:47], a[28:31], v[152:155], v[44:47]
    s_waitcnt vmcnt(13)
    v_max3_u32 v2, v160, v164, v168
    v_mfma_f32_16x16x32_bf16 v[48:51], a[32:35], v[152:155], v[48:51]
    buffer_load_dwordx4 v[212:215], v3, s[16:19], s88 offen offset:0 sc1
    v_max_u32 v2, v2, v172
    v_mfma_f32_16x16x32_bf16 v[52:55], a[36:39], v[152:155], v[52:55]
    v_cmp_eq_u32 vcc, -1, v2
    v_mfma_f32_16x16x32_bf16 v[36:39], a[80:83], v[156:159], v[36:39]
    v_mfma_f32_16x16x32_bf16 v[40:43], a[84:87], v[156:159], v[40:43]
    buffer_load_dwordx4 v[216:219], v3, s[16:19], s88 offen offset:3072 sc1
    s_cbranch_vccnz pk_c106_s
pk_c106_r:
    v_mfma_f32_16x16x32_bf16 v[44:47], a[88:91], v[156:159], v[44:47]
    v_mfma_f32_16x16x32_bf16 v[48:51], a[92:95], v[156:159], v[48:51]
    v_mfma_f32_16x16x32_bf16 v[52:55], a[96:99], v[156:159], v[52:55]
    buffer_load_dwordx4 v[220:223], v3, s[16:19], s88 offen offset:1024 sc1
    v_mfma_f32_16x16x32_bf16 v[56:59], a[20:23], v[160:163], v[56:59]
    v_mfma_f32_16x16x32_bf16 v[60:63], a[24:27], v[160:163], v[60:63]
    v_mfma_f32_16x16x32_bf16 v[64:67], a[28:31], v[160:163], v[64:67]
    buffer_load_dwordx4 v[224:227], v13, s[16:19], s88 offen offset:0 sc1
    v_mfma_f32_16x16x32_bf16 v[68:71], a[32:35], v[160:163], v[68:71]
    v_mfma_f32_16x16x32_bf16 v[72:75], a[36:39], v[160:163], v[72:75]
    v_mfma_f32_16x16x32_bf16 v[56:59], a[80:83], v[164:167], v[56:59]
    buffer_load_dwordx4 v[228:231], v3, s[16:19], s88 offen offset:2048 sc1
    v_mfma_f32_16x16x32_bf16 v[60:63], a[84:87], v[164:167], v[60:63]
    v_mfma_f32_16x16x32_bf16 v[64:67], a[88:91], v[164:167], v[64:67]
    v_mfma_f32_16x16x32_bf16 v[68:71], a[92:95], v[164:167], v[68:71]
    buffer_load_dwordx4 v[232:235], v13, s[16:19], s88 offen offset:1024 sc1
    v_mfma_f32_16x16x32_bf16 v[72:75], a[96:99], v[164:167], v[72:75]
    v_mfma_f32_16x16x32_bf16 v[76:79], a[20:23], v[168:171], v[76:79]
    v_mfma_f32_16x16x32_bf16 v[80:83], a[24:27], v[168:171], v[80:83]
    buffer_load_dwordx4 v[236:239], v14, s[16:19], s88 offen offset:2048 sc1
    v_mfma_f32_16x16x32_bf16 v[84:87], a[28:31], v[168:171], v[84:87]
    s_waitcnt vmcnt(14)
    v_max3_u32 v2, v176, v180, v184
    v_mfma_f32_16x16x32_bf16 v[88:91], a[32:35], v[168:171], v[88:91]
    v_max_u32 v2, v2, v186
    v_mfma_f32_16x16x32_bf16 v[92:95], a[36:39], v[168:171], v[92:95]
    v_cmp_eq_u32 vcc, -1, v2
    v_mfma_f32_16x16x32_bf16 v[76:79], a[80:83], v[172:175], v[76:79]
    v_mfma_f32_16x16x32_bf16 v[80:83], a[84:87], v[172:175], v[80:83]
    s_cbranch_vccnz pk_c107_s
pk_c107_r:
    v_mfma_f32_16x16x32_bf16 v[84:87], a[88:91], v[172:175], v[84:87]
    v_mfma_f32_16x16x32_bf16 v[88:91], a[92:95], v[172:175], v[88:91]
    v_mfma_f32_16x16x32_bf16 v[92:95], a[96:99], v[172:175], v[92:95]
    v_mfma_f32_16x16x32_bf16 v[36:39], a[40:43], v[176:179], v[36:39]
    v_mfma_f32_16x16x32_bf16 v[40:43], a[44:47], v[176:179], v[40:43]
    v_mfma_f32_16x16x32_bf16 v[44:47], a[48:51], v[176:179], v[44:47]
    v_mfma_f32_16x16x32_bf16 v[48:51], a[52:55], v[176:179], v[48:51]
    v_mfma_f32_16x16x32_bf16 v[52:55], a[56:59], v[176:179], v[52:55]
    v_mfma_f32_16x16x32_bf16 v[36:39], a[100:103], v[180:183], v[36:39]
    v_mfma_f32_16x16x32_bf16 v[40:43], a[104:107], v[180:183], v[40:43]
    v_mfma_f32_16x16x32_bf16 v[44:47], a[108:111], v[180:183], v[44:47]
    s_waitcnt vmcnt(10)
    v_max3_u32 v2, v188, v192, v196
    v_mfma_f32_16x16x32_bf16 v[48:51], a[112:115], v[180:183], v[48:51]
    v_max_u32 v2, v2, v198
    v_mfma_f32_16x16x32_bf16 v[52:55], a[116:119], v[180:183], v[52:55]
    v_cmp_eq_u32 vcc, -1, v2
    v_mfma_f32_16x16x32_bf16 v[36:39], a[120:123], v[184:187], v[36:39]
    v_mfma_f32_16x16x32_bf16 v[40:43], a[124:127], v[184:187], v[40:43]
    s_cbranch_vccnz pk_c108_s
pk_c108_r:
    v_mfma_f32_16x16x32_bf16 v[44:47], a[128:131], v[184:187], v[44:47]
    v_mfma_f32_16x16x32_bf16 v[48:51], a[132:135], v[184:187], v[48:51]
    v_mfma_f32_16x16x32_bf16 v[52:55], a[136:139], v[184:187], v[52:55]
    s_nop 2
    ds_write_b128 v113, v[36:39] offset:0
    v_mfma_f32_16x16x32_bf16 v[56:59], a[40:43], v[188:191], v[56:59]
    ds_write_b128 v113, v[40:43] offset:1024
    v_mfma_f32_16x16x32_bf16 v[60:63], a[44:47], v[188:191], v[60:63]
    ds_write_b128 v113, v[44:47] offset:2048
    v_mfma_f32_16x16x32_bf16 v[64:67], a[48:51], v[188:191], v[64:67]
    ds_write_b128 v113, v[48:51] offset:3072
    v_mfma_f32_16x16x32_bf16 v[68:71], a[52:55], v[188:191], v[68:71]
    ds_write_b128 v113, v[52:55] offset:4096
    v_mfma_f32_16x16x32_bf16 v[72:75], a[56:59], v[188:191], v[72:75]
    v_mfma_f32_16x16x32_bf16 v[56:59], a[100:103], v[192:195], v[56:59]
    v_mfma_f32_16x16x32_bf16 v[60:63], a[104:107], v[192:195], v[60:63]
    v_mfma_f32_16x16x32_bf16 v[64:67], a[108:111], v[192:195], v[64:67]
    s_waitcnt vmcnt(7)
    v_max3_u32 v2, v200, v204, v208
    v_mfma_f32_16x16x32_bf16 v[68:71], a[112:115], v[192:195], v[68:71]
    v_max_u32 v2, v2, v210
    v_mfma_f32_16x16x32_bf16 v[72:75], a[116:119], v[192:195], v[72:75]
    v_cmp_eq_u32 vcc, -1, v2
    v_mfma_f32_16x16x32_bf16 v[56:59], a[120:123], v[196:199], v[56:59]
    v_mfma_f32_16x16x32_bf16 v[60:63], a[124:127], v[196:199], v[60:63]
    s_cbranch_vccnz pk_c109_s
pk_c109_r:
    v_mfma_f32_16x16x32_bf16 v[64:67], a[128:131], v[196:199], v[64:67]
    v_mfma_f32_16x16x32_bf16 v[68:71], a[132:135], v[196:199], v[68:71]
    v_mfma_f32_16x16x32_bf16 v[72:75], a[136:139], v[196:199], v[72:75]
    s_nop 2
    ds_write_b128 v113, v[56:59] offset:20480
    v_mfma_f32_16x16x32_bf16 v[76:79], a[40:43], v[200:203], v[76:79]
    ds_write_b128 v113, v[60:63] offset:21504
    v_mfma_f32_16x16x32_bf16 v[80:83], a[44:47], v[200:203], v[80:83]
    ds_write_b128 v113, v[64:67] offset:22528
    v_mfma_f32_16x16x32_bf16 v[84:87], a[48:51], v[200:203], v[84:87]
    ds_write_b128 v113, v[68:71] offset:23552
    v_mfma_f32_16x16x32_bf16 v[88:91], a[52:55], v[200:203], v[88:91]
    ds_write_b128 v113, v[72:75] offset:24576
    v_mfma_f32_16x16x32_bf16 v[92:95], a[56:59], v[200:203], v[92:95]
    v_mfma_f32_16x16x32_bf16 v[76:79], a[100:103], v[204:207], v[76:79]
    v_mfma_f32_16x16x32_bf16 v[80:83], a[104:107], v[204:207], v[80:83]
    v_mfma_f32_16x16x32_bf16 v[84:87], a[108:111], v[204:207], v[84:87]
    s_waitcnt vmcnt(3)
    v_max3_u32 v2, v212, v216, v220
    v_mfma_f32_16x16x32_bf16 v[88:91], a[112:115], v[204:207], v[88:91]
    v_max_u32 v2, v2, v224
    v_mfma_f32_16x16x32_bf16 v[92:95], a[116:119], v[204:207], v[92:95]
    v_cmp_eq_u32 vcc, -1, v2
    v_mfma_f32_16x16x32_bf16 v[76:79], a[120:123], v[208:211], v[76:79]
    v_mfma_f32_16x16x32_bf16 v[80:83], a[124:127], v[208:211], v[80:83]
    s_cbranch_vccnz pk_c110_s
pk_c110_r:
    v_mfma_f32_16x16x32_bf16 v[84:87], a[128:131], v[208:211], v[84:87]
    v_mfma_f32_16x16x32_bf16 v[88:91], a[132:135], v[208:211], v[88:91]
    v_mfma_f32_16x16x32_bf16 v[92:95], a[136:139], v[208:211], v[92:95]
    s_nop 2
    ds_write_b128 v113, v[76:79] offset:40960
    v_mfma_f32_16x16x32_bf16 v[16:19], a[0:3], v[212:215], 0
    ds_write_b128 v113, v[80:83] offset:41984
    v_mfma_f32_16x16x32_bf16 v[20:23], a[4:7], v[212:215], 0
    ds_write_b128 v113, v[84:87] offset:43008
    v_mfma_f32_16x16x32_bf16 v[24:27], a[8:11], v[212:215], 0
    ds_write_b128 v113, v[88:91] offset:44032
    v_mfma_f32_16x16x32_bf16 v[28:31], a[12:15], v[212:215], 0
    ds_write_b128 v113, v[92:95] offset:45056
    v_mfma_f32_16x16x32_bf16 v[32:35], a[16:19], v[212:215], 0
    v_mfma_f32_16x16x32_bf16 v[16:19], a[60:63], v[216:219], v[16:19]
    v_mfma_f32_16x16x32_bf16 v[20:23], a[64:67], v[216:219], v[20:23]
    v_mfma_f32_16x16x32_bf16 v[24:27], a[68:71], v[216:219], v[24:27]
    v_mfma_f32_16x16x32_bf16 v[28:31], a[72:75], v[216:219], v[28:31]
    v_mfma_f32_16x16x32_bf16 v[32:35], a[76:79], v[216:219], v[32:35]
    v_mfma_f32_16x16x32_bf16 v[16:19], a[20:23], v[220:223], v[16:19]
    s_waitcnt lgkmcnt(0)
    s_barrier
    v_mfma_f32_16x16x32_bf16 v[20:23], a[24:27], v[220:223], v[20:23]
    ds_read_b128 v[128:131], v110 offset:0
    ds_read_b128 v[148:151], v111 offset:0
    v_mfma_f32_16x16x32_bf16 v[24:27], a[28:31], v[220:223], v[24:27]
    s_waitcnt vmcnt(0)
    v_max3_u32 v2, v228, v232, v236
    v_mfma_f32_16x16x32_bf16 v[28:31], a[32:35], v[220:223], v[28:31]
    v_max_u32 v2, v2, v238
    v_mfma_f32_16x16x32_bf16 v[32:35], a[36:39], v[220:223], v[32:35]
    v_cmp_eq_u32 vcc, -1, v2
    v_mfma_f32_16x16x32_bf16 v[16:19], a[80:83], v[224:227], v[16:19]
    v_mfma_f32_16x16x32_bf16 v[20:23], a[84:87], v[224:227], v[20:23]
    s_cbranch_vccnz pk_c111_s
pk_c111_r:
    v_mfma_f32_16x16x32_bf16 v[24:27], a[88:91], v[224:227], v[24:27]
    ds_read_b128 v[168:171], v112 offset:0
    ds_read_b128 v[132:135], v110 offset:1024
    v_mfma_f32_16x16x32_bf16 v[28:31], a[92:95], v[224:227], v[28:31]
    ds_read_b128 v[152:155], v111 offset:1024
    ds_read_b128 v[172:175], v112 offset:1024
    v_mfma_f32_16x16x32_bf16 v[32:35], a[96:99], v[224:227], v[32:35]
    ds_read_b128 v[136:139], v110 offset:2048
    ds_read_b128 v[156:159], v111 offset:2048
    v_mfma_f32_16x16x32_bf16 v[16:19], a[40:43], v[228:231], v[16:19]
    ds_read_b128 v[176:179], v112 offset:2048
    ds_read_b128 v[140:143], v110 offset:3072
    v_mfma_f32_16x16x32_bf16 v[20:23], a[44:47], v[228:231], v[20:23]
    ds_read_b128 v[160:163], v111 offset:3072
    ds_read_b128 v[180:183], v112 offset:3072
    v_mfma_f32_16x16x32_bf16 v[24:27], a[48:51], v[228:231], v[24:27]
    ds_read_b128 v[144:147], v110 offset:4096
    ds_read_b128 v[164:167], v111 offset:4096
    v_mfma_f32_16x16x32_bf16 v[28:31], a[52:55], v[228:231], v[28:31]
    ds_read_b128 v[184:187], v112 offset:4096
    s_waitcnt lgkmcnt(12)
    v_add_f32 v128, v128, v148
    v_add_f32 v128, v128, v168
    v_mfma_f32_16x16x32_bf16 v[32:35], a[56:59], v[228:231], v[32:35]
    v_add_f32 v129, v129, v149
    v_add_f32 v129, v129, v169
    v_mfma_f32_16x16x32_bf16 v[16:19], a[100:103], v[232:235], v[16:19]
    v_add_f32 v130, v130, v150
    v_add_f32 v130, v130, v170
    v_mfma_f32_16x16x32_bf16 v[20:23], a[104:107], v[232:235], v[20:23]
    v_add_f32 v131, v131, v151
    v_add_f32 v131, v131, v171
    v_mfma_f32_16x16x32_bf16 v[24:27], a[108:111], v[232:235], v[24:27]
    s_waitcnt lgkmcnt(9)
    v_add_f32 v132, v132, v152
    v_add_f32 v132, v132, v172
    v_mfma_f32_16x16x32_bf16 v[28:31], a[112:115], v[232:235], v[28:31]
    v_add_f32 v133, v133, v153
    v_add_f32 v133, v133, v173
    v_mfma_f32_16x16x32_bf16 v[32:35], a[116:119], v[232:235], v[32:35]
    v_add_f32 v134, v134, v154
    v_add_f32 v134, v134, v174
    v_mfma_f32_16x16x32_bf16 v[16:19], a[120:123], v[236:239], v[16:19]
    v_add_f32 v135, v135, v155
    v_add_f32 v135, v135, v175
    v_mfma_f32_16x16x32_bf16 v[20:23], a[124:127], v[236:239], v[20:23]
    s_waitcnt lgkmcnt(6)
    v_add_f32 v136, v136, v156
    v_add_f32 v136, v136, v176
    v_mfma_f32_16x16x32_bf16 v[24:27], a[128:131], v[236:239], v[24:27]
    v_add_f32 v137, v137, v157
    v_add_f32 v137, v137, v177
    v_mfma_f32_16x16x32_bf16 v[28:31], a[132:135], v[236:239], v[28:31]
    v_add_f32 v138, v138, v158
    v_add_f32 v138, v138, v178
    v_mfma_f32_16x16x32_bf16 v[32:35], a[136:139], v[236:239], v[32:35]
    v_add_f32 v139, v139, v159
    v_add_f32 v139, v139, v179
    s_waitcnt lgkmcnt(3)
    v_add_f32 v140, v140, v160
    v_add_f32 v140, v140, v180
    v_add_f32 v141, v141, v161
    v_add_f32 v141, v141, v181
    v_add_f32 v142, v142, v162
    v_add_f32 v142, v142, v182
    v_add_f32 v143, v143, v163
    v_add_f32 v143, v143, v183
    s_waitcnt lgkmcnt(0)
    v_add_f32 v144, v144, v164
    v_add_f32 v144, v144, v184
    v_add_f32 v145, v145, v165
    v_add_f32 v145, v145, v185
    v_add_f32 v146, v146, v166
    v_add_f32 v146, v146, v186
    v_add_f32 v147, v147, v167
    v_add_f32 v147, v147, v187
    v_pk_add_f32 v[16:17], v[16:17], v[128:129]
    v_lshlrev_b32 v194, 16, v100
    v_and_b32 v195, 0xffff0000, v100
    v_cvt_pk_bf16_f32 v192, v16, v17
    v_lshlrev_b32 v16, 16, v192
    v_and_b32 v17, 0xffff0000, v192
    v_pk_add_f32 v[16:17], v[16:17], v[194:195]
    v_cvt_pk_bf16_f32 v116, v16, v17
    v_pk_add_f32 v[18:19], v[18:19], v[130:131]
    v_lshlrev_b32 v198, 16, v101
    v_and_b32 v199, 0xffff0000, v101
    v_cvt_pk_bf16_f32 v196, v18, v19
    v_lshlrev_b32 v18, 16, v196
    v_and_b32 v19, 0xffff0000, v196
    v_pk_add_f32 v[18:19], v[18:19], v[198:199]
    v_cvt_pk_bf16_f32 v117, v18, v19
    v_pk_add_f32 v[20:21], v[20:21], v[132:133]
    v_lshlrev_b32 v202, 16, v102
    v_and_b32 v203, 0xffff0000, v102
    v_cvt_pk_bf16_f32 v200, v20, v21
    v_lshlrev_b32 v20, 16, v200
    v_and_b32 v21, 0xffff0000, v200
    v_pk_add_f32 v[20:21], v[20:21], v[202:203]
    v_cvt_pk_bf16_f32 v118, v20, v21
    v_pk_add_f32 v[22:23], v[22:23], v[134:135]
    v_lshlrev_b32 v206, 16, v103
    v_and_b32 v207, 0xffff0000, v103
    v_cvt_pk_bf16_f32 v204, v22, v23
    v_lshlrev_b32 v22, 16, v204
    v_and_b32 v23, 0xffff0000, v204
    v_pk_add_f32 v[22:23], v[22:23], v[206:207]
    v_cvt_pk_bf16_f32 v119, v22, v23
    buffer_store_dwordx4 v[116:119], v15, s[4:7], s43 offen offset:0
    v_pk_add_f32 v[24:25], v[24:25], v[136:137]
    v_lshlrev_b32 v210, 16, v104
    v_and_b32 v211, 0xffff0000, v104
    v_cvt_pk_bf16_f32 v208, v24, v25
    v_lshlrev_b32 v24, 16, v208
    v_and_b32 v25, 0xffff0000, v208
    v_pk_add_f32 v[24:25], v[24:25], v[210:211]
    v_cvt_pk_bf16_f32 v120, v24, v25
    v_pk_add_f32 v[26:27], v[26:27], v[138:139]
    v_lshlrev_b32 v214, 16, v105
    v_and_b32 v215, 0xffff0000, v105
    v_cvt_pk_bf16_f32 v212, v26, v27
    v_lshlrev_b32 v26, 16, v212
    v_and_b32 v27, 0xffff0000, v212
    v_pk_add_f32 v[26:27], v[26:27], v[214:215]
    v_cvt_pk_bf16_f32 v121, v26, v27
    v_pk_add_f32 v[28:29], v[28:29], v[140:141]
    v_lshlrev_b32 v218, 16, v106
    v_and_b32 v219, 0xffff0000, v106
    v_cvt_pk_bf16_f32 v216, v28, v29
    v_lshlrev_b32 v28, 16, v216
    v_and_b32 v29, 0xffff0000, v216
    v_pk_add_f32 v[28:29], v[28:29], v[218:219]
    v_cvt_pk_bf16_f32 v122, v28, v29
    v_pk_add_f32 v[30:31], v[30:31], v[142:143]
    v_lshlrev_b32 v222, 16, v107
    v_and_b32 v223, 0xffff0000, v107
    v_cvt_pk_bf16_f32 v220, v30, v31
    v_lshlrev_b32 v30, 16, v220
    v_and_b32 v31, 0xffff0000, v220
    v_pk_add_f32 v[30:31], v[30:31], v[222:223]
    v_cvt_pk_bf16_f32 v123, v30, v31
    buffer_store_dwordx4 v[120:123], v15, s[4:7], s43 offen offset:64
    v_pk_add_f32 v[32:33], v[32:33], v[144:145]
    v_lshlrev_b32 v226, 16, v108
    v_and_b32 v227, 0xffff0000, v108
    v_cvt_pk_bf16_f32 v224, v32, v33
    v_lshlrev_b32 v32, 16, v224
    v_and_b32 v33, 0xffff0000, v224
    v_pk_add_f32 v[32:33], v[32:33], v[226:227]
    v_cvt_pk_bf16_f32 v124, v32, v33
    v_pk_add_f32 v[34:35], v[34:35], v[146:147]
    v_lshlrev_b32 v230, 16, v109
    v_and_b32 v231, 0xffff0000, v109
    v_cvt_pk_bf16_f32 v228, v34, v35
    v_lshlrev_b32 v34, 16, v228
    v_and_b32 v35, 0xffff0000, v228
    v_pk_add_f32 v[34:35], v[34:35], v[230:231]
    v_cvt_pk_bf16_f32 v125, v34, v35
    buffer_store_dwordx2 v[124:125], v114, s[4:7], s43 offen offset:128
    s_nop 0
pk_end:
    s_endpgm
pk_end0:
    s_waitcnt lgkmcnt(0)
    s_endpgm
pk_n1_s:
    s_mov_b32 s45, 0
pk_n1_l:
    s_sleep 1
    buffer_load_dword v90, v91, s[28:31], 0 offen sc1
    s_add_u32 s45, s45, 1
    s_waitcnt vmcnt(0)
    v_and_b32 v89, 0xff, v90
    v_cmp_ne_u32 vcc, 32, v89
    s_cmp_lg_u64 vcc, 0
    s_cbranch_scc0 pk_n1_x
    s_cmp_lt_u32 s45, 0x2000
    s_cbranch_scc1 pk_n1_l
pk_n1_x:
    s_branch pk_n1_r
pk_w3_s:
    s_nop 7
    s_nop 7
    buffer_store_dword v9, v9, s[16:19], s41 offen sc1
    s_nop 4
    s_branch pk_w3_r
pk_c4_s:
    s_nop 7
    s_nop 7
    s_mov_b32 s47, 0
pk_c4_l:
    s_mov_b64 exec, vcc
    s_sleep 1
    s_mov_b32 s40, 0x288000
    buffer_load_dwordx4 v[12:15], v3, s[16:19], s40 offen sc1
    s_add_u32 s47, s47, 1
    s_waitcnt vmcnt(0)
    v_max3_u32 v9, v12, v13, v14
    v_max_u32 v9, v9, v15
    v_cmp_eq_u32 vcc, -1, v9
    s_cmp_eq_u64 vcc, 0
    s_cbranch_scc1 pk_c4_x
    s_cmp_lt_u32 s47, 0x2000
    s_cbranch_scc1 pk_c4_l
pk_c4_x:
    s_mov_b64 exec, -1
    s_nop 4
    s_branch pk_c4_r
pk_c5_s:
    s_nop 7
    s_nop 7
    s_mov_b32 s47, 0
pk_c5_l:
    s_mov_b64 exec, vcc
    s_sleep 1
    buffer_load_dword v11, off, s[16:19], s54 sc1
    s_add_u32 s47, s47, 1
    s_waitcnt vmcnt(0)
    v_cmp_eq_u32 vcc, -1, v11
    s_cmp_eq_u64 vcc, 0
    s_cbranch_scc1 pk_c5_x
    s_cmp_lt_u32 s47, 0x2000
    s_cbranch_scc1 pk_c5_l
pk_c5_x:
    s_mov_b64 exec, -1
    s_nop 4
    s_branch pk_c5_r
pk_n6_s:
    s_mov_b32 s45, 0
pk_n6_l:
    s_sleep 1
    buffer_load_dword v90, v91, s[28:31], 0 offen sc1
    s_add_u32 s45, s45, 1
    s_waitcnt vmcnt(0)
    v_and_b32 v89, 0xff, v90
    v_cmp_ne_u32 vcc, 32, v89
    s_cmp_lg_u64 vcc, 0
    s_cbranch_scc0 pk_n6_x
    s_cmp_lt_u32 s45, 0x2000
    s_cbranch_scc1 pk_n6_l
pk_n6_x:
    s_branch pk_n6_r
pk_c7_s:
    s_nop 7
    s_nop 7
    s_mov_b32 s47, 0
pk_c7_l:
    s_mov_b64 exec, vcc
    s_sleep 1
    s_mov_b32 s40, 0x288000
    buffer_load_dwordx4 v[12:15], v3, s[16:19], s40 offen sc1
    s_add_u32 s47, s47, 1
    s_waitcnt vmcnt(0)
    v_max3_u32 v9, v12, v13, v14
    v_max_u32 v9, v9, v15
    v_cmp_eq_u32 vcc, -1, v9
    s_cmp_eq_u64 vcc, 0
    s_cbranch_scc1 pk_c7_x
    s_cmp_lt_u32 s47, 0x2000
    s_cbranch_scc1 pk_c7_l
pk_c7_x:
    s_mov_b64 exec, -1
    s_nop 4
    s_branch pk_c7_r
pk_c8_s:
    s_nop 7
    s_nop 7
    s_mov_b32 s47, 0
pk_c8_l:
    s_mov_b64 exec, vcc
    s_sleep 8
    buffer_load_dword v253, v25, s[16:19], 0 offen sc1
    buffer_load_dword v254, v27, s[16:19], 0 offen sc1
    s_add_u32 s47, s47, 1
    s_waitcnt vmcnt(0)
    v_max_u32 v9, v253, v254
    v_cmp_eq_u32 vcc, -1, v9
    s_cmp_eq_u64 vcc, 0
    s_cbranch_scc1 pk_c8_x
    s_cmp_lt_u32 s47, 0x2000
    s_cbranch_scc1 pk_c8_l
pk_c8_x:
    s_mov_b64 exec, -1
    s_nop 4
    s_branch pk_c8_r
pk_w10_s:
    s_nop 7
    s_nop 7
    s_waitcnt lgkmcnt(2)
    buffer_store_dwordx4 v[192:195], v252, s[16:19], s36 offen sc1
    s_waitcnt lgkmcnt(1)
    buffer_store_dwordx4 v[196:199], v252, s[16:19], s37 offen sc1
    s_mov_b32 exec_hi, 0
    s_waitcnt lgkmcnt(0)
    buffer_store_dwordx4 v[200:203], v252, s[16:19], s38 offen sc1
    s_mov_b32 exec_hi, -1
    s_nop 4
    s_branch pk_w10_r
pk_c12_s:
    s_nop 7
    s_nop 7
    s_mov_b32 s47, 0
pk_c12_l:
    s_mov_b64 exec, vcc
    s_sleep 1
    buffer_load_dwordx4 a[196:199], v6, s[16:19], s36 offen offset:1024 sc1
    buffer_load_dwordx4 v[244:247], v7, s[16:19], s36 offen offset:1024 sc1
    buffer_load_dwordx4 a[200:203], v6, s[16:19], s36 offen offset:2048 sc1
    buffer_load_dwordx4 v[248:251], v7, s[16:19], s36 offen offset:2048 sc1
    buffer_load_dwordx4 a[204:207], v6, s[16:19], s36 offen offset:3072 sc1
    buffer_load_dwordx4 v[252:255], v7, s[16:19], s36 offen offset:3072 sc1
    s_xor_b32 s40, s59, 0
    buffer_load_dwordx4 a[128:131], v6, s[16:19], s40 offen offset:0 sc1
    buffer_load_dwordx4 v[176:179], v7, s[16:19], s40 offen offset:0 sc1
    s_xor_b32 s40, s59, 0
    buffer_load_dwordx4 a[132:135], v6, s[16:19], s40 offen offset:1024 sc1
    buffer_load_dwordx4 v[180:183], v7, s[16:19], s40 offen offset:1024 sc1
    s_xor_b32 s40, s59, 2048
    buffer_load_dwordx4 a[136:139], v6, s[16:19], s40 offen offset:0 sc1
    buffer_load_dwordx4 v[184:187], v7, s[16:19], s40 offen offset:0 sc1
    s_add_u32 s47, s47, 1
    s_waitcnt vmcnt(0)
    v_accvgpr_read_b32 v12, a196
    v_max_u32 v12, v12, v244
    v_cmp_eq_u32 vcc, -1, v12
    s_cmp_eq_u64 vcc, 0
    s_cbranch_scc1 pk_c12_x
    s_cmp_lt_u32 s47, 0x2000
    s_cbranch_scc1 pk_c12_l
pk_c12_x:
    s_mov_b64 exec, -1
    s_nop 4
    s_branch pk_c12_r
pk_c13_s:
    s_nop 7
    s_nop 7
    s_mov_b32 s47, 0
pk_c13_l:
    s_mov_b64 exec, vcc
    s_sleep 1
    buffer_load_dwordx4 a[200:203], v6, s[16:19], s36 offen offset:2048 sc1
    buffer_load_dwordx4 v[248:251], v7, s[16:19], s36 offen offset:2048 sc1
    buffer_load_dwordx4 a[204:207], v6, s[16:19], s36 offen offset:3072 sc1
    buffer_load_dwordx4 v[252:255], v7, s[16:19], s36 offen offset:3072 sc1
    s_xor_b32 s40, s59, 0
    buffer_load_dwordx4 a[128:131], v6, s[16:19], s40 offen offset:0 sc1
    buffer_load_dwordx4 v[176:179], v7, s[16:19], s40 offen offset:0 sc1
    s_xor_b32 s40, s59, 0
    buffer_load_dwordx4 a[132:135], v6, s[16:19], s40 offen offset:1024 sc1
    buffer_load_dwordx4 v[180:183], v7, s[16:19], s40 offen offset:1024 sc1
    s_xor_b32 s40, s59, 2048
    buffer_load_dwordx4 a[136:139], v6, s[16:19], s40 offen offset:0 sc1
    buffer_load_dwordx4 v[184:187], v7, s[16:19], s40 offen offset:0 sc1
    s_xor_b32 s40, s59, 2048
    buffer_load_dwordx4 a[140:143], v6, s[16:19], s40 offen offset:1024 sc1
    buffer_load_dwordx4 v[188:191], v7, s[16:19], s40 offen offset:1024 sc1
    s_add_u32 s47, s47, 1
    s_waitcnt vmcnt(0)
    v_accvgpr_read_b32 v12, a200
    v_max_u32 v12, v12, v248
    v_cmp_eq_u32 vcc, -1, v12
    s_cmp_eq_u64 vcc, 0
    s_cbranch_scc1 pk_c13_x
    s_cmp_lt_u32 s47, 0x2000
    s_cbranch_scc1 pk_c13_l
pk_c13_x:
    s_mov_b64 exec, -1
    s_nop 4
    s_branch pk_c13_r
pk_c14_s:
    s_nop 7
    s_nop 7
    s_mov_b32 s47, 0
pk_c14_l:
    s_mov_b64 exec, vcc
    s_sleep 1
    buffer_load_dwordx4 a[204:207], v6, s[16:19], s36 offen offset:3072 sc1
    buffer_load_dwordx4 v[252:255], v7, s[16:19], s36 offen offset:3072 sc1
    s_xor_b32 s40, s59, 0
    buffer_load_dwordx4 a[128:131], v6, s[16:19], s40 offen offset:0 sc1
    buffer_load_dwordx4 v[176:179], v7, s[16:19], s40 offen offset:0 sc1
    s_xor_b32 s40, s59, 0
    buffer_load_dwordx4 a[132:135], v6, s[16:19], s40 offen offset:1024 sc1
    buffer_load_dwordx4 v[180:183], v7, s[16:19], s40 offen offset:1024 sc1
    s_xor_b32 s40, s59, 2048
    buffer_load_dwordx4 a[136:139], v6, s[16:19], s40 offen offset:0 sc1
    buffer_load_dwordx4 v[184:187], v7, s[16:19], s40 offen offset:0 sc1
    s_xor_b32 s40, s59, 2048
    buffer_load_dwordx4 a[140:143], v6, s[16:19], s40 offen offset:1024 sc1
    buffer_load_dwordx4 v[188:191], v7, s[16:19], s40 offen offset:1024 sc1
    s_xor_b32 s40, s59, 4096
    buffer_load_dwordx4 a[144:147], v6, s[16:19], s40 offen offset:0 sc1
    buffer_load_dwordx4 v[192:195], v7, s[16:19], s40 offen offset:0 sc1
    s_add_u32 s47, s47, 1
    s_waitcnt vmcnt(0)
    v_accvgpr_read_b32 v12, a204
    v_max_u32 v12, v12, v252
    v_cmp_eq_u32 vcc, -1, v12
    s_cmp_eq_u64 vcc, 0
    s_cbranch_scc1 pk_c14_x
    s_cmp_lt_u32 s47, 0x2000
    s_cbranch_scc1 pk_c14_l
pk_c14_x:
    s_mov_b64 exec, -1
    s_nop 4
    s_branch pk_c14_r
pk_c15_s:
    s_nop 7
    s_nop 7
    s_mov_b32 s47, 0
pk_c15_l:
    s_mov_b64 exec, vcc
    s_sleep 1
    s_xor_b32 s40, s59, 0
    buffer_load_dwordx4 a[128:131], v6, s[16:19], s40 offen offset:0 sc1
    buffer_load_dwordx4 v[176:179], v7, s[16:19], s40 offen offset:0 sc1
    s_xor_b32 s40, s59, 0
    buffer_load_dwordx4 a[132:135], v6, s[16:19], s40 offen offset:1024 sc1
    buffer_load_dwordx4 v[180:183], v7, s[16:19], s40 offen offset:1024 sc1
    s_xor_b32 s40, s59, 2048
    buffer_load_dwordx4 a[136:139], v6, s[16:19], s40 offen offset:0 sc1
    buffer_load_dwordx4 v[184:187], v7, s[16:19], s40 offen offset:0 sc1
    s_xor_b32 s40, s59, 2048
    buffer_load_dwordx4 a[140:143], v6, s[16:19], s40 offen offset:1024 sc1
    buffer_load_dwordx4 v[188:191], v7, s[16:19], s40 offen offset:1024 sc1
    s_xor_b32 s40, s59, 4096
    buffer_load_dwordx4 a[144:147], v6, s[16:19], s40 offen offset:0 sc1
    buffer_load_dwordx4 v[192:195], v7, s[16:19], s40 offen offset:0 sc1
    s_xor_b32 s40, s59, 4096
    buffer_load_dwordx4 a[148:151], v6, s[16:19], s40 offen offset:1024 sc1
    buffer_load_dwordx4 v[196:199], v7, s[16:19], s40 offen offset:1024 sc1
    s_add_u32 s47, s47, 1
    s_waitcnt vmcnt(0)
    v_accvgpr_read_b32 v12, a128
    v_max_u32 v12, v12, v176
    v_cmp_eq_u32 vcc, -1, v12
    s_cmp_eq_u64 vcc, 0
    s_cbranch_scc1 pk_c15_x
    s_cmp_lt_u32 s47, 0x2000
    s_cbranch_scc1 pk_c15_l
pk_c15_x:
    s_mov_b64 exec, -1
    s_nop 4
    s_branch pk_c15_r
pk_c16_s:
    s_nop 7
    s_nop 7
    s_mov_b32 s47, 0
pk_c16_l:
    s_mov_b64 exec, vcc
    s_sleep 1
    s_xor_b32 s40, s59, 0
    buffer_load_dwordx4 a[132:135], v6, s[16:19], s40 offen offset:1024 sc1
    buffer_load_dwordx4 v[180:183], v7, s[16:19], s40 offen offset:1024 sc1
    s_xor_b32 s40, s59, 2048
    buffer_load_dwordx4 a[136:139], v6, s[16:19], s40 offen offset:0 sc1
    buffer_load_dwordx4 v[184:187], v7, s[16:19], s40 offen offset:0 sc1
    s_xor_b32 s40, s59, 2048
    buffer_load_dwordx4 a[140:143], v6, s[16:19], s40 offen offset:1024 sc1
    buffer_load_dwordx4 v[188:191], v7, s[16:19], s40 offen offset:1024 sc1
    s_xor_b32 s40, s59, 4096
    buffer_load_dwordx4 a[144:147], v6, s[16:19], s40 offen offset:0 sc1
    buffer_load_dwordx4 v[192:195], v7, s[16:19], s40 offen offset:0 sc1
    s_xor_b32 s40, s59, 4096
    buffer_load_dwordx4 a[148:151], v6, s[16:19], s40 offen offset:1024 sc1
    buffer_load_dwordx4 v[196:199], v7, s[16:19], s40 offen offset:1024 sc1
    s_xor_b32 s40, s59, 6144
    buffer_load_dwordx4 a[152:155], v6, s[16:19], s40 offen offset:0 sc1
    buffer_load_dwordx4 v[200:203], v7, s[16:19], s40 offen offset:0 sc1
    s_add_u32 s47, s47, 1
    s_waitcnt vmcnt(0)
    v_accvgpr_read_b32 v12, a132
    v_max_u32 v12, v12, v180
    v_cmp_eq_u32 vcc, -1, v12
    s_cmp_eq_u64 vcc, 0
    s_cbranch_scc1 pk_c16_x
    s_cmp_lt_u32 s47, 0x2000
    s_cbranch_scc1 pk_c16_l
pk_c16_x:
    s_mov_b64 exec, -1
    s_nop 4
    s_branch pk_c16_r
pk_c17_s:
    s_nop 7
    s_nop 7
    s_mov_b32 s47, 0
pk_c17_l:
    s_mov_b64 exec, vcc
    s_sleep 1
    s_xor_b32 s40, s59, 2048
    buffer_load_dwordx4 a[136:139], v6, s[16:19], s40 offen offset:0 sc1
    buffer_load_dwordx4 v[184:187], v7, s[16:19], s40 offen offset:0 sc1
    s_xor_b32 s40, s59, 2048
    buffer_load_dwordx4 a[140:143], v6, s[16:19], s40 offen offset:1024 sc1
    buffer_load_dwordx4 v[188:191], v7, s[16:19], s40 offen offset:1024 sc1
    s_xor_b32 s40, s59, 4096
    buffer_load_dwordx4 a[144:147], v6, s[16:19], s40 offen offset:0 sc1
    buffer_load_dwordx4 v[192:195], v7, s[16:19], s40 offen offset:0 sc1
    s_xor_b32 s40, s59, 4096
    buffer_load_dwordx4 a[148:151], v6, s[16:19], s40 offen offset:1024 sc1
    buffer_load_dwordx4 v[196:199], v7, s[16:19], s40 offen offset:1024 sc1
    s_xor_b32 s40, s59, 6144
    buffer_load_dwordx4 a[152:155], v6, s[16:19], s40 offen offset:0 sc1
    buffer_load_dwordx4 v[200:203], v7, s[16:19], s40 offen offset:0 sc1
    s_xor_b32 s40, s59, 6144
    buffer_load_dwordx4 a[156:159], v6, s[16:19], s40 offen offset:1024 sc1
    buffer_load_dwordx4 v[204:207], v7, s[16:19], s40 offen offset:1024 sc1
    s_add_u32 s47, s47, 1
    s_waitcnt vmcnt(0)
    v_accvgpr_read_b32 v12, a136
    v_max_u32 v12, v12, v184
    v_cmp_eq_u32 vcc, -1, v12
    s_cmp_eq_u64 vcc, 0
    s_cbranch_scc1 pk_c17_x
    s_cmp_lt_u32 s47, 0x2000
    s_cbranch_scc1 pk_c17_l
pk_c17_x:
    s_mov_b64 exec, -1
    s_nop 4
    s_branch pk_c17_r
pk_c18_s:
    s_nop 7
    s_nop 7
    s_mov_b32 s47, 0
pk_c18_l:
    s_mov_b64 exec, vcc
    s_sleep 1
    s_xor_b32 s40, s59, 2048
    buffer_load_dwordx4 a[140:143], v6, s[16:19], s40 offen offset:1024 sc1
    buffer_load_dwordx4 v[188:191], v7, s[16:19], s40 offen offset:1024 sc1
    s_xor_b32 s40, s59, 4096
    buffer_load_dwordx4 a[144:147], v6, s[16:19], s40 offen offset:0 sc1
    buffer_load_dwordx4 v[192:195], v7, s[16:19], s40 offen offset:0 sc1
    s_xor_b32 s40, s59, 4096
    buffer_load_dwordx4 a[148:151], v6, s[16:19], s40 offen offset:1024 sc1
    buffer_load_dwordx4 v[196:199], v7, s[16:19], s40 offen offset:1024 sc1
    s_xor_b32 s40, s59, 6144
    buffer_load_dwordx4 a[152:155], v6, s[16:19], s40 offen offset:0 sc1
    buffer_load_dwordx4 v[200:203], v7, s[16:19], s40 offen offset:0 sc1
    s_xor_b32 s40, s59, 6144
    buffer_load_dwordx4 a[156:159], v6, s[16:19], s40 offen offset:1024 sc1
    buffer_load_dwordx4 v[204:207], v7, s[16:19], s40 offen offset:1024 sc1
    s_xor_b32 s40, s59, 8192
    buffer_load_dwordx4 a[160:163], v6, s[16:19], s40 offen offset:0 sc1
    buffer_load_dwordx4 v[208:211], v7, s[16:19], s40 offen offset:0 sc1
    s_add_u32 s47, s47, 1
    s_waitcnt vmcnt(0)
    v_accvgpr_read_b32 v12, a140
    v_max_u32 v12, v12, v188
    v_cmp_eq_u32 vcc, -1, v12
    s_cmp_eq_u64 vcc, 0
    s_cbranch_scc1 pk_c18_x
    s_cmp_lt_u32 s47, 0x2000
    s_cbranch_scc1 pk_c18_l
pk_c18_x:
    s_mov_b64 exec, -1
    s_nop 4
    s_branch pk_c18_r
pk_c19_s:
    s_nop 7
    s_nop 7
    s_mov_b32 s47, 0
pk_c19_l:
    s_mov_b64 exec, vcc
    s_sleep 1
    s_xor_b32 s40, s59, 4096
    buffer_load_dwordx4 a[144:147], v6, s[16:19], s40 offen offset:0 sc1
    buffer_load_dwordx4 v[192:195], v7, s[16:19], s40 offen offset:0 sc1
    s_xor_b32 s40, s59, 4096
    buffer_load_dwordx4 a[148:151], v6, s[16:19], s40 offen offset:1024 sc1
    buffer_load_dwordx4 v[196:199], v7, s[16:19], s40 offen offset:1024 sc1
    s_xor_b32 s40, s59, 6144
    buffer_load_dwordx4 a[152:155], v6, s[16:19], s40 offen offset:0 sc1
    buffer_load_dwordx4 v[200:203], v7, s[16:19], s40 offen offset:0 sc1
    s_xor_b32 s40, s59, 6144
    buffer_load_dwordx4 a[156:159], v6, s[16:19], s40 offen offset:1024 sc1
    buffer_load_dwordx4 v[204:207], v7, s[16:19], s40 offen offset:1024 sc1
    s_xor_b32 s40, s59, 8192
    buffer_load_dwordx4 a[160:163], v6, s[16:19], s40 offen offset:0 sc1
    buffer_load_dwordx4 v[208:211], v7, s[16:19], s40 offen offset:0 sc1
    s_xor_b32 s40, s59, 8192
    buffer_load_dwordx4 a[164:167], v6, s[16:19], s40 offen offset:1024 sc1
    buffer_load_dwordx4 v[212:215], v7, s[16:19], s40 offen offset:1024 sc1
    s_add_u32 s47, s47, 1
    s_waitcnt vmcnt(0)
    v_accvgpr_read_b32 v12, a144
    v_max_u32 v12, v12, v192
    v_cmp_eq_u32 vcc, -1, v12
    s_cmp_eq_u64 vcc, 0
    s_cbranch_scc1 pk_c19_x
    s_cmp_lt_u32 s47, 0x2000
    s_cbranch_scc1 pk_c19_l
pk_c19_x:
    s_mov_b64 exec, -1
    s_nop 4
    s_branch pk_c19_r
pk_c20_s:
    s_nop 7
    s_nop 7
    s_mov_b32 s47, 0
pk_c20_l:
    s_mov_b64 exec, vcc
    s_sleep 1
    s_xor_b32 s40, s59, 4096
    buffer_load_dwordx4 a[148:151], v6, s[16:19], s40 offen offset:1024 sc1
    buffer_load_dwordx4 v[196:199], v7, s[16:19], s40 offen offset:1024 sc1
    s_xor_b32 s40, s59, 6144
    buffer_load_dwordx4 a[152:155], v6, s[16:19], s40 offen offset:0 sc1
    buffer_load_dwordx4 v[200:203], v7, s[16:19], s40 offen offset:0 sc1
    s_xor_b32 s40, s59, 6144
    buffer_load_dwordx4 a[156:159], v6, s[16:19], s40 offen offset:1024 sc1
    buffer_load_dwordx4 v[204:207], v7, s[16:19], s40 offen offset:1024 sc1
    s_xor_b32 s40, s59, 8192
    buffer_load_dwordx4 a[160:163], v6, s[16:19], s40 offen offset:0 sc1
    buffer_load_dwordx4 v[208:211], v7, s[16:19], s40 offen offset:0 sc1
    s_xor_b32 s40, s59, 8192
    buffer_load_dwordx4 a[164:167], v6, s[16:19], s40 offen offset:1024 sc1
    buffer_load_dwordx4 v[212:215], v7, s[16:19], s40 offen offset:1024 sc1
    s_xor_b32 s40, s59, 10240
    buffer_load_dwordx4 a[168:171], v6, s[16:19], s40 offen offset:0 sc1
    buffer_load_dwordx4 v[216:219], v7, s[16:19], s40 offen offset:0 sc1
    s_add_u32 s47, s47, 1
    s_waitcnt vmcnt(0)
    v_accvgpr_read_b32 v12, a148
    v_max_u32 v12, v12, v196
    v_cmp_eq_u32 vcc, -1, v12
    s_cmp_eq_u64 vcc, 0
    s_cbranch_scc1 pk_c20_x
    s_cmp_lt_u32 s47, 0x2000
    s_cbranch_scc1 pk_c20_l
pk_c20_x:
    s_mov_b64 exec, -1
    s_nop 4
    s_branch pk_c20_r
pk_c21_s:
    s_nop 7
    s_nop 7
    s_mov_b32 s47, 0
pk_c21_l:
    s_mov_b64 exec, vcc
    s_sleep 1
    s_xor_b32 s40, s59, 6144
    buffer_load_dwordx4 a[152:155], v6, s[16:19], s40 offen offset:0 sc1
    buffer_load_dwordx4 v[200:203], v7, s[16:19], s40 offen offset:0 sc1
    s_xor_b32 s40, s59, 6144
    buffer_load_dwordx4 a[156:159], v6, s[16:19], s40 offen offset:1024 sc1
    buffer_load_dwordx4 v[204:207], v7, s[16:19], s40 offen offset:1024 sc1
    s_xor_b32 s40, s59, 8192
    buffer_load_dwordx4 a[160:163], v6, s[16:19], s40 offen offset:0 sc1
    buffer_load_dwordx4 v[208:211], v7, s[16:19], s40 offen offset:0 sc1
    s_xor_b32 s40, s59, 8192
    buffer_load_dwordx4 a[164:167], v6, s[16:19], s40 offen offset:1024 sc1
    buffer_load_dwordx4 v[212:215], v7, s[16:19], s40 offen offset:1024 sc1
    s_xor_b32 s40, s59, 10240
    buffer_load_dwordx4 a[168:171], v6, s[16:19], s40 offen offset:0 sc1
    buffer_load_dwordx4 v[216:219], v7, s[16:19], s40 offen offset:0 sc1
    s_xor_b32 s40, s59, 10240
    buffer_load_dwordx4 a[172:175], v6, s[16:19], s40 offen offset:1024 sc1
    buffer_load_dwordx4 v[220:223], v7, s[16:19], s40 offen offset:1024 sc1
    s_add_u32 s47, s47, 1
    s_waitcnt vmcnt(0)
    v_accvgpr_read_b32 v12, a152
    v_max_u32 v12, v12, v200
    v_cmp_eq_u32 vcc, -1, v12
    s_cmp_eq_u64 vcc, 0
    s_cbranch_scc1 pk_c21_x
    s_cmp_lt_u32 s47, 0x2000
    s_cbranch_scc1 pk_c21_l
pk_c21_x:
    s_mov_b64 exec, -1
    s_nop 4
    s_branch pk_c21_r
pk_c22_s:
    s_nop 7
    s_nop 7
    s_mov_b32 s47, 0
pk_c22_l:
    s_mov_b64 exec, vcc
    s_sleep 1
    s_xor_b32 s40, s59, 6144
    buffer_load_dwordx4 a[156:159], v6, s[16:19], s40 offen offset:1024 sc1
    buffer_load_dwordx4 v[204:207], v7, s[16:19], s40 offen offset:1024 sc1
    s_xor_b32 s40, s59, 8192
    buffer_load_dwordx4 a[160:163], v6, s[16:19], s40 offen offset:0 sc1
    buffer_load_dwordx4 v[208:211], v7, s[16:19], s40 offen offset:0 sc1
    s_xor_b32 s40, s59, 8192
    buffer_load_dwordx4 a[164:167], v6, s[16:19], s40 offen offset:1024 sc1
    buffer_load_dwordx4 v[212:215], v7, s[16:19], s40 offen offset:1024 sc1
    s_xor_b32 s40, s59, 10240
    buffer_load_dwordx4 a[168:171], v6, s[16:19], s40 offen offset:0 sc1
    buffer_load_dwordx4 v[216:219], v7, s[16:19], s40 offen offset:0 sc1
    s_xor_b32 s40, s59, 10240
    buffer_load_dwordx4 a[172:175], v6, s[16:19], s40 offen offset:1024 sc1
    buffer_load_dwordx4 v[220:223], v7, s[16:19], s40 offen offset:1024 sc1
    s_xor_b32 s40, s59, 12288
    buffer_load_dwordx4 a[176:179], v6, s[16:19], s40 offen offset:0 sc1
    buffer_load_dwordx4 v[224:227], v7, s[16:19], s40 offen offset:0 sc1
    s_add_u32 s47, s47, 1
    s_waitcnt vmcnt(0)
    v_accvgpr_read_b32 v12, a156
    v_max_u32 v12, v12, v204
    v_cmp_eq_u32 vcc, -1, v12
    s_cmp_eq_u64 vcc, 0
    s_cbranch_scc1 pk_c22_x
    s_cmp_lt_u32 s47, 0x2000
    s_cbranch_scc1 pk_c22_l
pk_c22_x:
    s_mov_b64 exec, -1
    s_nop 4
    s_branch pk_c22_r
pk_c23_s:
    s_nop 7
    s_nop 7
    s_mov_b32 s47, 0
pk_c23_l:
    s_mov_b64 exec, vcc
    s_sleep 1
    s_xor_b32 s40, s59, 8192
    buffer_load_dwordx4 a[160:163], v6, s[16:19], s40 offen offset:0 sc1
    buffer_load_dwordx4 v[208:211], v7, s[16:19], s40 offen offset:0 sc1
    s_xor_b32 s40, s59, 8192
    buffer_load_dwordx4 a[164:167], v6, s[16:19], s40 offen offset:1024 sc1
    buffer_load_dwordx4 v[212:215], v7, s[16:19], s40 offen offset:1024 sc1
    s_xor_b32 s40, s59, 10240
    buffer_load_dwordx4 a[168:171], v6, s[16:19], s40 offen offset:0 sc1
    buffer_load_dwordx4 v[216:219], v7, s[16:19], s40 offen offset:0 sc1
    s_xor_b32 s40, s59, 10240
    buffer_load_dwordx4 a[172:175], v6, s[16:19], s40 offen offset:1024 sc1
    buffer_load_dwordx4 v[220:223], v7, s[16:19], s40 offen offset:1024 sc1
    s_xor_b32 s40, s59, 12288
    buffer_load_dwordx4 a[176:179], v6, s[16:19], s40 offen offset:0 sc1
    buffer_load_dwordx4 v[224:227], v7, s[16:19], s40 offen offset:0 sc1
    s_xor_b32 s40, s59, 12288
    buffer_load_dwordx4 a[180:183], v6, s[16:19], s40 offen offset:1024 sc1
    buffer_load_dwordx4 v[228:231], v7, s[16:19], s40 offen offset:1024 sc1
    s_add_u32 s47, s47, 1
    s_waitcnt vmcnt(0)
    v_accvgpr_read_b32 v12, a160
    v_max_u32 v12, v12, v208
    v_cmp_eq_u32 vcc, -1, v12
    s_cmp_eq_u64 vcc, 0
    s_cbranch_scc1 pk_c23_x
    s_cmp_lt_u32 s47, 0x2000
    s_cbranch_scc1 pk_c23_l
pk_c23_x:
    s_mov_b64 exec, -1
    s_nop 4
    s_branch pk_c23_r
pk_c24_s:
    s_nop 7
    s_nop 7
    s_mov_b32 s47, 0
pk_c24_l:
    s_mov_b64 exec, vcc
    s_sleep 1
    s_xor_b32 s40, s59, 8192
    buffer_load_dwordx4 a[164:167], v6, s[16:19], s40 offen offset:1024 sc1
    buffer_load_dwordx4 v[212:215], v7, s[16:19], s40 offen offset:1024 sc1
    s_xor_b32 s40, s59, 10240
    buffer_load_dwordx4 a[168:171], v6, s[16:19], s40 offen offset:0 sc1
    buffer_load_dwordx4 v[216:219], v7, s[16:19], s40 offen offset:0 sc1
    s_xor_b32 s40, s59, 10240
    buffer_load_dwordx4 a[172:175], v6, s[16:19], s40 offen offset:1024 sc1
    buffer_load_dwordx4 v[220:223], v7, s[16:19], s40 offen offset:1024 sc1
    s_xor_b32 s40, s59, 12288
    buffer_load_dwordx4 a[176:179], v6, s[16:19], s40 offen offset:0 sc1
    buffer_load_dwordx4 v[224:227], v7, s[16:19], s40 offen offset:0 sc1
    s_xor_b32 s40, s59, 12288
    buffer_load_dwordx4 a[180:183], v6, s[16:19], s40 offen offset:1024 sc1
    buffer_load_dwordx4 v[228:231], v7, s[16:19], s40 offen offset:1024 sc1
    s_xor_b32 s40, s59, 14336
    buffer_load_dwordx4 a[184:187], v6, s[16:19], s40 offen offset:0 sc1
    buffer_load_dwordx4 v[232:235], v7, s[16:19], s40 offen offset:0 sc1
    s_add_u32 s47, s47, 1
    s_waitcnt vmcnt(0)
    v_accvgpr_read_b32 v12, a164
    v_max_u32 v12, v12, v212
    v_cmp_eq_u32 vcc, -1, v12
    s_cmp_eq_u64 vcc, 0
    s_cbranch_scc1 pk_c24_x
    s_cmp_lt_u32 s47, 0x2000
    s_cbranch_scc1 pk_c24_l
pk_c24_x:
    s_mov_b64 exec, -1
    s_nop 4
    s_branch pk_c24_r
pk_c25_s:
    s_nop 7
    s_nop 7
    s_mov_b32 s47, 0
pk_c25_l:
    s_mov_b64 exec, vcc
    s_sleep 1
    s_xor_b32 s40, s59, 10240
    buffer_load_dwordx4 a[168:171], v6, s[16:19], s40 offen offset:0 sc1
    buffer_load_dwordx4 v[216:219], v7, s[16:19], s40 offen offset:0 sc1
    s_xor_b32 s40, s59, 10240
    buffer_load_dwordx4 a[172:175], v6, s[16:19], s40 offen offset:1024 sc1
    buffer_load_dwordx4 v[220:223], v7, s[16:19], s40 offen offset:1024 sc1
    s_xor_b32 s40, s59, 12288
    buffer_load_dwordx4 a[176:179], v6, s[16:19], s40 offen offset:0 sc1
    buffer_load_dwordx4 v[224:227], v7, s[16:19], s40 offen offset:0 sc1
    s_xor_b32 s40, s59, 12288
    buffer_load_dwordx4 a[180:183], v6, s[16:19], s40 offen offset:1024 sc1
    buffer_load_dwordx4 v[228:231], v7, s[16:19], s40 offen offset:1024 sc1
    s_xor_b32 s40, s59, 14336
    buffer_load_dwordx4 a[184:187], v6, s[16:19], s40 offen offset:0 sc1
    buffer_load_dwordx4 v[232:235], v7, s[16:19], s40 offen offset:0 sc1
    s_xor_b32 s40, s59, 14336
    buffer_load_dwordx4 a[188:191], v6, s[16:19], s40 offen offset:1024 sc1
    buffer_load_dwordx4 v[236:239], v7, s[16:19], s40 offen offset:1024 sc1
    s_add_u32 s47, s47, 1
    s_waitcnt vmcnt(0)
    v_accvgpr_read_b32 v12, a168
    v_max_u32 v12, v12, v216
    v_cmp_eq_u32 vcc, -1, v12
    s_cmp_eq_u64 vcc, 0
    s_cbranch_scc1 pk_c25_x
    s_cmp_lt_u32 s47, 0x2000
    s_cbranch_scc1 pk_c25_l
pk_c25_x:
    s_mov_b64 exec, -1
    s_nop 4
    s_branch pk_c25_r
pk_c26_s:
    s_nop 7
    s_nop 7
    s_mov_b32 s47, 0
pk_c26_l:
    s_mov_b64 exec, vcc
    s_sleep 1
    s_xor_b32 s40, s59, 10240
    buffer_load_dwordx4 a[172:175], v6, s[16:19], s40 offen offset:1024 sc1
    buffer_load_dwordx4 v[220:223], v7, s[16:19], s40 offen offset:1024 sc1
    s_xor_b32 s40, s59, 12288
    buffer_load_dwordx4 a[176:179], v6, s[16:19], s40 offen offset:0 sc1
    buffer_load_dwordx4 v[224:227], v7, s[16:19], s40 offen offset:0 sc1
    s_xor_b32 s40, s59, 12288
    buffer_load_dwordx4 a[180:183], v6, s[16:19], s40 offen offset:1024 sc1
    buffer_load_dwordx4 v[228:231], v7, s[16:19], s40 offen offset:1024 sc1
    s_xor_b32 s40, s59, 14336
    buffer_load_dwordx4 a[184:187], v6, s[16:19], s40 offen offset:0 sc1
    buffer_load_dwordx4 v[232:235], v7, s[16:19], s40 offen offset:0 sc1
    s_xor_b32 s40, s59, 14336
    buffer_load_dwordx4 a[188:191], v6, s[16:19], s40 offen offset:1024 sc1
    buffer_load_dwordx4 v[236:239], v7, s[16:19], s40 offen offset:1024 sc1
    s_add_u32 s47, s47, 1
    s_waitcnt vmcnt(0)
    v_accvgpr_read_b32 v12, a172
    v_max_u32 v12, v12, v220
    v_cmp_eq_u32 vcc, -1, v12
    s_cmp_eq_u64 vcc, 0
    s_cbranch_scc1 pk_c26_x
    s_cmp_lt_u32 s47, 0x2000
    s_cbranch_scc1 pk_c26_l
pk_c26_x:
    s_mov_b64 exec, -1
    s_nop 4
    s_branch pk_c26_r
pk_c27_s:
    s_nop 7
    s_nop 7
    s_mov_b32 s47, 0
pk_c27_l:
    s_mov_b64 exec, vcc
    s_sleep 1
    s_xor_b32 s40, s59, 12288
    buffer_load_dwordx4 a[176:179], v6, s[16:19], s40 offen offset:0 sc1
    buffer_load_dwordx4 v[224:227], v7, s[16:19], s40 offen offset:0 sc1
    s_xor_b32 s40, s59, 12288
    buffer_load_dwordx4 a[180:183], v6, s[16:19], s40 offen offset:1024 sc1
    buffer_load_dwordx4 v[228:231], v7, s[16:19], s40 offen offset:1024 sc1
    s_xor_b32 s40, s59, 14336
    buffer_load_dwordx4 a[184:187], v6, s[16:19], s40 offen offset:0 sc1
    buffer_load_dwordx4 v[232:235], v7, s[16:19], s40 offen offset:0 sc1
    s_xor_b32 s40, s59, 14336
    buffer_load_dwordx4 a[188:191], v6, s[16:19], s40 offen offset:1024 sc1
    buffer_load_dwordx4 v[236:239], v7, s[16:19], s40 offen offset:1024 sc1
    s_add_u32 s47, s47, 1
    s_waitcnt vmcnt(0)
    v_accvgpr_read_b32 v12, a176
    v_max_u32 v12, v12, v224
    v_cmp_eq_u32 vcc, -1, v12
    s_cmp_eq_u64 vcc, 0
    s_cbranch_scc1 pk_c27_x
    s_cmp_lt_u32 s47, 0x2000
    s_cbranch_scc1 pk_c27_l
pk_c27_x:
    s_mov_b64 exec, -1
    s_nop 4
    s_branch pk_c27_r
pk_c28_s:
    s_nop 7
    s_nop 7
    s_mov_b32 s47, 0
pk_c28_l:
    s_mov_b64 exec, vcc
    s_sleep 1
    s_xor_b32 s40, s59, 12288
    buffer_load_dwordx4 a[180:183], v6, s[16:19], s40 offen offset:1024 sc1
    buffer_load_dwordx4 v[228:231], v7, s[16:19], s40 offen offset:1024 sc1
    s_xor_b32 s40, s59, 14336
    buffer_load_dwordx4 a[184:187], v6, s[16:19], s40 offen offset:0 sc1
    buffer_load_dwordx4 v[232:235], v7, s[16:19], s40 offen offset:0 sc1
    s_xor_b32 s40, s59, 14336
    buffer_load_dwordx4 a[188:191], v6, s[16:19], s40 offen offset:1024 sc1
    buffer_load_dwordx4 v[236:239], v7, s[16:19], s40 offen offset:1024 sc1
    s_add_u32 s47, s47, 1
    s_waitcnt vmcnt(0)
    v_accvgpr_read_b32 v12, a180
    v_max_u32 v12, v12, v228
    v_cmp_eq_u32 vcc, -1, v12
    s_cmp_eq_u64 vcc, 0
    s_cbranch_scc1 pk_c28_x
    s_cmp_lt_u32 s47, 0x2000
    s_cbranch_scc1 pk_c28_l
pk_c28_x:
    s_mov_b64 exec, -1
    s_nop 4
    s_branch pk_c28_r
pk_c29_s:
    s_nop 7
    s_nop 7
    s_mov_b32 s47, 0
pk_c29_l:
    s_mov_b64 exec, vcc
    s_sleep 1
    s_xor_b32 s40, s59, 14336
    buffer_load_dwordx4 a[184:187], v6, s[16:19], s40 offen offset:0 sc1
    buffer_load_dwordx4 v[232:235], v7, s[16:19], s40 offen offset:0 sc1
    s_xor_b32 s40, s59, 14336
    buffer_load_dwordx4 a[188:191], v6, s[16:19], s40 offen offset:1024 sc1
    buffer_load_dwordx4 v[236:239], v7, s[16:19], s40 offen offset:1024 sc1
    s_add_u32 s47, s47, 1
    s_waitcnt vmcnt(0)
    v_accvgpr_read_b32 v12, a184
    v_max_u32 v12, v12, v232
    v_cmp_eq_u32 vcc, -1, v12
    s_cmp_eq_u64 vcc, 0
    s_cbranch_scc1 pk_c29_x
    s_cmp_lt_u32 s47, 0x2000
    s_cbranch_scc1 pk_c29_l
pk_c29_x:
    s_mov_b64 exec, -1
    s_nop 4
    s_branch pk_c29_r
pk_c30_s:
    s_nop 7
    s_nop 7
    s_mov_b32 s47, 0
pk_c30_l:
    s_mov_b64 exec, vcc
    s_sleep 1
    s_xor_b32 s40, s59, 14336
    buffer_load_dwordx4 a[188:191], v6, s[16:19], s40 offen offset:1024 sc1
    buffer_load_dwordx4 v[236:239], v7, s[16:19], s40 offen offset:1024 sc1
    s_add_u32 s47, s47, 1
    s_waitcnt vmcnt(0)
    v_accvgpr_read_b32 v12, a188
    v_max_u32 v12, v12, v236
    v_cmp_eq_u32 vcc, -1, v12
    s_cmp_eq_u64 vcc, 0
    s_cbranch_scc1 pk_c30_x
    s_cmp_lt_u32 s47, 0x2000
    s_cbranch_scc1 pk_c30_l
pk_c30_x:
    s_mov_b64 exec, -1
    s_nop 4
    s_branch pk_c30_r
pk_c31_s:
    s_nop 7
    s_nop 7
    s_mov_b32 s47, 0
pk_c31_l:
    s_mov_b64 exec, vcc
    s_sleep 1
    buffer_load_dwordx4 a[196:199], v6, s[16:19], s36 offen offset:1024 sc1
    buffer_load_dwordx4 v[244:247], v7, s[16:19], s36 offen offset:1024 sc1
    buffer_load_dwordx4 a[200:203], v6, s[16:19], s36 offen offset:2048 sc1
    buffer_load_dwordx4 v[248:251], v7, s[16:19], s36 offen offset:2048 sc1
    buffer_load_dwordx4 a[204:207], v6, s[16:19], s36 offen offset:3072 sc1
    buffer_load_dwordx4 v[252:255], v7, s[16:19], s36 offen offset:3072 sc1
    s_xor_b32 s40, s59, 0
    buffer_load_dwordx4 a[128:131], v6, s[16:19], s40 offen offset:0 sc1
    buffer_load_dwordx4 v[176:179], v7, s[16:19], s40 offen offset:0 sc1
    s_xor_b32 s40, s59, 0
    buffer_load_dwordx4 a[132:135], v6, s[16:19], s40 offen offset:1024 sc1
    buffer_load_dwordx4 v[180:183], v7, s[16:19], s40 offen offset:1024 sc1
    s_xor_b32 s40, s59, 2048
    buffer_load_dwordx4 a[136:139], v6, s[16:19], s40 offen offset:0 sc1
    buffer_load_dwordx4 v[184:187], v7, s[16:19], s40 offen offset:0 sc1
    s_add_u32 s47, s47, 1
    s_waitcnt vmcnt(0)
    v_accvgpr_read_b32 v12, a196
    v_max_u32 v12, v12, v244
    v_cmp_eq_u32 vcc, -1, v12
    s_cmp_eq_u64 vcc, 0
    s_cbranch_scc1 pk_c31_x
    s_cmp_lt_u32 s47, 0x2000
    s_cbranch_scc1 pk_c31_l
pk_c31_x:
    s_mov_b64 exec, -1
    s_nop 4
    s_branch pk_c31_r
pk_c32_s:
    s_nop 7
    s_nop 7
    s_mov_b32 s47, 0
pk_c32_l:
    s_mov_b64 exec, vcc
    s_sleep 1
    buffer_load_dwordx4 a[200:203], v6, s[16:19], s36 offen offset:2048 sc1
    buffer_load_dwordx4 v[248:251], v7, s[16:19], s36 offen offset:2048 sc1
    buffer_load_dwordx4 a[204:207], v6, s[16:19], s36 offen offset:3072 sc1
    buffer_load_dwordx4 v[252:255], v7, s[16:19], s36 offen offset:3072 sc1
    s_xor_b32 s40, s59, 0
    buffer_load_dwordx4 a[128:131], v6, s[16:19], s40 offen offset:0 sc1
    buffer_load_dwordx4 v[176:179], v7, s[16:19], s40 offen offset:0 sc1
    s_xor_b32 s40, s59, 0
    buffer_load_dwordx4 a[132:135], v6, s[16:19], s40 offen offset:1024 sc1
    buffer_load_dwordx4 v[180:183], v7, s[16:19], s40 offen offset:1024 sc1
    s_xor_b32 s40, s59, 2048
    buffer_load_dwordx4 a[136:139], v6, s[16:19], s40 offen offset:0 sc1
    buffer_load_dwordx4 v[184:187], v7, s[16:19], s40 offen offset:0 sc1
    s_xor_b32 s40, s59, 2048
    buffer_load_dwordx4 a[140:143], v6, s[16:19], s40 offen offset:1024 sc1
    buffer_load_dwordx4 v[188:191], v7, s[16:19], s40 offen offset:1024 sc1
    s_add_u32 s47, s47, 1
    s_waitcnt vmcnt(0)
    v_accvgpr_read_b32 v12, a200
    v_max_u32 v12, v12, v248
    v_cmp_eq_u32 vcc, -1, v12
    s_cmp_eq_u64 vcc, 0
    s_cbranch_scc1 pk_c32_x
    s_cmp_lt_u32 s47, 0x2000
    s_cbranch_scc1 pk_c32_l
pk_c32_x:
    s_mov_b64 exec, -1
    s_nop 4
    s_branch pk_c32_r
pk_c33_s:
    s_nop 7
    s_nop 7
    s_mov_b32 s47, 0
pk_c33_l:
    s_mov_b64 exec, vcc
    s_sleep 1
    buffer_load_dwordx4 a[204:207], v6, s[16:19], s36 offen offset:3072 sc1
    buffer_load_dwordx4 v[252:255], v7, s[16:19], s36 offen offset:3072 sc1
    s_xor_b32 s40, s59, 0
    buffer_load_dwordx4 a[128:131], v6, s[16:19], s40 offen offset:0 sc1
    buffer_load_dwordx4 v[176:179], v7, s[16:19], s40 offen offset:0 sc1
    s_xor_b32 s40, s59, 0
    buffer_load_dwordx4 a[132:135], v6, s[16:19], s40 offen offset:1024 sc1
    buffer_load_dwordx4 v[180:183], v7, s[16:19], s40 offen offset:1024 sc1
    s_xor_b32 s40, s59, 2048
    buffer_load_dwordx4 a[136:139], v6, s[16:19], s40 offen offset:0 sc1
    buffer_load_dwordx4 v[184:187], v7, s[16:19], s40 offen offset:0 sc1
    s_xor_b32 s40, s59, 2048
    buffer_load_dwordx4 a[140:143], v6, s[16:19], s40 offen offset:1024 sc1
    buffer_load_dwordx4 v[188:191], v7, s[16:19], s40 offen offset:1024 sc1
    s_xor_b32 s40, s59, 4096
    buffer_load_dwordx4 a[144:147], v6, s[16:19], s40 offen offset:0 sc1
    buffer_load_dwordx4 v[192:195], v7, s[16:19], s40 offen offset:0 sc1
    s_add_u32 s47, s47, 1
    s_waitcnt vmcnt(0)
    v_accvgpr_read_b32 v12, a204
    v_max_u32 v12, v12, v252
    v_cmp_eq_u32 vcc, -1, v12
    s_cmp_eq_u64 vcc, 0
    s_cbranch_scc1 pk_c33_x
    s_cmp_lt_u32 s47, 0x2000
    s_cbranch_scc1 pk_c33_l
pk_c33_x:
    s_mov_b64 exec, -1
    s_nop 4
    s_branch pk_c33_r
pk_c34_s:
    s_nop 7
    s_nop 7
    s_mov_b32 s47, 0
pk_c34_l:
    s_mov_b64 exec, vcc
    s_sleep 1
    s_xor_b32 s40, s59, 0
    buffer_load_dwordx4 a[128:131], v6, s[16:19], s40 offen offset:0 sc1
    buffer_load_dwordx4 v[176:179], v7, s[16:19], s40 offen offset:0 sc1
    s_xor_b32 s40, s59, 0
    buffer_load_dwordx4 a[132:135], v6, s[16:19], s40 offen offset:1024 sc1
    buffer_load_dwordx4 v[180:183], v7, s[16:19], s40 offen offset:1024 sc1
    s_xor_b32 s40, s59, 2048
    buffer_load_dwordx4 a[136:139], v6, s[16:19], s40 offen offset:0 sc1
    buffer_load_dwordx4 v[184:187], v7, s[16:19], s40 offen offset:0 sc1
    s_xor_b32 s40, s59, 2048
    buffer_load_dwordx4 a[140:143], v6, s[16:19], s40 offen offset:1024 sc1
    buffer_load_dwordx4 v[188:191], v7, s[16:19], s40 offen offset:1024 sc1
    s_xor_b32 s40, s59, 4096
    buffer_load_dwordx4 a[144:147], v6, s[16:19], s40 offen offset:0 sc1
    buffer_load_dwordx4 v[192:195], v7, s[16:19], s40 offen offset:0 sc1
    s_xor_b32 s40, s59, 4096
    buffer_load_dwordx4 a[148:151], v6, s[16:19], s40 offen offset:1024 sc1
    buffer_load_dwordx4 v[196:199], v7, s[16:19], s40 offen offset:1024 sc1
    s_add_u32 s47, s47, 1
    s_waitcnt vmcnt(0)
    v_accvgpr_read_b32 v12, a128
    v_max_u32 v12, v12, v176
    v_cmp_eq_u32 vcc, -1, v12
    s_cmp_eq_u64 vcc, 0
    s_cbranch_scc1 pk_c34_x
    s_cmp_lt_u32 s47, 0x2000
    s_cbranch_scc1 pk_c34_l
pk_c34_x:
    s_mov_b64 exec, -1
    s_nop 4
    s_branch pk_c34_r
pk_c35_s:
    s_nop 7
    s_nop 7
    s_mov_b32 s47, 0
pk_c35_l:
    s_mov_b64 exec, vcc
    s_sleep 1
    s_xor_b32 s40, s59, 0
    buffer_load_dwordx4 a[132:135], v6, s[16:19], s40 offen offset:1024 sc1
    buffer_load_dwordx4 v[180:183], v7, s[16:19], s40 offen offset:1024 sc1
    s_xor_b32 s40, s59, 2048
    buffer_load_dwordx4 a[136:139], v6, s[16:19], s40 offen offset:0 sc1
    buffer_load_dwordx4 v[184:187], v7, s[16:19], s40 offen offset:0 sc1
    s_xor_b32 s40, s59, 2048
    buffer_load_dwordx4 a[140:143], v6, s[16:19], s40 offen offset:1024 sc1
    buffer_load_dwordx4 v[188:191], v7, s[16:19], s40 offen offset:1024 sc1
    s_xor_b32 s40, s59, 4096
    buffer_load_dwordx4 a[144:147], v6, s[16:19], s40 offen offset:0 sc1
    buffer_load_dwordx4 v[192:195], v7, s[16:19], s40 offen offset:0 sc1
    s_xor_b32 s40, s59, 4096
    buffer_load_dwordx4 a[148:151], v6, s[16:19], s40 offen offset:1024 sc1
    buffer_load_dwordx4 v[196:199], v7, s[16:19], s40 offen offset:1024 sc1
    s_xor_b32 s40, s59, 6144
    buffer_load_dwordx4 a[152:155], v6, s[16:19], s40 offen offset:0 sc1
    buffer_load_dwordx4 v[200:203], v7, s[16:19], s40 offen offset:0 sc1
    s_add_u32 s47, s47, 1
    s_waitcnt vmcnt(0)
    v_accvgpr_read_b32 v12, a132
    v_max_u32 v12, v12, v180
    v_cmp_eq_u32 vcc, -1, v12
    s_cmp_eq_u64 vcc, 0
    s_cbranch_scc1 pk_c35_x
    s_cmp_lt_u32 s47, 0x2000
    s_cbranch_scc1 pk_c35_l
pk_c35_x:
    s_mov_b64 exec, -1
    s_nop 4
    s_branch pk_c35_r
pk_c36_s:
    s_nop 7
    s_nop 7
    s_mov_b32 s47, 0
pk_c36_l:
    s_mov_b64 exec, vcc
    s_sleep 1
    s_xor_b32 s40, s59, 2048
    buffer_load_dwordx4 a[136:139], v6, s[16:19], s40 offen offset:0 sc1
    buffer_load_dwordx4 v[184:187], v7, s[16:19], s40 offen offset:0 sc1
    s_xor_b32 s40, s59, 2048
    buffer_load_dwordx4 a[140:143], v6, s[16:19], s40 offen offset:1024 sc1
    buffer_load_dwordx4 v[188:191], v7, s[16:19], s40 offen offset:1024 sc1
    s_xor_b32 s40, s59, 4096
    buffer_load_dwordx4 a[144:147], v6, s[16:19], s40 offen offset:0 sc1
    buffer_load_dwordx4 v[192:195], v7, s[16:19], s40 offen offset:0 sc1
    s_xor_b32 s40, s59, 4096
    buffer_load_dwordx4 a[148:151], v6, s[16:19], s40 offen offset:1024 sc1
    buffer_load_dwordx4 v[196:199], v7, s[16:19], s40 offen offset:1024 sc1
    s_xor_b32 s40, s59, 6144
    buffer_load_dwordx4 a[152:155], v6, s[16:19], s40 offen offset:0 sc1
    buffer_load_dwordx4 v[200:203], v7, s[16:19], s40 offen offset:0 sc1
    s_xor_b32 s40, s59, 6144
    buffer_load_dwordx4 a[156:159], v6, s[16:19], s40 offen offset:1024 sc1
    buffer_load_dwordx4 v[204:207], v7, s[16:19], s40 offen offset:1024 sc1
    s_add_u32 s47, s47, 1
    s_waitcnt vmcnt(0)
    v_accvgpr_read_b32 v12, a136
    v_max_u32 v12, v12, v184
    v_cmp_eq_u32 vcc, -1, v12
    s_cmp_eq_u64 vcc, 0
    s_cbranch_scc1 pk_c36_x
    s_cmp_lt_u32 s47, 0x2000
    s_cbranch_scc1 pk_c36_l
pk_c36_x:
    s_mov_b64 exec, -1
    s_nop 4
    s_branch pk_c36_r
pk_c37_s:
    s_nop 7
    s_nop 7
    s_mov_b32 s47, 0
pk_c37_l:
    s_mov_b64 exec, vcc
    s_sleep 1
    s_xor_b32 s40, s59, 2048
    buffer_load_dwordx4 a[140:143], v6, s[16:19], s40 offen offset:1024 sc1
    buffer_load_dwordx4 v[188:191], v7, s[16:19], s40 offen offset:1024 sc1
    s_xor_b32 s40, s59, 4096
    buffer_load_dwordx4 a[144:147], v6, s[16:19], s40 offen offset:0 sc1
    buffer_load_dwordx4 v[192:195], v7, s[16:19], s40 offen offset:0 sc1
    s_xor_b32 s40, s59, 4096
    buffer_load_dwordx4 a[148:151], v6, s[16:19], s40 offen offset:1024 sc1
    buffer_load_dwordx4 v[196:199], v7, s[16:19], s40 offen offset:1024 sc1
    s_xor_b32 s40, s59, 6144
    buffer_load_dwordx4 a[152:155], v6, s[16:19], s40 offen offset:0 sc1
    buffer_load_dwordx4 v[200:203], v7, s[16:19], s40 offen offset:0 sc1
    s_xor_b32 s40, s59, 6144
    buffer_load_dwordx4 a[156:159], v6, s[16:19], s40 offen offset:1024 sc1
    buffer_load_dwordx4 v[204:207], v7, s[16:19], s40 offen offset:1024 sc1
    s_xor_b32 s40, s59, 8192
    buffer_load_dwordx4 a[160:163], v6, s[16:19], s40 offen offset:0 sc1
    buffer_load_dwordx4 v[208:211], v7, s[16:19], s40 offen offset:0 sc1
    s_add_u32 s47, s47, 1
    s_waitcnt vmcnt(0)
    v_accvgpr_read_b32 v12, a140
    v_max_u32 v12, v12, v188
    v_cmp_eq_u32 vcc, -1, v12
    s_cmp_eq_u64 vcc, 0
    s_cbranch_scc1 pk_c37_x
    s_cmp_lt_u32 s47, 0x2000
    s_cbranch_scc1 pk_c37_l
pk_c37_x:
    s_mov_b64 exec, -1
    s_nop 4
    s_branch pk_c37_r
pk_c38_s:
    s_nop 7
    s_nop 7
    s_mov_b32 s47, 0
pk_c38_l:
    s_mov_b64 exec, vcc
    s_sleep 1
    s_xor_b32 s40, s59, 4096
    buffer_load_dwordx4 a[144:147], v6, s[16:19], s40 offen offset:0 sc1
    buffer_load_dwordx4 v[192:195], v7, s[16:19], s40 offen offset:0 sc1
    s_xor_b32 s40, s59, 4096
    buffer_load_dwordx4 a[148:151], v6, s[16:19], s40 offen offset:1024 sc1
    buffer_load_dwordx4 v[196:199], v7, s[16:19], s40 offen offset:1024 sc1
    s_xor_b32 s40, s59, 6144
    buffer_load_dwordx4 a[152:155], v6, s[16:19], s40 offen offset:0 sc1
    buffer_load_dwordx4 v[200:203], v7, s[16:19], s40 offen offset:0 sc1
    s_xor_b32 s40, s59, 6144
    buffer_load_dwordx4 a[156:159], v6, s[16:19], s40 offen offset:1024 sc1
    buffer_load_dwordx4 v[204:207], v7, s[16:19], s40 offen offset:1024 sc1
    s_xor_b32 s40, s59, 8192
    buffer_load_dwordx4 a[160:163], v6, s[16:19], s40 offen offset:0 sc1
    buffer_load_dwordx4 v[208:211], v7, s[16:19], s40 offen offset:0 sc1
    s_xor_b32 s40, s59, 8192
    buffer_load_dwordx4 a[164:167], v6, s[16:19], s40 offen offset:1024 sc1
    buffer_load_dwordx4 v[212:215], v7, s[16:19], s40 offen offset:1024 sc1
    s_add_u32 s47, s47, 1
    s_waitcnt vmcnt(0)
    v_accvgpr_read_b32 v12, a144
    v_max_u32 v12, v12, v192
    v_cmp_eq_u32 vcc, -1, v12
    s_cmp_eq_u64 vcc, 0
    s_cbranch_scc1 pk_c38_x
    s_cmp_lt_u32 s47, 0x2000
    s_cbranch_scc1 pk_c38_l
pk_c38_x:
    s_mov_b64 exec, -1
    s_nop 4
    s_branch pk_c38_r
pk_c39_s:
    s_nop 7
    s_nop 7
    s_mov_b32 s47, 0
pk_c39_l:
    s_mov_b64 exec, vcc
    s_sleep 1
    s_xor_b32 s40, s59, 4096
    buffer_load_dwordx4 a[148:151], v6, s[16:19], s40 offen offset:1024 sc1
    buffer_load_dwordx4 v[196:199], v7, s[16:19], s40 offen offset:1024 sc1
    s_xor_b32 s40, s59, 6144
    buffer_load_dwordx4 a[152:155], v6, s[16:19], s40 offen offset:0 sc1
    buffer_load_dwordx4 v[200:203], v7, s[16:19], s40 offen offset:0 sc1
    s_xor_b32 s40, s59, 6144
    buffer_load_dwordx4 a[156:159], v6, s[16:19], s40 offen offset:1024 sc1
    buffer_load_dwordx4 v[204:207], v7, s[16:19], s40 offen offset:1024 sc1
    s_xor_b32 s40, s59, 8192
    buffer_load_dwordx4 a[160:163], v6, s[16:19], s40 offen offset:0 sc1
    buffer_load_dwordx4 v[208:211], v7, s[16:19], s40 offen offset:0 sc1
    s_xor_b32 s40, s59, 8192
    buffer_load_dwordx4 a[164:167], v6, s[16:19], s40 offen offset:1024 sc1
    buffer_load_dwordx4 v[212:215], v7, s[16:19], s40 offen offset:1024 sc1
    s_xor_b32 s40, s59, 10240
    buffer_load_dwordx4 a[168:171], v6, s[16:19], s40 offen offset:0 sc1
    buffer_load_dwordx4 v[216:219], v7, s[16:19], s40 offen offset:0 sc1
    s_add_u32 s47, s47, 1
    s_waitcnt vmcnt(0)
    v_accvgpr_read_b32 v12, a148
    v_max_u32 v12, v12, v196
    v_cmp_eq_u32 vcc, -1, v12
    s_cmp_eq_u64 vcc, 0
    s_cbranch_scc1 pk_c39_x
    s_cmp_lt_u32 s47, 0x2000
    s_cbranch_scc1 pk_c39_l
pk_c39_x:
    s_mov_b64 exec, -1
    s_nop 4
    s_branch pk_c39_r
pk_c40_s:
    s_nop 7
    s_nop 7
    s_mov_b32 s47, 0
pk_c40_l:
    s_mov_b64 exec, vcc
    s_sleep 1
    s_xor_b32 s40, s59, 6144
    buffer_load_dwordx4 a[152:155], v6, s[16:19], s40 offen offset:0 sc1
    buffer_load_dwordx4 v[200:203], v7, s[16:19], s40 offen offset:0 sc1
    s_xor_b32 s40, s59, 6144
    buffer_load_dwordx4 a[156:159], v6, s[16:19], s40 offen offset:1024 sc1
    buffer_load_dwordx4 v[204:207], v7, s[16:19], s40 offen offset:1024 sc1
    s_xor_b32 s40, s59, 8192
    buffer_load_dwordx4 a[160:163], v6, s[16:19], s40 offen offset:0 sc1
    buffer_load_dwordx4 v[208:211], v7, s[16:19], s40 offen offset:0 sc1
    s_xor_b32 s40, s59, 8192
    buffer_load_dwordx4 a[164:167], v6, s[16:19], s40 offen offset:1024 sc1
    buffer_load_dwordx4 v[212:215], v7, s[16:19], s40 offen offset:1024 sc1
    s_xor_b32 s40, s59, 10240
    buffer_load_dwordx4 a[168:171], v6, s[16:19], s40 offen offset:0 sc1
    buffer_load_dwordx4 v[216:219], v7, s[16:19], s40 offen offset:0 sc1
    s_xor_b32 s40, s59, 10240
    buffer_load_dwordx4 a[172:175], v6, s[16:19], s40 offen offset:1024 sc1
    buffer_load_dwordx4 v[220:223], v7, s[16:19], s40 offen offset:1024 sc1
    s_add_u32 s47, s47, 1
    s_waitcnt vmcnt(0)
    v_accvgpr_read_b32 v12, a152
    v_max_u32 v12, v12, v200
    v_cmp_eq_u32 vcc, -1, v12
    s_cmp_eq_u64 vcc, 0
    s_cbranch_scc1 pk_c40_x
    s_cmp_lt_u32 s47, 0x2000
    s_cbranch_scc1 pk_c40_l
pk_c40_x:
    s_mov_b64 exec, -1
    s_nop 4
    s_branch pk_c40_r
pk_c41_s:
    s_nop 7
    s_nop 7
    s_mov_b32 s47, 0
pk_c41_l:
    s_mov_b64 exec, vcc
    s_sleep 1
    s_xor_b32 s40, s59, 6144
    buffer_load_dwordx4 a[156:159], v6, s[16:19], s40 offen offset:1024 sc1
    buffer_load_dwordx4 v[204:207], v7, s[16:19], s40 offen offset:1024 sc1
    s_xor_b32 s40, s59, 8192
    buffer_load_dwordx4 a[160:163], v6, s[16:19], s40 offen offset:0 sc1
    buffer_load_dwordx4 v[208:211], v7, s[16:19], s40 offen offset:0 sc1
    s_xor_b32 s40, s59, 8192
    buffer_load_dwordx4 a[164:167], v6, s[16:19], s40 offen offset:1024 sc1
    buffer_load_dwordx4 v[212:215], v7, s[16:19], s40 offen offset:1024 sc1
    s_xor_b32 s40, s59, 10240
    buffer_load_dwordx4 a[168:171], v6, s[16:19], s40 offen offset:0 sc1
    buffer_load_dwordx4 v[216:219], v7, s[16:19], s40 offen offset:0 sc1
    s_xor_b32 s40, s59, 10240
    buffer_load_dwordx4 a[172:175], v6, s[16:19], s40 offen offset:1024 sc1
    buffer_load_dwordx4 v[220:223], v7, s[16:19], s40 offen offset:1024 sc1
    s_xor_b32 s40, s59, 12288
    buffer_load_dwordx4 a[176:179], v6, s[16:19], s40 offen offset:0 sc1
    buffer_load_dwordx4 v[224:227], v7, s[16:19], s40 offen offset:0 sc1
    s_add_u32 s47, s47, 1
    s_waitcnt vmcnt(0)
    v_accvgpr_read_b32 v12, a156
    v_max_u32 v12, v12, v204
    v_cmp_eq_u32 vcc, -1, v12
    s_cmp_eq_u64 vcc, 0
    s_cbranch_scc1 pk_c41_x
    s_cmp_lt_u32 s47, 0x2000
    s_cbranch_scc1 pk_c41_l
pk_c41_x:
    s_mov_b64 exec, -1
    s_nop 4
    s_branch pk_c41_r
pk_c42_s:
    s_nop 7
    s_nop 7
    s_mov_b32 s47, 0
pk_c42_l:
    s_mov_b64 exec, vcc
    s_sleep 1
    s_xor_b32 s40, s59, 8192
    buffer_load_dwordx4 a[160:163], v6, s[16:19], s40 offen offset:0 sc1
    buffer_load_dwordx4 v[208:211], v7, s[16:19], s40 offen offset:0 sc1
    s_xor_b32 s40, s59, 8192
    buffer_load_dwordx4 a[164:167], v6, s[16:19], s40 offen offset:1024 sc1
    buffer_load_dwordx4 v[212:215], v7, s[16:19], s40 offen offset:1024 sc1
    s_xor_b32 s40, s59, 10240
    buffer_load_dwordx4 a[168:171], v6, s[16:19], s40 offen offset:0 sc1
    buffer_load_dwordx4 v[216:219], v7, s[16:19], s40 offen offset:0 sc1
    s_xor_b32 s40, s59, 10240
    buffer_load_dwordx4 a[172:175], v6, s[16:19], s40 offen offset:1024 sc1
    buffer_load_dwordx4 v[220:223], v7, s[16:19], s40 offen offset:1024 sc1
    s_xor_b32 s40, s59, 12288
    buffer_load_dwordx4 a[176:179], v6, s[16:19], s40 offen offset:0 sc1
    buffer_load_dwordx4 v[224:227], v7, s[16:19], s40 offen offset:0 sc1
    s_xor_b32 s40, s59, 12288
    buffer_load_dwordx4 a[180:183], v6, s[16:19], s40 offen offset:1024 sc1
    buffer_load_dwordx4 v[228:231], v7, s[16:19], s40 offen offset:1024 sc1
    s_add_u32 s47, s47, 1
    s_waitcnt vmcnt(0)
    v_accvgpr_read_b32 v12, a160
    v_max_u32 v12, v12, v208
    v_cmp_eq_u32 vcc, -1, v12
    s_cmp_eq_u64 vcc, 0
    s_cbranch_scc1 pk_c42_x
    s_cmp_lt_u32 s47, 0x2000
    s_cbranch_scc1 pk_c42_l
pk_c42_x:
    s_mov_b64 exec, -1
    s_nop 4
    s_branch pk_c42_r
pk_c43_s:
    s_nop 7
    s_nop 7
    s_mov_b32 s47, 0
pk_c43_l:
    s_mov_b64 exec, vcc
    s_sleep 1
    s_xor_b32 s40, s59, 8192
    buffer_load_dwordx4 a[164:167], v6, s[16:19], s40 offen offset:1024 sc1
    buffer_load_dwordx4 v[212:215], v7, s[16:19], s40 offen offset:1024 sc1
    s_xor_b32 s40, s59, 10240
    buffer_load_dwordx4 a[168:171], v6, s[16:19], s40 offen offset:0 sc1
    buffer_load_dwordx4 v[216:219], v7, s[16:19], s40 offen offset:0 sc1
    s_xor_b32 s40, s59, 10240
    buffer_load_dwordx4 a[172:175], v6, s[16:19], s40 offen offset:1024 sc1
    buffer_load_dwordx4 v[220:223], v7, s[16:19], s40 offen offset:1024 sc1
    s_xor_b32 s40, s59, 12288
    buffer_load_dwordx4 a[176:179], v6, s[16:19], s40 offen offset:0 sc1
    buffer_load_dwordx4 v[224:227], v7, s[16:19], s40 offen offset:0 sc1
    s_xor_b32 s40, s59, 12288
    buffer_load_dwordx4 a[180:183], v6, s[16:19], s40 offen offset:1024 sc1
    buffer_load_dwordx4 v[228:231], v7, s[16:19], s40 offen offset:1024 sc1
    s_xor_b32 s40, s59, 14336
    buffer_load_dwordx4 a[184:187], v6, s[16:19], s40 offen offset:0 sc1
    buffer_load_dwordx4 v[232:235], v7, s[16:19], s40 offen offset:0 sc1
    s_add_u32 s47, s47, 1
    s_waitcnt vmcnt(0)
    v_accvgpr_read_b32 v12, a164
    v_max_u32 v12, v12, v212
    v_cmp_eq_u32 vcc, -1, v12
    s_cmp_eq_u64 vcc, 0
    s_cbranch_scc1 pk_c43_x
    s_cmp_lt_u32 s47, 0x2000
    s_cbranch_scc1 pk_c43_l
pk_c43_x:
    s_mov_b64 exec, -1
    s_nop 4
    s_branch pk_c43_r
pk_c44_s:
    s_nop 7
    s_nop 7
    s_mov_b32 s47, 0
pk_c44_l:
    s_mov_b64 exec, vcc
    s_sleep 1
    s_xor_b32 s40, s59, 10240
    buffer_load_dwordx4 a[168:171], v6, s[16:19], s40 offen offset:0 sc1
    buffer_load_dwordx4 v[216:219], v7, s[16:19], s40 offen offset:0 sc1
    s_xor_b32 s40, s59, 10240
    buffer_load_dwordx4 a[172:175], v6, s[16:19], s40 offen offset:1024 sc1
    buffer_load_dwordx4 v[220:223], v7, s[16:19], s40 offen offset:1024 sc1
    s_xor_b32 s40, s59, 12288
    buffer_load_dwordx4 a[176:179], v6, s[16:19], s40 offen offset:0 sc1
    buffer_load_dwordx4 v[224:227], v7, s[16:19], s40 offen offset:0 sc1
    s_xor_b32 s40, s59, 12288
    buffer_load_dwordx4 a[180:183], v6, s[16:19], s40 offen offset:1024 sc1
    buffer_load_dwordx4 v[228:231], v7, s[16:19], s40 offen offset:1024 sc1
    s_xor_b32 s40, s59, 14336
    buffer_load_dwordx4 a[184:187], v6, s[16:19], s40 offen offset:0 sc1
    buffer_load_dwordx4 v[232:235], v7, s[16:19], s40 offen offset:0 sc1
    s_xor_b32 s40, s59, 14336
    buffer_load_dwordx4 a[188:191], v6, s[16:19], s40 offen offset:1024 sc1
    buffer_load_dwordx4 v[236:239], v7, s[16:19], s40 offen offset:1024 sc1
    s_add_u32 s47, s47, 1
    s_waitcnt vmcnt(0)
    v_accvgpr_read_b32 v12, a168
    v_max_u32 v12, v12, v216
    v_cmp_eq_u32 vcc, -1, v12
    s_cmp_eq_u64 vcc, 0
    s_cbranch_scc1 pk_c44_x
    s_cmp_lt_u32 s47, 0x2000
    s_cbranch_scc1 pk_c44_l
pk_c44_x:
    s_mov_b64 exec, -1
    s_nop 4
    s_branch pk_c44_r
pk_c45_s:
    s_nop 7
    s_nop 7
    s_mov_b32 s47, 0
pk_c45_l:
    s_mov_b64 exec, vcc
    s_sleep 1
    s_xor_b32 s40, s59, 10240
    buffer_load_dwordx4 a[172:175], v6, s[16:19], s40 offen offset:1024 sc1
    buffer_load_dwordx4 v[220:223], v7, s[16:19], s40 offen offset:1024 sc1
    s_xor_b32 s40, s59, 12288
    buffer_load_dwordx4 a[176:179], v6, s[16:19], s40 offen offset:0 sc1
    buffer_load_dwordx4 v[224:227], v7, s[16:19], s40 offen offset:0 sc1
    s_xor_b32 s40, s59, 12288
    buffer_load_dwordx4 a[180:183], v6, s[16:19], s40 offen offset:1024 sc1
    buffer_load_dwordx4 v[228:231], v7, s[16:19], s40 offen offset:1024 sc1
    s_xor_b32 s40, s59, 14336
    buffer_load_dwordx4 a[184:187], v6, s[16:19], s40 offen offset:0 sc1
    buffer_load_dwordx4 v[232:235], v7, s[16:19], s40 offen offset:0 sc1
    s_xor_b32 s40, s59, 14336
    buffer_load_dwordx4 a[188:191], v6, s[16:19], s40 offen offset:1024 sc1
    buffer_load_dwordx4 v[236:239], v7, s[16:19], s40 offen offset:1024 sc1
    s_add_u32 s47, s47, 1
    s_waitcnt vmcnt(0)
    v_accvgpr_read_b32 v12, a172
    v_max_u32 v12, v12, v220
    v_cmp_eq_u32 vcc, -1, v12
    s_cmp_eq_u64 vcc, 0
    s_cbranch_scc1 pk_c45_x
    s_cmp_lt_u32 s47, 0x2000
    s_cbranch_scc1 pk_c45_l
pk_c45_x:
    s_mov_b64 exec, -1
    s_nop 4
    s_branch pk_c45_r
pk_c46_s:
    s_nop 7
    s_nop 7
    s_mov_b32 s47, 0
pk_c46_l:
    s_mov_b64 exec, vcc
    s_sleep 1
    s_xor_b32 s40, s59, 12288
    buffer_load_dwordx4 a[176:179], v6, s[16:19], s40 offen offset:0 sc1
    buffer_load_dwordx4 v[224:227], v7, s[16:19], s40 offen offset:0 sc1
    s_xor_b32 s40, s59, 12288
    buffer_load_dwordx4 a[180:183], v6, s[16:19], s40 offen offset:1024 sc1
    buffer_load_dwordx4 v[228:231], v7, s[16:19], s40 offen offset:1024 sc1
    s_xor_b32 s40, s59, 14336
    buffer_load_dwordx4 a[184:187], v6, s[16:19], s40 offen offset:0 sc1
    buffer_load_dwordx4 v[232:235], v7, s[16:19], s40 offen offset:0 sc1
    s_xor_b32 s40, s59, 14336
    buffer_load_dwordx4 a[188:191], v6, s[16:19], s40 offen offset:1024 sc1
    buffer_load_dwordx4 v[236:239], v7, s[16:19], s40 offen offset:1024 sc1
    s_add_u32 s47, s47, 1
    s_waitcnt vmcnt(0)
    v_accvgpr_read_b32 v12, a176
    v_max_u32 v12, v12, v224
    v_cmp_eq_u32 vcc, -1, v12
    s_cmp_eq_u64 vcc, 0
    s_cbranch_scc1 pk_c46_x
    s_cmp_lt_u32 s47, 0x2000
    s_cbranch_scc1 pk_c46_l
pk_c46_x:
    s_mov_b64 exec, -1
    s_nop 4
    s_branch pk_c46_r
pk_c47_s:
    s_nop 7
    s_nop 7
    s_mov_b32 s47, 0
pk_c47_l:
    s_mov_b64 exec, vcc
    s_sleep 1
    s_xor_b32 s40, s59, 12288
    buffer_load_dwordx4 a[180:183], v6, s[16:19], s40 offen offset:1024 sc1
    buffer_load_dwordx4 v[228:231], v7, s[16:19], s40 offen offset:1024 sc1
    s_xor_b32 s40, s59, 14336
    buffer_load_dwordx4 a[184:187], v6, s[16:19], s40 offen offset:0 sc1
    buffer_load_dwordx4 v[232:235], v7, s[16:19], s40 offen offset:0 sc1
    s_xor_b32 s40, s59, 14336
    buffer_load_dwordx4 a[188:191], v6, s[16:19], s40 offen offset:1024 sc1
    buffer_load_dwordx4 v[236:239], v7, s[16:19], s40 offen offset:1024 sc1
    s_add_u32 s47, s47, 1
    s_waitcnt vmcnt(0)
    v_accvgpr_read_b32 v12, a180
    v_max_u32 v12, v12, v228
    v_cmp_eq_u32 vcc, -1, v12
    s_cmp_eq_u64 vcc, 0
    s_cbranch_scc1 pk_c47_x
    s_cmp_lt_u32 s47, 0x2000
    s_cbranch_scc1 pk_c47_l
pk_c47_x:
    s_mov_b64 exec, -1
    s_nop 4
    s_branch pk_c47_r
pk_c48_s:
    s_nop 7
    s_nop 7
    s_mov_b32 s47, 0
pk_c48_l:
    s_mov_b64 exec, vcc
    s_sleep 1
    s_xor_b32 s40, s59, 14336
    buffer_load_dwordx4 a[184:187], v6, s[16:19], s40 offen offset:0 sc1
    buffer_load_dwordx4 v[232:235], v7, s[16:19], s40 offen offset:0 sc1
    s_xor_b32 s40, s59, 14336
    buffer_load_dwordx4 a[188:191], v6, s[16:19], s40 offen offset:1024 sc1
    buffer_load_dwordx4 v[236:239], v7, s[16:19], s40 offen offset:1024 sc1
    s_add_u32 s47, s47, 1
    s_waitcnt vmcnt(0)
    v_accvgpr_read_b32 v12, a184
    v_max_u32 v12, v12, v232
    v_cmp_eq_u32 vcc, -1, v12
    s_cmp_eq_u64 vcc, 0
    s_cbranch_scc1 pk_c48_x
    s_cmp_lt_u32 s47, 0x2000
    s_cbranch_scc1 pk_c48_l
pk_c48_x:
    s_mov_b64 exec, -1
    s_nop 4
    s_branch pk_c48_r
pk_c49_s:
    s_nop 7
    s_nop 7
    s_mov_b32 s47, 0
pk_c49_l:
    s_mov_b64 exec, vcc
    s_sleep 1
    s_xor_b32 s40, s59, 14336
    buffer_load_dwordx4 a[188:191], v6, s[16:19], s40 offen offset:1024 sc1
    buffer_load_dwordx4 v[236:239], v7, s[16:19], s40 offen offset:1024 sc1
    s_add_u32 s47, s47, 1
    s_waitcnt vmcnt(0)
    v_accvgpr_read_b32 v12, a188
    v_max_u32 v12, v12, v236
    v_cmp_eq_u32 vcc, -1, v12
    s_cmp_eq_u64 vcc, 0
    s_cbranch_scc1 pk_c49_x
    s_cmp_lt_u32 s47, 0x2000
    s_cbranch_scc1 pk_c49_l
pk_c49_x:
    s_mov_b64 exec, -1
    s_nop 4
    s_branch pk_c49_r
pk_w50_s:
    s_nop 7
    s_nop 7
    buffer_store_dwordx2 v[142:143], v10, s[16:19], s45 offen offset:2048 sc1
    buffer_store_dwordx2 v[144:145], v10, s[16:19], s45 offen offset:2560 sc1
    s_nop 4
    s_branch pk_w50_r
pk_w51_s:
    s_nop 7
    s_nop 7
    buffer_store_dwordx2 v[142:143], v10, s[16:19], s45 offen offset:3072 sc1
    buffer_store_dwordx2 v[144:145], v10, s[16:19], s45 offen offset:3584 sc1
    s_nop 4
    s_branch pk_w51_r
pk_c52_s:
    s_nop 7
    s_nop 7
    s_mov_b32 s47, 0
pk_c52_l:
    s_mov_b64 exec, vcc
    s_sleep 1
    buffer_load_dwordx4 a[196:199], v6, s[16:19], s36 offen offset:1024 sc1
    buffer_load_dwordx4 v[244:247], v7, s[16:19], s36 offen offset:1024 sc1
    buffer_load_dwordx4 a[200:203], v6, s[16:19], s36 offen offset:2048 sc1
    buffer_load_dwordx4 v[248:251], v7, s[16:19], s36 offen offset:2048 sc1
    buffer_load_dwordx4 a[204:207], v6, s[16:19], s36 offen offset:3072 sc1
    buffer_load_dwordx4 v[252:255], v7, s[16:19], s36 offen offset:3072 sc1
    s_xor_b32 s40, s59, 0
    buffer_load_dwordx4 a[128:131], v6, s[16:19], s40 offen offset:0 sc1
    buffer_load_dwordx4 v[176:179], v7, s[16:19], s40 offen offset:0 sc1
    s_xor_b32 s40, s59, 0
    buffer_load_dwordx4 a[132:135], v6, s[16:19], s40 offen offset:1024 sc1
    buffer_load_dwordx4 v[180:183], v7, s[16:19], s40 offen offset:1024 sc1
    s_xor_b32 s40, s59, 2048
    buffer_load_dwordx4 a[136:139], v6, s[16:19], s40 offen offset:0 sc1
    buffer_load_dwordx4 v[184:187], v7, s[16:19], s40 offen offset:0 sc1
    s_add_u32 s47, s47, 1
    s_waitcnt vmcnt(0)
    v_accvgpr_read_b32 v12, a196
    v_max_u32 v12, v12, v244
    v_cmp_eq_u32 vcc, -1, v12
    s_cmp_eq_u64 vcc, 0
    s_cbranch_scc1 pk_c52_x
    s_cmp_lt_u32 s47, 0x2000
    s_cbranch_scc1 pk_c52_l
pk_c52_x:
    s_mov_b64 exec, -1
    s_nop 4
    s_branch pk_c52_r
pk_c53_s:
    s_nop 7
    s_nop 7
    s_mov_b32 s47, 0
pk_c53_l:
    s_mov_b64 exec, vcc
    s_sleep 1
    buffer_load_dwordx4 a[200:203], v6, s[16:19], s36 offen offset:2048 sc1
    buffer_load_dwordx4 v[248:251], v7, s[16:19], s36 offen offset:2048 sc1
    buffer_load_dwordx4 a[204:207], v6, s[16:19], s36 offen offset:3072 sc1
    buffer_load_dwordx4 v[252:255], v7, s[16:19], s36 offen offset:3072 sc1
    s_xor_b32 s40, s59, 0
    buffer_load_dwordx4 a[128:131], v6, s[16:19], s40 offen offset:0 sc1
    buffer_load_dwordx4 v[176:179], v7, s[16:19], s40 offen offset:0 sc1
    s_xor_b32 s40, s59, 0
    buffer_load_dwordx4 a[132:135], v6, s[16:19], s40 offen offset:1024 sc1
    buffer_load_dwordx4 v[180:183], v7, s[16:19], s40 offen offset:1024 sc1
    s_xor_b32 s40, s59, 2048
    buffer_load_dwordx4 a[136:139], v6, s[16:19], s40 offen offset:0 sc1
    buffer_load_dwordx4 v[184:187], v7, s[16:19], s40 offen offset:0 sc1
    s_xor_b32 s40, s59, 2048
    buffer_load_dwordx4 a[140:143], v6, s[16:19], s40 offen offset:1024 sc1
    buffer_load_dwordx4 v[188:191], v7, s[16:19], s40 offen offset:1024 sc1
    s_add_u32 s47, s47, 1
    s_waitcnt vmcnt(0)
    v_accvgpr_read_b32 v12, a200
    v_max_u32 v12, v12, v248
    v_cmp_eq_u32 vcc, -1, v12
    s_cmp_eq_u64 vcc, 0
    s_cbranch_scc1 pk_c53_x
    s_cmp_lt_u32 s47, 0x2000
    s_cbranch_scc1 pk_c53_l
pk_c53_x:
    s_mov_b64 exec, -1
    s_nop 4
    s_branch pk_c53_r
pk_c54_s:
    s_nop 7
    s_nop 7
    s_mov_b32 s47, 0
pk_c54_l:
    s_mov_b64 exec, vcc
    s_sleep 1
    buffer_load_dwordx4 a[204:207], v6, s[16:19], s36 offen offset:3072 sc1
    buffer_load_dwordx4 v[252:255], v7, s[16:19], s36 offen offset:3072 sc1
    s_xor_b32 s40, s59, 0
    buffer_load_dwordx4 a[128:131], v6, s[16:19], s40 offen offset:0 sc1
    buffer_load_dwordx4 v[176:179], v7, s[16:19], s40 offen offset:0 sc1
    s_xor_b32 s40, s59, 0
    buffer_load_dwordx4 a[132:135], v6, s[16:19], s40 offen offset:1024 sc1
    buffer_load_dwordx4 v[180:183], v7, s[16:19], s40 offen offset:1024 sc1
    s_xor_b32 s40, s59, 2048
    buffer_load_dwordx4 a[136:139], v6, s[16:19], s40 offen offset:0 sc1
    buffer_load_dwordx4 v[184:187], v7, s[16:19], s40 offen offset:0 sc1
    s_xor_b32 s40, s59, 2048
    buffer_load_dwordx4 a[140:143], v6, s[16:19], s40 offen offset:1024 sc1
    buffer_load_dwordx4 v[188:191], v7, s[16:19], s40 offen offset:1024 sc1
    s_xor_b32 s40, s59, 4096
    buffer_load_dwordx4 a[144:147], v6, s[16:19], s40 offen offset:0 sc1
    buffer_load_dwordx4 v[192:195], v7, s[16:19], s40 offen offset:0 sc1
    s_add_u32 s47, s47, 1
    s_waitcnt vmcnt(0)
    v_accvgpr_read_b32 v12, a204
    v_max_u32 v12, v12, v252
    v_cmp_eq_u32 vcc, -1, v12
    s_cmp_eq_u64 vcc, 0
    s_cbranch_scc1 pk_c54_x
    s_cmp_lt_u32 s47, 0x2000
    s_cbranch_scc1 pk_c54_l
pk_c54_x:
    s_mov_b64 exec, -1
    s_nop 4
    s_branch pk_c54_r
pk_c55_s:
    s_nop 7
    s_nop 7
    s_mov_b32 s47, 0
pk_c55_l:
    s_mov_b64 exec, vcc
    s_sleep 1
    s_xor_b32 s40, s59, 0
    buffer_load_dwordx4 a[128:131], v6, s[16:19], s40 offen offset:0 sc1
    buffer_load_dwordx4 v[176:179], v7, s[16:19], s40 offen offset:0 sc1
    s_xor_b32 s40, s59, 0
    buffer_load_dwordx4 a[132:135], v6, s[16:19], s40 offen offset:1024 sc1
    buffer_load_dwordx4 v[180:183], v7, s[16:19], s40 offen offset:1024 sc1
    s_xor_b32 s40, s59, 2048
    buffer_load_dwordx4 a[136:139], v6, s[16:19], s40 offen offset:0 sc1
    buffer_load_dwordx4 v[184:187], v7, s[16:19], s40 offen offset:0 sc1
    s_xor_b32 s40, s59, 2048
    buffer_load_dwordx4 a[140:143], v6, s[16:19], s40 offen offset:1024 sc1
    buffer_load_dwordx4 v[188:191], v7, s[16:19], s40 offen offset:1024 sc1
    s_xor_b32 s40, s59, 4096
    buffer_load_dwordx4 a[144:147], v6, s[16:19], s40 offen offset:0 sc1
    buffer_load_dwordx4 v[192:195], v7, s[16:19], s40 offen offset:0 sc1
    s_xor_b32 s40, s59, 4096
    buffer_load_dwordx4 a[148:151], v6, s[16:19], s40 offen offset:1024 sc1
    buffer_load_dwordx4 v[196:199], v7, s[16:19], s40 offen offset:1024 sc1
    s_add_u32 s47, s47, 1
    s_waitcnt vmcnt(0)
    v_accvgpr_read_b32 v12, a128
    v_max_u32 v12, v12, v176
    v_cmp_eq_u32 vcc, -1, v12
    s_cmp_eq_u64 vcc, 0
    s_cbranch_scc1 pk_c55_x
    s_cmp_lt_u32 s47, 0x2000
    s_cbranch_scc1 pk_c55_l
pk_c55_x:
    s_mov_b64 exec, -1
    s_nop 4
    s_branch pk_c55_r
pk_c56_s:
    s_nop 7
    s_nop 7
    s_mov_b32 s47, 0
pk_c56_l:
    s_mov_b64 exec, vcc
    s_sleep 1
    s_xor_b32 s40, s59, 0
    buffer_load_dwordx4 a[132:135], v6, s[16:19], s40 offen offset:1024 sc1
    buffer_load_dwordx4 v[180:183], v7, s[16:19], s40 offen offset:1024 sc1
    s_xor_b32 s40, s59, 2048
    buffer_load_dwordx4 a[136:139], v6, s[16:19], s40 offen offset:0 sc1
    buffer_load_dwordx4 v[184:187], v7, s[16:19], s40 offen offset:0 sc1
    s_xor_b32 s40, s59, 2048
    buffer_load_dwordx4 a[140:143], v6, s[16:19], s40 offen offset:1024 sc1
    buffer_load_dwordx4 v[188:191], v7, s[16:19], s40 offen offset:1024 sc1
    s_xor_b32 s40, s59, 4096
    buffer_load_dwordx4 a[144:147], v6, s[16:19], s40 offen offset:0 sc1
    buffer_load_dwordx4 v[192:195], v7, s[16:19], s40 offen offset:0 sc1
    s_xor_b32 s40, s59, 4096
    buffer_load_dwordx4 a[148:151], v6, s[16:19], s40 offen offset:1024 sc1
    buffer_load_dwordx4 v[196:199], v7, s[16:19], s40 offen offset:1024 sc1
    s_xor_b32 s40, s59, 6144
    buffer_load_dwordx4 a[152:155], v6, s[16:19], s40 offen offset:0 sc1
    buffer_load_dwordx4 v[200:203], v7, s[16:19], s40 offen offset:0 sc1
    s_add_u32 s47, s47, 1
    s_waitcnt vmcnt(0)
    v_accvgpr_read_b32 v12, a132
    v_max_u32 v12, v12, v180
    v_cmp_eq_u32 vcc, -1, v12
    s_cmp_eq_u64 vcc, 0
    s_cbranch_scc1 pk_c56_x
    s_cmp_lt_u32 s47, 0x2000
    s_cbranch_scc1 pk_c56_l
pk_c56_x:
    s_mov_b64 exec, -1
    s_nop 4
    s_branch pk_c56_r
pk_c57_s:
    s_nop 7
    s_nop 7
    s_mov_b32 s47, 0
pk_c57_l:
    s_mov_b64 exec, vcc
    s_sleep 1
    s_xor_b32 s40, s59, 2048
    buffer_load_dwordx4 a[136:139], v6, s[16:19], s40 offen offset:0 sc1
    buffer_load_dwordx4 v[184:187], v7, s[16:19], s40 offen offset:0 sc1
    s_xor_b32 s40, s59, 2048
    buffer_load_dwordx4 a[140:143], v6, s[16:19], s40 offen offset:1024 sc1
    buffer_load_dwordx4 v[188:191], v7, s[16:19], s40 offen offset:1024 sc1
    s_xor_b32 s40, s59, 4096
    buffer_load_dwordx4 a[144:147], v6, s[16:19], s40 offen offset:0 sc1
    buffer_load_dwordx4 v[192:195], v7, s[16:19], s40 offen offset:0 sc1
    s_xor_b32 s40, s59, 4096
    buffer_load_dwordx4 a[148:151], v6, s[16:19], s40 offen offset:1024 sc1
    buffer_load_dwordx4 v[196:199], v7, s[16:19], s40 offen offset:1024 sc1
    s_xor_b32 s40, s59, 6144
    buffer_load_dwordx4 a[152:155], v6, s[16:19], s40 offen offset:0 sc1
    buffer_load_dwordx4 v[200:203], v7, s[16:19], s40 offen offset:0 sc1
    s_xor_b32 s40, s59, 6144
    buffer_load_dwordx4 a[156:159], v6, s[16:19], s40 offen offset:1024 sc1
    buffer_load_dwordx4 v[204:207], v7, s[16:19], s40 offen offset:1024 sc1
    s_add_u32 s47, s47, 1
    s_waitcnt vmcnt(0)
    v_accvgpr_read_b32 v12, a136
    v_max_u32 v12, v12, v184
    v_cmp_eq_u32 vcc, -1, v12
    s_cmp_eq_u64 vcc, 0
    s_cbranch_scc1 pk_c57_x
    s_cmp_lt_u32 s47, 0x2000
    s_cbranch_scc1 pk_c57_l
pk_c57_x:
    s_mov_b64 exec, -1
    s_nop 4
    s_branch pk_c57_r
pk_c58_s:
    s_nop 7
    s_nop 7
    s_mov_b32 s47, 0
pk_c58_l:
    s_mov_b64 exec, vcc
    s_sleep 1
    s_xor_b32 s40, s59, 2048
    buffer_load_dwordx4 a[140:143], v6, s[16:19], s40 offen offset:1024 sc1
    buffer_load_dwordx4 v[188:191], v7, s[16:19], s40 offen offset:1024 sc1
    s_xor_b32 s40, s59, 4096
    buffer_load_dwordx4 a[144:147], v6, s[16:19], s40 offen offset:0 sc1
    buffer_load_dwordx4 v[192:195], v7, s[16:19], s40 offen offset:0 sc1
    s_xor_b32 s40, s59, 4096
    buffer_load_dwordx4 a[148:151], v6, s[16:19], s40 offen offset:1024 sc1
    buffer_load_dwordx4 v[196:199], v7, s[16:19], s40 offen offset:1024 sc1
    s_xor_b32 s40, s59, 6144
    buffer_load_dwordx4 a[152:155], v6, s[16:19], s40 offen offset:0 sc1
    buffer_load_dwordx4 v[200:203], v7, s[16:19], s40 offen offset:0 sc1
    s_xor_b32 s40, s59, 6144
    buffer_load_dwordx4 a[156:159], v6, s[16:19], s40 offen offset:1024 sc1
    buffer_load_dwordx4 v[204:207], v7, s[16:19], s40 offen offset:1024 sc1
    s_xor_b32 s40, s59, 8192
    buffer_load_dwordx4 a[160:163], v6, s[16:19], s40 offen offset:0 sc1
    buffer_load_dwordx4 v[208:211], v7, s[16:19], s40 offen offset:0 sc1
    s_add_u32 s47, s47, 1
    s_waitcnt vmcnt(0)
    v_accvgpr_read_b32 v12, a140
    v_max_u32 v12, v12, v188
    v_cmp_eq_u32 vcc, -1, v12
    s_cmp_eq_u64 vcc, 0
    s_cbranch_scc1 pk_c58_x
    s_cmp_lt_u32 s47, 0x2000
    s_cbranch_scc1 pk_c58_l
pk_c58_x:
    s_mov_b64 exec, -1
    s_nop 4
    s_branch pk_c58_r
pk_c59_s:
    s_nop 7
    s_nop 7
    s_mov_b32 s47, 0
pk_c59_l:
    s_mov_b64 exec, vcc
    s_sleep 1
    s_xor_b32 s40, s59, 4096
    buffer_load_dwordx4 a[144:147], v6, s[16:19], s40 offen offset:0 sc1
    buffer_load_dwordx4 v[192:195], v7, s[16:19], s40 offen offset:0 sc1
    s_xor_b32 s40, s59, 4096
    buffer_load_dwordx4 a[148:151], v6, s[16:19], s40 offen offset:1024 sc1
    buffer_load_dwordx4 v[196:199], v7, s[16:19], s40 offen offset:1024 sc1
    s_xor_b32 s40, s59, 6144
    buffer_load_dwordx4 a[152:155], v6, s[16:19], s40 offen offset:0 sc1
    buffer_load_dwordx4 v[200:203], v7, s[16:19], s40 offen offset:0 sc1
    s_xor_b32 s40, s59, 6144
    buffer_load_dwordx4 a[156:159], v6, s[16:19], s40 offen offset:1024 sc1
    buffer_load_dwordx4 v[204:207], v7, s[16:19], s40 offen offset:1024 sc1
    s_xor_b32 s40, s59, 8192
    buffer_load_dwordx4 a[160:163], v6, s[16:19], s40 offen offset:0 sc1
    buffer_load_dwordx4 v[208:211], v7, s[16:19], s40 offen offset:0 sc1
    s_xor_b32 s40, s59, 8192
    buffer_load_dwordx4 a[164:167], v6, s[16:19], s40 offen offset:1024 sc1
    buffer_load_dwordx4 v[212:215], v7, s[16:19], s40 offen offset:1024 sc1
    s_add_u32 s47, s47, 1
    s_waitcnt vmcnt(0)
    v_accvgpr_read_b32 v12, a144
    v_max_u32 v12, v12, v192
    v_cmp_eq_u32 vcc, -1, v12
    s_cmp_eq_u64 vcc, 0
    s_cbranch_scc1 pk_c59_x
    s_cmp_lt_u32 s47, 0x2000
    s_cbranch_scc1 pk_c59_l
pk_c59_x:
    s_mov_b64 exec, -1
    s_nop 4
    s_branch pk_c59_r
pk_c60_s:
    s_nop 7
    s_nop 7
    s_mov_b32 s47, 0
pk_c60_l:
    s_mov_b64 exec, vcc
    s_sleep 1
    s_xor_b32 s40, s59, 4096
    buffer_load_dwordx4 a[148:151], v6, s[16:19], s40 offen offset:1024 sc1
    buffer_load_dwordx4 v[196:199], v7, s[16:19], s40 offen offset:1024 sc1
    s_xor_b32 s40, s59, 6144
    buffer_load_dwordx4 a[152:155], v6, s[16:19], s40 offen offset:0 sc1
    buffer_load_dwordx4 v[200:203], v7, s[16:19], s40 offen offset:0 sc1
    s_xor_b32 s40, s59, 6144
    buffer_load_dwordx4 a[156:159], v6, s[16:19], s40 offen offset:1024 sc1
    buffer_load_dwordx4 v[204:207], v7, s[16:19], s40 offen offset:1024 sc1
    s_xor_b32 s40, s59, 8192
    buffer_load_dwordx4 a[160:163], v6, s[16:19], s40 offen offset:0 sc1
    buffer_load_dwordx4 v[208:211], v7, s[16:19], s40 offen offset:0 sc1
    s_xor_b32 s40, s59, 8192
    buffer_load_dwordx4 a[164:167], v6, s[16:19], s40 offen offset:1024 sc1
    buffer_load_dwordx4 v[212:215], v7, s[16:19], s40 offen offset:1024 sc1
    s_xor_b32 s40, s59, 10240
    buffer_load_dwordx4 a[168:171], v6, s[16:19], s40 offen offset:0 sc1
    buffer_load_dwordx4 v[216:219], v7, s[16:19], s40 offen offset:0 sc1
    s_add_u32 s47, s47, 1
    s_waitcnt vmcnt(0)
    v_accvgpr_read_b32 v12, a148
    v_max_u32 v12, v12, v196
    v_cmp_eq_u32 vcc, -1, v12
    s_cmp_eq_u64 vcc, 0
    s_cbranch_scc1 pk_c60_x
    s_cmp_lt_u32 s47, 0x2000
    s_cbranch_scc1 pk_c60_l
pk_c60_x:
    s_mov_b64 exec, -1
    s_nop 4
    s_branch pk_c60_r
pk_c61_s:
    s_nop 7
    s_nop 7
    s_mov_b32 s47, 0
pk_c61_l:
    s_mov_b64 exec, vcc
    s_sleep 1
    s_xor_b32 s40, s59, 6144
    buffer_load_dwordx4 a[152:155], v6, s[16:19], s40 offen offset:0 sc1
    buffer_load_dwordx4 v[200:203], v7, s[16:19], s40 offen offset:0 sc1
    s_xor_b32 s40, s59, 6144
    buffer_load_dwordx4 a[156:159], v6, s[16:19], s40 offen offset:1024 sc1
    buffer_load_dwordx4 v[204:207], v7, s[16:19], s40 offen offset:1024 sc1
    s_xor_b32 s40, s59, 8192
    buffer_load_dwordx4 a[160:163], v6, s[16:19], s40 offen offset:0 sc1
    buffer_load_dwordx4 v[208:211], v7, s[16:19], s40 offen offset:0 sc1
    s_xor_b32 s40, s59, 8192
    buffer_load_dwordx4 a[164:167], v6, s[16:19], s40 offen offset:1024 sc1
    buffer_load_dwordx4 v[212:215], v7, s[16:19], s40 offen offset:1024 sc1
    s_xor_b32 s40, s59, 10240
    buffer_load_dwordx4 a[168:171], v6, s[16:19], s40 offen offset:0 sc1
    buffer_load_dwordx4 v[216:219], v7, s[16:19], s40 offen offset:0 sc1
    s_xor_b32 s40, s59, 10240
    buffer_load_dwordx4 a[172:175], v6, s[16:19], s40 offen offset:1024 sc1
    buffer_load_dwordx4 v[220:223], v7, s[16:19], s40 offen offset:1024 sc1
    s_add_u32 s47, s47, 1
    s_waitcnt vmcnt(0)
    v_accvgpr_read_b32 v12, a152
    v_max_u32 v12, v12, v200
    v_cmp_eq_u32 vcc, -1, v12
    s_cmp_eq_u64 vcc, 0
    s_cbranch_scc1 pk_c61_x
    s_cmp_lt_u32 s47, 0x2000
    s_cbranch_scc1 pk_c61_l
pk_c61_x:
    s_mov_b64 exec, -1
    s_nop 4
    s_branch pk_c61_r
pk_c62_s:
    s_nop 7
    s_nop 7
    s_mov_b32 s47, 0
pk_c62_l:
    s_mov_b64 exec, vcc
    s_sleep 1
    s_xor_b32 s40, s59, 6144
    buffer_load_dwordx4 a[156:159], v6, s[16:19], s40 offen offset:1024 sc1
    buffer_load_dwordx4 v[204:207], v7, s[16:19], s40 offen offset:1024 sc1
    s_xor_b32 s40, s59, 8192
    buffer_load_dwordx4 a[160:163], v6, s[16:19], s40 offen offset:0 sc1
    buffer_load_dwordx4 v[208:211], v7, s[16:19], s40 offen offset:0 sc1
    s_xor_b32 s40, s59, 8192
    buffer_load_dwordx4 a[164:167], v6, s[16:19], s40 offen offset:1024 sc1
    buffer_load_dwordx4 v[212:215], v7, s[16:19], s40 offen offset:1024 sc1
    s_xor_b32 s40, s59, 10240
    buffer_load_dwordx4 a[168:171], v6, s[16:19], s40 offen offset:0 sc1
    buffer_load_dwordx4 v[216:219], v7, s[16:19], s40 offen offset:0 sc1
    s_xor_b32 s40, s59, 10240
    buffer_load_dwordx4 a[172:175], v6, s[16:19], s40 offen offset:1024 sc1
    buffer_load_dwordx4 v[220:223], v7, s[16:19], s40 offen offset:1024 sc1
    s_xor_b32 s40, s59, 12288
    buffer_load_dwordx4 a[176:179], v6, s[16:19], s40 offen offset:0 sc1
    buffer_load_dwordx4 v[224:227], v7, s[16:19], s40 offen offset:0 sc1
    s_add_u32 s47, s47, 1
    s_waitcnt vmcnt(0)
    v_accvgpr_read_b32 v12, a156
    v_max_u32 v12, v12, v204
    v_cmp_eq_u32 vcc, -1, v12
    s_cmp_eq_u64 vcc, 0
    s_cbranch_scc1 pk_c62_x
    s_cmp_lt_u32 s47, 0x2000
    s_cbranch_scc1 pk_c62_l
pk_c62_x:
    s_mov_b64 exec, -1
    s_nop 4
    s_branch pk_c62_r
pk_c63_s:
    s_nop 7
    s_nop 7
    s_mov_b32 s47, 0
pk_c63_l:
    s_mov_b64 exec, vcc
    s_sleep 1
    s_xor_b32 s40, s59, 8192
    buffer_load_dwordx4 a[160:163], v6, s[16:19], s40 offen offset:0 sc1
    buffer_load_dwordx4 v[208:211], v7, s[16:19], s40 offen offset:0 sc1
    s_xor_b32 s40, s59, 8192
    buffer_load_dwordx4 a[164:167], v6, s[16:19], s40 offen offset:1024 sc1
    buffer_load_dwordx4 v[212:215], v7, s[16:19], s40 offen offset:1024 sc1
    s_xor_b32 s40, s59, 10240
    buffer_load_dwordx4 a[168:171], v6, s[16:19], s40 offen offset:0 sc1
    buffer_load_dwordx4 v[216:219], v7, s[16:19], s40 offen offset:0 sc1
    s_xor_b32 s40, s59, 10240
    buffer_load_dwordx4 a[172:175], v6, s[16:19], s40 offen offset:1024 sc1
    buffer_load_dwordx4 v[220:223], v7, s[16:19], s40 offen offset:1024 sc1
    s_xor_b32 s40, s59, 12288
    buffer_load_dwordx4 a[176:179], v6, s[16:19], s40 offen offset:0 sc1
    buffer_load_dwordx4 v[224:227], v7, s[16:19], s40 offen offset:0 sc1
    s_xor_b32 s40, s59, 12288
    buffer_load_dwordx4 a[180:183], v6, s[16:19], s40 offen offset:1024 sc1
    buffer_load_dwordx4 v[228:231], v7, s[16:19], s40 offen offset:1024 sc1
    s_add_u32 s47, s47, 1
    s_waitcnt vmcnt(0)
    v_accvgpr_read_b32 v12, a160
    v_max_u32 v12, v12, v208
    v_cmp_eq_u32 vcc, -1, v12
    s_cmp_eq_u64 vcc, 0
    s_cbranch_scc1 pk_c63_x
    s_cmp_lt_u32 s47, 0x2000
    s_cbranch_scc1 pk_c63_l
pk_c63_x:
    s_mov_b64 exec, -1
    s_nop 4
    s_branch pk_c63_r
pk_c64_s:
    s_nop 7
    s_nop 7
    s_mov_b32 s47, 0
pk_c64_l:
    s_mov_b64 exec, vcc
    s_sleep 1
    s_xor_b32 s40, s59, 8192
    buffer_load_dwordx4 a[164:167], v6, s[16:19], s40 offen offset:1024 sc1
    buffer_load_dwordx4 v[212:215], v7, s[16:19], s40 offen offset:1024 sc1
    s_xor_b32 s40, s59, 10240
    buffer_load_dwordx4 a[168:171], v6, s[16:19], s40 offen offset:0 sc1
    buffer_load_dwordx4 v[216:219], v7, s[16:19], s40 offen offset:0 sc1
    s_xor_b32 s40, s59, 10240
    buffer_load_dwordx4 a[172:175], v6, s[16:19], s40 offen offset:1024 sc1
    buffer_load_dwordx4 v[220:223], v7, s[16:19], s40 offen offset:1024 sc1
    s_xor_b32 s40, s59, 12288
    buffer_load_dwordx4 a[176:179], v6, s[16:19], s40 offen offset:0 sc1
    buffer_load_dwordx4 v[224:227], v7, s[16:19], s40 offen offset:0 sc1
    s_xor_b32 s40, s59, 12288
    buffer_load_dwordx4 a[180:183], v6, s[16:19], s40 offen offset:1024 sc1
    buffer_load_dwordx4 v[228:231], v7, s[16:19], s40 offen offset:1024 sc1
    s_xor_b32 s40, s59, 14336
    buffer_load_dwordx4 a[184:187], v6, s[16:19], s40 offen offset:0 sc1
    buffer_load_dwordx4 v[232:235], v7, s[16:19], s40 offen offset:0 sc1
    s_add_u32 s47, s47, 1
    s_waitcnt vmcnt(0)
    v_accvgpr_read_b32 v12, a164
    v_max_u32 v12, v12, v212
    v_cmp_eq_u32 vcc, -1, v12
    s_cmp_eq_u64 vcc, 0
    s_cbranch_scc1 pk_c64_x
    s_cmp_lt_u32 s47, 0x2000
    s_cbranch_scc1 pk_c64_l
pk_c64_x:
    s_mov_b64 exec, -1
    s_nop 4
    s_branch pk_c64_r
pk_c65_s:
    s_nop 7
    s_nop 7
    s_mov_b32 s47, 0
pk_c65_l:
    s_mov_b64 exec, vcc
    s_sleep 1
    s_xor_b32 s40, s59, 10240
    buffer_load_dwordx4 a[168:171], v6, s[16:19], s40 offen offset:0 sc1
    buffer_load_dwordx4 v[216:219], v7, s[16:19], s40 offen offset:0 sc1
    s_xor_b32 s40, s59, 10240
    buffer_load_dwordx4 a[172:175], v6, s[16:19], s40 offen offset:1024 sc1
    buffer_load_dwordx4 v[220:223], v7, s[16:19], s40 offen offset:1024 sc1
    s_xor_b32 s40, s59, 12288
    buffer_load_dwordx4 a[176:179], v6, s[16:19], s40 offen offset:0 sc1
    buffer_load_dwordx4 v[224:227], v7, s[16:19], s40 offen offset:0 sc1
    s_xor_b32 s40, s59, 12288
    buffer_load_dwordx4 a[180:183], v6, s[16:19], s40 offen offset:1024 sc1
    buffer_load_dwordx4 v[228:231], v7, s[16:19], s40 offen offset:1024 sc1
    s_xor_b32 s40, s59, 14336
    buffer_load_dwordx4 a[184:187], v6, s[16:19], s40 offen offset:0 sc1
    buffer_load_dwordx4 v[232:235], v7, s[16:19], s40 offen offset:0 sc1
    s_xor_b32 s40, s59, 14336
    buffer_load_dwordx4 a[188:191], v6, s[16:19], s40 offen offset:1024 sc1
    buffer_load_dwordx4 v[236:239], v7, s[16:19], s40 offen offset:1024 sc1
    s_add_u32 s47, s47, 1
    s_waitcnt vmcnt(0)
    v_accvgpr_read_b32 v12, a168
    v_max_u32 v12, v12, v216
    v_cmp_eq_u32 vcc, -1, v12
    s_cmp_eq_u64 vcc, 0
    s_cbranch_scc1 pk_c65_x
    s_cmp_lt_u32 s47, 0x2000
    s_cbranch_scc1 pk_c65_l
pk_c65_x:
    s_mov_b64 exec, -1
    s_nop 4
    s_branch pk_c65_r
pk_c66_s:
    s_nop 7
    s_nop 7
    s_mov_b32 s47, 0
pk_c66_l:
    s_mov_b64 exec, vcc
    s_sleep 1
    s_xor_b32 s40, s59, 10240
    buffer_load_dwordx4 a[172:175], v6, s[16:19], s40 offen offset:1024 sc1
    buffer_load_dwordx4 v[220:223], v7, s[16:19], s40 offen offset:1024 sc1
    s_xor_b32 s40, s59, 12288
    buffer_load_dwordx4 a[176:179], v6, s[16:19], s40 offen offset:0 sc1
    buffer_load_dwordx4 v[224:227], v7, s[16:19], s40 offen offset:0 sc1
    s_xor_b32 s40, s59, 12288
    buffer_load_dwordx4 a[180:183], v6, s[16:19], s40 offen offset:1024 sc1
    buffer_load_dwordx4 v[228:231], v7, s[16:19], s40 offen offset:1024 sc1
    s_xor_b32 s40, s59, 14336
    buffer_load_dwordx4 a[184:187], v6, s[16:19], s40 offen offset:0 sc1
    buffer_load_dwordx4 v[232:235], v7, s[16:19], s40 offen offset:0 sc1
    s_xor_b32 s40, s59, 14336
    buffer_load_dwordx4 a[188:191], v6, s[16:19], s40 offen offset:1024 sc1
    buffer_load_dwordx4 v[236:239], v7, s[16:19], s40 offen offset:1024 sc1
    s_add_u32 s47, s47, 1
    s_waitcnt vmcnt(0)
    v_accvgpr_read_b32 v12, a172
    v_max_u32 v12, v12, v220
    v_cmp_eq_u32 vcc, -1, v12
    s_cmp_eq_u64 vcc, 0
    s_cbranch_scc1 pk_c66_x
    s_cmp_lt_u32 s47, 0x2000
    s_cbranch_scc1 pk_c66_l
pk_c66_x:
    s_mov_b64 exec, -1
    s_nop 4
    s_branch pk_c66_r
pk_c67_s:
    s_nop 7
    s_nop 7
    s_mov_b32 s47, 0
pk_c67_l:
    s_mov_b64 exec, vcc
    s_sleep 1
    s_xor_b32 s40, s59, 12288
    buffer_load_dwordx4 a[176:179], v6, s[16:19], s40 offen offset:0 sc1
    buffer_load_dwordx4 v[224:227], v7, s[16:19], s40 offen offset:0 sc1
    s_xor_b32 s40, s59, 12288
    buffer_load_dwordx4 a[180:183], v6, s[16:19], s40 offen offset:1024 sc1
    buffer_load_dwordx4 v[228:231], v7, s[16:19], s40 offen offset:1024 sc1
    s_xor_b32 s40, s59, 14336
    buffer_load_dwordx4 a[184:187], v6, s[16:19], s40 offen offset:0 sc1
    buffer_load_dwordx4 v[232:235], v7, s[16:19], s40 offen offset:0 sc1
    s_xor_b32 s40, s59, 14336
    buffer_load_dwordx4 a[188:191], v6, s[16:19], s40 offen offset:1024 sc1
    buffer_load_dwordx4 v[236:239], v7, s[16:19], s40 offen offset:1024 sc1
    s_add_u32 s47, s47, 1
    s_waitcnt vmcnt(0)
    v_accvgpr_read_b32 v12, a176
    v_max_u32 v12, v12, v224
    v_cmp_eq_u32 vcc, -1, v12
    s_cmp_eq_u64 vcc, 0
    s_cbranch_scc1 pk_c67_x
    s_cmp_lt_u32 s47, 0x2000
    s_cbranch_scc1 pk_c67_l
pk_c67_x:
    s_mov_b64 exec, -1
    s_nop 4
    s_branch pk_c67_r
pk_c68_s:
    s_nop 7
    s_nop 7
    s_mov_b32 s47, 0
pk_c68_l:
    s_mov_b64 exec, vcc
    s_sleep 1
    s_xor_b32 s40, s59, 12288
    buffer_load_dwordx4 a[180:183], v6, s[16:19], s40 offen offset:1024 sc1
    buffer_load_dwordx4 v[228:231], v7, s[16:19], s40 offen offset:1024 sc1
    s_xor_b32 s40, s59, 14336
    buffer_load_dwordx4 a[184:187], v6, s[16:19], s40 offen offset:0 sc1
    buffer_load_dwordx4 v[232:235], v7, s[16:19], s40 offen offset:0 sc1
    s_xor_b32 s40, s59, 14336
    buffer_load_dwordx4 a[188:191], v6, s[16:19], s40 offen offset:1024 sc1
    buffer_load_dwordx4 v[236:239], v7, s[16:19], s40 offen offset:1024 sc1
    s_add_u32 s47, s47, 1
    s_waitcnt vmcnt(0)
    v_accvgpr_read_b32 v12, a180
    v_max_u32 v12, v12, v228
    v_cmp_eq_u32 vcc, -1, v12
    s_cmp_eq_u64 vcc, 0
    s_cbranch_scc1 pk_c68_x
    s_cmp_lt_u32 s47, 0x2000
    s_cbranch_scc1 pk_c68_l
pk_c68_x:
    s_mov_b64 exec, -1
    s_nop 4
    s_branch pk_c68_r
pk_c69_s:
    s_nop 7
    s_nop 7
    s_mov_b32 s47, 0
pk_c69_l:
    s_mov_b64 exec, vcc
    s_sleep 1
    s_xor_b32 s40, s59, 14336
    buffer_load_dwordx4 a[184:187], v6, s[16:19], s40 offen offset:0 sc1
    buffer_load_dwordx4 v[232:235], v7, s[16:19], s40 offen offset:0 sc1
    s_xor_b32 s40, s59, 14336
    buffer_load_dwordx4 a[188:191], v6, s[16:19], s40 offen offset:1024 sc1
    buffer_load_dwordx4 v[236:239], v7, s[16:19], s40 offen offset:1024 sc1
    s_add_u32 s47, s47, 1
    s_waitcnt vmcnt(0)
    v_accvgpr_read_b32 v12, a184
    v_max_u32 v12, v12, v232
    v_cmp_eq_u32 vcc, -1, v12
    s_cmp_eq_u64 vcc, 0
    s_cbranch_scc1 pk_c69_x
    s_cmp_lt_u32 s47, 0x2000
    s_cbranch_scc1 pk_c69_l
pk_c69_x:
    s_mov_b64 exec, -1
    s_nop 4
    s_branch pk_c69_r
pk_c70_s:
    s_nop 7
    s_nop 7
    s_mov_b32 s47, 0
pk_c70_l:
    s_mov_b64 exec, vcc
    s_sleep 1
    s_xor_b32 s40, s59, 14336
    buffer_load_dwordx4 a[188:191], v6, s[16:19], s40 offen offset:1024 sc1
    buffer_load_dwordx4 v[236:239], v7, s[16:19], s40 offen offset:1024 sc1
    s_add_u32 s47, s47, 1
    s_waitcnt vmcnt(0)
    v_accvgpr_read_b32 v12, a188
    v_max_u32 v12, v12, v236
    v_cmp_eq_u32 vcc, -1, v12
    s_cmp_eq_u64 vcc, 0
    s_cbranch_scc1 pk_c70_x
    s_cmp_lt_u32 s47, 0x2000
    s_cbranch_scc1 pk_c70_l
pk_c70_x:
    s_mov_b64 exec, -1
    s_nop 4
    s_branch pk_c70_r
pk_w71_s:
    s_nop 7
    s_nop 7
    buffer_store_dwordx2 v[142:143], v10, s[16:19], s45 offen offset:0 sc1
    buffer_store_dwordx2 v[144:145], v10, s[16:19], s45 offen offset:512 sc1
    s_nop 4
    s_branch pk_w71_r
pk_w72_s:
    s_nop 7
    s_nop 7
    buffer_store_dwordx2 v[142:143], v10, s[16:19], s45 offen offset:1024 sc1
    buffer_store_dwordx2 v[144:145], v10, s[16:19], s45 offen offset:1536 sc1
    s_nop 4
    s_branch pk_w72_r
pk_w73_s:
    s_nop 7
    s_nop 7
    buffer_store_dwordx2 v[142:143], v10, s[16:19], s45 offen offset:2048 sc1
    buffer_store_dwordx2 v[144:145], v10, s[16:19], s45 offen offset:2560 sc1
    s_nop 4
    s_branch pk_w73_r
pk_w74_s:
    s_nop 7
    s_nop 7
    buffer_store_dwordx2 v[142:143], v10, s[16:19], s45 offen offset:3072 sc1
    buffer_store_dwordx2 v[144:145], v10, s[16:19], s45 offen offset:3584 sc1
    s_nop 4
    s_branch pk_w74_r
.p2align 6
pk_wu2:
    s_branch pk_wur
pk_dn2:
    s_cmp_eq_u32 s42, 0
    s_cbranch_scc1 pk_dn0
    s_waitcnt lgkmcnt(15)
    v_mfma_f32_16x16x32_bf16 v[16:19], a[192:195], v[72:75], 0
    s_waitcnt vmcnt(8)
    v_accvgpr_read_b32 v12, a196
    v_mfma_f32_16x16x32_bf16 v[32:35], v[240:243], v[72:75], 0
    ds_read_b64_tr_b16 v[72:73], v8 offset:12672
    ds_read_b64_tr_b16 v[74:75], v8 offset:13184
    v_mfma_f32_16x16x32_bf16 v[20:23], a[192:195], v[76:79], 0
    v_max_u32 v12, v12, v244
    v_mfma_f32_16x16x32_bf16 v[36:39], v[240:243], v[76:79], 0
    ds_read_b64_tr_b16 v[76:77], v8 offset:12704
    ds_read_b64_tr_b16 v[78:79], v8 offset:13216
    v_mfma_f32_16x16x32_bf16 v[24:27], v[80:83], a[192:195], 0
    v_cmp_eq_u32 vcc, -1, v12
    v_mfma_f32_16x16x32_bf16 v[40:43], v[80:83], v[240:243], 0
    ds_read_b64_tr_b16 v[80:81], v8 offset:12736
    ds_read_b64_tr_b16 v[82:83], v8 offset:13248
    s_xor_b32 s40, s59, 2048
    buffer_load_dwordx4 a[136:139], v6, s[16:19], s40 offen offset:0 sc1
    v_mfma_f32_16x16x32_bf16 v[28:31], v[84:87], a[192:195], 0
    s_cbranch_vccnz pk_c31_s
pk_c31_r:
    v_mfma_f32_16x16x32_bf16 v[44:47], v[84:87], v[240:243], 0
    ds_read_b64_tr_b16 v[84:85], v8 offset:12768
    ds_read_b64_tr_b16 v[86:87], v8 offset:13280
    buffer_load_dwordx4 v[184:187], v7, s[16:19], s40 offen offset:0 sc1
    v_mfma_f32_16x16x32_bf16 v[16:19], a[196:199], v[88:91], v[16:19]
    s_waitcnt vmcnt(8)
    v_accvgpr_read_b32 v12, a200
    v_mfma_f32_16x16x32_bf16 v[32:35], v[244:247], v[88:91], v[32:35]
    ds_read_b64_tr_b16 v[88:89], v8 offset:16896
    ds_read_b64_tr_b16 v[90:91], v8 offset:17408
    v_mfma_f32_16x16x32_bf16 v[20:23], a[196:199], v[92:95], v[20:23]
    v_max_u32 v12, v12, v248
    v_mfma_f32_16x16x32_bf16 v[36:39], v[244:247], v[92:95], v[36:39]
    ds_read_b64_tr_b16 v[92:93], v8 offset:16928
    ds_read_b64_tr_b16 v[94:95], v8 offset:17440
    v_mfma_f32_16x16x32_bf16 v[24:27], v[96:99], a[196:199], v[24:27]
    v_cmp_eq_u32 vcc, -1, v12
    v_mfma_f32_16x16x32_bf16 v[40:43], v[96:99], v[244:247], v[40:43]
    ds_read_b64_tr_b16 v[96:97], v8 offset:16960
    ds_read_b64_tr_b16 v[98:99], v8 offset:17472
    s_xor_b32 s40, s59, 2048
    buffer_load_dwordx4 a[140:143], v6, s[16:19], s40 offen offset:1024 sc1
    v_mfma_f32_16x16x32_bf16 v[28:31], v[100:103], a[196:199], v[28:31]
    s_cbranch_vccnz pk_c32_s
pk_c32_r:
    v_mfma_f32_16x16x32_bf16 v[44:47], v[100:103], v[244:247], v[44:47]
    ds_read_b64_tr_b16 v[100:101], v8 offset:16992
    ds_read_b64_tr_b16 v[102:103], v8 offset:17504
    buffer_load_dwordx4 v[188:191], v7, s[16:19], s40 offen offset:1024 sc1
    v_mfma_f32_16x16x32_bf16 v[16:19], a[200:203], v[104:107], v[16:19]
    s_waitcnt vmcnt(8)
    v_accvgpr_read_b32 v12, a204
    v_mfma_f32_16x16x32_bf16 v[32:35], v[248:251], v[104:107], v[32:35]
    ds_read_b64_tr_b16 v[104:105], v8 offset:21120
    ds_read_b64_tr_b16 v[106:107], v8 offset:21632
    v_mfma_f32_16x16x32_bf16 v[20:23], a[200:203], v[108:111], v[20:23]
    v_max_u32 v12, v12, v252
    v_mfma_f32_16x16x32_bf16 v[36:39], v[248:251], v[108:111], v[36:39]
    ds_read_b64_tr_b16 v[108:109], v8 offset:21152
    ds_read_b64_tr_b16 v[110:111], v8 offset:21664
    v_mfma_f32_16x16x32_bf16 v[24:27], v[112:115], a[200:203], v[24:27]
    v_cmp_eq_u32 vcc, -1, v12
    v_mfma_f32_16x16x32_bf16 v[40:43], v[112:115], v[248:251], v[40:43]
    ds_read_b64_tr_b16 v[112:113], v8 offset:21184
    ds_read_b64_tr_b16 v[114:115], v8 offset:21696
    s_xor_b32 s40, s59, 4096
    buffer_load_dwordx4 a[144:147], v6, s[16:19], s40 offen offset:0 sc1
    v_mfma_f32_16x16x32_bf16 v[28:31], v[116:119], a[200:203], v[28:31]
    s_cbranch_vccnz pk_c33_s
pk_c33_r:
    v_mfma_f32_16x16x32_bf16 v[44:47], v[116:119], v[248:251], v[44:47]
    ds_read_b64_tr_b16 v[116:117], v8 offset:21216
    ds_read_b64_tr_b16 v[118:119], v8 offset:21728
    buffer_load_dwordx4 v[192:195], v7, s[16:19], s40 offen offset:0 sc1
    v_mfma_f32_16x16x32_bf16 v[16:19], a[204:207], v[120:123], v[16:19]
    s_waitcnt vmcnt(8)
    v_accvgpr_read_b32 v12, a128
    v_mfma_f32_16x16x32_bf16 v[32:35], v[252:255], v[120:123], v[32:35]
    ds_read_b64_tr_b16 v[120:121], v8 offset:25344
    ds_read_b64_tr_b16 v[122:123], v8 offset:25856
    v_mfma_f32_16x16x32_bf16 v[20:23], a[204:207], v[124:127], v[20:23]
    v_max_u32 v12, v12, v176
    v_mfma_f32_16x16x32_bf16 v[36:39], v[252:255], v[124:127], v[36:39]
    ds_read_b64_tr_b16 v[124:125], v8 offset:25376
    ds_read_b64_tr_b16 v[126:127], v8 offset:25888
    v_mfma_f32_16x16x32_bf16 v[24:27], v[128:131], a[204:207], v[24:27]
    v_cmp_eq_u32 vcc, -1, v12
    v_mfma_f32_16x16x32_bf16 v[40:43], v[128:131], v[252:255], v[40:43]
    ds_read_b64_tr_b16 v[128:129], v8 offset:25408
    ds_read_b64_tr_b16 v[130:131], v8 offset:25920
    s_xor_b32 s40, s59, 4096
    buffer_load_dwordx4 a[148:151], v6, s[16:19], s40 offen offset:1024 sc1
    v_mfma_f32_16x16x32_bf16 v[28:31], v[132:135], a[204:207], v[28:31]
    s_cbranch_vccnz pk_c34_s
pk_c34_r:
    v_mfma_f32_16x16x32_bf16 v[44:47], v[132:135], v[252:255], v[44:47]
    ds_read_b64_tr_b16 v[132:133], v8 offset:25440
    ds_read_b64_tr_b16 v[134:135], v8 offset:25952
    buffer_load_dwordx4 v[196:199], v7, s[16:19], s40 offen offset:1024 sc1
    v_mfma_f32_16x16x32_bf16 v[16:19], a[128:131], a[208:211], v[16:19]
    s_waitcnt vmcnt(8)
    v_accvgpr_read_b32 v12, a132
    v_mfma_f32_16x16x32_bf16 v[32:35], v[176:179], a[208:211], v[32:35]
    ds_read_b64_tr_b16 a[208:209], v8 offset:29568
    ds_read_b64_tr_b16 a[210:211], v8 offset:30080
    v_mfma_f32_16x16x32_bf16 v[20:23], a[128:131], a[212:215], v[20:23]
    v_max_u32 v12, v12, v180
    v_mfma_f32_16x16x32_bf16 v[36:39], v[176:179], a[212:215], v[36:39]
    ds_read_b64_tr_b16 a[212:213], v8 offset:29600
    ds_read_b64_tr_b16 a[214:215], v8 offset:30112
    v_mfma_f32_16x16x32_bf16 v[24:27], a[216:219], a[128:131], v[24:27]
    v_cmp_eq_u32 vcc, -1, v12
    v_mfma_f32_16x16x32_bf16 v[40:43], a[216:219], v[176:179], v[40:43]
    ds_read_b64_tr_b16 a[216:217], v8 offset:29632
    ds_read_b64_tr_b16 a[218:219], v8 offset:30144
    s_xor_b32 s40, s59, 6144
    buffer_load_dwordx4 a[152:155], v6, s[16:19], s40 offen offset:0 sc1
    v_mfma_f32_16x16x32_bf16 v[28:31], a[220:223], a[128:131], v[28:31]
    s_cbranch_vccnz pk_c35_s
pk_c35_r:
    v_mfma_f32_16x16x32_bf16 v[44:47], a[220:223], v[176:179], v[44:47]
    ds_read_b64_tr_b16 a[220:221], v8 offset:29664
    ds_read_b64_tr_b16 a[222:223], v8 offset:30176
    buffer_load_dwordx4 v[200:203], v7, s[16:19], s40 offen offset:0 sc1
    s_waitcnt lgkmcnt(15)
    v_mfma_f32_16x16x32_bf16 v[16:19], a[132:135], a[224:227], v[16:19]
    s_waitcnt vmcnt(8)
    v_accvgpr_read_b32 v12, a136
    v_mfma_f32_16x16x32_bf16 v[32:35], v[180:183], a[224:227], v[32:35]
    ds_read_b64_tr_b16 a[224:225], v8 offset:33792
    ds_read_b64_tr_b16 a[226:227], v8 offset:34304
    v_mfma_f32_16x16x32_bf16 v[20:23], a[132:135], a[228:231], v[20:23]
    v_max_u32 v12, v12, v184
    v_mfma_f32_16x16x32_bf16 v[36:39], v[180:183], a[228:231], v[36:39]
    ds_read_b64_tr_b16 a[228:229], v8 offset:33824
    ds_read_b64_tr_b16 a[230:231], v8 offset:34336
    v_mfma_f32_16x16x32_bf16 v[24:27], a[232:235], a[132:135], v[24:27]
    v_cmp_eq_u32 vcc, -1, v12
    v_mfma_f32_16x16x32_bf16 v[40:43], a[232:235], v[180:183], v[40:43]
    ds_read_b64_tr_b16 a[232:233], v8 offset:33856
    ds_read_b64_tr_b16 a[234:235], v8 offset:34368
    s_xor_b32 s40, s59, 6144
    buffer_load_dwordx4 a[156:159], v6, s[16:19], s40 offen offset:1024 sc1
    v_mfma_f32_16x16x32_bf16 v[28:31], a[236:239], a[132:135], v[28:31]
    s_cbranch_vccnz pk_c36_s
pk_c36_r:
    v_mfma_f32_16x16x32_bf16 v[44:47], a[236:239], v[180:183], v[44:47]
    ds_read_b64_tr_b16 a[236:237], v8 offset:33888
    ds_read_b64_tr_b16 a[238:239], v8 offset:34400
    buffer_load_dwordx4 v[204:207], v7, s[16:19], s40 offen offset:1024 sc1
    v_mfma_f32_16x16x32_bf16 v[16:19], a[136:139], a[240:243], v[16:19]
    s_waitcnt vmcnt(8)
    v_accvgpr_read_b32 v12, a140
    v_mfma_f32_16x16x32_bf16 v[32:35], v[184:187], a[240:243], v[32:35]
    ds_read_b64_tr_b16 a[240:241], v8 offset:38016
    ds_read_b64_tr_b16 a[242:243], v8 offset:38528
    v_mfma_f32_16x16x32_bf16 v[20:23], a[136:139], a[244:247], v[20:23]
    v_max_u32 v12, v12, v188
    v_mfma_f32_16x16x32_bf16 v[36:39], v[184:187], a[244:247], v[36:39]
    ds_read_b64_tr_b16 a[244:245], v8 offset:38048
    ds_read_b64_tr_b16 a[246:247], v8 offset:38560
    v_mfma_f32_16x16x32_bf16 v[24:27], a[248:251], a[136:139], v[24:27]
    v_cmp_eq_u32 vcc, -1, v12
    v_mfma_f32_16x16x32_bf16 v[40:43], a[248:251], v[184:187], v[40:43]
    ds_read_b64_tr_b16 a[248:249], v8 offset:38080
    ds_read_b64_tr_b16 a[250:251], v8 offset:38592
    s_xor_b32 s40, s59, 8192
    buffer_load_dwordx4 a[160:163], v6, s[16:19], s40 offen offset:0 sc1
    v_mfma_f32_16x16x32_bf16 v[28:31], a[252:255], a[136:139], v[28:31]
    s_cbranch_vccnz pk_c37_s
pk_c37_r:
    v_mfma_f32_16x16x32_bf16 v[44:47], a[252:255], v[184:187], v[44:47]
    ds_read_b64_tr_b16 a[252:253], v8 offset:38112
    ds_read_b64_tr_b16 a[254:255], v8 offset:38624
    buffer_load_dwordx4 v[208:211], v7, s[16:19], s40 offen offset:0 sc1
    v_mfma_f32_16x16x32_bf16 v[16:19], a[140:143], v[72:75], v[16:19]
    s_waitcnt vmcnt(8)
    v_accvgpr_read_b32 v12, a144
    v_mfma_f32_16x16x32_bf16 v[32:35], v[188:191], v[72:75], v[32:35]
    ds_read_b64_tr_b16 v[72:73], v9 offset:0
    ds_read_b64_tr_b16 v[74:75], v9 offset:512
    v_mfma_f32_16x16x32_bf16 v[20:23], a[140:143], v[76:79], v[20:23]
    v_max_u32 v12, v12, v192
    v_mfma_f32_16x16x32_bf16 v[36:39], v[188:191], v[76:79], v[36:39]
    ds_read_b64_tr_b16 v[76:77], v9 offset:32
    ds_read_b64_tr_b16 v[78:79], v9 offset:544
    v_mfma_f32_16x16x32_bf16 v[24:27], v[80:83], a[140:143], v[24:27]
    v_cmp_eq_u32 vcc, -1, v12
    v_mfma_f32_16x16x32_bf16 v[40:43], v[80:83], v[188:191], v[40:43]
    ds_read_b64_tr_b16 v[80:81], v9 offset:64
    ds_read_b64_tr_b16 v[82:83], v9 offset:576
    s_xor_b32 s40, s59, 8192
    buffer_load_dwordx4 a[164:167], v6, s[16:19], s40 offen offset:1024 sc1
    v_mfma_f32_16x16x32_bf16 v[28:31], v[84:87], a[140:143], v[28:31]
    s_cbranch_vccnz pk_c38_s
pk_c38_r:
    v_mfma_f32_16x16x32_bf16 v[44:47], v[84:87], v[188:191], v[44:47]
    ds_read_b64_tr_b16 v[84:85], v9 offset:96
    ds_read_b64_tr_b16 v[86:87], v9 offset:608
    buffer_load_dwordx4 v[212:215], v7, s[16:19], s40 offen offset:1024 sc1
    v_mfma_f32_16x16x32_bf16 v[16:19], a[144:147], v[88:91], v[16:19]
    s_waitcnt vmcnt(8)
    v_accvgpr_read_b32 v12, a148
    v_mfma_f32_16x16x32_bf16 v[32:35], v[192:195], v[88:91], v[32:35]
    ds_read_b64_tr_b16 v[88:89], v9 offset:4224
    ds_read_b64_tr_b16 v[90:91], v9 offset:4736
    v_mfma_f32_16x16x32_bf16 v[20:23], a[144:147], v[92:95], v[20:23]
    v_max_u32 v12, v12, v196
    v_mfma_f32_16x16x32_bf16 v[36:39], v[192:195], v[92:95], v[36:39]
    ds_read_b64_tr_b16 v[92:93], v9 offset:4256
    ds_read_b64_tr_b16 v[94:95], v9 offset:4768
    v_mfma_f32_16x16x32_bf16 v[24:27], v[96:99], a[144:147], v[24:27]
    v_cmp_eq_u32 vcc, -1, v12
    v_mfma_f32_16x16x32_bf16 v[40:43], v[96:99], v[192:195], v[40:43]
    ds_read_b64_tr_b16 v[96:97], v9 offset:4288
    ds_read_b64_tr_b16 v[98:99], v9 offset:4800
    s_xor_b32 s40, s59, 10240
    buffer_load_dwordx4 a[168:171], v6, s[16:19], s40 offen offset:0 sc1
    v_mfma_f32_16x16x32_bf16 v[28:31], v[100:103], a[144:147], v[28:31]
    s_cbranch_vccnz pk_c39_s
pk_c39_r:
    v_mfma_f32_16x16x32_bf16 v[44:47], v[100:103], v[192:195], v[44:47]
    ds_read_b64_tr_b16 v[100:101], v9 offset:4320
    ds_read_b64_tr_b16 v[102:103], v9 offset:4832
    buffer_load_dwordx4 v[216:219], v7, s[16:19], s40 offen offset:0 sc1
    v_mfma_f32_16x16x32_bf16 v[16:19], a[148:151], v[104:107], v[16:19]
    s_waitcnt vmcnt(8)
    v_accvgpr_read_b32 v12, a152
    v_mfma_f32_16x16x32_bf16 v[32:35], v[196:199], v[104:107], v[32:35]
    ds_read_b64_tr_b16 v[104:105], v9 offset:8448
    ds_read_b64_tr_b16 v[106:107], v9 offset:8960
    v_mfma_f32_16x16x32_bf16 v[20:23], a[148:151], v[108:111], v[20:23]
    v_max_u32 v12, v12, v200
    v_mfma_f32_16x16x32_bf16 v[36:39], v[196:199], v[108:111], v[36:39]
    ds_read_b64_tr_b16 v[108:109], v9 offset:8480
    ds_read_b64_tr_b16 v[110:111], v9 offset:8992
    v_mfma_f32_16x16x32_bf16 v[24:27], v[112:115], a[148:151], v[24:27]
    v_cmp_eq_u32 vcc, -1, v12
    v_mfma_f32_16x16x32_bf16 v[40:43], v[112:115], v[196:199], v[40:43]
    ds_read_b64_tr_b16 v[112:113], v9 offset:8512
    ds_read_b64_tr_b16 v[114:115], v9 offset:9024
    s_xor_b32 s40, s59, 10240
    buffer_load_dwordx4 a[172:175], v6, s[16:19], s40 offen offset:1024 sc1
    v_mfma_f32_16x16x32_bf16 v[28:31], v[116:119], a[148:151], v[28:31]
    s_cbranch_vccnz pk_c40_s
pk_c40_r:
    v_mfma_f32_16x16x32_bf16 v[44:47], v[116:119], v[196:199], v[44:47]
    ds_read_b64_tr_b16 v[116:117], v9 offset:8544
    ds_read_b64_tr_b16 v[118:119], v9 offset:9056
    buffer_load_dwordx4 v[220:223], v7, s[16:19], s40 offen offset:1024 sc1
    s_waitcnt lgkmcnt(15)
    v_mfma_f32_16x16x32_bf16 v[16:19], a[152:155], v[120:123], v[16:19]
    s_waitcnt vmcnt(8)
    v_accvgpr_read_b32 v12, a156
    v_mfma_f32_16x16x32_bf16 v[32:35], v[200:203], v[120:123], v[32:35]
    ds_read_b64_tr_b16 v[120:121], v9 offset:12672
    ds_read_b64_tr_b16 v[122:123], v9 offset:13184
    v_mfma_f32_16x16x32_bf16 v[20:23], a[152:155], v[124:127], v[20:23]
    v_max_u32 v12, v12, v204
    v_mfma_f32_16x16x32_bf16 v[36:39], v[200:203], v[124:127], v[36:39]
    ds_read_b64_tr_b16 v[124:125], v9 offset:12704
    ds_read_b64_tr_b16 v[126:127], v9 offset:13216
    v_mfma_f32_16x16x32_bf16 v[24:27], v[128:131], a[152:155], v[24:27]
    v_cmp_eq_u32 vcc, -1, v12
    v_mfma_f32_16x16x32_bf16 v[40:43], v[128:131], v[200:203], v[40:43]
    ds_read_b64_tr_b16 v[128:129], v9 offset:12736
    ds_read_b64_tr_b16 v[130:131], v9 offset:13248
    s_xor_b32 s40, s59, 12288
    buffer_load_dwordx4 a[176:179], v6, s[16:19], s40 offen offset:0 sc1
    v_mfma_f32_16x16x32_bf16 v[28:31], v[132:135], a[152:155], v[28:31]
    s_cbranch_vccnz pk_c41_s
pk_c41_r:
    v_mfma_f32_16x16x32_bf16 v[44:47], v[132:135], v[200:203], v[44:47]
    ds_read_b64_tr_b16 v[132:133], v9 offset:12768
    ds_read_b64_tr_b16 v[134:135], v9 offset:13280
    buffer_load_dwordx4 v[224:227], v7, s[16:19], s40 offen offset:0 sc1
    v_mfma_f32_16x16x32_bf16 v[16:19], a[156:159], a[208:211], v[16:19]
    s_waitcnt vmcnt(8)
    v_accvgpr_read_b32 v12, a160
    v_mfma_f32_16x16x32_bf16 v[32:35], v[204:207], a[208:211], v[32:35]
    ds_read_b64_tr_b16 a[208:209], v9 offset:16896
    ds_read_b64_tr_b16 a[210:211], v9 offset:17408
    v_mfma_f32_16x16x32_bf16 v[20:23], a[156:159], a[212:215], v[20:23]
    v_max_u32 v12, v12, v208
    v_mfma_f32_16x16x32_bf16 v[36:39], v[204:207], a[212:215], v[36:39]
    ds_read_b64_tr_b16 a[212:213], v9 offset:16928
    ds_read_b64_tr_b16 a[214:215], v9 offset:17440
    v_mfma_f32_16x16x32_bf16 v[24:27], a[216:219], a[156:159], v[24:27]
    v_cmp_eq_u32 vcc, -1, v12
    v_mfma_f32_16x16x32_bf16 v[40:43], a[216:219], v[204:207], v[40:43]
    ds_read_b64_tr_b16 a[216:217], v9 offset:16960
    ds_read_b64_tr_b16 a[218:219], v9 offset:17472
    s_xor_b32 s40, s59, 12288
    buffer_load_dwordx4 a[180:183], v6, s[16:19], s40 offen offset:1024 sc1
    v_mfma_f32_16x16x32_bf16 v[28:31], a[220:223], a[156:159], v[28:31]
    s_cbranch_vccnz pk_c42_s
pk_c42_r:
    v_mfma_f32_16x16x32_bf16 v[44:47], a[220:223], v[204:207], v[44:47]
    ds_read_b64_tr_b16 a[220:221], v9 offset:16992
    ds_read_b64_tr_b16 a[222:223], v9 offset:17504
    buffer_load_dwordx4 v[228:231], v7, s[16:19], s40 offen offset:1024 sc1
    v_mfma_f32_16x16x32_bf16 v[16:19], a[160:163], a[224:227], v[16:19]
    s_waitcnt vmcnt(8)
    v_accvgpr_read_b32 v12, a164
    v_mfma_f32_16x16x32_bf16 v[32:35], v[208:211], a[224:227], v[32:35]
    ds_read_b64_tr_b16 a[224:225], v9 offset:21120
    ds_read_b64_tr_b16 a[226:227], v9 offset:21632
    v_mfma_f32_16x16x32_bf16 v[20:23], a[160:163], a[228:231], v[20:23]
    v_max_u32 v12, v12, v212
    v_mfma_f32_16x16x32_bf16 v[36:39], v[208:211], a[228:231], v[36:39]
    ds_read_b64_tr_b16 a[228:229], v9 offset:21152
    ds_read_b64_tr_b16 a[230:231], v9 offset:21664
    v_mfma_f32_16x16x32_bf16 v[24:27], a[232:235], a[160:163], v[24:27]
    v_cmp_eq_u32 vcc, -1, v12
    v_mfma_f32_16x16x32_bf16 v[40:43], a[232:235], v[208:211], v[40:43]
    ds_read_b64_tr_b16 a[232:233], v9 offset:21184
    ds_read_b64_tr_b16 a[234:235], v9 offset:21696
    s_xor_b32 s40, s59, 14336
    buffer_load_dwordx4 a[184:187], v6, s[16:19], s40 offen offset:0 sc1
    v_mfma_f32_16x16x32_bf16 v[28:31], a[236:239], a[160:163], v[28:31]
    s_cbranch_vccnz pk_c43_s
pk_c43_r:
    v_mfma_f32_16x16x32_bf16 v[44:47], a[236:239], v[208:211], v[44:47]
    ds_read_b64_tr_b16 a[236:237], v9 offset:21216
    ds_read_b64_tr_b16 a[238:239], v9 offset:21728
    buffer_load_dwordx4 v[232:235], v7, s[16:19], s40 offen offset:0 sc1
    v_mfma_f32_16x16x32_bf16 v[16:19], a[164:167], a[240:243], v[16:19]
    s_waitcnt vmcnt(8)
    v_accvgpr_read_b32 v12, a168
    v_mfma_f32_16x16x32_bf16 v[32:35], v[212:215], a[240:243], v[32:35]
    v_mfma_f32_16x16x32_bf16 v[20:23], a[164:167], a[244:247], v[20:23]
    v_max_u32 v12, v12, v216
    v_mfma_f32_16x16x32_bf16 v[36:39], v[212:215], a[244:247], v[36:39]
    v_mfma_f32_16x16x32_bf16 v[24:27], a[248:251], a[164:167], v[24:27]
    v_cmp_eq_u32 vcc, -1, v12
    v_mfma_f32_16x16x32_bf16 v[40:43], a[248:251], v[212:215], v[40:43]
    s_xor_b32 s40, s59, 14336
    buffer_load_dwordx4 a[188:191], v6, s[16:19], s40 offen offset:1024 sc1
    v_mfma_f32_16x16x32_bf16 v[28:31], a[252:255], a[164:167], v[28:31]
    s_cbranch_vccnz pk_c44_s
pk_c44_r:
    v_mfma_f32_16x16x32_bf16 v[44:47], a[252:255], v[212:215], v[44:47]
    buffer_load_dwordx4 v[236:239], v7, s[16:19], s40 offen offset:1024 sc1
    v_mfma_f32_16x16x32_bf16 v[16:19], a[168:171], v[72:75], v[16:19]
    s_waitcnt vmcnt(8)
    v_accvgpr_read_b32 v12, a172
    v_mfma_f32_16x16x32_bf16 v[32:35], v[216:219], v[72:75], v[32:35]
    v_mfma_f32_16x16x32_bf16 v[20:23], a[168:171], v[76:79], v[20:23]
    v_max_u32 v12, v12, v220
    v_mfma_f32_16x16x32_bf16 v[36:39], v[216:219], v[76:79], v[36:39]
    v_mfma_f32_16x16x32_bf16 v[24:27], v[80:83], a[168:171], v[24:27]
    v_cmp_eq_u32 vcc, -1, v12
    v_mfma_f32_16x16x32_bf16 v[40:43], v[80:83], v[216:219], v[40:43]
    s_andn2_b32 s45, 7, s2
    s_lshl_b32 s45, s45, 5
    s_lshr_b32 s46, s2, 3
    s_add_u32 s45, s45, s46
    s_lshl_b32 s45, s45, 2
    s_add_u32 s45, s45, s32
    s_lshl_b32 s45, s45, 13
    s_mov_b32 s46, 8
    s_bitcmp1_b32 s46, s32
    s_cselect_b32 s45, s45, 0x7f000000
    v_lshlrev_b32 v10, 7, v1
    v_add_u32 v10, s45, v10
    buffer_load_dword v13, v10, s[24:27], 0 offen
    v_mfma_f32_16x16x32_bf16 v[28:31], v[84:87], a[168:171], v[28:31]
    s_cbranch_vccnz pk_c45_s
pk_c45_r:
    v_mfma_f32_16x16x32_bf16 v[44:47], v[84:87], v[216:219], v[44:47]
    buffer_store_dwordx4 v[146:149], v3, s[16:19], s44 offen offset:0 sc1
    s_waitcnt lgkmcnt(15)
    v_mfma_f32_16x16x32_bf16 v[16:19], a[172:175], v[88:91], v[16:19]
    s_waitcnt vmcnt(8)
    v_accvgpr_read_b32 v12, a176
    v_mfma_f32_16x16x32_bf16 v[32:35], v[220:223], v[88:91], v[32:35]
    v_mfma_f32_16x16x32_bf16 v[20:23], a[172:175], v[92:95], v[20:23]
    v_max_u32 v12, v12, v224
    v_mfma_f32_16x16x32_bf16 v[36:39], v[220:223], v[92:95], v[36:39]
    v_mfma_f32_16x16x32_bf16 v[24:27], v[96:99], a[172:175], v[24:27]
    v_cmp_eq_u32 vcc, -1, v12
    v_mfma_f32_16x16x32_bf16 v[40:43], v[96:99], v[220:223], v[40:43]
    buffer_store_dwordx4 v[146:149], v3, s[16:19], s44 offen offset:1024 sc1
    v_mfma_f32_16x16x32_bf16 v[28:31], v[100:103], a[172:175], v[28:31]
    s_cbranch_vccnz pk_c46_s
pk_c46_r:
    v_mfma_f32_16x16x32_bf16 v[44:47], v[100:103], v[220:223], v[44:47]
    buffer_store_dwordx4 v[146:149], v3, s[16:19], s44 offen offset:2048 sc1
    v_mfma_f32_16x16x32_bf16 v[16:19], a[176:179], v[104:107], v[16:19]
    s_waitcnt vmcnt(8)
    v_accvgpr_read_b32 v12, a180
    v_mfma_f32_16x16x32_bf16 v[32:35], v[224:227], v[104:107], v[32:35]
    v_mfma_f32_16x16x32_bf16 v[20:23], a[176:179], v[108:111], v[20:23]
    v_max_u32 v12, v12, v228
    v_mfma_f32_16x16x32_bf16 v[36:39], v[224:227], v[108:111], v[36:39]
    v_mfma_f32_16x16x32_bf16 v[24:27], v[112:115], a[176:179], v[24:27]
    v_cmp_eq_u32 vcc, -1, v12
    v_mfma_f32_16x16x32_bf16 v[40:43], v[112:115], v[224:227], v[40:43]
    buffer_store_dwordx4 v[146:149], v3, s[16:19], s44 offen offset:2432 sc1
    v_mfma_f32_16x16x32_bf16 v[28:31], v[116:119], a[176:179], v[28:31]
    s_cbranch_vccnz pk_c47_s
pk_c47_r:
    v_mfma_f32_16x16x32_bf16 v[44:47], v[116:119], v[224:227], v[44:47]
    v_mfma_f32_16x16x32_bf16 v[16:19], a[180:183], v[120:123], v[16:19]
    s_waitcnt vmcnt(7)
    v_accvgpr_read_b32 v12, a184
    v_mfma_f32_16x16x32_bf16 v[32:35], v[228:231], v[120:123], v[32:35]
    v_mfma_f32_16x16x32_bf16 v[20:23], a[180:183], v[124:127], v[20:23]
    v_max_u32 v12, v12, v232
    v_mfma_f32_16x16x32_bf16 v[36:39], v[228:231], v[124:127], v[36:39]
    v_mfma_f32_16x16x32_bf16 v[24:27], v[128:131], a[180:183], v[24:27]
    v_cmp_eq_u32 vcc, -1, v12
    v_mfma_f32_16x16x32_bf16 v[40:43], v[128:131], v[228:231], v[40:43]
    v_mfma_f32_16x16x32_bf16 v[28:31], v[132:135], a[180:183], v[28:31]
    s_cbranch_vccnz pk_c48_s
pk_c48_r:
    v_mfma_f32_16x16x32_bf16 v[44:47], v[132:135], v[228:231], v[44:47]
    s_waitcnt lgkmcnt(8)
    v_mfma_f32_16x16x32_bf16 v[16:19], a[184:187], a[208:211], v[16:19]
    s_waitcnt vmcnt(5)
    v_accvgpr_read_b32 v12, a188
    v_mfma_f32_16x16x32_bf16 v[32:35], v[232:235], a[208:211], v[32:35]
    v_mfma_f32_16x16x32_bf16 v[20:23], a[184:187], a[212:215], v[20:23]
    v_max_u32 v12, v12, v236
    v_mfma_f32_16x16x32_bf16 v[36:39], v[232:235], a[212:215], v[36:39]
    v_mfma_f32_16x16x32_bf16 v[24:27], a[216:219], a[184:187], v[24:27]
    v_cmp_eq_u32 vcc, -1, v12
    v_mfma_f32_16x16x32_bf16 v[40:43], a[216:219], v[232:235], v[40:43]
    v_mfma_f32_16x16x32_bf16 v[28:31], a[220:223], a[184:187], v[28:31]
    s_cbranch_vccnz pk_c49_s
pk_c49_r:
    v_mfma_f32_16x16x32_bf16 v[44:47], a[220:223], v[232:235], v[44:47]
    s_waitcnt lgkmcnt(0)
    v_mfma_f32_16x16x32_bf16 v[16:19], a[188:191], a[224:227], v[16:19]
    v_mfma_f32_16x16x32_bf16 v[32:35], v[236:239], a[224:227], v[32:35]
    v_mfma_f32_16x16x32_bf16 v[20:23], a[188:191], a[228:231], v[20:23]
    v_mfma_f32_16x16x32_bf16 v[36:39], v[236:239], a[228:231], v[36:39]
    v_mfma_f32_16x16x32_bf16 v[24:27], a[232:235], a[188:191], v[24:27]
    v_mfma_f32_16x16x32_bf16 v[40:43], a[232:235], v[236:239], v[40:43]
    v_mfma_f32_16x16x32_bf16 v[28:31], a[236:239], a[188:191], v[28:31]
    v_mfma_f32_16x16x32_bf16 v[44:47], a[236:239], v[236:239], v[44:47]
    s_bfe_u32 s45, s69, 0x80008
    s_lshl_b32 s45, s45, 10
    s_add_u32 s45, s45, s43
    s_barrier
    ds_read_b64_tr_b16 v[72:73], v14 offset:0
    ds_read_b64_tr_b16 v[74:75], v14 offset:1536
    ds_read_b64_tr_b16 v[76:77], v14 offset:32
    ds_read_b64_tr_b16 v[78:79], v14 offset:1568
    ds_read_b64_tr_b16 v[80:81], v14 offset:64
    ds_read_b64_tr_b16 v[82:83], v14 offset:1600
    v_cvt_pk_bf16_f32 v168, v16, v17
    v_cvt_pk_bf16_f32 v170, v18, v19
    v_cvt_pk_bf16_f32 v172, v32, v33
    v_cvt_pk_bf16_f32 v174, v34, v35
    v_lshlrev_b32 v16, 16, v168
    v_and_b32 v17, 0xffff0000, v168
    v_lshlrev_b32 v18, 16, v170
    s_add_u32 m0, s39, 0
    s_xor_b32 s46, s3, 0
    buffer_load_dwordx4 v150, s[24:27], s46 offen lds
    v_and_b32 v19, 0xffff0000, v170
    v_lshlrev_b32 v32, 16, v172
    v_and_b32 v33, 0xffff0000, v172
    v_lshlrev_b32 v34, 16, v174
    v_and_b32 v35, 0xffff0000, v174
    v_pk_mul_f32 v[168:169], v[16:17], v[16:17]
    v_pk_mul_f32 v[170:171], v[18:19], v[18:19]
    v_pk_mul_f32 v[172:173], v[32:33], v[32:33]
    v_pk_mul_f32 v[174:175], v[34:35], v[34:35]
    v_pk_fma_f32 v[168:169], v[168:169], v[138:139], v[136:137]
    v_pk_fma_f32 v[170:171], v[170:171], v[138:139], v[136:137]
    v_pk_fma_f32 v[172:173], v[172:173], v[138:139], v[136:137]
    v_pk_fma_f32 v[174:175], v[174:175], v[138:139], v[136:137]
    buffer_store_dwordx4 v[152:155], v3, s[16:19], s94 offen sc1
    v_pk_mul_f32 v[168:169], v[168:169], v[16:17]
    v_pk_mul_f32 v[170:171], v[170:171], v[18:19]
    v_pk_mul_f32 v[172:173], v[172:173], v[32:33]
    v_pk_mul_f32 v[174:175], v[174:175], v[34:35]
    v_exp_f32 v168, v168
    v_exp_f32 v169, v169
    v_exp_f32 v170, v170
    s_add_u32 m0, s39, 1024
    s_xor_b32 s46, s3, 0
    buffer_load_dwordx4 v151, s[24:27], s46 offen lds
    v_exp_f32 v171, v171
    v_exp_f32 v172, v172
    v_exp_f32 v173, v173
    v_exp_f32 v174, v174
    buffer_store_dwordx4 v[156:159], v3, s[16:19], s95 offen sc1
    v_exp_f32 v175, v175
    v_pk_add_f32 v[168:169], v[168:169], v[140:141]
    v_pk_add_f32 v[170:171], v[170:171], v[140:141]
    v_pk_add_f32 v[172:173], v[172:173], v[140:141]
    v_pk_add_f32 v[174:175], v[174:175], v[140:141]
    v_rcp_f32 v168, v168
    v_rcp_f32 v169, v169
    s_add_u32 m0, s39, 2048
    s_xor_b32 s46, s3, 16384
    buffer_load_dwordx4 v150, s[24:27], s46 offen lds
    v_rcp_f32 v170, v170
    v_rcp_f32 v171, v171
    v_rcp_f32 v172, v172
    v_rcp_f32 v173, v173
    s_mov_b32 exec_hi, 0
    buffer_store_dwordx4 v[160:163], v164, s[16:19], 0 offen sc1
    s_mov_b32 exec_hi, -1
    v_rcp_f32 v174, v174
    v_rcp_f32 v175, v175
    v_pk_mul_f32 v[16:17], v[16:17], v[168:169]
    v_pk_mul_f32 v[18:19], v[18:19], v[170:171]
    v_pk_mul_f32 v[32:33], v[32:33], v[172:173]
    v_pk_mul_f32 v[34:35], v[34:35], v[174:175]
    v_cvt_pk_bf16_f32 v142, v16, v17
    s_add_u32 m0, s39, 3072
    s_xor_b32 s46, s3, 16384
    buffer_load_dwordx4 v151, s[24:27], s46 offen lds
    v_cvt_pk_bf16_f32 v143, v18, v19
    v_cvt_pk_bf16_f32 v144, v32, v33
    v_cvt_pk_bf16_f32 v145, v34, v35
    s_nop 1
    v_mov_b32 v152, 0
    v_mov_b32 v153, 0
    v_mov_b32 v154, 0
    v_mov_b32 v155, 0
    v_mov_b32 v156, 0
    v_mov_b32 v157, 0
    v_mov_b32 v158, 0
    v_mov_b32 v159, 0
    v_mov_b32 v160, 0
    s_add_u32 m0, s39, 4096
    s_xor_b32 s46, s3, 65536
    buffer_load_dwordx4 v150, s[24:27], s46 offen lds
    v_mov_b32 v161, 0
    v_mov_b32 v162, 0
    v_mov_b32 v163, 0
    v_mov_b32 v164, 0
    v_mov_b32 v165, 0
    v_mov_b32 v166, 0
    v_mov_b32 v167, 0
    ds_read_b64_tr_b16 v[84:85], v14 offset:3072
    ds_read_b64_tr_b16 v[86:87], v14 offset:4608
    ds_read_b64_tr_b16 v[88:89], v14 offset:3104
    ds_read_b64_tr_b16 v[90:91], v14 offset:4640
    ds_read_b64_tr_b16 v[92:93], v14 offset:3136
    ds_read_b64_tr_b16 v[94:95], v14 offset:4672
    s_add_u32 m0, s39, 5120
    s_xor_b32 s46, s3, 65536
    buffer_load_dwordx4 v151, s[24:27], s46 offen lds
    v_lshlrev_b32 v16, 16, v142
    v_and_b32 v17, 0xffff0000, v142
    v_lshlrev_b32 v18, 16, v143
    v_and_b32 v19, 0xffff0000, v143
    v_lshlrev_b32 v32, 16, v144
    v_and_b32 v33, 0xffff0000, v144
    v_lshlrev_b32 v34, 16, v145
    v_and_b32 v35, 0xffff0000, v145
    v_pk_add_f32 v[152:153], v[152:153], v[16:17]
    v_pk_fma_f32 v[160:161], v[16:17], v[16:17], v[160:161]
    v_pk_add_f32 v[154:155], v[154:155], v[18:19]
    v_pk_fma_f32 v[162:163], v[18:19], v[18:19], v[162:163]
    v_pk_add_f32 v[156:157], v[156:157], v[32:33]
    s_add_u32 m0, s39, 6144
    s_xor_b32 s46, s3, 81920
    buffer_load_dwordx4 v150, s[24:27], s46 offen lds
    v_pk_fma_f32 v[164:165], v[32:33], v[32:33], v[164:165]
    v_pk_add_f32 v[158:159], v[158:159], v[34:35]
    v_pk_fma_f32 v[166:167], v[34:35], v[34:35], v[166:167]
    ds_read_b64_tr_b16 v[96:97], v14 offset:6144
    ds_read_b64_tr_b16 v[98:99], v14 offset:7680
    ds_read_b64_tr_b16 v[100:101], v14 offset:6176
    ds_read_b64_tr_b16 v[102:103], v14 offset:7712
    ds_read_b64_tr_b16 v[104:105], v14 offset:6208
    ds_read_b64_tr_b16 v[106:107], v14 offset:7744
    v_cvt_pk_bf16_f32 v168, v20, v21
    v_cvt_pk_bf16_f32 v170, v22, v23
    v_cvt_pk_bf16_f32 v172, v36, v37
    v_cvt_pk_bf16_f32 v174, v38, v39
    s_add_u32 m0, s39, 7168
    s_xor_b32 s46, s3, 81920
    buffer_load_dwordx4 v151, s[24:27], s46 offen lds
    v_lshlrev_b32 v20, 16, v168
    v_and_b32 v21, 0xffff0000, v168
    v_lshlrev_b32 v22, 16, v170
    v_and_b32 v23, 0xffff0000, v170
    v_lshlrev_b32 v36, 16, v172
    v_and_b32 v37, 0xffff0000, v172
    v_lshlrev_b32 v38, 16, v174
    v_and_b32 v39, 0xffff0000, v174
    v_pk_mul_f32 v[168:169], v[20:21], v[20:21]
    v_pk_mul_f32 v[170:171], v[22:23], v[22:23]
    v_pk_mul_f32 v[172:173], v[36:37], v[36:37]
    v_pk_mul_f32 v[174:175], v[38:39], v[38:39]
    v_pk_fma_f32 v[168:169], v[168:169], v[138:139], v[136:137]
    s_add_u32 m0, s39, 32768
    s_xor_b32 s46, s3, 128
    buffer_load_dwordx4 v150, s[24:27], s46 offen lds
    v_pk_fma_f32 v[170:171], v[170:171], v[138:139], v[136:137]
    v_pk_fma_f32 v[172:173], v[172:173], v[138:139], v[136:137]
    v_pk_fma_f32 v[174:175], v[174:175], v[138:139], v[136:137]
    v_pk_mul_f32 v[168:169], v[168:169], v[20:21]
    v_pk_mul_f32 v[170:171], v[170:171], v[22:23]
    v_pk_mul_f32 v[172:173], v[172:173], v[36:37]
    v_pk_mul_f32 v[174:175], v[174:175], v[38:39]
    v_exp_f32 v168, v168
    v_exp_f32 v169, v169
    s_add_u32 m0, s39, 33792
    s_xor_b32 s46, s3, 128
    buffer_load_dwordx4 v151, s[24:27], s46 offen lds
    v_exp_f32 v170, v170
    v_exp_f32 v171, v171
    v_exp_f32 v172, v172
    v_exp_f32 v173, v173
    s_add_u32 m0, s39, 34816
    s_xor_b32 s46, s3, 16512
    buffer_load_dwordx4 v150, s[24:27], s46 offen lds
    v_exp_f32 v174, v174
    v_exp_f32 v175, v175
    v_pk_add_f32 v[168:169], v[168:169], v[140:141]
    v_pk_add_f32 v[170:171], v[170:171], v[140:141]
    v_pk_add_f32 v[172:173], v[172:173], v[140:141]
    v_pk_add_f32 v[174:175], v[174:175], v[140:141]
    v_rcp_f32 v168, v168
    s_add_u32 m0, s39, 35840
    s_xor_b32 s46, s3, 16512
    buffer_load_dwordx4 v151, s[24:27], s46 offen lds
    v_rcp_f32 v169, v169
    v_rcp_f32 v170, v170
    v_rcp_f32 v171, v171
    v_rcp_f32 v172, v172
    s_add_u32 m0, s39, 36864
    s_xor_b32 s46, s3, 65664
    buffer_load_dwordx4 v150, s[24:27], s46 offen lds
    v_rcp_f32 v173, v173
    v_rcp_f32 v174, v174
    v_rcp_f32 v175, v175
    v_pk_mul_f32 v[20:21], v[20:21], v[168:169]
    s_add_u32 m0, s39, 37888
    s_xor_b32 s46, s3, 65664
    buffer_load_dwordx4 v151, s[24:27], s46 offen lds
    v_pk_mul_f32 v[22:23], v[22:23], v[170:171]
    v_pk_mul_f32 v[36:37], v[36:37], v[172:173]
    v_pk_mul_f32 v[38:39], v[38:39], v[174:175]
    v_cvt_pk_bf16_f32 v142, v20, v21
    v_cvt_pk_bf16_f32 v143, v22, v23
    v_cvt_pk_bf16_f32 v144, v36, v37
    v_cvt_pk_bf16_f32 v145, v38, v39
    ds_read_b64_tr_b16 v[108:109], v14 offset:9216
    ds_read_b64_tr_b16 v[110:111], v14 offset:10752
    ds_read_b64_tr_b16 v[112:113], v14 offset:9248
    ds_read_b64_tr_b16 v[114:115], v14 offset:10784
    ds_read_b64_tr_b16 v[116:117], v14 offset:9280
    ds_read_b64_tr_b16 v[118:119], v14 offset:10816
    s_add_u32 m0, s39, 38912
    s_xor_b32 s46, s3, 82048
    buffer_load_dwordx4 v150, s[24:27], s46 offen lds
    v_lshlrev_b32 v20, 16, v142
    v_and_b32 v21, 0xffff0000, v142
    v_lshlrev_b32 v22, 16, v143
    v_and_b32 v23, 0xffff0000, v143
    v_lshlrev_b32 v36, 16, v144
    v_and_b32 v37, 0xffff0000, v144
    v_lshlrev_b32 v38, 16, v145
    v_and_b32 v39, 0xffff0000, v145
    v_pk_add_f32 v[152:153], v[152:153], v[20:21]
    v_pk_fma_f32 v[160:161], v[20:21], v[20:21], v[160:161]
    v_pk_add_f32 v[154:155], v[154:155], v[22:23]
    v_pk_fma_f32 v[162:163], v[22:23], v[22:23], v[162:163]
    v_pk_add_f32 v[156:157], v[156:157], v[36:37]
    s_add_u32 m0, s39, 39936
    s_xor_b32 s46, s3, 82048
    buffer_load_dwordx4 v151, s[24:27], s46 offen lds
    v_pk_fma_f32 v[164:165], v[36:37], v[36:37], v[164:165]
    v_pk_add_f32 v[158:159], v[158:159], v[38:39]
    v_pk_fma_f32 v[166:167], v[38:39], v[38:39], v[166:167]
    ds_read_b64_tr_b16 v[120:121], v14 offset:12288
    ds_read_b64_tr_b16 v[122:123], v14 offset:13824
    ds_read_b64_tr_b16 v[124:125], v14 offset:12320
    ds_read_b64_tr_b16 v[126:127], v14 offset:13856
    ds_read_b64_tr_b16 v[128:129], v14 offset:12352
    ds_read_b64_tr_b16 v[130:131], v14 offset:13888
    v_cvt_pk_bf16_f32 v168, v24, v25
    v_cvt_pk_bf16_f32 v170, v26, v27
    v_cvt_pk_bf16_f32 v172, v40, v41
    v_cvt_pk_bf16_f32 v174, v42, v43
    s_add_u32 m0, s39, 65536
    s_xor_b32 s46, s3, 256
    buffer_load_dwordx4 v150, s[24:27], s46 offen lds
    v_lshlrev_b32 v24, 16, v168
    v_and_b32 v25, 0xffff0000, v168
    v_lshlrev_b32 v26, 16, v170
    v_and_b32 v27, 0xffff0000, v170
    v_lshlrev_b32 v40, 16, v172
    v_and_b32 v41, 0xffff0000, v172
    v_lshlrev_b32 v42, 16, v174
    v_and_b32 v43, 0xffff0000, v174
    v_pk_mul_f32 v[168:169], v[24:25], v[24:25]
    v_pk_mul_f32 v[170:171], v[26:27], v[26:27]
    v_pk_mul_f32 v[172:173], v[40:41], v[40:41]
    v_pk_mul_f32 v[174:175], v[42:43], v[42:43]
    v_pk_fma_f32 v[168:169], v[168:169], v[138:139], v[136:137]
    s_add_u32 m0, s39, 66560
    s_xor_b32 s46, s3, 256
    buffer_load_dwordx4 v151, s[24:27], s46 offen lds
    v_pk_fma_f32 v[170:171], v[170:171], v[138:139], v[136:137]
    v_pk_fma_f32 v[172:173], v[172:173], v[138:139], v[136:137]
    v_pk_fma_f32 v[174:175], v[174:175], v[138:139], v[136:137]
    v_pk_mul_f32 v[168:169], v[168:169], v[24:25]
    v_pk_mul_f32 v[170:171], v[170:171], v[26:27]
    v_pk_mul_f32 v[172:173], v[172:173], v[40:41]
    v_pk_mul_f32 v[174:175], v[174:175], v[42:43]
    v_exp_f32 v168, v168
    v_exp_f32 v169, v169
    s_add_u32 m0, s39, 67584
    s_xor_b32 s46, s3, 16640
    buffer_load_dwordx4 v150, s[24:27], s46 offen lds
    v_exp_f32 v170, v170
    v_exp_f32 v171, v171
    v_exp_f32 v172, v172
    v_exp_f32 v173, v173
    s_add_u32 m0, s39, 68608
    s_xor_b32 s46, s3, 16640
    buffer_load_dwordx4 v151, s[24:27], s46 offen lds
    v_exp_f32 v174, v174
    v_exp_f32 v175, v175
    v_pk_add_f32 v[168:169], v[168:169], v[140:141]
    v_pk_add_f32 v[170:171], v[170:171], v[140:141]
    v_pk_add_f32 v[172:173], v[172:173], v[140:141]
    v_pk_add_f32 v[174:175], v[174:175], v[140:141]
    v_rcp_f32 v168, v168
    s_add_u32 m0, s39, 69632
    s_xor_b32 s46, s3, 65792
    buffer_load_dwordx4 v150, s[24:27], s46 offen lds
    v_rcp_f32 v169, v169
    v_rcp_f32 v170, v170
    v_rcp_f32 v171, v171
    v_rcp_f32 v172, v172
    s_add_u32 m0, s39, 70656
    s_xor_b32 s46, s3, 65792
    buffer_load_dwordx4 v151, s[24:27], s46 offen lds
    v_rcp_f32 v173, v173
    v_rcp_f32 v174, v174
    v_rcp_f32 v175, v175
    v_pk_mul_f32 v[24:25], v[24:25], v[168:169]
    s_add_u32 m0, s39, 71680
    s_xor_b32 s46, s3, 82176
    buffer_load_dwordx4 v150, s[24:27], s46 offen lds
    v_pk_mul_f32 v[26:27], v[26:27], v[170:171]
    v_pk_mul_f32 v[40:41], v[40:41], v[172:173]
    v_pk_mul_f32 v[42:43], v[42:43], v[174:175]
    v_cvt_pk_bf16_f32 v142, v24, v25
    v_cvt_pk_bf16_f32 v143, v26, v27
    v_cvt_pk_bf16_f32 v144, v40, v41
    v_cvt_pk_bf16_f32 v145, v42, v43
    ds_read_b64_tr_b16 a[208:209], v14 offset:15360
    ds_read_b64_tr_b16 a[210:211], v14 offset:16896
    ds_read_b64_tr_b16 a[212:213], v14 offset:15392
    ds_read_b64_tr_b16 a[214:215], v14 offset:16928
    ds_read_b64_tr_b16 a[216:217], v14 offset:15424
    ds_read_b64_tr_b16 a[218:219], v14 offset:16960
    s_add_u32 m0, s39, 72704
    s_xor_b32 s46, s3, 82176
    buffer_load_dwordx4 v151, s[24:27], s46 offen lds
    v_lshlrev_b32 v10, 3, v1
    s_cmp_lg_u32 s1, 0
    s_cbranch_scc0 pk_w50_s
    buffer_store_dwordx2 v[142:143], v10, s[16:19], s45 offen offset:2048
    buffer_store_dwordx2 v[144:145], v10, s[16:19], s45 offen offset:2560
pk_w50_r:
    v_cvt_pk_bf16_f32 v168, v28, v29
    v_cvt_pk_bf16_f32 v170, v30, v31
    v_cvt_pk_bf16_f32 v172, v44, v45
    v_cvt_pk_bf16_f32 v174, v46, v47
    v_lshlrev_b32 v28, 16, v168
    v_and_b32 v29, 0xffff0000, v168
    v_lshlrev_b32 v30, 16, v170
    v_and_b32 v31, 0xffff0000, v170
    v_lshlrev_b32 v44, 16, v172
    v_and_b32 v45, 0xffff0000, v172
    v_lshlrev_b32 v46, 16, v174
    v_and_b32 v47, 0xffff0000, v174
    v_pk_mul_f32 v[168:169], v[28:29], v[28:29]
    v_pk_mul_f32 v[170:171], v[30:31], v[30:31]
    v_pk_mul_f32 v[172:173], v[44:45], v[44:45]
    v_pk_mul_f32 v[174:175], v[46:47], v[46:47]
    v_pk_fma_f32 v[168:169], v[168:169], v[138:139], v[136:137]
    v_pk_fma_f32 v[170:171], v[170:171], v[138:139], v[136:137]
    v_pk_fma_f32 v[172:173], v[172:173], v[138:139], v[136:137]
    v_pk_fma_f32 v[174:175], v[174:175], v[138:139], v[136:137]
    v_pk_mul_f32 v[168:169], v[168:169], v[28:29]
    v_pk_mul_f32 v[170:171], v[170:171], v[30:31]
    v_pk_mul_f32 v[172:173], v[172:173], v[44:45]
    v_pk_mul_f32 v[174:175], v[174:175], v[46:47]
    v_exp_f32 v168, v168
    v_exp_f32 v169, v169
    v_exp_f32 v170, v170
    v_exp_f32 v171, v171
    v_exp_f32 v172, v172
    v_exp_f32 v173, v173
    v_exp_f32 v174, v174
    v_exp_f32 v175, v175
    v_pk_add_f32 v[168:169], v[168:169], v[140:141]
    v_pk_add_f32 v[170:171], v[170:171], v[140:141]
    v_pk_add_f32 v[172:173], v[172:173], v[140:141]
    v_pk_add_f32 v[174:175], v[174:175], v[140:141]
    v_rcp_f32 v168, v168
    v_rcp_f32 v169, v169
    v_rcp_f32 v170, v170
    v_rcp_f32 v171, v171
    v_rcp_f32 v172, v172
    v_rcp_f32 v173, v173
    v_rcp_f32 v174, v174
    v_rcp_f32 v175, v175
    v_pk_mul_f32 v[28:29], v[28:29], v[168:169]
    v_pk_mul_f32 v[30:31], v[30:31], v[170:171]
    v_pk_mul_f32 v[44:45], v[44:45], v[172:173]
    v_pk_mul_f32 v[46:47], v[46:47], v[174:175]
    v_cvt_pk_bf16_f32 v142, v28, v29
    v_cvt_pk_bf16_f32 v143, v30, v31
    v_cvt_pk_bf16_f32 v144, v44, v45
    v_cvt_pk_bf16_f32 v145, v46, v47
    v_lshlrev_b32 v10, 3, v1
    s_cmp_lg_u32 s1, 0
    s_cbranch_scc0 pk_w51_s
    buffer_store_dwordx2 v[142:143], v10, s[16:19], s45 offen offset:3072
    buffer_store_dwordx2 v[144:145], v10, s[16:19], s45 offen offset:3584
pk_w51_r:
    s_branch pk_dz2
.p2align 6
pk_wu0:
    s_branch pk_wur
pk_dn0:
    s_waitcnt lgkmcnt(15)
    v_mfma_f32_16x16x32_bf16 v[16:19], v[72:75], a[192:195], 0
    s_waitcnt vmcnt(8)
    v_accvgpr_read_b32 v12, a196
    v_mfma_f32_16x16x32_bf16 v[32:35], v[72:75], v[240:243], 0
    ds_read_b64_tr_b16 v[72:73], v8 offset:12672
    ds_read_b64_tr_b16 v[74:75], v8 offset:13184
    v_mfma_f32_16x16x32_bf16 v[20:23], v[76:79], a[192:195], 0
    v_max_u32 v12, v12, v244
    v_mfma_f32_16x16x32_bf16 v[36:39], v[76:79], v[240:243], 0
    ds_read_b64_tr_b16 v[76:77], v8 offset:12704
    ds_read_b64_tr_b16 v[78:79], v8 offset:13216
    v_mfma_f32_16x16x32_bf16 v[24:27], v[80:83], a[192:195], 0
    v_cmp_eq_u32 vcc, -1, v12
    v_mfma_f32_16x16x32_bf16 v[40:43], v[80:83], v[240:243], 0
    ds_read_b64_tr_b16 v[80:81], v8 offset:12736
    ds_read_b64_tr_b16 v[82:83], v8 offset:13248
    s_xor_b32 s40, s59, 2048
    buffer_load_dwordx4 a[136:139], v6, s[16:19], s40 offen offset:0 sc1
    v_mfma_f32_16x16x32_bf16 v[28:31], v[84:87], a[192:195], 0
    s_cbranch_vccnz pk_c52_s
pk_c52_r:
    v_mfma_f32_16x16x32_bf16 v[44:47], v[84:87], v[240:243], 0
    ds_read_b64_tr_b16 v[84:85], v8 offset:12768
    ds_read_b64_tr_b16 v[86:87], v8 offset:13280
    buffer_load_dwordx4 v[184:187], v7, s[16:19], s40 offen offset:0 sc1
    v_mfma_f32_16x16x32_bf16 v[16:19], v[88:91], a[196:199], v[16:19]
    s_waitcnt vmcnt(8)
    v_accvgpr_read_b32 v12, a200
    v_mfma_f32_16x16x32_bf16 v[32:35], v[88:91], v[244:247], v[32:35]
    ds_read_b64_tr_b16 v[88:89], v8 offset:16896
    ds_read_b64_tr_b16 v[90:91], v8 offset:17408
    v_mfma_f32_16x16x32_bf16 v[20:23], v[92:95], a[196:199], v[20:23]
    v_max_u32 v12, v12, v248
    v_mfma_f32_16x16x32_bf16 v[36:39], v[92:95], v[244:247], v[36:39]
    ds_read_b64_tr_b16 v[92:93], v8 offset:16928
    ds_read_b64_tr_b16 v[94:95], v8 offset:17440
    v_mfma_f32_16x16x32_bf16 v[24:27], v[96:99], a[196:199], v[24:27]
    v_cmp_eq_u32 vcc, -1, v12
    v_mfma_f32_16x16x32_bf16 v[40:43], v[96:99], v[244:247], v[40:43]
    ds_read_b64_tr_b16 v[96:97], v8 offset:16960
    ds_read_b64_tr_b16 v[98:99], v8 offset:17472
    s_xor_b32 s40, s59, 2048
    buffer_load_dwordx4 a[140:143], v6, s[16:19], s40 offen offset:1024 sc1
    v_mfma_f32_16x16x32_bf16 v[28:31], v[100:103], a[196:199], v[28:31]
    s_cbranch_vccnz pk_c53_s
pk_c53_r:
    v_mfma_f32_16x16x32_bf16 v[44:47], v[100:103], v[244:247], v[44:47]
    ds_read_b64_tr_b16 v[100:101], v8 offset:16992
    ds_read_b64_tr_b16 v[102:103], v8 offset:17504
    buffer_load_dwordx4 v[188:191], v7, s[16:19], s40 offen offset:1024 sc1
    v_mfma_f32_16x16x32_bf16 v[16:19], v[104:107], a[200:203], v[16:19]
    s_waitcnt vmcnt(8)
    v_accvgpr_read_b32 v12, a204
    v_mfma_f32_16x16x32_bf16 v[32:35], v[104:107], v[248:251], v[32:35]
    ds_read_b64_tr_b16 v[104:105], v8 offset:21120
    ds_read_b64_tr_b16 v[106:107], v8 offset:21632
    v_mfma_f32_16x16x32_bf16 v[20:23], v[108:111], a[200:203], v[20:23]
    v_max_u32 v12, v12, v252
    v_mfma_f32_16x16x32_bf16 v[36:39], v[108:111], v[248:251], v[36:39]
    ds_read_b64_tr_b16 v[108:109], v8 offset:21152
    ds_read_b64_tr_b16 v[110:111], v8 offset:21664
    v_mfma_f32_16x16x32_bf16 v[24:27], v[112:115], a[200:203], v[24:27]
    v_cmp_eq_u32 vcc, -1, v12
    v_mfma_f32_16x16x32_bf16 v[40:43], v[112:115], v[248:251], v[40:43]
    ds_read_b64_tr_b16 v[112:113], v8 offset:21184
    ds_read_b64_tr_b16 v[114:115], v8 offset:21696
    s_xor_b32 s40, s59, 4096
    buffer_load_dwordx4 a[144:147], v6, s[16:19], s40 offen offset:0 sc1
    v_mfma_f32_16x16x32_bf16 v[28:31], v[116:119], a[200:203], v[28:31]
    s_cbranch_vccnz pk_c54_s
pk_c54_r:
    v_mfma_f32_16x16x32_bf16 v[44:47], v[116:119], v[248:251], v[44:47]
    ds_read_b64_tr_b16 v[116:117], v8 offset:21216
    ds_read_b64_tr_b16 v[118:119], v8 offset:21728
    buffer_load_dwordx4 v[192:195], v7, s[16:19], s40 offen offset:0 sc1
    v_mfma_f32_16x16x32_bf16 v[16:19], v[120:123], a[204:207], v[16:19]
    s_waitcnt vmcnt(8)
    v_accvgpr_read_b32 v12, a128
    v_mfma_f32_16x16x32_bf16 v[32:35], v[120:123], v[252:255], v[32:35]
    ds_read_b64_tr_b16 v[120:121], v8 offset:25344
    ds_read_b64_tr_b16 v[122:123], v8 offset:25856
    v_mfma_f32_16x16x32_bf16 v[20:23], v[124:127], a[204:207], v[20:23]
    v_max_u32 v12, v12, v176
    v_mfma_f32_16x16x32_bf16 v[36:39], v[124:127], v[252:255], v[36:39]
    ds_read_b64_tr_b16 v[124:125], v8 offset:25376
    ds_read_b64_tr_b16 v[126:127], v8 offset:25888
    v_mfma_f32_16x16x32_bf16 v[24:27], v[128:131], a[204:207], v[24:27]
    v_cmp_eq_u32 vcc, -1, v12
    v_mfma_f32_16x16x32_bf16 v[40:43], v[128:131], v[252:255], v[40:43]
    ds_read_b64_tr_b16 v[128:129], v8 offset:25408
    ds_read_b64_tr_b16 v[130:131], v8 offset:25920
    s_xor_b32 s40, s59, 4096
    buffer_load_dwordx4 a[148:151], v6, s[16:19], s40 offen offset:1024 sc1
    v_mfma_f32_16x16x32_bf16 v[28:31], v[132:135], a[204:207], v[28:31]
    s_cbranch_vccnz pk_c55_s
pk_c55_r:
    v_mfma_f32_16x16x32_bf16 v[44:47], v[132:135], v[252:255], v[44:47]
    ds_read_b64_tr_b16 v[132:133], v8 offset:25440
    ds_read_b64_tr_b16 v[134:135], v8 offset:25952
    buffer_load_dwordx4 v[196:199], v7, s[16:19], s40 offen offset:1024 sc1
    v_mfma_f32_16x16x32_bf16 v[16:19], a[208:211], a[128:131], v[16:19]
    s_waitcnt vmcnt(8)
    v_accvgpr_read_b32 v12, a132
    v_mfma_f32_16x16x32_bf16 v[32:35], a[208:211], v[176:179], v[32:35]
    ds_read_b64_tr_b16 a[208:209], v8 offset:29568
    ds_read_b64_tr_b16 a[210:211], v8 offset:30080
    v_mfma_f32_16x16x32_bf16 v[20:23], a[212:215], a[128:131], v[20:23]
    v_max_u32 v12, v12, v180
    v_mfma_f32_16x16x32_bf16 v[36:39], a[212:215], v[176:179], v[36:39]
    ds_read_b64_tr_b16 a[212:213], v8 offset:29600
    ds_read_b64_tr_b16 a[214:215], v8 offset:30112
    v_mfma_f32_16x16x32_bf16 v[24:27], a[216:219], a[128:131], v[24:27]
    v_cmp_eq_u32 vcc, -1, v12
    v_mfma_f32_16x16x32_bf16 v[40:43], a[216:219], v[176:179], v[40:43]
    ds_read_b64_tr_b16 a[216:217], v8 offset:29632
    ds_read_b64_tr_b16 a[218:219], v8 offset:30144
    s_xor_b32 s40, s59, 6144
    buffer_load_dwordx4 a[152:155], v6, s[16:19], s40 offen offset:0 sc1
    v_mfma_f32_16x16x32_bf16 v[28:31], a[220:223], a[128:131], v[28:31]
    s_cbranch_vccnz pk_c56_s
pk_c56_r:
    v_mfma_f32_16x16x32_bf16 v[44:47], a[220:223], v[176:179], v[44:47]
    ds_read_b64_tr_b16 a[220:221], v8 offset:29664
    ds_read_b64_tr_b16 a[222:223], v8 offset:30176
    buffer_load_dwordx4 v[200:203], v7, s[16:19], s40 offen offset:0 sc1
    s_waitcnt lgkmcnt(15)
    v_mfma_f32_16x16x32_bf16 v[16:19], a[224:227], a[132:135], v[16:19]
    s_waitcnt vmcnt(8)
    v_accvgpr_read_b32 v12, a136
    v_mfma_f32_16x16x32_bf16 v[32:35], a[224:227], v[180:183], v[32:35]
    ds_read_b64_tr_b16 a[224:225], v8 offset:33792
    ds_read_b64_tr_b16 a[226:227], v8 offset:34304
    v_mfma_f32_16x16x32_bf16 v[20:23], a[228:231], a[132:135], v[20:23]
    v_max_u32 v12, v12, v184
    v_mfma_f32_16x16x32_bf16 v[36:39], a[228:231], v[180:183], v[36:39]
    ds_read_b64_tr_b16 a[228:229], v8 offset:33824
    ds_read_b64_tr_b16 a[230:231], v8 offset:34336
    v_mfma_f32_16x16x32_bf16 v[24:27], a[232:235], a[132:135], v[24:27]
    v_cmp_eq_u32 vcc, -1, v12
    v_mfma_f32_16x16x32_bf16 v[40:43], a[232:235], v[180:183], v[40:43]
    ds_read_b64_tr_b16 a[232:233], v8 offset:33856
    ds_read_b64_tr_b16 a[234:235], v8 offset:34368
    s_xor_b32 s40, s59, 6144
    buffer_load_dwordx4 a[156:159], v6, s[16:19], s40 offen offset:1024 sc1
    v_mfma_f32_16x16x32_bf16 v[28:31], a[236:239], a[132:135], v[28:31]
    s_cbranch_vccnz pk_c57_s
pk_c57_r:
    v_mfma_f32_16x16x32_bf16 v[44:47], a[236:239], v[180:183], v[44:47]
    ds_read_b64_tr_b16 a[236:237], v8 offset:33888
    ds_read_b64_tr_b16 a[238:239], v8 offset:34400
    buffer_load_dwordx4 v[204:207], v7, s[16:19], s40 offen offset:1024 sc1
    v_mfma_f32_16x16x32_bf16 v[16:19], a[240:243], a[136:139], v[16:19]
    s_waitcnt vmcnt(8)
    v_accvgpr_read_b32 v12, a140
    v_mfma_f32_16x16x32_bf16 v[32:35], a[240:243], v[184:187], v[32:35]
    ds_read_b64_tr_b16 a[240:241], v8 offset:38016
    ds_read_b64_tr_b16 a[242:243], v8 offset:38528
    v_mfma_f32_16x16x32_bf16 v[20:23], a[244:247], a[136:139], v[20:23]
    v_max_u32 v12, v12, v188
    v_mfma_f32_16x16x32_bf16 v[36:39], a[244:247], v[184:187], v[36:39]
    ds_read_b64_tr_b16 a[244:245], v8 offset:38048
    ds_read_b64_tr_b16 a[246:247], v8 offset:38560
    v_mfma_f32_16x16x32_bf16 v[24:27], a[248:251], a[136:139], v[24:27]
    v_cmp_eq_u32 vcc, -1, v12
    v_mfma_f32_16x16x32_bf16 v[40:43], a[248:251], v[184:187], v[40:43]
    ds_read_b64_tr_b16 a[248:249], v8 offset:38080
    ds_read_b64_tr_b16 a[250:251], v8 offset:38592
    s_xor_b32 s40, s59, 8192
    buffer_load_dwordx4 a[160:163], v6, s[16:19], s40 offen offset:0 sc1
    v_mfma_f32_16x16x32_bf16 v[28:31], a[252:255], a[136:139], v[28:31]
    s_cbranch_vccnz pk_c58_s
pk_c58_r:
    v_mfma_f32_16x16x32_bf16 v[44:47], a[252:255], v[184:187], v[44:47]
    ds_read_b64_tr_b16 a[252:253], v8 offset:38112
    ds_read_b64_tr_b16 a[254:255], v8 offset:38624
    buffer_load_dwordx4 v[208:211], v7, s[16:19], s40 offen offset:0 sc1
    v_mfma_f32_16x16x32_bf16 v[16:19], v[72:75], a[140:143], v[16:19]
    s_waitcnt vmcnt(8)
    v_accvgpr_read_b32 v12, a144
    v_mfma_f32_16x16x32_bf16 v[32:35], v[72:75], v[188:191], v[32:35]
    ds_read_b64_tr_b16 v[72:73], v9 offset:0
    ds_read_b64_tr_b16 v[74:75], v9 offset:512
    v_mfma_f32_16x16x32_bf16 v[20:23], v[76:79], a[140:143], v[20:23]
    v_max_u32 v12, v12, v192
    v_mfma_f32_16x16x32_bf16 v[36:39], v[76:79], v[188:191], v[36:39]
    ds_read_b64_tr_b16 v[76:77], v9 offset:32
    ds_read_b64_tr_b16 v[78:79], v9 offset:544
    v_mfma_f32_16x16x32_bf16 v[24:27], v[80:83], a[140:143], v[24:27]
    v_cmp_eq_u32 vcc, -1, v12
    v_mfma_f32_16x16x32_bf16 v[40:43], v[80:83], v[188:191], v[40:43]
    ds_read_b64_tr_b16 v[80:81], v9 offset:64
    ds_read_b64_tr_b16 v[82:83], v9 offset:576
    s_xor_b32 s40, s59, 8192
    buffer_load_dwordx4 a[164:167], v6, s[16:19], s40 offen offset:1024 sc1
    v_mfma_f32_16x16x32_bf16 v[28:31], v[84:87], a[140:143], v[28:31]
    s_cbranch_vccnz pk_c59_s
pk_c59_r:
    v_mfma_f32_16x16x32_bf16 v[44:47], v[84:87], v[188:191], v[44:47]
    ds_read_b64_tr_b16 v[84:85], v9 offset:96
    ds_read_b64_tr_b16 v[86:87], v9 offset:608
    buffer_load_dwordx4 v[212:215], v7, s[16:19], s40 offen offset:1024 sc1
    v_mfma_f32_16x16x32_bf16 v[16:19], v[88:91], a[144:147], v[16:19]
    s_waitcnt vmcnt(8)
    v_accvgpr_read_b32 v12, a148
    v_mfma_f32_16x16x32_bf16 v[32:35], v[88:91], v[192:195], v[32:35]
    ds_read_b64_tr_b16 v[88:89], v9 offset:4224
    ds_read_b64_tr_b16 v[90:91], v9 offset:4736
    v_mfma_f32_16x16x32_bf16 v[20:23], v[92:95], a[144:147], v[20:23]
    v_max_u32 v12, v12, v196
    v_mfma_f32_16x16x32_bf16 v[36:39], v[92:95], v[192:195], v[36:39]
    ds_read_b64_tr_b16 v[92:93], v9 offset:4256
    ds_read_b64_tr_b16 v[94:95], v9 offset:4768
    v_mfma_f32_16x16x32_bf16 v[24:27], v[96:99], a[144:147], v[24:27]
    v_cmp_eq_u32 vcc, -1, v12
    v_mfma_f32_16x16x32_bf16 v[40:43], v[96:99], v[192:195], v[40:43]
    ds_read_b64_tr_b16 v[96:97], v9 offset:4288
    ds_read_b64_tr_b16 v[98:99], v9 offset:4800
    s_xor_b32 s40, s59, 10240
    buffer_load_dwordx4 a[168:171], v6, s[16:19], s40 offen offset:0 sc1
    v_mfma_f32_16x16x32_bf16 v[28:31], v[100:103], a[144:147], v[28:31]
    s_cbranch_vccnz pk_c60_s
pk_c60_r:
    v_mfma_f32_16x16x32_bf16 v[44:47], v[100:103], v[192:195], v[44:47]
    ds_read_b64_tr_b16 v[100:101], v9 offset:4320
    ds_read_b64_tr_b16 v[102:103], v9 offset:4832
    buffer_load_dwordx4 v[216:219], v7, s[16:19], s40 offen offset:0 sc1
    v_mfma_f32_16x16x32_bf16 v[16:19], v[104:107], a[148:151], v[16:19]
    s_waitcnt vmcnt(8)
    v_accvgpr_read_b32 v12, a152
    v_mfma_f32_16x16x32_bf16 v[32:35], v[104:107], v[196:199], v[32:35]
    ds_read_b64_tr_b16 v[104:105], v9 offset:8448
    ds_read_b64_tr_b16 v[106:107], v9 offset:8960
    v_mfma_f32_16x16x32_bf16 v[20:23], v[108:111], a[148:151], v[20:23]
    v_max_u32 v12, v12, v200
    v_mfma_f32_16x16x32_bf16 v[36:39], v[108:111], v[196:199], v[36:39]
    ds_read_b64_tr_b16 v[108:109], v9 offset:8480
    ds_read_b64_tr_b16 v[110:111], v9 offset:8992
    v_mfma_f32_16x16x32_bf16 v[24:27], v[112:115], a[148:151], v[24:27]
    v_cmp_eq_u32 vcc, -1, v12
    v_mfma_f32_16x16x32_bf16 v[40:43], v[112:115], v[196:199], v[40:43]
    ds_read_b64_tr_b16 v[112:113], v9 offset:8512
    ds_read_b64_tr_b16 v[114:115], v9 offset:9024
    s_xor_b32 s40, s59, 10240
    buffer_load_dwordx4 a[172:175], v6, s[16:19], s40 offen offset:1024 sc1
    v_mfma_f32_16x16x32_bf16 v[28:31], v[116:119], a[148:151], v[28:31]
    s_cbranch_vccnz pk_c61_s
pk_c61_r:
    v_mfma_f32_16x16x32_bf16 v[44:47], v[116:119], v[196:199], v[44:47]
    ds_read_b64_tr_b16 v[116:117], v9 offset:8544
    ds_read_b64_tr_b16 v[118:119], v9 offset:9056
    buffer_load_dwordx4 v[220:223], v7, s[16:19], s40 offen offset:1024 sc1
    s_waitcnt lgkmcnt(15)
    v_mfma_f32_16x16x32_bf16 v[16:19], v[120:123], a[152:155], v[16:19]
    s_waitcnt vmcnt(8)
    v_accvgpr_read_b32 v12, a156
    v_mfma_f32_16x16x32_bf16 v[32:35], v[120:123], v[200:203], v[32:35]
    ds_read_b64_tr_b16 v[120:121], v9 offset:12672
    ds_read_b64_tr_b16 v[122:123], v9 offset:13184
    v_mfma_f32_16x16x32_bf16 v[20:23], v[124:127], a[152:155], v[20:23]
    v_max_u32 v12, v12, v204
    v_mfma_f32_16x16x32_bf16 v[36:39], v[124:127], v[200:203], v[36:39]
    ds_read_b64_tr_b16 v[124:125], v9 offset:12704
    ds_read_b64_tr_b16 v[126:127], v9 offset:13216
    v_mfma_f32_16x16x32_bf16 v[24:27], v[128:131], a[152:155], v[24:27]
    v_cmp_eq_u32 vcc, -1, v12
    v_mfma_f32_16x16x32_bf16 v[40:43], v[128:131], v[200:203], v[40:43]
    ds_read_b64_tr_b16 v[128:129], v9 offset:12736
    ds_read_b64_tr_b16 v[130:131], v9 offset:13248
    s_xor_b32 s40, s59, 12288
    buffer_load_dwordx4 a[176:179], v6, s[16:19], s40 offen offset:0 sc1
    v_mfma_f32_16x16x32_bf16 v[28:31], v[132:135], a[152:155], v[28:31]
    s_cbranch_vccnz pk_c62_s
pk_c62_r:
    v_mfma_f32_16x16x32_bf16 v[44:47], v[132:135], v[200:203], v[44:47]
    ds_read_b64_tr_b16 v[132:133], v9 offset:12768
    ds_read_b64_tr_b16 v[134:135], v9 offset:13280
    buffer_load_dwordx4 v[224:227], v7, s[16:19], s40 offen offset:0 sc1
    v_mfma_f32_16x16x32_bf16 v[16:19], a[208:211], a[156:159], v[16:19]
    s_waitcnt vmcnt(8)
    v_accvgpr_read_b32 v12, a160
    v_mfma_f32_16x16x32_bf16 v[32:35], a[208:211], v[204:207], v[32:35]
    ds_read_b64_tr_b16 a[208:209], v9 offset:16896
    ds_read_b64_tr_b16 a[210:211], v9 offset:17408
    v_mfma_f32_16x16x32_bf16 v[20:23], a[212:215], a[156:159], v[20:23]
    v_max_u32 v12, v12, v208
    v_mfma_f32_16x16x32_bf16 v[36:39], a[212:215], v[204:207], v[36:39]
    ds_read_b64_tr_b16 a[212:213], v9 offset:16928
    ds_read_b64_tr_b16 a[214:215], v9 offset:17440
    v_mfma_f32_16x16x32_bf16 v[24:27], a[216:219], a[156:159], v[24:27]
    v_cmp_eq_u32 vcc, -1, v12
    v_mfma_f32_16x16x32_bf16 v[40:43], a[216:219], v[204:207], v[40:43]
    ds_read_b64_tr_b16 a[216:217], v9 offset:16960
    ds_read_b64_tr_b16 a[218:219], v9 offset:17472
    s_xor_b32 s40, s59, 12288
    buffer_load_dwordx4 a[180:183], v6, s[16:19], s40 offen offset:1024 sc1
    v_mfma_f32_16x16x32_bf16 v[28:31], a[220:223], a[156:159], v[28:31]
    s_cbranch_vccnz pk_c63_s
pk_c63_r:
    v_mfma_f32_16x16x32_bf16 v[44:47], a[220:223], v[204:207], v[44:47]
    ds_read_b64_tr_b16 a[220:221], v9 offset:16992
    ds_read_b64_tr_b16 a[222:223], v9 offset:17504
    buffer_load_dwordx4 v[228:231], v7, s[16:19], s40 offen offset:1024 sc1
    v_mfma_f32_16x16x32_bf16 v[16:19], a[224:227], a[160:163], v[16:19]
    s_waitcnt vmcnt(8)
    v_accvgpr_read_b32 v12, a164
    v_mfma_f32_16x16x32_bf16 v[32:35], a[224:227], v[208:211], v[32:35]
    ds_read_b64_tr_b16 a[224:225], v9 offset:21120
    ds_read_b64_tr_b16 a[226:227], v9 offset:21632
    v_mfma_f32_16x16x32_bf16 v[20:23], a[228:231], a[160:163], v[20:23]
    v_max_u32 v12, v12, v212
    v_mfma_f32_16x16x32_bf16 v[36:39], a[228:231], v[208:211], v[36:39]
    ds_read_b64_tr_b16 a[228:229], v9 offset:21152
    ds_read_b64_tr_b16 a[230:231], v9 offset:21664
    v_mfma_f32_16x16x32_bf16 v[24:27], a[232:235], a[160:163], v[24:27]
    v_cmp_eq_u32 vcc, -1, v12
    v_mfma_f32_16x16x32_bf16 v[40:43], a[232:235], v[208:211], v[40:43]
    ds_read_b64_tr_b16 a[232:233], v9 offset:21184
    ds_read_b64_tr_b16 a[234:235], v9 offset:21696
    s_xor_b32 s40, s59, 14336
    buffer_load_dwordx4 a[184:187], v6, s[16:19], s40 offen offset:0 sc1
    v_mfma_f32_16x16x32_bf16 v[28:31], a[236:239], a[160:163], v[28:31]
    s_cbranch_vccnz pk_c64_s
pk_c64_r:
    v_mfma_f32_16x16x32_bf16 v[44:47], a[236:239], v[208:211], v[44:47]
    ds_read_b64_tr_b16 a[236:237], v9 offset:21216
    ds_read_b64_tr_b16 a[238:239], v9 offset:21728
    buffer_load_dwordx4 v[232:235], v7, s[16:19], s40 offen offset:0 sc1
    v_mfma_f32_16x16x32_bf16 v[16:19], a[240:243], a[164:167], v[16:19]
    s_waitcnt vmcnt(8)
    v_accvgpr_read_b32 v12, a168
    v_mfma_f32_16x16x32_bf16 v[32:35], a[240:243], v[212:215], v[32:35]
    v_mfma_f32_16x16x32_bf16 v[20:23], a[244:247], a[164:167], v[20:23]
    v_max_u32 v12, v12, v216
    v_mfma_f32_16x16x32_bf16 v[36:39], a[244:247], v[212:215], v[36:39]
    v_mfma_f32_16x16x32_bf16 v[24:27], a[248:251], a[164:167], v[24:27]
    v_cmp_eq_u32 vcc, -1, v12
    v_mfma_f32_16x16x32_bf16 v[40:43], a[248:251], v[212:215], v[40:43]
    s_xor_b32 s40, s59, 14336
    buffer_load_dwordx4 a[188:191], v6, s[16:19], s40 offen offset:1024 sc1
    v_mfma_f32_16x16x32_bf16 v[28:31], a[252:255], a[164:167], v[28:31]
    s_cbranch_vccnz pk_c65_s
pk_c65_r:
    v_mfma_f32_16x16x32_bf16 v[44:47], a[252:255], v[212:215], v[44:47]
    buffer_load_dwordx4 v[236:239], v7, s[16:19], s40 offen offset:1024 sc1
    v_mfma_f32_16x16x32_bf16 v[16:19], v[72:75], a[168:171], v[16:19]
    s_waitcnt vmcnt(8)
    v_accvgpr_read_b32 v12, a172
    v_mfma_f32_16x16x32_bf16 v[32:35], v[72:75], v[216:219], v[32:35]
    v_mfma_f32_16x16x32_bf16 v[20:23], v[76:79], a[168:171], v[20:23]
    v_max_u32 v12, v12, v220
    v_mfma_f32_16x16x32_bf16 v[36:39], v[76:79], v[216:219], v[36:39]
    v_mfma_f32_16x16x32_bf16 v[24:27], v[80:83], a[168:171], v[24:27]
    v_cmp_eq_u32 vcc, -1, v12
    v_mfma_f32_16x16x32_bf16 v[40:43], v[80:83], v[216:219], v[40:43]
    s_andn2_b32 s45, 7, s2
    s_lshl_b32 s45, s45, 5
    s_lshr_b32 s46, s2, 3
    s_add_u32 s45, s45, s46
    s_lshl_b32 s45, s45, 2
    s_add_u32 s45, s45, s32
    s_lshl_b32 s45, s45, 13
    s_mov_b32 s46, 8
    s_bitcmp1_b32 s46, s32
    s_cselect_b32 s45, s45, 0x7f000000
    v_lshlrev_b32 v10, 7, v1
    v_add_u32 v10, s45, v10
    buffer_load_dword v13, v10, s[24:27], 0 offen
    v_mfma_f32_16x16x32_bf16 v[28:31], v[84:87], a[168:171], v[28:31]
    s_cbranch_vccnz pk_c66_s
pk_c66_r:
    v_mfma_f32_16x16x32_bf16 v[44:47], v[84:87], v[216:219], v[44:47]
    buffer_store_dwordx4 v[146:149], v3, s[16:19], s44 offen offset:0 sc1
    s_waitcnt lgkmcnt(15)
    v_mfma_f32_16x16x32_bf16 v[16:19], v[88:91], a[172:175], v[16:19]
    s_waitcnt vmcnt(8)
    v_accvgpr_read_b32 v12, a176
    v_mfma_f32_16x16x32_bf16 v[32:35], v[88:91], v[220:223], v[32:35]
    v_mfma_f32_16x16x32_bf16 v[20:23], v[92:95], a[172:175], v[20:23]
    v_max_u32 v12, v12, v224
    v_mfma_f32_16x16x32_bf16 v[36:39], v[92:95], v[220:223], v[36:39]
    v_mfma_f32_16x16x32_bf16 v[24:27], v[96:99], a[172:175], v[24:27]
    v_cmp_eq_u32 vcc, -1, v12
    v_mfma_f32_16x16x32_bf16 v[40:43], v[96:99], v[220:223], v[40:43]
    buffer_store_dwordx4 v[146:149], v3, s[16:19], s44 offen offset:1024 sc1
    v_mfma_f32_16x16x32_bf16 v[28:31], v[100:103], a[172:175], v[28:31]
    s_cbranch_vccnz pk_c67_s
pk_c67_r:
    v_mfma_f32_16x16x32_bf16 v[44:47], v[100:103], v[220:223], v[44:47]
    buffer_store_dwordx4 v[146:149], v3, s[16:19], s44 offen offset:2048 sc1
    v_mfma_f32_16x16x32_bf16 v[16:19], v[104:107], a[176:179], v[16:19]
    s_waitcnt vmcnt(8)
    v_accvgpr_read_b32 v12, a180
    v_mfma_f32_16x16x32_bf16 v[32:35], v[104:107], v[224:227], v[32:35]
    v_mfma_f32_16x16x32_bf16 v[20:23], v[108:111], a[176:179], v[20:23]
    v_max_u32 v12, v12, v228
    v_mfma_f32_16x16x32_bf16 v[36:39], v[108:111], v[224:227], v[36:39]
    v_mfma_f32_16x16x32_bf16 v[24:27], v[112:115], a[176:179], v[24:27]
    v_cmp_eq_u32 vcc, -1, v12
    v_mfma_f32_16x16x32_bf16 v[40:43], v[112:115], v[224:227], v[40:43]
    buffer_store_dwordx4 v[146:149], v3, s[16:19], s44 offen offset:2432 sc1
    v_mfma_f32_16x16x32_bf16 v[28:31], v[116:119], a[176:179], v[28:31]
    s_cbranch_vccnz pk_c68_s
pk_c68_r:
    v_mfma_f32_16x16x32_bf16 v[44:47], v[116:119], v[224:227], v[44:47]
    v_mfma_f32_16x16x32_bf16 v[16:19], v[120:123], a[180:183], v[16:19]
    s_waitcnt vmcnt(7)
    v_accvgpr_read_b32 v12, a184
    v_mfma_f32_16x16x32_bf16 v[32:35], v[120:123], v[228:231], v[32:35]
    v_mfma_f32_16x16x32_bf16 v[20:23], v[124:127], a[180:183], v[20:23]
    v_max_u32 v12, v12, v232
    v_mfma_f32_16x16x32_bf16 v[36:39], v[124:127], v[228:231], v[36:39]
    v_mfma_f32_16x16x32_bf16 v[24:27], v[128:131], a[180:183], v[24:27]
    v_cmp_eq_u32 vcc, -1, v12
    v_mfma_f32_16x16x32_bf16 v[40:43], v[128:131], v[228:231], v[40:43]
    v_mfma_f32_16x16x32_bf16 v[28:31], v[132:135], a[180:183], v[28:31]
    s_cbranch_vccnz pk_c69_s
pk_c69_r:
    v_mfma_f32_16x16x32_bf16 v[44:47], v[132:135], v[228:231], v[44:47]
    s_waitcnt lgkmcnt(8)
    v_mfma_f32_16x16x32_bf16 v[16:19], a[208:211], a[184:187], v[16:19]
    s_waitcnt vmcnt(5)
    v_accvgpr_read_b32 v12, a188
    v_mfma_f32_16x16x32_bf16 v[32:35], a[208:211], v[232:235], v[32:35]
    v_mfma_f32_16x16x32_bf16 v[20:23], a[212:215], a[184:187], v[20:23]
    v_max_u32 v12, v12, v236
    v_mfma_f32_16x16x32_bf16 v[36:39], a[212:215], v[232:235], v[36:39]
    v_mfma_f32_16x16x32_bf16 v[24:27], a[216:219], a[184:187], v[24:27]
    v_cmp_eq_u32 vcc, -1, v12
    v_mfma_f32_16x16x32_bf16 v[40:43], a[216:219], v[232:235], v[40:43]
    v_mfma_f32_16x16x32_bf16 v[28:31], a[220:223], a[184:187], v[28:31]
    s_cbranch_vccnz pk_c70_s
pk_c70_r:
    v_mfma_f32_16x16x32_bf16 v[44:47], a[220:223], v[232:235], v[44:47]
    s_waitcnt lgkmcnt(0)
    v_mfma_f32_16x16x32_bf16 v[16:19], a[224:227], a[188:191], v[16:19]
    v_mfma_f32_16x16x32_bf16 v[32:35], a[224:227], v[236:239], v[32:35]
    v_mfma_f32_16x16x32_bf16 v[20:23], a[228:231], a[188:191], v[20:23]
    v_mfma_f32_16x16x32_bf16 v[36:39], a[228:231], v[236:239], v[36:39]
    v_mfma_f32_16x16x32_bf16 v[24:27], a[232:235], a[188:191], v[24:27]
    v_mfma_f32_16x16x32_bf16 v[40:43], a[232:235], v[236:239], v[40:43]
    v_mfma_f32_16x16x32_bf16 v[28:31], a[236:239], a[188:191], v[28:31]
    v_mfma_f32_16x16x32_bf16 v[44:47], a[236:239], v[236:239], v[44:47]
    s_bfe_u32 s45, s69, 0x80008
    s_lshl_b32 s45, s45, 10
    s_add_u32 s45, s45, s43
    s_barrier
    ds_read_b64_tr_b16 v[72:73], v14 offset:0
    ds_read_b64_tr_b16 v[74:75], v14 offset:1536
    ds_read_b64_tr_b16 v[76:77], v14 offset:32
    ds_read_b64_tr_b16 v[78:79], v14 offset:1568
    ds_read_b64_tr_b16 v[80:81], v14 offset:64
    ds_read_b64_tr_b16 v[82:83], v14 offset:1600
    v_cvt_pk_bf16_f32 v168, v16, v17
    v_cvt_pk_bf16_f32 v170, v18, v19
    v_cvt_pk_bf16_f32 v172, v32, v33
    v_cvt_pk_bf16_f32 v174, v34, v35
    v_lshlrev_b32 v16, 16, v168
    v_and_b32 v17, 0xffff0000, v168
    v_lshlrev_b32 v18, 16, v170
    s_add_u32 m0, s39, 0
    s_xor_b32 s46, s3, 0
    buffer_load_dwordx4 v150, s[24:27], s46 offen lds
    v_and_b32 v19, 0xffff0000, v170
    v_lshlrev_b32 v32, 16, v172
    v_and_b32 v33, 0xffff0000, v172
    v_lshlrev_b32 v34, 16, v174
    v_and_b32 v35, 0xffff0000, v174
    v_pk_mul_f32 v[168:169], v[16:17], v[16:17]
    v_pk_mul_f32 v[170:171], v[18:19], v[18:19]
    v_pk_mul_f32 v[172:173], v[32:33], v[32:33]
    v_pk_mul_f32 v[174:175], v[34:35], v[34:35]
    v_pk_fma_f32 v[168:169], v[168:169], v[138:139], v[136:137]
    v_pk_fma_f32 v[170:171], v[170:171], v[138:139], v[136:137]
    v_pk_fma_f32 v[172:173], v[172:173], v[138:139], v[136:137]
    v_pk_fma_f32 v[174:175], v[174:175], v[138:139], v[136:137]
    buffer_store_dwordx4 v[152:155], v3, s[16:19], s94 offen sc1
    v_pk_mul_f32 v[168:169], v[168:169], v[16:17]
    v_pk_mul_f32 v[170:171], v[170:171], v[18:19]
    v_pk_mul_f32 v[172:173], v[172:173], v[32:33]
    v_pk_mul_f32 v[174:175], v[174:175], v[34:35]
    v_exp_f32 v168, v168
    v_exp_f32 v169, v169
    v_exp_f32 v170, v170
    s_add_u32 m0, s39, 1024
    s_xor_b32 s46, s3, 0
    buffer_load_dwordx4 v151, s[24:27], s46 offen lds
    v_exp_f32 v171, v171
    v_exp_f32 v172, v172
    v_exp_f32 v173, v173
    v_exp_f32 v174, v174
    buffer_store_dwordx4 v[156:159], v3, s[16:19], s95 offen sc1
    v_exp_f32 v175, v175
    v_pk_add_f32 v[168:169], v[168:169], v[140:141]
    v_pk_add_f32 v[170:171], v[170:171], v[140:141]
    v_pk_add_f32 v[172:173], v[172:173], v[140:141]
    v_pk_add_f32 v[174:175], v[174:175], v[140:141]
    v_rcp_f32 v168, v168
    v_rcp_f32 v169, v169
    s_add_u32 m0, s39, 2048
    s_xor_b32 s46, s3, 16384
    buffer_load_dwordx4 v150, s[24:27], s46 offen lds
    v_rcp_f32 v170, v170
    v_rcp_f32 v171, v171
    v_rcp_f32 v172, v172
    v_rcp_f32 v173, v173
    s_mov_b32 exec_hi, 0
    buffer_store_dwordx4 v[160:163], v164, s[16:19], 0 offen sc1
    s_mov_b32 exec_hi, -1
    v_rcp_f32 v174, v174
    v_rcp_f32 v175, v175
    v_pk_mul_f32 v[16:17], v[16:17], v[168:169]
    v_pk_mul_f32 v[18:19], v[18:19], v[170:171]
    v_pk_mul_f32 v[32:33], v[32:33], v[172:173]
    v_pk_mul_f32 v[34:35], v[34:35], v[174:175]
    v_cvt_pk_bf16_f32 v142, v16, v17
    s_add_u32 m0, s39, 3072
    s_xor_b32 s46, s3, 16384
    buffer_load_dwordx4 v151, s[24:27], s46 offen lds
    v_cvt_pk_bf16_f32 v143, v18, v19
    v_cvt_pk_bf16_f32 v144, v32, v33
    v_cvt_pk_bf16_f32 v145, v34, v35
    s_nop 1
    v_mov_b32 v152, 0
    v_mov_b32 v153, 0
    v_mov_b32 v154, 0
    v_mov_b32 v155, 0
    v_mov_b32 v156, 0
    v_mov_b32 v157, 0
    v_mov_b32 v158, 0
    v_mov_b32 v159, 0
    v_mov_b32 v160, 0
    s_add_u32 m0, s39, 4096
    s_xor_b32 s46, s3, 65536
    buffer_load_dwordx4 v150, s[24:27], s46 offen lds
    v_mov_b32 v161, 0
    v_mov_b32 v162, 0
    v_mov_b32 v163, 0
    v_mov_b32 v164, 0
    v_mov_b32 v165, 0
    v_mov_b32 v166, 0
    v_mov_b32 v167, 0
    ds_read_b64_tr_b16 v[84:85], v14 offset:3072
    ds_read_b64_tr_b16 v[86:87], v14 offset:4608
    ds_read_b64_tr_b16 v[88:89], v14 offset:3104
    ds_read_b64_tr_b16 v[90:91], v14 offset:4640
    ds_read_b64_tr_b16 v[92:93], v14 offset:3136
    ds_read_b64_tr_b16 v[94:95], v14 offset:4672
    s_add_u32 m0, s39, 5120
    s_xor_b32 s46, s3, 65536
    buffer_load_dwordx4 v151, s[24:27], s46 offen lds
    v_lshlrev_b32 v10, 3, v1
    s_cmp_lg_u32 s1, 0
    s_cbranch_scc0 pk_w71_s
    buffer_store_dwordx2 v[142:143], v10, s[16:19], s45 offen offset:0
    buffer_store_dwordx2 v[144:145], v10, s[16:19], s45 offen offset:512
pk_w71_r:
    ds_read_b64_tr_b16 v[96:97], v14 offset:6144
    ds_read_b64_tr_b16 v[98:99], v14 offset:7680
    ds_read_b64_tr_b16 v[100:101], v14 offset:6176
    ds_read_b64_tr_b16 v[102:103], v14 offset:7712
    ds_read_b64_tr_b16 v[104:105], v14 offset:6208
    ds_read_b64_tr_b16 v[106:107], v14 offset:7744
    v_cvt_pk_bf16_f32 v168, v20, v21
    v_cvt_pk_bf16_f32 v170, v22, v23
    v_cvt_pk_bf16_f32 v172, v36, v37
    v_cvt_pk_bf16_f32 v174, v38, v39
    v_lshlrev_b32 v20, 16, v168
    v_and_b32 v21, 0xffff0000, v168
    v_lshlrev_b32 v22, 16, v170
    s_add_u32 m0, s39, 6144
    s_xor_b32 s46, s3, 81920
    buffer_load_dwordx4 v150, s[24:27], s46 offen lds
    v_and_b32 v23, 0xffff0000, v170
    v_lshlrev_b32 v36, 16, v172
    v_and_b32 v37, 0xffff0000, v172
    v_lshlrev_b32 v38, 16, v174
    v_and_b32 v39, 0xffff0000, v174
    v_pk_mul_f32 v[168:169], v[20:21], v[20:21]
    v_pk_mul_f32 v[170:171], v[22:23], v[22:23]
    v_pk_mul_f32 v[172:173], v[36:37], v[36:37]
    v_pk_mul_f32 v[174:175], v[38:39], v[38:39]
    v_pk_fma_f32 v[168:169], v[168:169], v[138:139], v[136:137]
    v_pk_fma_f32 v[170:171], v[170:171], v[138:139], v[136:137]
    v_pk_fma_f32 v[172:173], v[172:173], v[138:139], v[136:137]
    v_pk_fma_f32 v[174:175], v[174:175], v[138:139], v[136:137]
    s_add_u32 m0, s39, 7168
    s_xor_b32 s46, s3, 81920
    buffer_load_dwordx4 v151, s[24:27], s46 offen lds
    v_pk_mul_f32 v[168:169], v[168:169], v[20:21]
    v_pk_mul_f32 v[170:171], v[170:171], v[22:23]
    v_pk_mul_f32 v[172:173], v[172:173], v[36:37]
    v_pk_mul_f32 v[174:175], v[174:175], v[38:39]
    v_exp_f32 v168, v168
    v_exp_f32 v169, v169
    v_exp_f32 v170, v170
    s_add_u32 m0, s39, 32768
    s_xor_b32 s46, s3, 128
    buffer_load_dwordx4 v150, s[24:27], s46 offen lds
    v_exp_f32 v171, v171
    v_exp_f32 v172, v172
    v_exp_f32 v173, v173
    v_exp_f32 v174, v174
    s_add_u32 m0, s39, 33792
    s_xor_b32 s46, s3, 128
    buffer_load_dwordx4 v151, s[24:27], s46 offen lds
    v_exp_f32 v175, v175
    v_pk_add_f32 v[168:169], v[168:169], v[140:141]
    v_pk_add_f32 v[170:171], v[170:171], v[140:141]
    v_pk_add_f32 v[172:173], v[172:173], v[140:141]
    v_pk_add_f32 v[174:175], v[174:175], v[140:141]
    v_rcp_f32 v168, v168
    v_rcp_f32 v169, v169
    s_add_u32 m0, s39, 34816
    s_xor_b32 s46, s3, 16512
    buffer_load_dwordx4 v150, s[24:27], s46 offen lds
    v_rcp_f32 v170, v170
    v_rcp_f32 v171, v171
    v_rcp_f32 v172, v172
    v_rcp_f32 v173, v173
    s_add_u32 m0, s39, 35840
    s_xor_b32 s46, s3, 16512
    buffer_load_dwordx4 v151, s[24:27], s46 offen lds
    v_rcp_f32 v174, v174
    v_rcp_f32 v175, v175
    v_pk_mul_f32 v[20:21], v[20:21], v[168:169]
    v_pk_mul_f32 v[22:23], v[22:23], v[170:171]
    v_pk_mul_f32 v[36:37], v[36:37], v[172:173]
    v_pk_mul_f32 v[38:39], v[38:39], v[174:175]
    v_cvt_pk_bf16_f32 v142, v20, v21
    s_add_u32 m0, s39, 36864
    s_xor_b32 s46, s3, 65664
    buffer_load_dwordx4 v150, s[24:27], s46 offen lds
    v_cvt_pk_bf16_f32 v143, v22, v23
    v_cvt_pk_bf16_f32 v144, v36, v37
    v_cvt_pk_bf16_f32 v145, v38, v39
    ds_read_b64_tr_b16 v[108:109], v14 offset:9216
    ds_read_b64_tr_b16 v[110:111], v14 offset:10752
    ds_read_b64_tr_b16 v[112:113], v14 offset:9248
    ds_read_b64_tr_b16 v[114:115], v14 offset:10784
    ds_read_b64_tr_b16 v[116:117], v14 offset:9280
    ds_read_b64_tr_b16 v[118:119], v14 offset:10816
    v_lshlrev_b32 v10, 3, v1
    s_cmp_lg_u32 s1, 0
    s_cbranch_scc0 pk_w72_s
    buffer_store_dwordx2 v[142:143], v10, s[16:19], s45 offen offset:1024
    buffer_store_dwordx2 v[144:145], v10, s[16:19], s45 offen offset:1536
pk_w72_r:
    ds_read_b64_tr_b16 v[120:121], v14 offset:12288
    ds_read_b64_tr_b16 v[122:123], v14 offset:13824
    ds_read_b64_tr_b16 v[124:125], v14 offset:12320
    ds_read_b64_tr_b16 v[126:127], v14 offset:13856
    ds_read_b64_tr_b16 v[128:129], v14 offset:12352
    ds_read_b64_tr_b16 v[130:131], v14 offset:13888
    v_cvt_pk_bf16_f32 v168, v24, v25
    v_cvt_pk_bf16_f32 v170, v26, v27
    v_cvt_pk_bf16_f32 v172, v40, v41
    v_cvt_pk_bf16_f32 v174, v42, v43
    v_lshlrev_b32 v24, 16, v168
    v_and_b32 v25, 0xffff0000, v168
    v_lshlrev_b32 v26, 16, v170
    s_add_u32 m0, s39, 37888
    s_xor_b32 s46, s3, 65664
    buffer_load_dwordx4 v151, s[24:27], s46 offen lds
    v_and_b32 v27, 0xffff0000, v170
    v_lshlrev_b32 v40, 16, v172
    v_and_b32 v41, 0xffff0000, v172
    v_lshlrev_b32 v42, 16, v174
    v_and_b32 v43, 0xffff0000, v174
    v_pk_mul_f32 v[168:169], v[24:25], v[24:25]
    v_pk_mul_f32 v[170:171], v[26:27], v[26:27]
    v_pk_mul_f32 v[172:173], v[40:41], v[40:41]
    v_pk_mul_f32 v[174:175], v[42:43], v[42:43]
    v_pk_fma_f32 v[168:169], v[168:169], v[138:139], v[136:137]
    v_pk_fma_f32 v[170:171], v[170:171], v[138:139], v[136:137]
    v_pk_fma_f32 v[172:173], v[172:173], v[138:139], v[136:137]
    v_pk_fma_f32 v[174:175], v[174:175], v[138:139], v[136:137]
    s_add_u32 m0, s39, 38912
    s_xor_b32 s46, s3, 82048
    buffer_load_dwordx4 v150, s[24:27], s46 offen lds
    v_pk_mul_f32 v[168:169], v[168:169], v[24:25]
    v_pk_mul_f32 v[170:171], v[170:171], v[26:27]
    v_pk_mul_f32 v[172:173], v[172:173], v[40:41]
    v_pk_mul_f32 v[174:175], v[174:175], v[42:43]
    v_exp_f32 v168, v168
    v_exp_f32 v169, v169
    v_exp_f32 v170, v170
    s_add_u32 m0, s39, 39936
    s_xor_b32 s46, s3, 82048
    buffer_load_dwordx4 v151, s[24:27], s46 offen lds
    v_exp_f32 v171, v171
    v_exp_f32 v172, v172
    v_exp_f32 v173, v173
    v_exp_f32 v174, v174
    s_add_u32 m0, s39, 65536
    s_xor_b32 s46, s3, 256
    buffer_load_dwordx4 v150, s[24:27], s46 offen lds
    v_exp_f32 v175, v175
    v_pk_add_f32 v[168:169], v[168:169], v[140:141]
    v_pk_add_f32 v[170:171], v[170:171], v[140:141]
    v_pk_add_f32 v[172:173], v[172:173], v[140:141]
    v_pk_add_f32 v[174:175], v[174:175], v[140:141]
    v_rcp_f32 v168, v168
    v_rcp_f32 v169, v169
    s_add_u32 m0, s39, 66560
    s_xor_b32 s46, s3, 256
    buffer_load_dwordx4 v151, s[24:27], s46 offen lds
    v_rcp_f32 v170, v170
    v_rcp_f32 v171, v171
    v_rcp_f32 v172, v172
    v_rcp_f32 v173, v173
    s_add_u32 m0, s39, 67584
    s_xor_b32 s46, s3, 16640
    buffer_load_dwordx4 v150, s[24:27], s46 offen lds
    v_rcp_f32 v174, v174
    v_rcp_f32 v175, v175
    v_pk_mul_f32 v[24:25], v[24:25], v[168:169]
    v_pk_mul_f32 v[26:27], v[26:27], v[170:171]
    v_pk_mul_f32 v[40:41], v[40:41], v[172:173]
    v_pk_mul_f32 v[42:43], v[42:43], v[174:175]
    v_cvt_pk_bf16_f32 v142, v24, v25
    s_add_u32 m0, s39, 68608
    s_xor_b32 s46, s3, 16640
    buffer_load_dwordx4 v151, s[24:27], s46 offen lds
    v_cvt_pk_bf16_f32 v143, v26, v27
    v_cvt_pk_bf16_f32 v144, v40, v41
    v_cvt_pk_bf16_f32 v145, v42, v43
    ds_read_b64_tr_b16 a[208:209], v14 offset:15360
    ds_read_b64_tr_b16 a[210:211], v14 offset:16896
    ds_read_b64_tr_b16 a[212:213], v14 offset:15392
    ds_read_b64_tr_b16 a[214:215], v14 offset:16928
    ds_read_b64_tr_b16 a[216:217], v14 offset:15424
    ds_read_b64_tr_b16 a[218:219], v14 offset:16960
    v_lshlrev_b32 v10, 3, v1
    s_cmp_lg_u32 s1, 0
    s_cbranch_scc0 pk_w73_s
    buffer_store_dwordx2 v[142:143], v10, s[16:19], s45 offen offset:2048
    buffer_store_dwordx2 v[144:145], v10, s[16:19], s45 offen offset:2560
pk_w73_r:
    v_cvt_pk_bf16_f32 v168, v28, v29
    v_cvt_pk_bf16_f32 v170, v30, v31
    v_cvt_pk_bf16_f32 v172, v44, v45
    v_cvt_pk_bf16_f32 v174, v46, v47
    v_lshlrev_b32 v28, 16, v168
    v_and_b32 v29, 0xffff0000, v168
    v_lshlrev_b32 v30, 16, v170
    v_and_b32 v31, 0xffff0000, v170
    v_lshlrev_b32 v44, 16, v172
    v_and_b32 v45, 0xffff0000, v172
    v_lshlrev_b32 v46, 16, v174
    v_and_b32 v47, 0xffff0000, v174
    v_pk_mul_f32 v[168:169], v[28:29], v[28:29]
    s_add_u32 m0, s39, 69632
    s_xor_b32 s46, s3, 65792
    buffer_load_dwordx4 v150, s[24:27], s46 offen lds
    v_pk_mul_f32 v[170:171], v[30:31], v[30:31]
    v_pk_mul_f32 v[172:173], v[44:45], v[44:45]
    v_pk_mul_f32 v[174:175], v[46:47], v[46:47]
    v_pk_fma_f32 v[168:169], v[168:169], v[138:139], v[136:137]
    v_pk_fma_f32 v[170:171], v[170:171], v[138:139], v[136:137]
    v_pk_fma_f32 v[172:173], v[172:173], v[138:139], v[136:137]
    v_pk_fma_f32 v[174:175], v[174:175], v[138:139], v[136:137]
    v_pk_mul_f32 v[168:169], v[168:169], v[28:29]
    v_pk_mul_f32 v[170:171], v[170:171], v[30:31]
    v_pk_mul_f32 v[172:173], v[172:173], v[44:45]
    v_pk_mul_f32 v[174:175], v[174:175], v[46:47]
    v_exp_f32 v168, v168
    s_add_u32 m0, s39, 70656
    s_xor_b32 s46, s3, 65792
    buffer_load_dwordx4 v151, s[24:27], s46 offen lds
    v_exp_f32 v169, v169
    v_exp_f32 v170, v170
    v_exp_f32 v171, v171
    v_exp_f32 v172, v172
    s_add_u32 m0, s39, 71680
    s_xor_b32 s46, s3, 82176
    buffer_load_dwordx4 v150, s[24:27], s46 offen lds
    v_exp_f32 v173, v173
    v_exp_f32 v174, v174
    v_exp_f32 v175, v175
    v_pk_add_f32 v[168:169], v[168:169], v[140:141]
    s_add_u32 m0, s39, 72704
    s_xor_b32 s46, s3, 82176
    buffer_load_dwordx4 v151, s[24:27], s46 offen lds
    v_pk_add_f32 v[170:171], v[170:171], v[140:141]
    v_pk_add_f32 v[172:173], v[172:173], v[140:141]
    v_pk_add_f32 v[174:175], v[174:175], v[140:141]
    v_rcp_f32 v168, v168
    v_rcp_f32 v169, v169
    v_rcp_f32 v170, v170
    v_rcp_f32 v171, v171
    v_rcp_f32 v172, v172
    v_rcp_f32 v173, v173
    v_rcp_f32 v174, v174
    v_rcp_f32 v175, v175
    v_pk_mul_f32 v[28:29], v[28:29], v[168:169]
    v_pk_mul_f32 v[30:31], v[30:31], v[170:171]
    v_pk_mul_f32 v[44:45], v[44:45], v[172:173]
    v_pk_mul_f32 v[46:47], v[46:47], v[174:175]
    v_cvt_pk_bf16_f32 v142, v28, v29
    v_cvt_pk_bf16_f32 v143, v30, v31
    v_cvt_pk_bf16_f32 v144, v44, v45
    v_cvt_pk_bf16_f32 v145, v46, v47
    v_lshlrev_b32 v10, 3, v1
    s_cmp_lg_u32 s1, 0
    s_cbranch_scc0 pk_w74_s
    buffer_store_dwordx2 v[142:143], v10, s[16:19], s45 offen offset:3072
    buffer_store_dwordx2 v[144:145], v10, s[16:19], s45 offen offset:3584
pk_w74_r:
    s_branch pk_dz2
pk_w75_s:
    s_nop 7
    s_nop 7
    buffer_store_dwordx4 v[142:145], v10, s[16:19], s36 offen sc1
    s_nop 4
    s_branch pk_w75_r
pk_w77_s:
    s_nop 7
    s_nop 7
    buffer_store_dwordx2 v[78:79], v93, s[16:19], s44 offen offset:0 sc1
    buffer_store_dwordx2 v[80:81], v93, s[16:19], s44 offen offset:512 sc1
    s_nop 4
    s_branch pk_w77_r
pk_w78_s:
    s_nop 7
    s_nop 7
    buffer_store_dwordx2 v[78:79], v93, s[16:19], s44 offen offset:0 sc1
    buffer_store_dwordx2 v[80:81], v93, s[16:19], s44 offen offset:512 sc1
    s_nop 4
    s_branch pk_w78_r
pk_w79_s:
    s_nop 7
    s_nop 7
    buffer_store_dwordx2 v[78:79], v93, s[16:19], s44 offen offset:0 sc1
    buffer_store_dwordx2 v[80:81], v93, s[16:19], s44 offen offset:512 sc1
    s_nop 4
    s_branch pk_w79_r
pk_c80_s:
    s_nop 7
    s_nop 7
    s_mov_b32 s47, 0
pk_c80_l:
    s_mov_b64 exec, vcc
    s_sleep 1
    s_mov_b32 s46, 0x1880000
    buffer_load_dwordx4 v[128:131], v11, s[16:19], s46 offen sc1
    s_mov_b32 s46, 0x1880400
    buffer_load_dwordx4 v[132:135], v11, s[16:19], s46 offen sc1
    s_mov_b32 s46, 0x1880800
    buffer_load_dwordx4 v[136:139], v11, s[16:19], s46 offen sc1
    s_mov_b32 s46, 0x1880c00
    buffer_load_dwordx4 v[140:143], v11, s[16:19], s46 offen sc1
    s_mov_b32 s46, 0x1881000
    buffer_load_dwordx4 v[144:147], v11, s[16:19], s46 offen sc1
    s_mov_b32 s46, 0x1881400
    buffer_load_dwordx4 v[148:151], v11, s[16:19], s46 offen sc1
    s_mov_b32 s46, 0x1881800
    buffer_load_dwordx4 v[152:155], v12, s[16:19], s46 offen sc1
    s_mov_b32 s46, 0x188d800
    buffer_load_dwordx4 v[156:159], v11, s[16:19], s46 offen sc1
    s_mov_b32 s46, 0x188dc00
    buffer_load_dwordx4 v[160:163], v11, s[16:19], s46 offen sc1
    s_mov_b32 s46, 0x188e000
    buffer_load_dwordx4 v[164:167], v11, s[16:19], s46 offen sc1
    s_mov_b32 s46, 0x188e400
    buffer_load_dwordx4 v[168:171], v11, s[16:19], s46 offen sc1
    s_mov_b32 s46, 0x188e800
    buffer_load_dwordx4 v[172:175], v11, s[16:19], s46 offen sc1
    s_mov_b32 s46, 0x188ec00
    buffer_load_dwordx4 v[176:179], v11, s[16:19], s46 offen sc1
    s_mov_b32 s46, 0x188f000
    buffer_load_dwordx4 v[180:183], v12, s[16:19], s46 offen sc1
    s_add_u32 s47, s47, 1
    s_waitcnt vmcnt(0)
    v_max3_u32 v2, v128, v132, v136
    v_max3_u32 v2, v2, v140, v144
    v_max3_u32 v2, v2, v148, v152
    v_cmp_eq_u32 vcc, -1, v2
    s_cmp_eq_u64 vcc, 0
    s_cbranch_scc1 pk_c80_x
    s_cmp_lt_u32 s47, 0x2000
    s_cbranch_scc1 pk_c80_l
pk_c80_x:
    s_mov_b64 exec, -1
    s_nop 4
    s_branch pk_c80_r
pk_c81_s:
    s_nop 7
    s_nop 7
    s_mov_b32 s47, 0
pk_c81_l:
    s_mov_b64 exec, vcc
    s_sleep 1
    s_mov_b32 s46, 0x188d800
    buffer_load_dwordx4 v[156:159], v11, s[16:19], s46 offen sc1
    s_mov_b32 s46, 0x188dc00
    buffer_load_dwordx4 v[160:163], v11, s[16:19], s46 offen sc1
    s_mov_b32 s46, 0x188e000
    buffer_load_dwordx4 v[164:167], v11, s[16:19], s46 offen sc1
    s_mov_b32 s46, 0x188e400
    buffer_load_dwordx4 v[168:171], v11, s[16:19], s46 offen sc1
    s_mov_b32 s46, 0x188e800
    buffer_load_dwordx4 v[172:175], v11, s[16:19], s46 offen sc1
    s_mov_b32 s46, 0x188ec00
    buffer_load_dwordx4 v[176:179], v11, s[16:19], s46 offen sc1
    s_mov_b32 s46, 0x188f000
    buffer_load_dwordx4 v[180:183], v12, s[16:19], s46 offen sc1
    s_mov_b32 s46, 0x189b000
    buffer_load_dwordx4 v[184:187], v11, s[16:19], s46 offen sc1
    s_mov_b32 s46, 0x189b400
    buffer_load_dwordx4 v[188:191], v11, s[16:19], s46 offen sc1
    s_mov_b32 s46, 0x189b800
    buffer_load_dwordx4 v[192:195], v11, s[16:19], s46 offen sc1
    s_mov_b32 s46, 0x189bc00
    buffer_load_dwordx4 v[196:199], v11, s[16:19], s46 offen sc1
    s_mov_b32 s46, 0x189c000
    buffer_load_dwordx4 v[200:203], v11, s[16:19], s46 offen sc1
    s_mov_b32 s46, 0x189c400
    buffer_load_dwordx4 v[204:207], v11, s[16:19], s46 offen sc1
    s_mov_b32 s46, 0x189c800
    buffer_load_dwordx4 v[208:211], v12, s[16:19], s46 offen sc1
    s_mov_b32 s46, 0x18a8800
    buffer_load_dwordx4 v[212:215], v11, s[16:19], s46 offen sc1
    s_mov_b32 s46, 0x18a8c00
    buffer_load_dwordx4 v[216:219], v11, s[16:19], s46 offen sc1
    s_mov_b32 s46, 0x18a9000
    buffer_load_dwordx4 v[220:223], v11, s[16:19], s46 offen sc1
    s_add_u32 s47, s47, 1
    s_waitcnt vmcnt(0)
    v_max3_u32 v2, v156, v160, v164
    v_max3_u32 v2, v2, v168, v172
    v_max3_u32 v2, v2, v176, v180
    v_cmp_eq_u32 vcc, -1, v2
    s_cmp_eq_u64 vcc, 0
    s_cbranch_scc1 pk_c81_x
    s_cmp_lt_u32 s47, 0x2000
    s_cbranch_scc1 pk_c81_l
pk_c81_x:
    s_mov_b64 exec, -1
    s_nop 4
    s_branch pk_c81_r
pk_c82_s:
    s_nop 7
    s_nop 7
    s_mov_b32 s47, 0
pk_c82_l:
    s_mov_b64 exec, vcc
    s_sleep 1
    s_mov_b32 s46, 0x189b000
    buffer_load_dwordx4 v[184:187], v11, s[16:19], s46 offen sc1
    s_mov_b32 s46, 0x189b400
    buffer_load_dwordx4 v[188:191], v11, s[16:19], s46 offen sc1
    s_mov_b32 s46, 0x189b800
    buffer_load_dwordx4 v[192:195], v11, s[16:19], s46 offen sc1
    s_mov_b32 s46, 0x189bc00
    buffer_load_dwordx4 v[196:199], v11, s[16:19], s46 offen sc1
    s_mov_b32 s46, 0x189c000
    buffer_load_dwordx4 v[200:203], v11, s[16:19], s46 offen sc1
    s_mov_b32 s46, 0x189c400
    buffer_load_dwordx4 v[204:207], v11, s[16:19], s46 offen sc1
    s_mov_b32 s46, 0x189c800
    buffer_load_dwordx4 v[208:211], v12, s[16:19], s46 offen sc1
    s_mov_b32 s46, 0x18a8800
    buffer_load_dwordx4 v[212:215], v11, s[16:19], s46 offen sc1
    s_mov_b32 s46, 0x18a8c00
    buffer_load_dwordx4 v[216:219], v11, s[16:19], s46 offen sc1
    s_mov_b32 s46, 0x18a9000
    buffer_load_dwordx4 v[220:223], v11, s[16:19], s46 offen sc1
    s_mov_b32 s46, 0x18a9400
    buffer_load_dwordx4 v[224:227], v11, s[16:19], s46 offen sc1
    s_mov_b32 s46, 0x18a9800
    buffer_load_dwordx4 v[228:231], v11, s[16:19], s46 offen sc1
    s_mov_b32 s46, 0x18a9c00
    buffer_load_dwordx4 v[232:235], v11, s[16:19], s46 offen sc1
    s_mov_b32 s46, 0x18aa000
    buffer_load_dwordx4 v[236:239], v12, s[16:19], s46 offen sc1
    s_mov_b32 s46, 0x18b6000
    buffer_load_dwordx4 v[128:131], v11, s[16:19], s46 offen sc1
    s_mov_b32 s46, 0x18b6400
    buffer_load_dwordx4 v[132:135], v11, s[16:19], s46 offen sc1
    s_mov_b32 s46, 0x18b6800
    buffer_load_dwordx4 v[136:139], v11, s[16:19], s46 offen sc1
    s_add_u32 s47, s47, 1
    s_waitcnt vmcnt(0)
    v_max3_u32 v2, v184, v188, v192
    v_max3_u32 v2, v2, v196, v200
    v_max3_u32 v2, v2, v204, v208
    v_cmp_eq_u32 vcc, -1, v2
    s_cmp_eq_u64 vcc, 0
    s_cbranch_scc1 pk_c82_x
    s_cmp_lt_u32 s47, 0x2000
    s_cbranch_scc1 pk_c82_l
pk_c82_x:
    s_mov_b64 exec, -1
    s_nop 4
    s_branch pk_c82_r
pk_c83_s:
    s_nop 7
    s_nop 7
    s_mov_b32 s47, 0
pk_c83_l:
    s_mov_b64 exec, vcc
    s_sleep 1
    s_mov_b32 s46, 0x18a8800
    buffer_load_dwordx4 v[212:215], v11, s[16:19], s46 offen sc1
    s_mov_b32 s46, 0x18a8c00
    buffer_load_dwordx4 v[216:219], v11, s[16:19], s46 offen sc1
    s_mov_b32 s46, 0x18a9000
    buffer_load_dwordx4 v[220:223], v11, s[16:19], s46 offen sc1
    s_mov_b32 s46, 0x18a9400
    buffer_load_dwordx4 v[224:227], v11, s[16:19], s46 offen sc1
    s_mov_b32 s46, 0x18a9800
    buffer_load_dwordx4 v[228:231], v11, s[16:19], s46 offen sc1
    s_mov_b32 s46, 0x18a9c00
    buffer_load_dwordx4 v[232:235], v11, s[16:19], s46 offen sc1
    s_mov_b32 s46, 0x18aa000
    buffer_load_dwordx4 v[236:239], v12, s[16:19], s46 offen sc1
    s_mov_b32 s46, 0x18b6000
    buffer_load_dwordx4 v[128:131], v11, s[16:19], s46 offen sc1
    s_mov_b32 s46, 0x18b6400
    buffer_load_dwordx4 v[132:135], v11, s[16:19], s46 offen sc1
    s_mov_b32 s46, 0x18b6800
    buffer_load_dwordx4 v[136:139], v11, s[16:19], s46 offen sc1
    s_mov_b32 s46, 0x18b6c00
    buffer_load_dwordx4 v[140:143], v11, s[16:19], s46 offen sc1
    s_mov_b32 s46, 0x18b7000
    buffer_load_dwordx4 v[144:147], v11, s[16:19], s46 offen sc1
    s_mov_b32 s46, 0x18b7400
    buffer_load_dwordx4 v[148:151], v11, s[16:19], s46 offen sc1
    s_mov_b32 s46, 0x18b7800
    buffer_load_dwordx4 v[152:155], v12, s[16:19], s46 offen sc1
    s_mov_b32 s46, 0x18c3800
    buffer_load_dwordx4 v[156:159], v11, s[16:19], s46 offen sc1
    s_mov_b32 s46, 0x18c3c00
    buffer_load_dwordx4 v[160:163], v11, s[16:19], s46 offen sc1
    s_mov_b32 s46, 0x18c4000
    buffer_load_dwordx4 v[164:167], v11, s[16:19], s46 offen sc1
    s_add_u32 s47, s47, 1
    s_waitcnt vmcnt(0)
    v_max3_u32 v2, v212, v216, v220
    v_max3_u32 v2, v2, v224, v228
    v_max3_u32 v2, v2, v232, v236
    v_cmp_eq_u32 vcc, -1, v2
    s_cmp_eq_u64 vcc, 0
    s_cbranch_scc1 pk_c83_x
    s_cmp_lt_u32 s47, 0x2000
    s_cbranch_scc1 pk_c83_l
pk_c83_x:
    s_mov_b64 exec, -1
    s_nop 4
    s_branch pk_c83_r
pk_w84_s:
    s_nop 7
    s_nop 7
    buffer_store_dword v2, v2, s[16:19], s35 offen sc1
    s_nop 4
    s_branch pk_w84_r
pk_c85_s:
    s_nop 7
    s_nop 7
    s_mov_b32 s47, 0
pk_c85_l:
    s_mov_b64 exec, vcc
    s_sleep 1
    s_mov_b32 s46, 0x18b6000
    buffer_load_dwordx4 v[128:131], v11, s[16:19], s46 offen sc1
    s_mov_b32 s46, 0x18b6400
    buffer_load_dwordx4 v[132:135], v11, s[16:19], s46 offen sc1
    s_mov_b32 s46, 0x18b6800
    buffer_load_dwordx4 v[136:139], v11, s[16:19], s46 offen sc1
    s_mov_b32 s46, 0x18b6c00
    buffer_load_dwordx4 v[140:143], v11, s[16:19], s46 offen sc1
    s_mov_b32 s46, 0x18b7000
    buffer_load_dwordx4 v[144:147], v11, s[16:19], s46 offen sc1
    s_mov_b32 s46, 0x18b7400
    buffer_load_dwordx4 v[148:151], v11, s[16:19], s46 offen sc1
    s_mov_b32 s46, 0x18b7800
    buffer_load_dwordx4 v[152:155], v12, s[16:19], s46 offen sc1
    s_mov_b32 s46, 0x18c3800
    buffer_load_dwordx4 v[156:159], v11, s[16:19], s46 offen sc1
    s_mov_b32 s46, 0x18c3c00
    buffer_load_dwordx4 v[160:163], v11, s[16:19], s46 offen sc1
    s_mov_b32 s46, 0x18c4000
    buffer_load_dwordx4 v[164:167], v11, s[16:19], s46 offen sc1
    s_mov_b32 s46, 0x18c4400
    buffer_load_dwordx4 v[168:171], v11, s[16:19], s46 offen sc1
    s_mov_b32 s46, 0x18c4800
    buffer_load_dwordx4 v[172:175], v11, s[16:19], s46 offen sc1
    s_mov_b32 s46, 0x18c4c00
    buffer_load_dwordx4 v[176:179], v11, s[16:19], s46 offen sc1
    s_mov_b32 s46, 0x18c5000
    buffer_load_dwordx4 v[180:183], v12, s[16:19], s46 offen sc1
    s_mov_b32 s46, 0x18d1000
    buffer_load_dwordx4 v[184:187], v11, s[16:19], s46 offen sc1
    s_mov_b32 s46, 0x18d1400
    buffer_load_dwordx4 v[188:191], v11, s[16:19], s46 offen sc1
    s_mov_b32 s46, 0x18d1800
    buffer_load_dwordx4 v[192:195], v11, s[16:19], s46 offen sc1
    s_add_u32 s47, s47, 1
    s_waitcnt vmcnt(0)
    v_max3_u32 v2, v128, v132, v136
    v_max3_u32 v2, v2, v140, v144
    v_max3_u32 v2, v2, v148, v152
    v_cmp_eq_u32 vcc, -1, v2
    s_cmp_eq_u64 vcc, 0
    s_cbranch_scc1 pk_c85_x
    s_cmp_lt_u32 s47, 0x2000
    s_cbranch_scc1 pk_c85_l
pk_c85_x:
    s_mov_b64 exec, -1
    s_nop 4
    s_branch pk_c85_r
pk_c86_s:
    s_nop 7
    s_nop 7
    s_mov_b32 s47, 0
pk_c86_l:
    s_mov_b64 exec, vcc
    s_sleep 1
    s_mov_b32 s46, 0x18c3800
    buffer_load_dwordx4 v[156:159], v11, s[16:19], s46 offen sc1
    s_mov_b32 s46, 0x18c3c00
    buffer_load_dwordx4 v[160:163], v11, s[16:19], s46 offen sc1
    s_mov_b32 s46, 0x18c4000
    buffer_load_dwordx4 v[164:167], v11, s[16:19], s46 offen sc1
    s_mov_b32 s46, 0x18c4400
    buffer_load_dwordx4 v[168:171], v11, s[16:19], s46 offen sc1
    s_mov_b32 s46, 0x18c4800
    buffer_load_dwordx4 v[172:175], v11, s[16:19], s46 offen sc1
    s_mov_b32 s46, 0x18c4c00
    buffer_load_dwordx4 v[176:179], v11, s[16:19], s46 offen sc1
    s_mov_b32 s46, 0x18c5000
    buffer_load_dwordx4 v[180:183], v12, s[16:19], s46 offen sc1
    s_mov_b32 s46, 0x18d1000
    buffer_load_dwordx4 v[184:187], v11, s[16:19], s46 offen sc1
    s_mov_b32 s46, 0x18d1400
    buffer_load_dwordx4 v[188:191], v11, s[16:19], s46 offen sc1
    s_mov_b32 s46, 0x18d1800
    buffer_load_dwordx4 v[192:195], v11, s[16:19], s46 offen sc1
    s_mov_b32 s46, 0x18d1c00
    buffer_load_dwordx4 v[196:199], v11, s[16:19], s46 offen sc1
    s_mov_b32 s46, 0x18d2000
    buffer_load_dwordx4 v[200:203], v11, s[16:19], s46 offen sc1
    s_mov_b32 s46, 0x18d2400
    buffer_load_dwordx4 v[204:207], v11, s[16:19], s46 offen sc1
    s_mov_b32 s46, 0x18d2800
    buffer_load_dwordx4 v[208:211], v12, s[16:19], s46 offen sc1
    s_mov_b32 s46, 0x18de800
    buffer_load_dwordx4 v[212:215], v11, s[16:19], s46 offen sc1
    s_mov_b32 s46, 0x18dec00
    buffer_load_dwordx4 v[216:219], v11, s[16:19], s46 offen sc1
    s_mov_b32 s46, 0x18df000
    buffer_load_dwordx4 v[220:223], v11, s[16:19], s46 offen sc1
    s_add_u32 s47, s47, 1
    s_waitcnt vmcnt(0)
    v_max3_u32 v2, v156, v160, v164
    v_max3_u32 v2, v2, v168, v172
    v_max3_u32 v2, v2, v176, v180
    v_cmp_eq_u32 vcc, -1, v2
    s_cmp_eq_u64 vcc, 0
    s_cbranch_scc1 pk_c86_x
    s_cmp_lt_u32 s47, 0x2000
    s_cbranch_scc1 pk_c86_l
pk_c86_x:
    s_mov_b64 exec, -1
    s_nop 4
    s_branch pk_c86_r
pk_c87_s:
    s_nop 7
    s_nop 7
    s_mov_b32 s47, 0
pk_c87_l:
    s_mov_b64 exec, vcc
    s_sleep 1
    s_mov_b32 s46, 0x18d1000
    buffer_load_dwordx4 v[184:187], v11, s[16:19], s46 offen sc1
    s_mov_b32 s46, 0x18d1400
    buffer_load_dwordx4 v[188:191], v11, s[16:19], s46 offen sc1
    s_mov_b32 s46, 0x18d1800
    buffer_load_dwordx4 v[192:195], v11, s[16:19], s46 offen sc1
    s_mov_b32 s46, 0x18d1c00
    buffer_load_dwordx4 v[196:199], v11, s[16:19], s46 offen sc1
    s_mov_b32 s46, 0x18d2000
    buffer_load_dwordx4 v[200:203], v11, s[16:19], s46 offen sc1
    s_mov_b32 s46, 0x18d2400
    buffer_load_dwordx4 v[204:207], v11, s[16:19], s46 offen sc1
    s_mov_b32 s46, 0x18d2800
    buffer_load_dwordx4 v[208:211], v12, s[16:19], s46 offen sc1
    s_mov_b32 s46, 0x18de800
    buffer_load_dwordx4 v[212:215], v11, s[16:19], s46 offen sc1
    s_mov_b32 s46, 0x18dec00
    buffer_load_dwordx4 v[216:219], v11, s[16:19], s46 offen sc1
    s_mov_b32 s46, 0x18df000
    buffer_load_dwordx4 v[220:223], v11, s[16:19], s46 offen sc1
    s_mov_b32 s46, 0x18df400
    buffer_load_dwordx4 v[224:227], v11, s[16:19], s46 offen sc1
    s_mov_b32 s46, 0x18df800
    buffer_load_dwordx4 v[228:231], v11, s[16:19], s46 offen sc1
    s_mov_b32 s46, 0x18dfc00
    buffer_load_dwordx4 v[232:235], v11, s[16:19], s46 offen sc1
    s_mov_b32 s46, 0x18e0000
    buffer_load_dwordx4 v[236:239], v12, s[16:19], s46 offen sc1
    s_mov_b32 s46, 0x18ec000
    buffer_load_dwordx4 v[128:131], v11, s[16:19], s46 offen sc1
    s_mov_b32 s46, 0x18ec400
    buffer_load_dwordx4 v[132:135], v11, s[16:19], s46 offen sc1
    s_mov_b32 s46, 0x18ec800
    buffer_load_dwordx4 v[136:139], v11, s[16:19], s46 offen sc1
    s_add_u32 s47, s47, 1
    s_waitcnt vmcnt(0)
    v_max3_u32 v2, v184, v188, v192
    v_max3_u32 v2, v2, v196, v200
    v_max3_u32 v2, v2, v204, v208
    v_cmp_eq_u32 vcc, -1, v2
    s_cmp_eq_u64 vcc, 0
    s_cbranch_scc1 pk_c87_x
    s_cmp_lt_u32 s47, 0x2000
    s_cbranch_scc1 pk_c87_l
pk_c87_x:
    s_mov_b64 exec, -1
    s_nop 4
    s_branch pk_c87_r
pk_c88_s:
    s_nop 7
    s_nop 7
    s_mov_b32 s47, 0
pk_c88_l:
    s_mov_b64 exec, vcc
    s_sleep 1
    s_mov_b32 s46, 0x18de800
    buffer_load_dwordx4 v[212:215], v11, s[16:19], s46 offen sc1
    s_mov_b32 s46, 0x18dec00
    buffer_load_dwordx4 v[216:219], v11, s[16:19], s46 offen sc1
    s_mov_b32 s46, 0x18df000
    buffer_load_dwordx4 v[220:223], v11, s[16:19], s46 offen sc1
    s_mov_b32 s46, 0x18df400
    buffer_load_dwordx4 v[224:227], v11, s[16:19], s46 offen sc1
    s_mov_b32 s46, 0x18df800
    buffer_load_dwordx4 v[228:231], v11, s[16:19], s46 offen sc1
    s_mov_b32 s46, 0x18dfc00
    buffer_load_dwordx4 v[232:235], v11, s[16:19], s46 offen sc1
    s_mov_b32 s46, 0x18e0000
    buffer_load_dwordx4 v[236:239], v12, s[16:19], s46 offen sc1
    s_mov_b32 s46, 0x18ec000
    buffer_load_dwordx4 v[128:131], v11, s[16:19], s46 offen sc1
    s_mov_b32 s46, 0x18ec400
    buffer_load_dwordx4 v[132:135], v11, s[16:19], s46 offen sc1
    s_mov_b32 s46, 0x18ec800
    buffer_load_dwordx4 v[136:139], v11, s[16:19], s46 offen sc1
    s_mov_b32 s46, 0x18ecc00
    buffer_load_dwordx4 v[140:143], v11, s[16:19], s46 offen sc1
    s_mov_b32 s46, 0x18ed000
    buffer_load_dwordx4 v[144:147], v11, s[16:19], s46 offen sc1
    s_mov_b32 s46, 0x18ed400
    buffer_load_dwordx4 v[148:151], v11, s[16:19], s46 offen sc1
    s_mov_b32 s46, 0x18ed800
    buffer_load_dwordx4 v[152:155], v12, s[16:19], s46 offen sc1
    s_mov_b32 s46, 0x18f9800
    buffer_load_dwordx4 v[156:159], v11, s[16:19], s46 offen sc1
    s_mov_b32 s46, 0x18f9c00
    buffer_load_dwordx4 v[160:163], v11, s[16:19], s46 offen sc1
    s_mov_b32 s46, 0x18fa000
    buffer_load_dwordx4 v[164:167], v11, s[16:19], s46 offen sc1
    s_add_u32 s47, s47, 1
    s_waitcnt vmcnt(0)
    v_max3_u32 v2, v212, v216, v220
    v_max3_u32 v2, v2, v224, v228
    v_max3_u32 v2, v2, v232, v236
    v_cmp_eq_u32 vcc, -1, v2
    s_cmp_eq_u64 vcc, 0
    s_cbranch_scc1 pk_c88_x
    s_cmp_lt_u32 s47, 0x2000
    s_cbranch_scc1 pk_c88_l
pk_c88_x:
    s_mov_b64 exec, -1
    s_nop 4
    s_branch pk_c88_r
pk_c89_s:
    s_nop 7
    s_nop 7
    s_mov_b32 s47, 0
pk_c89_l:
    s_mov_b64 exec, vcc
    s_sleep 1
    s_mov_b32 s46, 0x18ec000
    buffer_load_dwordx4 v[128:131], v11, s[16:19], s46 offen sc1
    s_mov_b32 s46, 0x18ec400
    buffer_load_dwordx4 v[132:135], v11, s[16:19], s46 offen sc1
    s_mov_b32 s46, 0x18ec800
    buffer_load_dwordx4 v[136:139], v11, s[16:19], s46 offen sc1
    s_mov_b32 s46, 0x18ecc00
    buffer_load_dwordx4 v[140:143], v11, s[16:19], s46 offen sc1
    s_mov_b32 s46, 0x18ed000
    buffer_load_dwordx4 v[144:147], v11, s[16:19], s46 offen sc1
    s_mov_b32 s46, 0x18ed400
    buffer_load_dwordx4 v[148:151], v11, s[16:19], s46 offen sc1
    s_mov_b32 s46, 0x18ed800
    buffer_load_dwordx4 v[152:155], v12, s[16:19], s46 offen sc1
    s_mov_b32 s46, 0x18f9800
    buffer_load_dwordx4 v[156:159], v11, s[16:19], s46 offen sc1
    s_mov_b32 s46, 0x18f9c00
    buffer_load_dwordx4 v[160:163], v11, s[16:19], s46 offen sc1
    s_mov_b32 s46, 0x18fa000
    buffer_load_dwordx4 v[164:167], v11, s[16:19], s46 offen sc1
    s_mov_b32 s46, 0x18fa400
    buffer_load_dwordx4 v[168:171], v11, s[16:19], s46 offen sc1
    s_mov_b32 s46, 0x18fa800
    buffer_load_dwordx4 v[172:175], v11, s[16:19], s46 offen sc1
    s_mov_b32 s46, 0x18fac00
    buffer_load_dwordx4 v[176:179], v11, s[16:19], s46 offen sc1
    s_mov_b32 s46, 0x18fb000
    buffer_load_dwordx4 v[180:183], v12, s[16:19], s46 offen sc1
    s_mov_b32 s46, 0x1907000
    buffer_load_dwordx4 v[184:187], v11, s[16:19], s46 offen sc1
    s_mov_b32 s46, 0x1914800
    buffer_load_dwordx4 v[188:191], v11, s[16:19], s46 offen sc1
    s_mov_b32 s46, 0x1922000
    buffer_load_dwordx4 v[192:195], v11, s[16:19], s46 offen sc1
    s_add_u32 s47, s47, 1
    s_waitcnt vmcnt(0)
    v_max3_u32 v2, v128, v132, v136
    v_max3_u32 v2, v2, v140, v144
    v_max3_u32 v2, v2, v148, v152
    v_cmp_eq_u32 vcc, -1, v2
    s_cmp_eq_u64 vcc, 0
    s_cbranch_scc1 pk_c89_x
    s_cmp_lt_u32 s47, 0x2000
    s_cbranch_scc1 pk_c89_l
pk_c89_x:
    s_mov_b64 exec, -1
    s_nop 4
    s_branch pk_c89_r
pk_c90_s:
    s_nop 7
    s_nop 7
    s_mov_b32 s47, 0
pk_c90_l:
    s_mov_b64 exec, vcc
    s_sleep 1
    s_mov_b32 s46, 0x18f9800
    buffer_load_dwordx4 v[156:159], v11, s[16:19], s46 offen sc1
    s_mov_b32 s46, 0x18f9c00
    buffer_load_dwordx4 v[160:163], v11, s[16:19], s46 offen sc1
    s_mov_b32 s46, 0x18fa000
    buffer_load_dwordx4 v[164:167], v11, s[16:19], s46 offen sc1
    s_mov_b32 s46, 0x18fa400
    buffer_load_dwordx4 v[168:171], v11, s[16:19], s46 offen sc1
    s_mov_b32 s46, 0x18fa800
    buffer_load_dwordx4 v[172:175], v11, s[16:19], s46 offen sc1
    s_mov_b32 s46, 0x18fac00
    buffer_load_dwordx4 v[176:179], v11, s[16:19], s46 offen sc1
    s_mov_b32 s46, 0x18fb000
    buffer_load_dwordx4 v[180:183], v12, s[16:19], s46 offen sc1
    s_mov_b32 s46, 0x1907000
    buffer_load_dwordx4 v[184:187], v11, s[16:19], s46 offen sc1
    s_mov_b32 s46, 0x1914800
    buffer_load_dwordx4 v[188:191], v11, s[16:19], s46 offen sc1
    s_mov_b32 s46, 0x1922000
    buffer_load_dwordx4 v[192:195], v11, s[16:19], s46 offen sc1
    s_mov_b32 s46, 0x192f800
    buffer_load_dwordx4 v[196:199], v11, s[16:19], s46 offen sc1
    s_mov_b32 s46, 0x193d000
    buffer_load_dwordx4 v[200:203], v11, s[16:19], s46 offen sc1
    s_mov_b32 s46, 0x194a800
    buffer_load_dwordx4 v[204:207], v11, s[16:19], s46 offen sc1
    s_mov_b32 s46, 0x1907400
    buffer_load_dwordx4 v[208:211], v11, s[16:19], s46 offen sc1
    s_mov_b32 s46, 0x1914c00
    buffer_load_dwordx4 v[212:215], v11, s[16:19], s46 offen sc1
    s_mov_b32 s46, 0x1922400
    buffer_load_dwordx4 v[216:219], v11, s[16:19], s46 offen sc1
    s_mov_b32 s46, 0x192fc00
    buffer_load_dwordx4 v[220:223], v11, s[16:19], s46 offen sc1
    s_add_u32 s47, s47, 1
    s_waitcnt vmcnt(0)
    v_max3_u32 v2, v156, v160, v164
    v_max3_u32 v2, v2, v168, v172
    v_max3_u32 v2, v2, v176, v180
    v_cmp_eq_u32 vcc, -1, v2
    s_cmp_eq_u64 vcc, 0
    s_cbranch_scc1 pk_c90_x
    s_cmp_lt_u32 s47, 0x2000
    s_cbranch_scc1 pk_c90_l
pk_c90_x:
    s_mov_b64 exec, -1
    s_nop 4
    s_branch pk_c90_r
pk_c91_s:
    s_nop 7
    s_nop 7
    s_mov_b32 s47, 0
pk_c91_l:
    s_mov_b64 exec, vcc
    s_sleep 1
    s_mov_b32 s46, 0x1907000
    buffer_load_dwordx4 v[184:187], v11, s[16:19], s46 offen sc1
    s_mov_b32 s46, 0x1914800
    buffer_load_dwordx4 v[188:191], v11, s[16:19], s46 offen sc1
    s_mov_b32 s46, 0x1922000
    buffer_load_dwordx4 v[192:195], v11, s[16:19], s46 offen sc1
    s_mov_b32 s46, 0x192f800
    buffer_load_dwordx4 v[196:199], v11, s[16:19], s46 offen sc1
    s_mov_b32 s46, 0x193d000
    buffer_load_dwordx4 v[200:203], v11, s[16:19], s46 offen sc1
    s_mov_b32 s46, 0x194a800
    buffer_load_dwordx4 v[204:207], v11, s[16:19], s46 offen sc1
    s_mov_b32 s46, 0x1907400
    buffer_load_dwordx4 v[208:211], v11, s[16:19], s46 offen sc1
    s_mov_b32 s46, 0x1914c00
    buffer_load_dwordx4 v[212:215], v11, s[16:19], s46 offen sc1
    s_mov_b32 s46, 0x1922400
    buffer_load_dwordx4 v[216:219], v11, s[16:19], s46 offen sc1
    s_mov_b32 s46, 0x192fc00
    buffer_load_dwordx4 v[220:223], v11, s[16:19], s46 offen sc1
    s_mov_b32 s46, 0x193d400
    buffer_load_dwordx4 v[224:227], v11, s[16:19], s46 offen sc1
    s_mov_b32 s46, 0x194ac00
    buffer_load_dwordx4 v[228:231], v11, s[16:19], s46 offen sc1
    s_mov_b32 s46, 0x1907800
    buffer_load_dwordx4 v[232:235], v11, s[16:19], s46 offen sc1
    s_mov_b32 s46, 0x1915000
    buffer_load_dwordx4 v[236:239], v11, s[16:19], s46 offen sc1
    s_mov_b32 s46, 0x1922800
    buffer_load_dwordx4 v[128:131], v11, s[16:19], s46 offen sc1
    s_mov_b32 s46, 0x1930000
    buffer_load_dwordx4 v[132:135], v11, s[16:19], s46 offen sc1
    s_mov_b32 s46, 0x193d800
    buffer_load_dwordx4 v[136:139], v11, s[16:19], s46 offen sc1
    s_add_u32 s47, s47, 1
    s_waitcnt vmcnt(0)
    v_max3_u32 v2, v184, v188, v192
    v_max3_u32 v2, v2, v196, v200
    v_max_u32 v2, v2, v204
    v_cmp_eq_u32 vcc, -1, v2
    s_cmp_eq_u64 vcc, 0
    s_cbranch_scc1 pk_c91_x
    s_cmp_lt_u32 s47, 0x2000
    s_cbranch_scc1 pk_c91_l
pk_c91_x:
    s_mov_b64 exec, -1
    s_nop 4
    s_branch pk_c91_r
pk_c92_s:
    s_nop 7
    s_nop 7
    s_mov_b32 s47, 0
pk_c92_l:
    s_mov_b64 exec, vcc
    buffer_load_dword v255, v14, s[16:19], s36 offen sc1
    s_add_u32 s47, s47, 1
    s_waitcnt vmcnt(0)
    v_cmp_eq_u32 vcc, -1, v255
    s_cmp_eq_u64 vcc, 0
    s_cbranch_scc1 pk_c92_x
    s_cmp_lt_u32 s47, 0x2000
    s_cbranch_scc1 pk_c92_l
pk_c92_x:
    s_mov_b64 exec, -1
    s_nop 4
    s_branch pk_c92_r
pk_c93_s:
    s_nop 7
    s_nop 7
    s_mov_b32 s47, 0
pk_c93_l:
    s_mov_b64 exec, vcc
    s_sleep 1
    s_mov_b32 s46, 0x1907400
    buffer_load_dwordx4 v[208:211], v11, s[16:19], s46 offen sc1
    s_mov_b32 s46, 0x1914c00
    buffer_load_dwordx4 v[212:215], v11, s[16:19], s46 offen sc1
    s_mov_b32 s46, 0x1922400
    buffer_load_dwordx4 v[216:219], v11, s[16:19], s46 offen sc1
    s_mov_b32 s46, 0x192fc00
    buffer_load_dwordx4 v[220:223], v11, s[16:19], s46 offen sc1
    s_mov_b32 s46, 0x193d400
    buffer_load_dwordx4 v[224:227], v11, s[16:19], s46 offen sc1
    s_mov_b32 s46, 0x194ac00
    buffer_load_dwordx4 v[228:231], v11, s[16:19], s46 offen sc1
    s_mov_b32 s46, 0x1907800
    buffer_load_dwordx4 v[232:235], v11, s[16:19], s46 offen sc1
    s_mov_b32 s46, 0x1915000
    buffer_load_dwordx4 v[236:239], v11, s[16:19], s46 offen sc1
    s_mov_b32 s46, 0x1922800
    buffer_load_dwordx4 v[128:131], v11, s[16:19], s46 offen sc1
    s_mov_b32 s46, 0x1930000
    buffer_load_dwordx4 v[132:135], v11, s[16:19], s46 offen sc1
    s_mov_b32 s46, 0x193d800
    buffer_load_dwordx4 v[136:139], v11, s[16:19], s46 offen sc1
    s_mov_b32 s46, 0x194b000
    buffer_load_dwordx4 v[140:143], v11, s[16:19], s46 offen sc1
    s_mov_b32 s46, 0x1907c00
    buffer_load_dwordx4 v[144:147], v11, s[16:19], s46 offen sc1
    s_mov_b32 s46, 0x1915400
    buffer_load_dwordx4 v[148:151], v11, s[16:19], s46 offen sc1
    s_mov_b32 s46, 0x1922c00
    buffer_load_dwordx4 v[152:155], v11, s[16:19], s46 offen sc1
    s_mov_b32 s46, 0x1930400
    buffer_load_dwordx4 v[156:159], v11, s[16:19], s46 offen sc1
    s_mov_b32 s46, 0x193dc00
    buffer_load_dwordx4 v[160:163], v11, s[16:19], s46 offen sc1
    s_add_u32 s47, s47, 1
    s_waitcnt vmcnt(0)
    v_max3_u32 v2, v208, v212, v216
    v_max3_u32 v2, v2, v220, v224
    v_max_u32 v2, v2, v228
    v_cmp_eq_u32 vcc, -1, v2
    s_cmp_eq_u64 vcc, 0
    s_cbranch_scc1 pk_c93_x
    s_cmp_lt_u32 s47, 0x2000
    s_cbranch_scc1 pk_c93_l
pk_c93_x:
    s_mov_b64 exec, -1
    s_nop 4
    s_branch pk_c93_r
pk_c94_s:
    s_nop 7
    s_nop 7
    s_mov_b32 s47, 0
pk_c94_l:
    s_mov_b64 exec, vcc
    s_sleep 1
    s_mov_b32 s46, 0x1907800
    buffer_load_dwordx4 v[232:235], v11, s[16:19], s46 offen sc1
    s_mov_b32 s46, 0x1915000
    buffer_load_dwordx4 v[236:239], v11, s[16:19], s46 offen sc1
    s_mov_b32 s46, 0x1922800
    buffer_load_dwordx4 v[128:131], v11, s[16:19], s46 offen sc1
    s_mov_b32 s46, 0x1930000
    buffer_load_dwordx4 v[132:135], v11, s[16:19], s46 offen sc1
    s_mov_b32 s46, 0x193d800
    buffer_load_dwordx4 v[136:139], v11, s[16:19], s46 offen sc1
    s_mov_b32 s46, 0x194b000
    buffer_load_dwordx4 v[140:143], v11, s[16:19], s46 offen sc1
    s_mov_b32 s46, 0x1907c00
    buffer_load_dwordx4 v[144:147], v11, s[16:19], s46 offen sc1
    s_mov_b32 s46, 0x1915400
    buffer_load_dwordx4 v[148:151], v11, s[16:19], s46 offen sc1
    s_mov_b32 s46, 0x1922c00
    buffer_load_dwordx4 v[152:155], v11, s[16:19], s46 offen sc1
    s_mov_b32 s46, 0x1930400
    buffer_load_dwordx4 v[156:159], v11, s[16:19], s46 offen sc1
    s_mov_b32 s46, 0x193dc00
    buffer_load_dwordx4 v[160:163], v11, s[16:19], s46 offen sc1
    s_mov_b32 s46, 0x194b400
    buffer_load_dwordx4 v[164:167], v11, s[16:19], s46 offen sc1
    s_mov_b32 s46, 0x1908000
    buffer_load_dwordx4 v[168:171], v11, s[16:19], s46 offen sc1
    s_mov_b32 s46, 0x1915800
    buffer_load_dwordx4 v[172:175], v11, s[16:19], s46 offen sc1
    s_mov_b32 s46, 0x1923000
    buffer_load_dwordx4 v[176:179], v11, s[16:19], s46 offen sc1
    s_mov_b32 s46, 0x1930800
    buffer_load_dwordx4 v[180:183], v11, s[16:19], s46 offen sc1
    s_mov_b32 s46, 0x193e000
    buffer_load_dwordx4 v[184:187], v11, s[16:19], s46 offen sc1
    s_add_u32 s47, s47, 1
    s_waitcnt vmcnt(0)
    v_max3_u32 v2, v232, v236, v128
    v_max3_u32 v2, v2, v132, v136
    v_max_u32 v2, v2, v140
    v_cmp_eq_u32 vcc, -1, v2
    s_cmp_eq_u64 vcc, 0
    s_cbranch_scc1 pk_c94_x
    s_cmp_lt_u32 s47, 0x2000
    s_cbranch_scc1 pk_c94_l
pk_c94_x:
    s_mov_b64 exec, -1
    s_nop 4
    s_branch pk_c94_r
pk_c95_s:
    s_nop 7
    s_nop 7
    s_mov_b32 s47, 0
pk_c95_l:
    s_mov_b64 exec, vcc
    s_sleep 1
    s_mov_b32 s46, 0x1907c00
    buffer_load_dwordx4 v[144:147], v11, s[16:19], s46 offen sc1
    s_mov_b32 s46, 0x1915400
    buffer_load_dwordx4 v[148:151], v11, s[16:19], s46 offen sc1
    s_mov_b32 s46, 0x1922c00
    buffer_load_dwordx4 v[152:155], v11, s[16:19], s46 offen sc1
    s_mov_b32 s46, 0x1930400
    buffer_load_dwordx4 v[156:159], v11, s[16:19], s46 offen sc1
    s_mov_b32 s46, 0x193dc00
    buffer_load_dwordx4 v[160:163], v11, s[16:19], s46 offen sc1
    s_mov_b32 s46, 0x194b400
    buffer_load_dwordx4 v[164:167], v11, s[16:19], s46 offen sc1
    s_mov_b32 s46, 0x1908000
    buffer_load_dwordx4 v[168:171], v11, s[16:19], s46 offen sc1
    s_mov_b32 s46, 0x1915800
    buffer_load_dwordx4 v[172:175], v11, s[16:19], s46 offen sc1
    s_mov_b32 s46, 0x1923000
    buffer_load_dwordx4 v[176:179], v11, s[16:19], s46 offen sc1
    s_mov_b32 s46, 0x1930800
    buffer_load_dwordx4 v[180:183], v11, s[16:19], s46 offen sc1
    s_mov_b32 s46, 0x193e000
    buffer_load_dwordx4 v[184:187], v11, s[16:19], s46 offen sc1
    s_mov_b32 s46, 0x194b800
    buffer_load_dwordx4 v[188:191], v11, s[16:19], s46 offen sc1
    s_mov_b32 s46, 0x1908400
    buffer_load_dwordx4 v[192:195], v11, s[16:19], s46 offen sc1
    s_mov_b32 s46, 0x1915c00
    buffer_load_dwordx4 v[196:199], v11, s[16:19], s46 offen sc1
    s_mov_b32 s46, 0x1923400
    buffer_load_dwordx4 v[200:203], v11, s[16:19], s46 offen sc1
    s_mov_b32 s46, 0x1930c00
    buffer_load_dwordx4 v[204:207], v11, s[16:19], s46 offen sc1
    s_mov_b32 s46, 0x193e400
    buffer_load_dwordx4 v[208:211], v11, s[16:19], s46 offen sc1
    s_add_u32 s47, s47, 1
    s_waitcnt vmcnt(0)
    v_max3_u32 v2, v144, v148, v152
    v_max3_u32 v2, v2, v156, v160
    v_max_u32 v2, v2, v164
    v_cmp_eq_u32 vcc, -1, v2
    s_cmp_eq_u64 vcc, 0
    s_cbranch_scc1 pk_c95_x
    s_cmp_lt_u32 s47, 0x2000
    s_cbranch_scc1 pk_c95_l
pk_c95_x:
    s_mov_b64 exec, -1
    s_nop 4
    s_branch pk_c95_r
pk_c96_s:
    s_nop 7
    s_nop 7
    s_mov_b32 s47, 0
pk_c96_l:
    s_mov_b64 exec, vcc
    s_sleep 1
    s_mov_b32 s46, 0x1908000
    buffer_load_dwordx4 v[168:171], v11, s[16:19], s46 offen sc1
    s_mov_b32 s46, 0x1915800
    buffer_load_dwordx4 v[172:175], v11, s[16:19], s46 offen sc1
    s_mov_b32 s46, 0x1923000
    buffer_load_dwordx4 v[176:179], v11, s[16:19], s46 offen sc1
    s_mov_b32 s46, 0x1930800
    buffer_load_dwordx4 v[180:183], v11, s[16:19], s46 offen sc1
    s_mov_b32 s46, 0x193e000
    buffer_load_dwordx4 v[184:187], v11, s[16:19], s46 offen sc1
    s_mov_b32 s46, 0x194b800
    buffer_load_dwordx4 v[188:191], v11, s[16:19], s46 offen sc1
    s_mov_b32 s46, 0x1908400
    buffer_load_dwordx4 v[192:195], v11, s[16:19], s46 offen sc1
    s_mov_b32 s46, 0x1915c00
    buffer_load_dwordx4 v[196:199], v11, s[16:19], s46 offen sc1
    s_mov_b32 s46, 0x1923400
    buffer_load_dwordx4 v[200:203], v11, s[16:19], s46 offen sc1
    s_mov_b32 s46, 0x1930c00
    buffer_load_dwordx4 v[204:207], v11, s[16:19], s46 offen sc1
    s_mov_b32 s46, 0x193e400
    buffer_load_dwordx4 v[208:211], v11, s[16:19], s46 offen sc1
    s_mov_b32 s46, 0x194bc00
    buffer_load_dwordx4 v[212:215], v11, s[16:19], s46 offen sc1
    s_mov_b32 s46, 0x1908800
    buffer_load_dwordx4 v[216:219], v12, s[16:19], s46 offen sc1
    s_mov_b32 s46, 0x1916000
    buffer_load_dwordx4 v[220:223], v12, s[16:19], s46 offen sc1
    s_mov_b32 s46, 0x1923800
    buffer_load_dwordx4 v[224:227], v12, s[16:19], s46 offen sc1
    s_mov_b32 s46, 0x1931000
    buffer_load_dwordx4 v[228:231], v12, s[16:19], s46 offen sc1
    s_mov_b32 s46, 0x193e800
    buffer_load_dwordx4 v[232:235], v12, s[16:19], s46 offen sc1
    s_add_u32 s47, s47, 1
    s_waitcnt vmcnt(0)
    v_max3_u32 v2, v168, v172, v176
    v_max3_u32 v2, v2, v180, v184
    v_max_u32 v2, v2, v188
    v_cmp_eq_u32 vcc, -1, v2
    s_cmp_eq_u64 vcc, 0
    s_cbranch_scc1 pk_c96_x
    s_cmp_lt_u32 s47, 0x2000
    s_cbranch_scc1 pk_c96_l
pk_c96_x:
    s_mov_b64 exec, -1
    s_nop 4
    s_branch pk_c96_r
pk_w97_s:
    s_nop 7
    s_nop 7
    buffer_store_dwordx4 v[100:103], v3, s[16:19], s44 offen offset:0 sc1
    s_nop 4
    s_branch pk_w97_r
pk_c98_s:
    s_nop 7
    s_nop 7
    s_mov_b32 s47, 0
pk_c98_l:
    s_mov_b64 exec, vcc
    s_sleep 1
    s_mov_b32 s46, 0x1908400
    buffer_load_dwordx4 v[192:195], v11, s[16:19], s46 offen sc1
    s_mov_b32 s46, 0x1915c00
    buffer_load_dwordx4 v[196:199], v11, s[16:19], s46 offen sc1
    s_mov_b32 s46, 0x1923400
    buffer_load_dwordx4 v[200:203], v11, s[16:19], s46 offen sc1
    s_mov_b32 s46, 0x1930c00
    buffer_load_dwordx4 v[204:207], v11, s[16:19], s46 offen sc1
    s_mov_b32 s46, 0x193e400
    buffer_load_dwordx4 v[208:211], v11, s[16:19], s46 offen sc1
    s_mov_b32 s46, 0x194bc00
    buffer_load_dwordx4 v[212:215], v11, s[16:19], s46 offen sc1
    s_mov_b32 s46, 0x1908800
    buffer_load_dwordx4 v[216:219], v12, s[16:19], s46 offen sc1
    s_mov_b32 s46, 0x1916000
    buffer_load_dwordx4 v[220:223], v12, s[16:19], s46 offen sc1
    s_mov_b32 s46, 0x1923800
    buffer_load_dwordx4 v[224:227], v12, s[16:19], s46 offen sc1
    s_mov_b32 s46, 0x1931000
    buffer_load_dwordx4 v[228:231], v12, s[16:19], s46 offen sc1
    s_mov_b32 s46, 0x193e800
    buffer_load_dwordx4 v[232:235], v12, s[16:19], s46 offen sc1
    s_mov_b32 s46, 0x194c000
    buffer_load_dwordx4 v[236:239], v12, s[16:19], s46 offen sc1
    s_add_u32 s47, s47, 1
    s_waitcnt vmcnt(0)
    v_max3_u32 v2, v192, v196, v200
    v_max3_u32 v2, v2, v204, v208
    v_max_u32 v2, v2, v212
    v_cmp_eq_u32 vcc, -1, v2
    s_cmp_eq_u64 vcc, 0
    s_cbranch_scc1 pk_c98_x
    s_cmp_lt_u32 s47, 0x2000
    s_cbranch_scc1 pk_c98_l
pk_c98_x:
    s_mov_b64 exec, -1
    s_nop 4
    s_branch pk_c98_r
pk_c99_s:
    s_nop 7
    s_nop 7
    s_mov_b32 s47, 0
pk_c99_l:
    s_mov_b64 exec, vcc
    s_sleep 1
    s_mov_b32 s46, 0x1908800
    buffer_load_dwordx4 v[216:219], v12, s[16:19], s46 offen sc1
    s_mov_b32 s46, 0x1916000
    buffer_load_dwordx4 v[220:223], v12, s[16:19], s46 offen sc1
    s_mov_b32 s46, 0x1923800
    buffer_load_dwordx4 v[224:227], v12, s[16:19], s46 offen sc1
    s_mov_b32 s46, 0x1931000
    buffer_load_dwordx4 v[228:231], v12, s[16:19], s46 offen sc1
    s_mov_b32 s46, 0x193e800
    buffer_load_dwordx4 v[232:235], v12, s[16:19], s46 offen sc1
    s_mov_b32 s46, 0x194c000
    buffer_load_dwordx4 v[236:239], v12, s[16:19], s46 offen sc1
    s_add_u32 s47, s47, 1
    s_waitcnt vmcnt(0)
    v_max3_u32 v2, v216, v220, v224
    v_max3_u32 v2, v2, v228, v232
    v_max_u32 v2, v2, v236
    v_cmp_eq_u32 vcc, -1, v2
    s_cmp_eq_u64 vcc, 0
    s_cbranch_scc1 pk_c99_x
    s_cmp_lt_u32 s47, 0x2000
    s_cbranch_scc1 pk_c99_l
pk_c99_x:
    s_mov_b64 exec, -1
    s_nop 4
    s_branch pk_c99_r
pk_w100_s:
    s_nop 7
    s_nop 7
    buffer_store_dwordx4 v[108:111], v3, s[16:19], s44 offen offset:1024 sc1
    s_nop 4
    s_branch pk_w100_r
pk_w101_s:
    s_nop 7
    s_nop 7
    buffer_store_dwordx4 v[116:119], v3, s[16:19], s44 offen offset:2048 sc1
    s_nop 4
    s_branch pk_w101_r
pk_w102_s:
    s_nop 7
    s_nop 7
    buffer_store_dwordx2 v[124:125], v12, s[16:19], s45 offen sc1
    s_nop 4
    s_branch pk_w102_r
pk_c103_s:
    s_nop 7
    s_nop 7
    s_mov_b32 s47, 0
pk_c103_l:
    s_mov_b64 exec, vcc
    s_sleep 1
    buffer_load_dwordx4 v[128:131], v3, s[16:19], s89 offen offset:0 sc1
    buffer_load_dwordx4 v[132:135], v3, s[16:19], s89 offen offset:3072 sc1
    buffer_load_dwordx4 v[136:139], v3, s[16:19], s90 offen offset:0 sc1
    buffer_load_dwordx4 v[140:143], v3, s[16:19], s90 offen offset:3072 sc1
    buffer_load_dwordx4 v[144:147], v3, s[16:19], s91 offen offset:0 sc1
    buffer_load_dwordx4 v[148:151], v3, s[16:19], s91 offen offset:3072 sc1
    buffer_load_dwordx4 v[152:155], v3, s[16:19], s89 offen offset:1024 sc1
    buffer_load_dwordx4 v[156:159], v13, s[16:19], s89 offen offset:0 sc1
    buffer_load_dwordx4 v[160:163], v3, s[16:19], s90 offen offset:1024 sc1
    buffer_load_dwordx4 v[164:167], v13, s[16:19], s90 offen offset:0 sc1
    s_add_u32 s47, s47, 1
    s_waitcnt vmcnt(0)
    v_max3_u32 v2, v128, v132, v136
    v_max_u32 v2, v2, v140
    v_cmp_eq_u32 vcc, -1, v2
    s_cmp_eq_u64 vcc, 0
    s_cbranch_scc1 pk_c103_x
    s_cmp_lt_u32 s47, 0x2000
    s_cbranch_scc1 pk_c103_l
pk_c103_x:
    s_mov_b64 exec, -1
    s_nop 4
    s_branch pk_c103_r
pk_c104_s:
    s_nop 7
    s_nop 7
    s_mov_b32 s47, 0
pk_c104_l:
    s_mov_b64 exec, vcc
    s_sleep 1
    buffer_load_dwordx4 v[144:147], v3, s[16:19], s91 offen offset:0 sc1
    buffer_load_dwordx4 v[148:151], v3, s[16:19], s91 offen offset:3072 sc1
    buffer_load_dwordx4 v[152:155], v3, s[16:19], s89 offen offset:1024 sc1
    buffer_load_dwordx4 v[156:159], v13, s[16:19], s89 offen offset:0 sc1
    buffer_load_dwordx4 v[160:163], v3, s[16:19], s90 offen offset:1024 sc1
    buffer_load_dwordx4 v[164:167], v13, s[16:19], s90 offen offset:0 sc1
    buffer_load_dwordx4 v[168:171], v3, s[16:19], s91 offen offset:1024 sc1
    buffer_load_dwordx4 v[172:175], v13, s[16:19], s91 offen offset:0 sc1
    buffer_load_dwordx4 v[176:179], v3, s[16:19], s89 offen offset:2048 sc1
    buffer_load_dwordx4 v[180:183], v13, s[16:19], s89 offen offset:1024 sc1
    buffer_load_dwordx4 v[184:187], v14, s[16:19], s89 offen offset:2048 sc1
    buffer_load_dwordx4 v[188:191], v3, s[16:19], s90 offen offset:2048 sc1
    s_add_u32 s47, s47, 1
    s_waitcnt vmcnt(0)
    v_max_u32 v2, v144, v148
    v_cmp_eq_u32 vcc, -1, v2
    s_cmp_eq_u64 vcc, 0
    s_cbranch_scc1 pk_c104_x
    s_cmp_lt_u32 s47, 0x2000
    s_cbranch_scc1 pk_c104_l
pk_c104_x:
    s_mov_b64 exec, -1
    s_nop 4
    s_branch pk_c104_r
pk_c105_s:
    s_nop 7
    s_nop 7
    s_mov_b32 s47, 0
pk_c105_l:
    s_mov_b64 exec, vcc
    s_sleep 1
    buffer_load_dwordx4 v[152:155], v3, s[16:19], s89 offen offset:1024 sc1
    buffer_load_dwordx4 v[156:159], v13, s[16:19], s89 offen offset:0 sc1
    buffer_load_dwordx4 v[160:163], v3, s[16:19], s90 offen offset:1024 sc1
    buffer_load_dwordx4 v[164:167], v13, s[16:19], s90 offen offset:0 sc1
    buffer_load_dwordx4 v[168:171], v3, s[16:19], s91 offen offset:1024 sc1
    buffer_load_dwordx4 v[172:175], v13, s[16:19], s91 offen offset:0 sc1
    buffer_load_dwordx4 v[176:179], v3, s[16:19], s89 offen offset:2048 sc1
    buffer_load_dwordx4 v[180:183], v13, s[16:19], s89 offen offset:1024 sc1
    buffer_load_dwordx4 v[184:187], v14, s[16:19], s89 offen offset:2048 sc1
    buffer_load_dwordx4 v[188:191], v3, s[16:19], s90 offen offset:2048 sc1
    buffer_load_dwordx4 v[192:195], v13, s[16:19], s90 offen offset:1024 sc1
    buffer_load_dwordx4 v[196:199], v14, s[16:19], s90 offen offset:2048 sc1
    buffer_load_dwordx4 v[200:203], v3, s[16:19], s91 offen offset:2048 sc1
    s_add_u32 s47, s47, 1
    s_waitcnt vmcnt(0)
    v_max_u32 v2, v152, v156
    v_cmp_eq_u32 vcc, -1, v2
    s_cmp_eq_u64 vcc, 0
    s_cbranch_scc1 pk_c105_x
    s_cmp_lt_u32 s47, 0x2000
    s_cbranch_scc1 pk_c105_l
pk_c105_x:
    s_mov_b64 exec, -1
    s_nop 4
    s_branch pk_c105_r
pk_c106_s:
    s_nop 7
    s_nop 7
    s_mov_b32 s47, 0
pk_c106_l:
    s_mov_b64 exec, vcc
    s_sleep 1
    buffer_load_dwordx4 v[160:163], v3, s[16:19], s90 offen offset:1024 sc1
    buffer_load_dwordx4 v[164:167], v13, s[16:19], s90 offen offset:0 sc1
    buffer_load_dwordx4 v[168:171], v3, s[16:19], s91 offen offset:1024 sc1
    buffer_load_dwordx4 v[172:175], v13, s[16:19], s91 offen offset:0 sc1
    buffer_load_dwordx4 v[176:179], v3, s[16:19], s89 offen offset:2048 sc1
    buffer_load_dwordx4 v[180:183], v13, s[16:19], s89 offen offset:1024 sc1
    buffer_load_dwordx4 v[184:187], v14, s[16:19], s89 offen offset:2048 sc1
    buffer_load_dwordx4 v[188:191], v3, s[16:19], s90 offen offset:2048 sc1
    buffer_load_dwordx4 v[192:195], v13, s[16:19], s90 offen offset:1024 sc1
    buffer_load_dwordx4 v[196:199], v14, s[16:19], s90 offen offset:2048 sc1
    buffer_load_dwordx4 v[200:203], v3, s[16:19], s91 offen offset:2048 sc1
    buffer_load_dwordx4 v[204:207], v13, s[16:19], s91 offen offset:1024 sc1
    buffer_load_dwordx4 v[208:211], v14, s[16:19], s91 offen offset:2048 sc1
    buffer_load_dwordx4 v[212:215], v3, s[16:19], s88 offen offset:0 sc1
    buffer_load_dwordx4 v[216:219], v3, s[16:19], s88 offen offset:3072 sc1
    s_add_u32 s47, s47, 1
    s_waitcnt vmcnt(0)
    v_max3_u32 v2, v160, v164, v168
    v_max_u32 v2, v2, v172
    v_cmp_eq_u32 vcc, -1, v2
    s_cmp_eq_u64 vcc, 0
    s_cbranch_scc1 pk_c106_x
    s_cmp_lt_u32 s47, 0x2000
    s_cbranch_scc1 pk_c106_l
pk_c106_x:
    s_mov_b64 exec, -1
    s_nop 4
    s_branch pk_c106_r
pk_c107_s:
    s_nop 7
    s_nop 7
    s_mov_b32 s47, 0
pk_c107_l:
    s_mov_b64 exec, vcc
    s_sleep 1
    buffer_load_dwordx4 v[176:179], v3, s[16:19], s89 offen offset:2048 sc1
    buffer_load_dwordx4 v[180:183], v13, s[16:19], s89 offen offset:1024 sc1
    buffer_load_dwordx4 v[184:187], v14, s[16:19], s89 offen offset:2048 sc1
    buffer_load_dwordx4 v[188:191], v3, s[16:19], s90 offen offset:2048 sc1
    buffer_load_dwordx4 v[192:195], v13, s[16:19], s90 offen offset:1024 sc1
    buffer_load_dwordx4 v[196:199], v14, s[16:19], s90 offen offset:2048 sc1
    buffer_load_dwordx4 v[200:203], v3, s[16:19], s91 offen offset:2048 sc1
    buffer_load_dwordx4 v[204:207], v13, s[16:19], s91 offen offset:1024 sc1
    buffer_load_dwordx4 v[208:211], v14, s[16:19], s91 offen offset:2048 sc1
    buffer_load_dwordx4 v[212:215], v3, s[16:19], s88 offen offset:0 sc1
    buffer_load_dwordx4 v[216:219], v3, s[16:19], s88 offen offset:3072 sc1
    buffer_load_dwordx4 v[220:223], v3, s[16:19], s88 offen offset:1024 sc1
    buffer_load_dwordx4 v[224:227], v13, s[16:19], s88 offen offset:0 sc1
    buffer_load_dwordx4 v[228:231], v3, s[16:19], s88 offen offset:2048 sc1
    buffer_load_dwordx4 v[232:235], v13, s[16:19], s88 offen offset:1024 sc1
    buffer_load_dwordx4 v[236:239], v14, s[16:19], s88 offen offset:2048 sc1
    s_add_u32 s47, s47, 1
    s_waitcnt vmcnt(0)
    v_max3_u32 v2, v176, v180, v184
    v_max_u32 v2, v2, v186
    v_cmp_eq_u32 vcc, -1, v2
    s_cmp_eq_u64 vcc, 0
    s_cbranch_scc1 pk_c107_x
    s_cmp_lt_u32 s47, 0x2000
    s_cbranch_scc1 pk_c107_l
pk_c107_x:
    s_mov_b64 exec, -1
    s_nop 4
    s_branch pk_c107_r
pk_c108_s:
    s_nop 7
    s_nop 7
    s_mov_b32 s47, 0
pk_c108_l:
    s_mov_b64 exec, vcc
    s_sleep 1
    buffer_load_dwordx4 v[188:191], v3, s[16:19], s90 offen offset:2048 sc1
    buffer_load_dwordx4 v[192:195], v13, s[16:19], s90 offen offset:1024 sc1
    buffer_load_dwordx4 v[196:199], v14, s[16:19], s90 offen offset:2048 sc1
    buffer_load_dwordx4 v[200:203], v3, s[16:19], s91 offen offset:2048 sc1
    buffer_load_dwordx4 v[204:207], v13, s[16:19], s91 offen offset:1024 sc1
    buffer_load_dwordx4 v[208:211], v14, s[16:19], s91 offen offset:2048 sc1
    buffer_load_dwordx4 v[212:215], v3, s[16:19], s88 offen offset:0 sc1
    buffer_load_dwordx4 v[216:219], v3, s[16:19], s88 offen offset:3072 sc1
    buffer_load_dwordx4 v[220:223], v3, s[16:19], s88 offen offset:1024 sc1
    buffer_load_dwordx4 v[224:227], v13, s[16:19], s88 offen offset:0 sc1
    buffer_load_dwordx4 v[228:231], v3, s[16:19], s88 offen offset:2048 sc1
    buffer_load_dwordx4 v[232:235], v13, s[16:19], s88 offen offset:1024 sc1
    buffer_load_dwordx4 v[236:239], v14, s[16:19], s88 offen offset:2048 sc1
    s_add_u32 s47, s47, 1
    s_waitcnt vmcnt(0)
    v_max3_u32 v2, v188, v192, v196
    v_max_u32 v2, v2, v198
    v_cmp_eq_u32 vcc, -1, v2
    s_cmp_eq_u64 vcc, 0
    s_cbranch_scc1 pk_c108_x
    s_cmp_lt_u32 s47, 0x2000
    s_cbranch_scc1 pk_c108_l
pk_c108_x:
    s_mov_b64 exec, -1
    s_nop 4
    s_branch pk_c108_r
pk_c109_s:
    s_nop 7
    s_nop 7
    s_mov_b32 s47, 0
pk_c109_l:
    s_mov_b64 exec, vcc
    s_sleep 1
    buffer_load_dwordx4 v[200:203], v3, s[16:19], s91 offen offset:2048 sc1
    buffer_load_dwordx4 v[204:207], v13, s[16:19], s91 offen offset:1024 sc1
    buffer_load_dwordx4 v[208:211], v14, s[16:19], s91 offen offset:2048 sc1
    buffer_load_dwordx4 v[212:215], v3, s[16:19], s88 offen offset:0 sc1
    buffer_load_dwordx4 v[216:219], v3, s[16:19], s88 offen offset:3072 sc1
    buffer_load_dwordx4 v[220:223], v3, s[16:19], s88 offen offset:1024 sc1
    buffer_load_dwordx4 v[224:227], v13, s[16:19], s88 offen offset:0 sc1
    buffer_load_dwordx4 v[228:231], v3, s[16:19], s88 offen offset:2048 sc1
    buffer_load_dwordx4 v[232:235], v13, s[16:19], s88 offen offset:1024 sc1
    buffer_load_dwordx4 v[236:239], v14, s[16:19], s88 offen offset:2048 sc1
    s_add_u32 s47, s47, 1
    s_waitcnt vmcnt(0)
    v_max3_u32 v2, v200, v204, v208
    v_max_u32 v2, v2, v210
    v_cmp_eq_u32 vcc, -1, v2
    s_cmp_eq_u64 vcc, 0
    s_cbranch_scc1 pk_c109_x
    s_cmp_lt_u32 s47, 0x2000
    s_cbranch_scc1 pk_c109_l
pk_c109_x:
    s_mov_b64 exec, -1
    s_nop 4
    s_branch pk_c109_r
pk_c110_s:
    s_nop 7
    s_nop 7
    s_mov_b32 s47, 0
pk_c110_l:
    s_mov_b64 exec, vcc
    s_sleep 1
    buffer_load_dwordx4 v[212:215], v3, s[16:19], s88 offen offset:0 sc1
    buffer_load_dwordx4 v[216:219], v3, s[16:19], s88 offen offset:3072 sc1
    buffer_load_dwordx4 v[220:223], v3, s[16:19], s88 offen offset:1024 sc1
    buffer_load_dwordx4 v[224:227], v13, s[16:19], s88 offen offset:0 sc1
    buffer_load_dwordx4 v[228:231], v3, s[16:19], s88 offen offset:2048 sc1
    buffer_load_dwordx4 v[232:235], v13, s[16:19], s88 offen offset:1024 sc1
    buffer_load_dwordx4 v[236:239], v14, s[16:19], s88 offen offset:2048 sc1
    s_add_u32 s47, s47, 1
    s_waitcnt vmcnt(0)
    v_max3_u32 v2, v212, v216, v220
    v_max_u32 v2, v2, v224
    v_cmp_eq_u32 vcc, -1, v2
    s_cmp_eq_u64 vcc, 0
    s_cbranch_scc1 pk_c110_x
    s_cmp_lt_u32 s47, 0x2000
    s_cbranch_scc1 pk_c110_l
pk_c110_x:
    s_mov_b64 exec, -1
    s_nop 4
    s_branch pk_c110_r
pk_c111_s:
    s_nop 7
    s_nop 7
    s_mov_b32 s47, 0
pk_c111_l:
    s_mov_b64 exec, vcc
    s_sleep 1
    buffer_load_dwordx4 v[228:231], v3, s[16:19], s88 offen offset:2048 sc1
    buffer_load_dwordx4 v[232:235], v13, s[16:19], s88 offen offset:1024 sc1
    buffer_load_dwordx4 v[236:239], v14, s[16:19], s88 offen offset:2048 sc1
    s_add_u32 s47, s47, 1
    s_waitcnt vmcnt(0)
    v_max3_u32 v2, v228, v232, v236
    v_max_u32 v2, v2, v238
    v_cmp_eq_u32 vcc, -1, v2
    s_cmp_eq_u64 vcc, 0
    s_cbranch_scc1 pk_c111_x
    s_cmp_lt_u32 s47, 0x2000
    s_cbranch_scc1 pk_c111_l
pk_c111_x:
    s_mov_b64 exec, -1
    s_nop 4
    s_branch pk_c111_r
pk_textend:
.section .rodata,"a"
.p2align 6
.amdhsa_kernel pk_kernel
  .amdhsa_next_free_vgpr 512
  .amdhsa_next_free_sgpr 102
  .amdhsa_accum_offset 256
  .amdhsa_group_segment_fixed_size 0
  .amdhsa_kernarg_size 88
  .amdhsa_user_sgpr_count 2
  .amdhsa_user_sgpr_kernarg_segment_ptr 1
  .amdhsa_system_sgpr_workgroup_id_x 1
  .amdhsa_float_denorm_mode_32 3
  .amdhsa_float_denorm_mode_16_64 3
.end_amdhsa_kernel
```
